```python
import torch

def _softmax(x, axis=-1):
    return torch.softmax(x, dim=axis)
def _gelu(x):
    return torch.nn.functional.gelu(x, approximate="tanh")
def _silu(x):
    return torch.nn.functional.silu(x)
def _sigmoid(x):
    return torch.sigmoid(x)
def _layernorm(x, axis=-1, eps=1e-5):
    m = x.mean(dim=axis, keepdim=True)
    v = x.var(dim=axis, keepdim=True, unbiased=False)
    return (x - m) / torch.sqrt(v + eps)
def _scatter_add(tgt, idx, src, axis=0):
    return tgt.clone().index_add_(axis, idx, src)
def _segment_sum(src, seg, n):
    out = torch.zeros((n,) + src.shape[1:], dtype=src.dtype)
    return out.index_add_(0, seg, src)
def _pad(x, pw):
    flat = tuple(v for pair in reversed(pw) for v in pair)
    return torch.nn.functional.pad(x, flat)

kernel_name = 'recurrent_scan__linear_kernel_hedgehog__swiglu_ffn__prompt'

def setup_inputs():

    _w = (lambda a: (lambda t: t.to(torch.bfloat16) if t.is_floating_point() else t)(torch.as_tensor(a)))
    def _A_setup():
        B, S, D, H = 1, 2048, 640, 32
        Dh = D // H
        return {
            "x": _w((lambda *s: torch.randn(*s, dtype=torch.bfloat16) * 0.05)(B, S, D)),
            "wqkv": _w((lambda *s: torch.randn(*s, dtype=torch.bfloat16) * 0.2)(D, 3 * D)),
            "w_phi": _w((lambda *s: torch.randn(*s, dtype=torch.bfloat16) * 0.2)(H, Dh, Dh) * (Dh ** -0.5)),
            "wo": _w((lambda *s: torch.randn(*s, dtype=torch.bfloat16) * 0.05)(D, D)),
        }
    _A_in = _A_setup()

    def _B_setup():
        B, S, D, F = 1, 2048, 640, 1728
        return {
            "x": _w((lambda *s: torch.randn(*s, dtype=torch.bfloat16) * 0.05)(B, S, D)),
            "w_gate": _w((lambda *s: torch.randn(*s, dtype=torch.bfloat16) * 0.05)(D, F)),
            "w_up": _w((lambda *s: torch.randn(*s, dtype=torch.bfloat16) * 0.05)(D, F)),
            "w_down": _w((lambda *s: torch.randn(*s, dtype=torch.bfloat16) * 0.05)(F, D)),
        }
    _B_in = _B_setup()

    return {
        "A_x": _A_in["x"],
        "A_wqkv": _A_in["wqkv"],
        "A_w_phi": _A_in["w_phi"],
        "A_wo": _A_in["wo"],
        "B_x": _B_in["x"],
        "B_w_gate": _B_in["w_gate"],
        "B_w_up": _B_in["w_up"],
        "B_w_down": _B_in["w_down"],
    }

def reference(A_x, A_wqkv, A_w_phi, A_wo, B_x, B_w_gate, B_w_up, B_w_down):
    def _A_ref(x, wqkv, w_phi, wo):
        B, S, D = x.shape
        H = 32; Dh = D // H
        qkv = (lambda x, *d: x.permute(*d))((x @ wqkv).reshape(B, S, 3, H, Dh), 2, 0, 3, 1, 4)
        q, k, v = qkv[0], qkv[1], qkv[2]
        pq = torch.einsum("bhsd,hdf->bhsf", q, w_phi)
        pk = torch.einsum("bhsd,hdf->bhsf", k, w_phi)
        phi_q = torch.concatenate([_softmax(pq, axis=-1), _softmax(-pq, axis=-1)], axis=-1)
        phi_k = torch.concatenate([_softmax(pk, axis=-1), _softmax(-pk, axis=-1)], axis=-1)
        kv = torch.einsum("bhsf,bhsd->bhfd", phi_k, v)
        z  = torch.einsum("bhsf->bhf", phi_k)
        num = torch.einsum("bhqf,bhfd->bhqd", phi_q, kv)
        den = torch.einsum("bhqf,bhf->bhq", phi_q, z)[..., None] + 1e-6
        o = num / den
        return (lambda x, *d: x.permute(*d))(o, 0, 2, 1, 3).reshape(B, S, D) @ wo

    def _B_ref(x, w_gate, w_up, w_down):
        g = _silu(x @ w_gate)
        u = x @ w_up
        return (g * u) @ w_down

    x = A_x
    xn = _layernorm(x, axis=-1)
    s = _A_ref(xn, A_wqkv, A_w_phi, A_wo)
    g = _silu(_B_ref(xn, B_w_gate, B_w_up, B_w_down))
    return x + s * g
```

```asm
; @launch grid=(256,1,1) block=(512,1,1) lds=163840
.amdgcn_target "amdgcn-amd-amdhsa--gfx950"
.text
.globl recurrent_scan__linear_kernel_hedgehog__swiglu_ffn__prompt_kernel
.p2align 8
.type recurrent_scan__linear_kernel_hedgehog__swiglu_ffn__prompt_kernel,@function
recurrent_scan__linear_kernel_hedgehog__swiglu_ffn__prompt_kernel:
    s_cmp_ge_u32 s2, 256
    s_cbranch_scc1 K_END
    s_load_dwordx16 s[52:67], s[0:1], 0
    s_load_dwordx4 s[68:71], s[0:1], 64
    s_load_dwordx2 s[72:73], s[0:1], 80
    v_lshrrev_b32 v16, 6, v0
    v_and_b32 v0, 63, v0
    s_and_b32 s45, s2, 7
    s_lshr_b32 s46, s2, 3
    v_readfirstlane_b32 s32, v16
    s_and_b32 s33, s45, 1
    s_lshl_b32 s33, s33, 2
    s_and_b32 s47, s46, 3
    s_add_u32 s33, s33, s47
    s_lshr_b32 s45, s45, 1
    s_lshr_b32 s80, s46, 2
    s_mul_i32 s34, s45, 5
    s_cmp_eq_u32 s45, 3
    s_cselect_b32 s47, 4, 3
    s_add_u32 s34, s34, s80
    s_sub_u32 s34, s34, s47
    s_add_u32 s36, s34, 12
    s_mov_b32 s35, 2
    s_lshl_b32 s47, s80, 2
    s_add_u32 s47, s47, s45
    s_cmp_ge_u32 s47, 30
    s_cselect_b32 s35, 3, s35
    s_lshl_b32 s47, s45, 1
    s_add_u32 s47, s47, s80
    s_sub_u32 s47, s47, 1
    s_add_u32 s48, s47, 4
    s_cmp_lt_u32 s80, 3
    s_cselect_b32 s34, s47, s34
    s_cselect_b32 s36, s48, s36
    s_cselect_b32 s35, 1, s35
    s_cmp_eq_u32 s80, 0
    s_cselect_b32 s34, s45, s34
    s_cselect_b32 s36, s45, s36
    s_cselect_b32 s35, 0, s35
    s_and_b32 s37, s32, 3
    s_lshr_b32 s38, s32, 2
    s_cmp_eq_u32 s32, 7
    s_cbranch_scc0 CPF_SKIP
    s_getpc_b64 s[74:75]
CPF_BASE:
    s_lshr_b32 s45, s2, 3
    s_lshl_b32 s45, s45, 4
    v_add_u32 v16, s45, v0
    v_lshlrev_b32 v16, 7, v16
    v_min_u32 v16, K_LAST-CPF_BASE, v16
    s_mov_b64 exec, 0xffff
    global_load_dword v253, v16, s[74:75]
    s_mov_b64 exec, -1
CPF_SKIP:
    v_lshrrev_b32 v16, 3, v0
    s_lshl_b32 s45, s32, 5
    v_add_u32 v16, s45, v16
    v_mul_u32_u24 v16, 1280, v16
    v_lshrrev_b32 v17, 4, v0
    v_xor_b32 v17, v17, v0
    v_and_b32 v17, 7, v17
    v_lshlrev_b32 v17, 4, v17
    v_add_u32 v1, v16, v17
    v_xor_b32 v17, 64, v17
    v_add_u32 v2, v16, v17
    v_add_u32 v2, 10240, v2
    v_add_u32 v3, 20480, v1
    v_add_u32 v4, 20480, v2
    s_lshl_b32 s39, s32, 12
    s_mov_b32 s41, 0
    s_cmp_eq_u32 s35, 3
    s_cbranch_scc1 SPARE
    s_cmp_eq_u32 s35, 2
    s_cbranch_scc0 P1_QKV
    s_mul_i32 s45, s37, 55296
    v_add_u32 v19, 0, v0
    v_mul_u32_u24 v16, 171, v19
    v_lshrrev_b32 v16, 11, v16
    v_mul_u32_u24 v17, 12, v16
    v_sub_u32 v17, v19, v17
    v_lshrrev_b32 v18, 2, v16
    v_and_b32 v18, 2, v18
    v_xor_b32 v17, v17, v18
    v_cmp_le_u32 vcc, 6, v17
    s_nop 1
    v_cndmask_b32 v18, 0, 2, vcc
    v_cmp_le_u32 vcc, 10, v17
    s_nop 1
    v_cndmask_b32 v18, v18, -4, vcc
    v_add_u32 v17, v17, v18
    v_mul_u32_u24 v16, 3456, v16
    v_lshl_add_u32 v16, v17, 4, v16
    v_add_u32 v5, s45, v16
    v_add_u32 v19, 64, v0
    v_mul_u32_u24 v16, 171, v19
    v_lshrrev_b32 v16, 11, v16
    v_mul_u32_u24 v17, 12, v16
    v_sub_u32 v17, v19, v17
    v_lshrrev_b32 v18, 2, v16
    v_and_b32 v18, 2, v18
    v_xor_b32 v17, v17, v18
    v_cmp_le_u32 vcc, 6, v17
    s_nop 1
    v_cndmask_b32 v18, 0, 2, vcc
    v_cmp_le_u32 vcc, 10, v17
    s_nop 1
    v_cndmask_b32 v18, v18, -4, vcc
    v_add_u32 v17, v17, v18
    v_mul_u32_u24 v16, 3456, v16
    v_lshl_add_u32 v16, v17, 4, v16
    v_add_u32 v6, s45, v16
    v_add_u32 v19, 128, v0
    v_mul_u32_u24 v16, 171, v19
    v_lshrrev_b32 v16, 11, v16
    v_mul_u32_u24 v17, 12, v16
    v_sub_u32 v17, v19, v17
    v_lshrrev_b32 v18, 2, v16
    v_and_b32 v18, 2, v18
    v_xor_b32 v17, v17, v18
    v_cmp_le_u32 vcc, 6, v17
    s_nop 1
    v_cndmask_b32 v18, 0, 2, vcc
    v_cmp_le_u32 vcc, 10, v17
    s_nop 1
    v_cndmask_b32 v18, v18, -4, vcc
    v_add_u32 v17, v17, v18
    v_mul_u32_u24 v16, 3456, v16
    v_lshl_add_u32 v16, v17, 4, v16
    v_add_u32 v7, s45, v16
    s_mul_i32 s40, s32, 3072
    s_mov_b32 s49, 221184
    s_waitcnt lgkmcnt(0)
    s_mul_i32 s45, s33, 327680
    s_add_u32 s8, s52, s45
    s_addc_u32 s9, s53, 0
    s_and_b32 s9, s9, 0xffff
    s_mov_b32 s10, 327680
    s_mov_b32 s11, 0x20000
    s_mov_b32 s24, s52
    s_and_b32 s25, s53, 0xffff
    s_mov_b32 s26, 2621440
    s_mov_b32 s27, 0x20000
    s_mov_b32 s20, s72
    s_and_b32 s21, s73, 0xffff
    s_mov_b32 s22, 268435456
    s_mov_b32 s23, 0x20000
    s_mul_i32 s45, s34, 192
    s_add_u32 s12, s62, s45
    s_addc_u32 s13, s63, 0
    s_and_b32 s13, s13, 0xffff
    s_sub_u32 s14, 2211840, s45
    s_mov_b32 s15, 0x20000
    s_add_u32 s16, s64, s45
    s_addc_u32 s17, s65, 0
    s_and_b32 s17, s17, 0xffff
    s_sub_u32 s18, 2211840, s45
    s_mov_b32 s19, 0x20000
    s_cmp_eq_u32 s38, 0
    s_cselect_b32 s76, s12, s16
    s_cselect_b32 s77, s13, s17
    s_mov_b32 s78, s14
    s_mov_b32 s79, 0x20000
    s_mov_b32 s3, 163840
    s_cmp_lg_u32 s38, 0
    s_cbranch_scc1 GU_ROLEP
    s_and_b32 s45, s2, 1
    s_lshl_b32 s45, s45, 7
    s_bfe_u32 s46, s2, 0x20001
    s_lshl_b32 s46, s46, 5
    s_add_u32 s45, s45, s46
    s_lshr_b32 s46, s2, 3
    s_add_u32 s45, s45, s46
    s_lshl_b32 s45, s45, 3
    s_add_u32 s50, s45, s32
    s_mul_i32 s45, s50, 1280
    v_lshlrev_b32 v16, 4, v0
    v_lshlrev_b32 v17, 2, v0
    buffer_load_dwordx4 v[244:247], v16, s[24:27], s45 offen
    buffer_load_dword v248, v17, s[24:27], s45 offen offset:1024
    s_add_u32 m0, s40, 0
    s_nop 0
    buffer_load_dwordx4 v5, s[76:79], s41 offen lds
    s_add_u32 m0, s40, 1024
    s_nop 0
    buffer_load_dwordx4 v6, s[76:79], s41 offen lds
    s_add_u32 m0, s40, 2048
    s_nop 0
    buffer_load_dwordx4 v7, s[76:79], s41 offen lds
    s_add_u32 s41, s41, s49
    s_add_u32 m0, s39, 49152
    s_nop 0
    buffer_load_dwordx4 v1, s[8:11], 0 offen offset:0 lds
    s_add_u32 m0, s39, 50176
    s_nop 0
    buffer_load_dwordx4 v2, s[8:11], 0 offen offset:0 lds
    s_add_u32 m0, s39, 51200
    s_nop 0
    buffer_load_dwordx4 v3, s[8:11], 0 offen offset:0 lds
    s_add_u32 m0, s39, 52224
    s_nop 0
    buffer_load_dwordx4 v4, s[8:11], 0 offen offset:0 lds
    s_mov_b32 s4, s70
    s_and_b32 s5, s71, 0xffff
    s_mov_b32 s6, 256
    s_mov_b32 s7, 0x20000
    v_and_b32 v16, 15, v0
    v_lshlrev_b32 v16, 7, v16
    v_bfe_u32 v17, v0, 1, 3
    v_lshrrev_b32 v18, 4, v0
    v_xor_b32 v17, v17, v18
    v_lshl_add_u32 v16, v17, 4, v16
    s_lshl_b32 s45, s37, 13
    s_add_u32 s45, s45, 49152
    v_add_u32 v10, s45, v16
    v_xor_b32 v11, 64, v10
    v_add_u32 v12, 65536, v10
    v_add_u32 v13, 65536, v11
    v_mul_u32_u24 v16, 1536, v18
    v_bfe_u32 v17, v0, 2, 2
    v_mul_u32_u24 v17, 192, v17
    v_add_u32 v16, v16, v17
    v_and_b32 v17, 3, v0
    v_mul_u32_u24 v17, 8, v17
    v_add_u32 v16, v16, v17
    s_mul_i32 s45, s38, 96
    v_add_u32 v14, s45, v16
    v_and_b32 v18, 1, v18
    s_cmp_eq_u32 s38, 0
    s_cselect_b32 s45, 32, -32
    v_mul_i32_i24 v18, s45, v18
    v_sub_u32 v15, v14, v18
    v_add_u32 v14, v14, v18
    s_waitcnt vmcnt(0) lgkmcnt(0)
    s_barrier
    s_setprio 1
    s_add_u32 m0, s40, 36864
    s_nop 0
    buffer_load_dwordx4 v5, s[16:19], s41 offen lds
    s_add_u32 m0, s40, 37888
    s_nop 0
    buffer_load_dwordx4 v6, s[16:19], s41 offen lds
    s_add_u32 m0, s40, 38912
    s_nop 0
    buffer_load_dwordx4 v7, s[16:19], s41 offen lds
    s_add_u32 m0, s40, 24576
    s_nop 0
    buffer_load_dwordx4 v5, s[12:15], s41 offen lds
    s_add_u32 m0, s40, 25600
    s_nop 0
    buffer_load_dwordx4 v6, s[12:15], s41 offen lds
    s_add_u32 m0, s40, 26624
    s_nop 0
    buffer_load_dwordx4 v7, s[12:15], s41 offen lds
    s_add_u32 s41, s41, s49
    s_add_u32 m0, s39, 81792
    s_nop 0
    buffer_load_dwordx4 v1, s[8:11], 0 offen offset:128 lds
    s_add_u32 m0, s39, 82816
    s_nop 0
    buffer_load_dwordx4 v2, s[8:11], 0 offen offset:128 lds
    s_add_u32 m0, s39, 83840
    s_nop 0
    buffer_load_dwordx4 v3, s[8:11], 0 offen offset:128 lds
    s_add_u32 m0, s39, 84864
    s_nop 0
    buffer_load_dwordx4 v4, s[8:11], 0 offen offset:128 lds
    s_add_u32 m0, s39, 98176
    s_nop 0
    buffer_load_dwordx4 v1, s[8:11], s3 offen offset:128 lds
    s_add_u32 m0, s39, 99200
    s_nop 0
    buffer_load_dwordx4 v2, s[8:11], s3 offen offset:128 lds
    s_add_u32 m0, s39, 100224
    s_nop 0
    buffer_load_dwordx4 v3, s[8:11], s3 offen offset:128 lds
    s_add_u32 m0, s39, 101248
    s_nop 0
    buffer_load_dwordx4 v4, s[8:11], s3 offen offset:128 lds
    ds_read_b128 v[128:131], v10 offset:0
    ds_read_b64_tr_b16 v[160:161], v14 offset:0
    ds_read_b64_tr_b16 v[162:163], v14 offset:768
    ds_read_b128 v[132:135], v10 offset:2048
    ds_read_b128 v[136:139], v10 offset:4096
    ds_read_b128 v[140:143], v10 offset:6144
    ds_read_b64_tr_b16 v[164:165], v15 offset:32
    ds_read_b64_tr_b16 v[166:167], v15 offset:800
    ds_read_b64_tr_b16 v[168:169], v14 offset:64
    ds_read_b64_tr_b16 v[170:171], v14 offset:832
    s_waitcnt lgkmcnt(0)
    v_mfma_f32_16x16x32_bf16 v[32:35], v[160:163], v[128:131], 0
    ds_read_b64_tr_b16 v[172:173], v14 offset:12288
    v_mfma_f32_16x16x32_bf16 v[36:39], v[160:163], v[132:135], 0
    ds_read_b64_tr_b16 v[174:175], v14 offset:13056
    v_mfma_f32_16x16x32_bf16 v[40:43], v[160:163], v[136:139], 0
    ds_read_b64_tr_b16 v[176:177], v15 offset:12320
    v_mfma_f32_16x16x32_bf16 v[44:47], v[160:163], v[140:143], 0
    ds_read_b64_tr_b16 v[178:179], v15 offset:13088
    v_mfma_f32_16x16x32_bf16 v[48:51], v[164:167], v[128:131], 0
    ds_read_b64_tr_b16 v[180:181], v14 offset:12352
    v_mfma_f32_16x16x32_bf16 v[52:55], v[164:167], v[132:135], 0
    ds_read_b64_tr_b16 v[182:183], v14 offset:13120
    v_mfma_f32_16x16x32_bf16 v[56:59], v[164:167], v[136:139], 0
    v_mfma_f32_16x16x32_bf16 v[60:63], v[164:167], v[140:143], 0
    v_mfma_f32_16x16x32_bf16 v[64:67], v[168:171], v[128:131], 0
    v_mfma_f32_16x16x32_bf16 v[68:71], v[168:171], v[132:135], 0
    v_mfma_f32_16x16x32_bf16 v[72:75], v[168:171], v[136:139], 0
    v_mfma_f32_16x16x32_bf16 v[76:79], v[168:171], v[140:143], 0
    s_waitcnt lgkmcnt(0)
    v_mfma_f32_16x16x32_bf16 v[80:83], v[172:175], v[128:131], 0
    ds_read_b128 v[144:147], v11 offset:0
    ds_read_b64_tr_b16 v[160:161], v14 offset:6144
    s_add_u32 m0, s39, 114432
    s_nop 0
    buffer_load_dwordx4 v1, s[8:11], 0 offen offset:256 lds
    v_mfma_f32_16x16x32_bf16 v[84:87], v[172:175], v[132:135], 0
    ds_read_b64_tr_b16 v[162:163], v14 offset:6912
    v_mfma_f32_16x16x32_bf16 v[88:91], v[172:175], v[136:139], 0
    ds_read_b128 v[148:151], v11 offset:2048
    v_mfma_f32_16x16x32_bf16 v[92:95], v[172:175], v[140:143], 0
    ds_read_b128 v[152:155], v11 offset:4096
    s_add_u32 m0, s39, 115456
    s_nop 0
    buffer_load_dwordx4 v2, s[8:11], 0 offen offset:256 lds
    v_mfma_f32_16x16x32_bf16 v[96:99], v[176:179], v[128:131], 0
    ds_read_b128 v[156:159], v11 offset:6144
    v_mfma_f32_16x16x32_bf16 v[100:103], v[176:179], v[132:135], 0
    ds_read_b64_tr_b16 v[164:165], v15 offset:6176
    v_mfma_f32_16x16x32_bf16 v[104:107], v[176:179], v[136:139], 0
    ds_read_b64_tr_b16 v[166:167], v15 offset:6944
    s_add_u32 m0, s39, 116480
    s_nop 0
    buffer_load_dwordx4 v3, s[8:11], 0 offen offset:256 lds
    v_mfma_f32_16x16x32_bf16 v[108:111], v[176:179], v[140:143], 0
    ds_read_b64_tr_b16 v[168:169], v14 offset:6208
    v_mfma_f32_16x16x32_bf16 v[112:115], v[180:183], v[128:131], 0
    ds_read_b64_tr_b16 v[170:171], v14 offset:6976
    v_mfma_f32_16x16x32_bf16 v[116:119], v[180:183], v[132:135], 0
    s_add_u32 m0, s39, 117504
    s_nop 0
    buffer_load_dwordx4 v4, s[8:11], 0 offen offset:256 lds
    v_mfma_f32_16x16x32_bf16 v[120:123], v[180:183], v[136:139], 0
    v_mfma_f32_16x16x32_bf16 v[124:127], v[180:183], v[140:143], 0
    s_waitcnt lgkmcnt(0)
    v_mfma_f32_16x16x32_bf16 v[32:35], v[160:163], v[144:147], v[32:35]
    ds_read_b64_tr_b16 v[172:173], v14 offset:18432
    s_add_u32 m0, s39, 130816
    s_nop 0
    buffer_load_dwordx4 v1, s[8:11], s3 offen offset:256 lds
    v_mfma_f32_16x16x32_bf16 v[36:39], v[160:163], v[148:151], v[36:39]
    ds_read_b64_tr_b16 v[174:175], v14 offset:19200
    v_mfma_f32_16x16x32_bf16 v[40:43], v[160:163], v[152:155], v[40:43]
    ds_read_b64_tr_b16 v[176:177], v15 offset:18464
    v_mfma_f32_16x16x32_bf16 v[44:47], v[160:163], v[156:159], v[44:47]
    ds_read_b64_tr_b16 v[178:179], v15 offset:19232
    s_add_u32 m0, s39, 131840
    s_nop 0
    buffer_load_dwordx4 v2, s[8:11], s3 offen offset:256 lds
    v_mfma_f32_16x16x32_bf16 v[48:51], v[164:167], v[144:147], v[48:51]
    ds_read_b64_tr_b16 v[180:181], v14 offset:18496
    v_mfma_f32_16x16x32_bf16 v[52:55], v[164:167], v[148:151], v[52:55]
    ds_read_b64_tr_b16 v[182:183], v14 offset:19264
    v_mfma_f32_16x16x32_bf16 v[56:59], v[164:167], v[152:155], v[56:59]
    s_add_u32 m0, s39, 132864
    s_nop 0
    buffer_load_dwordx4 v3, s[8:11], s3 offen offset:256 lds
    v_mfma_f32_16x16x32_bf16 v[60:63], v[164:167], v[156:159], v[60:63]
    v_mfma_f32_16x16x32_bf16 v[64:67], v[168:171], v[144:147], v[64:67]
    v_mfma_f32_16x16x32_bf16 v[68:71], v[168:171], v[148:151], v[68:71]
    s_add_u32 m0, s39, 133888
    s_nop 0
    buffer_load_dwordx4 v4, s[8:11], s3 offen offset:256 lds
    v_mfma_f32_16x16x32_bf16 v[72:75], v[168:171], v[152:155], v[72:75]
    v_mfma_f32_16x16x32_bf16 v[76:79], v[168:171], v[156:159], v[76:79]
    s_waitcnt vmcnt(8) lgkmcnt(0)
    s_barrier
    v_mfma_f32_16x16x32_bf16 v[80:83], v[172:175], v[144:147], v[80:83]
    ds_read_b128 v[128:131], v10 offset:32768
    ds_read_b64_tr_b16 v[160:161], v14 offset:24576
    v_lshlrev_b32 v200, 16, v244
    s_add_u32 m0, s40, 12288
    s_nop 0
    buffer_load_dwordx4 v5, s[16:19], s41 offen lds
    v_mfma_f32_16x16x32_bf16 v[84:87], v[172:175], v[148:151], v[84:87]
    ds_read_b64_tr_b16 v[162:163], v14 offset:25344
    v_and_b32 v201, 0xffff0000, v244
    v_mfma_f32_16x16x32_bf16 v[88:91], v[172:175], v[152:155], v[88:91]
    ds_read_b128 v[132:135], v10 offset:34816
    v_lshlrev_b32 v202, 16, v245
    v_mfma_f32_16x16x32_bf16 v[92:95], v[172:175], v[156:159], v[92:95]
    ds_read_b128 v[136:139], v10 offset:36864
    s_add_u32 m0, s40, 13312
    s_nop 0
    buffer_load_dwordx4 v6, s[16:19], s41 offen lds
    v_mfma_f32_16x16x32_bf16 v[96:99], v[176:179], v[144:147], v[96:99]
    ds_read_b128 v[140:143], v10 offset:38912
    v_and_b32 v203, 0xffff0000, v245
    v_lshlrev_b32 v204, 16, v246
    v_mfma_f32_16x16x32_bf16 v[100:103], v[176:179], v[148:151], v[100:103]
    ds_read_b64_tr_b16 v[164:165], v15 offset:24608
    v_and_b32 v205, 0xffff0000, v246
    v_mfma_f32_16x16x32_bf16 v[104:107], v[176:179], v[152:155], v[104:107]
    ds_read_b64_tr_b16 v[166:167], v15 offset:25376
    s_add_u32 m0, s40, 14336
    s_nop 0
    buffer_load_dwordx4 v7, s[16:19], s41 offen lds
    v_mfma_f32_16x16x32_bf16 v[108:111], v[176:179], v[156:159], v[108:111]
    ds_read_b64_tr_b16 v[168:169], v14 offset:24640
    v_lshlrev_b32 v206, 16, v247
    v_mfma_f32_16x16x32_bf16 v[112:115], v[180:183], v[144:147], v[112:115]
    ds_read_b64_tr_b16 v[170:171], v14 offset:25408
    v_and_b32 v207, 0xffff0000, v247
    v_lshlrev_b32 v208, 16, v248
    v_mfma_f32_16x16x32_bf16 v[116:119], v[180:183], v[148:151], v[116:119]
    s_add_u32 m0, s40, 0
    s_nop 0
    buffer_load_dwordx4 v5, s[12:15], s41 offen lds
    v_mfma_f32_16x16x32_bf16 v[120:123], v[180:183], v[152:155], v[120:123]
    v_and_b32 v209, 0xffff0000, v248
    v_mfma_f32_16x16x32_bf16 v[124:127], v[180:183], v[156:159], v[124:127]
    v_add_f32 v210, v200, v201
    s_waitcnt lgkmcnt(0)
    v_mfma_f32_16x16x32_bf16 v[32:35], v[160:163], v[128:131], v[32:35]
    ds_read_b64_tr_b16 v[172:173], v14 offset:36864
    v_add_f32 v210, v210, v202
    s_add_u32 m0, s40, 1024
    s_nop 0
    buffer_load_dwordx4 v6, s[12:15], s41 offen lds
    v_mfma_f32_16x16x32_bf16 v[36:39], v[160:163], v[132:135], v[36:39]
    ds_read_b64_tr_b16 v[174:175], v14 offset:37632
    v_add_f32 v210, v210, v203
    v_mfma_f32_16x16x32_bf16 v[40:43], v[160:163], v[136:139], v[40:43]
    ds_read_b64_tr_b16 v[176:177], v15 offset:36896
    v_add_f32 v210, v210, v204
    v_mfma_f32_16x16x32_bf16 v[44:47], v[160:163], v[140:143], v[44:47]
    ds_read_b64_tr_b16 v[178:179], v15 offset:37664
    v_add_f32 v210, v210, v205
    s_add_u32 m0, s40, 2048
    s_nop 0
    buffer_load_dwordx4 v7, s[12:15], s41 offen lds
    s_add_u32 s41, s41, s49
    v_mfma_f32_16x16x32_bf16 v[48:51], v[164:167], v[128:131], v[48:51]
    ds_read_b64_tr_b16 v[180:181], v14 offset:36928
    v_add_f32 v210, v210, v206
    v_mfma_f32_16x16x32_bf16 v[52:55], v[164:167], v[132:135], v[52:55]
    ds_read_b64_tr_b16 v[182:183], v14 offset:37696
    v_add_f32 v210, v210, v207
    v_mfma_f32_16x16x32_bf16 v[56:59], v[164:167], v[136:139], v[56:59]
    v_add_f32 v210, v210, v208
    s_add_u32 m0, s39, 48768
    s_nop 0
    buffer_load_dwordx4 v1, s[8:11], 0 offen offset:384 lds
    v_mfma_f32_16x16x32_bf16 v[60:63], v[164:167], v[140:143], v[60:63]
    v_add_f32 v210, v210, v209
    v_mfma_f32_16x16x32_bf16 v[64:67], v[168:171], v[128:131], v[64:67]
    s_nop 0
    v_add_f32_dpp v210, v210, v210 row_shr:1 row_mask:0xf bank_mask:0xf bound_ctrl:0
    v_mfma_f32_16x16x32_bf16 v[68:71], v[168:171], v[132:135], v[68:71]
    s_nop 0
    v_add_f32_dpp v210, v210, v210 row_shr:2 row_mask:0xf bank_mask:0xf bound_ctrl:0
    s_add_u32 m0, s39, 49792
    s_nop 0
    buffer_load_dwordx4 v2, s[8:11], 0 offen offset:384 lds
    v_mfma_f32_16x16x32_bf16 v[72:75], v[168:171], v[136:139], v[72:75]
    v_add_f32_dpp v210, v210, v210 row_shr:4 row_mask:0xf bank_mask:0xf bound_ctrl:0
    v_mfma_f32_16x16x32_bf16 v[76:79], v[168:171], v[140:143], v[76:79]
    s_nop 0
    v_add_f32_dpp v210, v210, v210 row_shr:8 row_mask:0xf bank_mask:0xf bound_ctrl:0
    s_waitcnt lgkmcnt(0)
    v_mfma_f32_16x16x32_bf16 v[80:83], v[172:175], v[128:131], v[80:83]
    ds_read_b128 v[144:147], v11 offset:32768
    ds_read_b64_tr_b16 v[160:161], v14 offset:30720
    v_add_f32_dpp v210, v210, v210 row_bcast:15 row_mask:0xa bank_mask:0xf
    s_add_u32 m0, s39, 50816
    s_nop 0
    buffer_load_dwordx4 v3, s[8:11], 0 offen offset:384 lds
    v_mfma_f32_16x16x32_bf16 v[84:87], v[172:175], v[132:135], v[84:87]
    ds_read_b64_tr_b16 v[162:163], v14 offset:31488
    v_add_f32_dpp v210, v210, v210 row_bcast:31 row_mask:0xc bank_mask:0xf
    v_mfma_f32_16x16x32_bf16 v[88:91], v[172:175], v[136:139], v[88:91]
    ds_read_b128 v[148:151], v11 offset:34816
    v_readlane_b32 s51, v210, 63
    v_mfma_f32_16x16x32_bf16 v[92:95], v[172:175], v[140:143], v[92:95]
    ds_read_b128 v[152:155], v11 offset:36864
    v_mov_b32 v211, 0x3acccccd
    v_mfma_f32_16x16x32_bf16 v[96:99], v[176:179], v[128:131], v[96:99]
    ds_read_b128 v[156:159], v11 offset:38912
    v_mul_f32 v211, s51, v211
    s_add_u32 m0, s39, 51840
    s_nop 0
    buffer_load_dwordx4 v4, s[8:11], 0 offen offset:384 lds
    v_mfma_f32_16x16x32_bf16 v[100:103], v[176:179], v[132:135], v[100:103]
    ds_read_b64_tr_b16 v[164:165], v15 offset:30752
    v_sub_f32 v200, v200, v211
    v_mfma_f32_16x16x32_bf16 v[104:107], v[176:179], v[136:139], v[104:107]
    ds_read_b64_tr_b16 v[166:167], v15 offset:31520
    v_sub_f32 v201, v201, v211
    v_mfma_f32_16x16x32_bf16 v[108:111], v[176:179], v[140:143], v[108:111]
    ds_read_b64_tr_b16 v[168:169], v14 offset:30784
    v_sub_f32 v202, v202, v211
    v_mfma_f32_16x16x32_bf16 v[112:115], v[180:183], v[128:131], v[112:115]
    ds_read_b64_tr_b16 v[170:171], v14 offset:31552
    v_sub_f32 v203, v203, v211
    s_add_u32 m0, s39, 65152
    s_nop 0
    buffer_load_dwordx4 v1, s[8:11], s3 offen offset:384 lds
    v_mfma_f32_16x16x32_bf16 v[116:119], v[180:183], v[132:135], v[116:119]
    v_sub_f32 v204, v204, v211
    v_mfma_f32_16x16x32_bf16 v[120:123], v[180:183], v[136:139], v[120:123]
    v_sub_f32 v205, v205, v211
    v_mfma_f32_16x16x32_bf16 v[124:127], v[180:183], v[140:143], v[124:127]
    v_sub_f32 v206, v206, v211
    s_waitcnt lgkmcnt(0)
    v_mfma_f32_16x16x32_bf16 v[32:35], v[160:163], v[144:147], v[32:35]
    ds_read_b64_tr_b16 v[172:173], v14 offset:43008
    v_sub_f32 v207, v207, v211
    s_add_u32 m0, s39, 66176
    s_nop 0
    buffer_load_dwordx4 v2, s[8:11], s3 offen offset:384 lds
    v_mfma_f32_16x16x32_bf16 v[36:39], v[160:163], v[148:151], v[36:39]
    ds_read_b64_tr_b16 v[174:175], v14 offset:43776
    v_sub_f32 v208, v208, v211
    v_mfma_f32_16x16x32_bf16 v[40:43], v[160:163], v[152:155], v[40:43]
    ds_read_b64_tr_b16 v[176:177], v15 offset:43040
    v_sub_f32 v209, v209, v211
    v_mfma_f32_16x16x32_bf16 v[44:47], v[160:163], v[156:159], v[44:47]
    ds_read_b64_tr_b16 v[178:179], v15 offset:43808
    v_mul_f32 v210, v200, v200
    v_mfma_f32_16x16x32_bf16 v[48:51], v[164:167], v[144:147], v[48:51]
    ds_read_b64_tr_b16 v[180:181], v14 offset:43072
    v_fmac_f32 v210, v201, v201
    s_add_u32 m0, s39, 67200
    s_nop 0
    buffer_load_dwordx4 v3, s[8:11], s3 offen offset:384 lds
    v_mfma_f32_16x16x32_bf16 v[52:55], v[164:167], v[148:151], v[52:55]
    ds_read_b64_tr_b16 v[182:183], v14 offset:43840
    v_fmac_f32 v210, v202, v202
    v_mfma_f32_16x16x32_bf16 v[56:59], v[164:167], v[152:155], v[56:59]
    v_fmac_f32 v210, v203, v203
    v_mfma_f32_16x16x32_bf16 v[60:63], v[164:167], v[156:159], v[60:63]
    v_fmac_f32 v210, v204, v204
    v_mfma_f32_16x16x32_bf16 v[64:67], v[168:171], v[144:147], v[64:67]
    v_fmac_f32 v210, v205, v205
    s_add_u32 m0, s39, 68224
    s_nop 0
    buffer_load_dwordx4 v4, s[8:11], s3 offen offset:384 lds
    v_mfma_f32_16x16x32_bf16 v[68:71], v[168:171], v[148:151], v[68:71]
    v_fmac_f32 v210, v206, v206
    v_mfma_f32_16x16x32_bf16 v[72:75], v[168:171], v[152:155], v[72:75]
    v_fmac_f32 v210, v207, v207
    v_mfma_f32_16x16x32_bf16 v[76:79], v[168:171], v[156:159], v[76:79]
    v_mov_b32 v242, 0
    buffer_load_dwordx2 v[242:243], v242, s[4:7], 0 offen sc1
    s_waitcnt vmcnt(9) lgkmcnt(0)
    s_barrier
    v_mfma_f32_16x16x32_bf16 v[80:83], v[172:175], v[144:147], v[80:83]
    ds_read_b128 v[128:131], v12 offset:0
    ds_read_b64_tr_b16 v[160:161], v14 offset:0
    v_fmac_f32 v210, v208, v208
    s_add_u32 m0, s40, 36864
    s_nop 0
    buffer_load_dwordx4 v5, s[16:19], s41 offen lds
    v_mfma_f32_16x16x32_bf16 v[84:87], v[172:175], v[148:151], v[84:87]
    ds_read_b64_tr_b16 v[162:163], v14 offset:768
    v_fmac_f32 v210, v209, v209
    v_mfma_f32_16x16x32_bf16 v[88:91], v[172:175], v[152:155], v[88:91]
    ds_read_b128 v[132:135], v12 offset:2048
    v_add_f32_dpp v210, v210, v210 row_shr:1 row_mask:0xf bank_mask:0xf bound_ctrl:0
    v_mfma_f32_16x16x32_bf16 v[92:95], v[172:175], v[156:159], v[92:95]
    ds_read_b128 v[136:139], v12 offset:4096
    v_add_f32_dpp v210, v210, v210 row_shr:2 row_mask:0xf bank_mask:0xf bound_ctrl:0
    s_add_u32 m0, s40, 37888
    s_nop 0
    buffer_load_dwordx4 v6, s[16:19], s41 offen lds
    v_mfma_f32_16x16x32_bf16 v[96:99], v[176:179], v[144:147], v[96:99]
    ds_read_b128 v[140:143], v12 offset:6144
    v_add_f32_dpp v210, v210, v210 row_shr:4 row_mask:0xf bank_mask:0xf bound_ctrl:0
    v_mfma_f32_16x16x32_bf16 v[100:103], v[176:179], v[148:151], v[100:103]
    ds_read_b64_tr_b16 v[164:165], v15 offset:32
    v_add_f32_dpp v210, v210, v210 row_shr:8 row_mask:0xf bank_mask:0xf bound_ctrl:0
    v_mfma_f32_16x16x32_bf16 v[104:107], v[176:179], v[152:155], v[104:107]
    ds_read_b64_tr_b16 v[166:167], v15 offset:800
    v_add_f32_dpp v210, v210, v210 row_bcast:15 row_mask:0xa bank_mask:0xf
    s_add_u32 m0, s40, 38912
    s_nop 0
    buffer_load_dwordx4 v7, s[16:19], s41 offen lds
    v_mfma_f32_16x16x32_bf16 v[108:111], v[176:179], v[156:159], v[108:111]
    ds_read_b64_tr_b16 v[168:169], v14 offset:64
    v_add_f32_dpp v210, v210, v210 row_bcast:31 row_mask:0xc bank_mask:0xf
    v_mfma_f32_16x16x32_bf16 v[112:115], v[180:183], v[144:147], v[112:115]
    ds_read_b64_tr_b16 v[170:171], v14 offset:832
    v_readlane_b32 s51, v210, 63
    v_mfma_f32_16x16x32_bf16 v[116:119], v[180:183], v[148:151], v[116:119]
    v_mov_b32 v210, 0x3acccccd
    s_add_u32 m0, s40, 24576
    s_nop 0
    buffer_load_dwordx4 v5, s[12:15], s41 offen lds
    v_mfma_f32_16x16x32_bf16 v[120:123], v[180:183], v[152:155], v[120:123]
    v_mul_f32 v210, s51, v210
    v_mfma_f32_16x16x32_bf16 v[124:127], v[180:183], v[156:159], v[124:127]
    v_cvt_pk_bf16_f32 v210, v210, v211
    s_waitcnt lgkmcnt(0)
    v_mfma_f32_16x16x32_bf16 v[32:35], v[160:163], v[128:131], v[32:35]
    ds_read_b64_tr_b16 v[172:173], v14 offset:12288
    v_and_b32 v200, 0xffff0000, v210
    s_add_u32 m0, s40, 25600
    s_nop 0
    buffer_load_dwordx4 v6, s[12:15], s41 offen lds
    v_mfma_f32_16x16x32_bf16 v[36:39], v[160:163], v[132:135], v[36:39]
    ds_read_b64_tr_b16 v[174:175], v14 offset:13056
    v_lshlrev_b32 v210, 16, v210
    v_mfma_f32_16x16x32_bf16 v[40:43], v[160:163], v[136:139], v[40:43]
    ds_read_b64_tr_b16 v[176:177], v15 offset:12320
    v_add_f32 v210, 0x3727c5ac, v210
    v_mfma_f32_16x16x32_bf16 v[44:47], v[160:163], v[140:143], v[44:47]
    ds_read_b64_tr_b16 v[178:179], v15 offset:13088
    v_cvt_pk_bf16_f32 v210, v210, v210
    s_add_u32 m0, s40, 26624
    s_nop 0
    buffer_load_dwordx4 v7, s[12:15], s41 offen lds
    s_add_u32 s41, s41, s49
    v_mfma_f32_16x16x32_bf16 v[48:51], v[164:167], v[128:131], v[48:51]
    ds_read_b64_tr_b16 v[180:181], v14 offset:12352
    v_lshlrev_b32 v210, 16, v210
    v_mfma_f32_16x16x32_bf16 v[52:55], v[164:167], v[132:135], v[52:55]
    ds_read_b64_tr_b16 v[182:183], v14 offset:13120
    v_sqrt_f32 v210, v210
    v_mfma_f32_16x16x32_bf16 v[56:59], v[164:167], v[136:139], v[56:59]
    v_cvt_pk_bf16_f32 v210, v210, v210
    s_add_u32 m0, s39, 81408
    s_nop 0
    buffer_load_dwordx4 v1, s[8:11], 0 offen offset:512 lds
    v_mfma_f32_16x16x32_bf16 v[60:63], v[164:167], v[140:143], v[60:63]
    v_lshlrev_b32 v201, 16, v210
    v_mfma_f32_16x16x32_bf16 v[64:67], v[168:171], v[128:131], v[64:67]
    s_lshl_b32 s51, s50, 3
    v_mfma_f32_16x16x32_bf16 v[68:71], v[168:171], v[132:135], v[68:71]
    s_add_u32 s51, s51, 32768
    s_add_u32 m0, s39, 82432
    s_nop 0
    buffer_load_dwordx4 v2, s[8:11], 0 offen offset:512 lds
    v_mfma_f32_16x16x32_bf16 v[72:75], v[168:171], v[136:139], v[72:75]
    v_mov_b32 v210, 0
    v_mfma_f32_16x16x32_bf16 v[76:79], v[168:171], v[140:143], v[76:79]
    s_mov_b64 exec, 1
    buffer_store_dwordx2 v[200:201], v210, s[20:23], s51 offen sc1
    s_mov_b64 exec, -1
    s_waitcnt lgkmcnt(0)
    v_mfma_f32_16x16x32_bf16 v[80:83], v[172:175], v[128:131], v[80:83]
    ds_read_b128 v[144:147], v13 offset:0
    ds_read_b64_tr_b16 v[160:161], v14 offset:6144
    s_add_u32 m0, s39, 83456
    s_nop 0
    buffer_load_dwordx4 v3, s[8:11], 0 offen offset:512 lds
    v_mfma_f32_16x16x32_bf16 v[84:87], v[172:175], v[132:135], v[84:87]
    ds_read_b64_tr_b16 v[162:163], v14 offset:6912
    v_mfma_f32_16x16x32_bf16 v[88:91], v[172:175], v[136:139], v[88:91]
    ds_read_b128 v[148:151], v13 offset:2048
    v_mfma_f32_16x16x32_bf16 v[92:95], v[172:175], v[140:143], v[92:95]
    ds_read_b128 v[152:155], v13 offset:4096
    v_mfma_f32_16x16x32_bf16 v[96:99], v[176:179], v[128:131], v[96:99]
    ds_read_b128 v[156:159], v13 offset:6144
    s_add_u32 m0, s39, 84480
    s_nop 0
    buffer_load_dwordx4 v4, s[8:11], 0 offen offset:512 lds
    v_mfma_f32_16x16x32_bf16 v[100:103], v[176:179], v[132:135], v[100:103]
    ds_read_b64_tr_b16 v[164:165], v15 offset:6176
    v_mfma_f32_16x16x32_bf16 v[104:107], v[176:179], v[136:139], v[104:107]
    ds_read_b64_tr_b16 v[166:167], v15 offset:6944
    v_mfma_f32_16x16x32_bf16 v[108:111], v[176:179], v[140:143], v[108:111]
    ds_read_b64_tr_b16 v[168:169], v14 offset:6208
    v_mfma_f32_16x16x32_bf16 v[112:115], v[180:183], v[128:131], v[112:115]
    ds_read_b64_tr_b16 v[170:171], v14 offset:6976
    s_add_u32 m0, s39, 97792
    s_nop 0
    buffer_load_dwordx4 v1, s[8:11], s3 offen offset:512 lds
    v_mfma_f32_16x16x32_bf16 v[116:119], v[180:183], v[132:135], v[116:119]
    v_mfma_f32_16x16x32_bf16 v[120:123], v[180:183], v[136:139], v[120:123]
    v_mfma_f32_16x16x32_bf16 v[124:127], v[180:183], v[140:143], v[124:127]
    s_waitcnt lgkmcnt(0)
    v_mfma_f32_16x16x32_bf16 v[32:35], v[160:163], v[144:147], v[32:35]
    ds_read_b64_tr_b16 v[172:173], v14 offset:18432
    s_add_u32 m0, s39, 98816
    s_nop 0
    buffer_load_dwordx4 v2, s[8:11], s3 offen offset:512 lds
    v_mfma_f32_16x16x32_bf16 v[36:39], v[160:163], v[148:151], v[36:39]
    ds_read_b64_tr_b16 v[174:175], v14 offset:19200
    v_mfma_f32_16x16x32_bf16 v[40:43], v[160:163], v[152:155], v[40:43]
    ds_read_b64_tr_b16 v[176:177], v15 offset:18464
    v_mfma_f32_16x16x32_bf16 v[44:47], v[160:163], v[156:159], v[44:47]
    ds_read_b64_tr_b16 v[178:179], v15 offset:19232
    v_mfma_f32_16x16x32_bf16 v[48:51], v[164:167], v[144:147], v[48:51]
    ds_read_b64_tr_b16 v[180:181], v14 offset:18496
    s_add_u32 m0, s39, 99840
    s_nop 0
    buffer_load_dwordx4 v3, s[8:11], s3 offen offset:512 lds
    v_mfma_f32_16x16x32_bf16 v[52:55], v[164:167], v[148:151], v[52:55]
    ds_read_b64_tr_b16 v[182:183], v14 offset:19264
    v_mfma_f32_16x16x32_bf16 v[56:59], v[164:167], v[152:155], v[56:59]
    v_mfma_f32_16x16x32_bf16 v[60:63], v[164:167], v[156:159], v[60:63]
    v_mfma_f32_16x16x32_bf16 v[64:67], v[168:171], v[144:147], v[64:67]
    s_add_u32 m0, s39, 100864
    s_nop 0
    buffer_load_dwordx4 v4, s[8:11], s3 offen offset:512 lds
    v_mfma_f32_16x16x32_bf16 v[68:71], v[168:171], v[148:151], v[68:71]
    v_mfma_f32_16x16x32_bf16 v[72:75], v[168:171], v[152:155], v[72:75]
    v_mfma_f32_16x16x32_bf16 v[76:79], v[168:171], v[156:159], v[76:79]
    s_waitcnt vmcnt(9) lgkmcnt(0)
    s_barrier
    s_waitcnt vmcnt(15)
    v_readfirstlane_b32 s82, v242
    v_readfirstlane_b32 s83, v243
    s_cmp_lg_u32 s82, 0
    s_cbranch_scc1 GUL_NON_OK
    s_mov_b32 s81, 0
GUL_NON_SP:
    s_sleep 2
    v_mov_b32 v242, 0
    buffer_load_dwordx2 v[242:243], v242, s[4:7], 0 offen sc1
    s_waitcnt vmcnt(0)
    v_readfirstlane_b32 s82, v242
    v_readfirstlane_b32 s83, v243
    s_add_u32 s81, s81, 1
    s_cmp_ge_u32 s81, 200000
    s_cbranch_scc1 GUL_NON_OK
    s_cmp_eq_u32 s82, 0
    s_cbranch_scc1 GUL_NON_SP
GUL_NON_OK:
    v_mfma_f32_16x16x32_bf16 v[80:83], v[172:175], v[144:147], v[80:83]
    ds_read_b128 v[128:131], v10 offset:0
    ds_read_b64_tr_b16 v[160:161], v14 offset:24576
    s_add_u32 m0, s40, 12288
    s_nop 0
    buffer_load_dwordx4 v5, s[16:19], s41 offen lds
    v_mfma_f32_16x16x32_bf16 v[84:87], v[172:175], v[148:151], v[84:87]
    ds_read_b64_tr_b16 v[162:163], v14 offset:25344
    v_mfma_f32_16x16x32_bf16 v[88:91], v[172:175], v[152:155], v[88:91]
    ds_read_b128 v[132:135], v10 offset:2048
    v_mfma_f32_16x16x32_bf16 v[92:95], v[172:175], v[156:159], v[92:95]
    ds_read_b128 v[136:139], v10 offset:4096
    s_add_u32 m0, s40, 13312
    s_nop 0
    buffer_load_dwordx4 v6, s[16:19], s41 offen lds
    v_mfma_f32_16x16x32_bf16 v[96:99], v[176:179], v[144:147], v[96:99]
    ds_read_b128 v[140:143], v10 offset:6144
    v_mfma_f32_16x16x32_bf16 v[100:103], v[176:179], v[148:151], v[100:103]
    ds_read_b64_tr_b16 v[164:165], v15 offset:24608
    v_mfma_f32_16x16x32_bf16 v[104:107], v[176:179], v[152:155], v[104:107]
    ds_read_b64_tr_b16 v[166:167], v15 offset:25376
    s_add_u32 m0, s40, 14336
    s_nop 0
    buffer_load_dwordx4 v7, s[16:19], s41 offen lds
    v_mfma_f32_16x16x32_bf16 v[108:111], v[176:179], v[156:159], v[108:111]
    ds_read_b64_tr_b16 v[168:169], v14 offset:24640
    v_mfma_f32_16x16x32_bf16 v[112:115], v[180:183], v[144:147], v[112:115]
    ds_read_b64_tr_b16 v[170:171], v14 offset:25408
    v_mfma_f32_16x16x32_bf16 v[116:119], v[180:183], v[148:151], v[116:119]
    s_add_u32 m0, s40, 0
    s_nop 0
    buffer_load_dwordx4 v5, s[12:15], s41 offen lds
    v_mfma_f32_16x16x32_bf16 v[120:123], v[180:183], v[152:155], v[120:123]
    v_mfma_f32_16x16x32_bf16 v[124:127], v[180:183], v[156:159], v[124:127]
    s_waitcnt lgkmcnt(0)
    v_mfma_f32_16x16x32_bf16 v[32:35], v[160:163], v[128:131], v[32:35]
    ds_read_b64_tr_b16 v[172:173], v14 offset:36864
    s_add_u32 m0, s40, 1024
    s_nop 0
    buffer_load_dwordx4 v6, s[12:15], s41 offen lds
    v_mfma_f32_16x16x32_bf16 v[36:39], v[160:163], v[132:135], v[36:39]
    ds_read_b64_tr_b16 v[174:175], v14 offset:37632
    v_mfma_f32_16x16x32_bf16 v[40:43], v[160:163], v[136:139], v[40:43]
    ds_read_b64_tr_b16 v[176:177], v15 offset:36896
    v_mfma_f32_16x16x32_bf16 v[44:47], v[160:163], v[140:143], v[44:47]
    ds_read_b64_tr_b16 v[178:179], v15 offset:37664
    s_add_u32 m0, s40, 2048
    s_nop 0
    buffer_load_dwordx4 v7, s[12:15], s41 offen lds
    s_add_u32 s41, s41, s49
    v_mfma_f32_16x16x32_bf16 v[48:51], v[164:167], v[128:131], v[48:51]
    ds_read_b64_tr_b16 v[180:181], v14 offset:36928
    v_mfma_f32_16x16x32_bf16 v[52:55], v[164:167], v[132:135], v[52:55]
    ds_read_b64_tr_b16 v[182:183], v14 offset:37696
    v_mfma_f32_16x16x32_bf16 v[56:59], v[164:167], v[136:139], v[56:59]
    s_add_u32 m0, s39, 114048
    s_nop 0
    buffer_load_dwordx4 v1, s[8:11], 0 offen offset:640 lds
    v_mfma_f32_16x16x32_bf16 v[60:63], v[164:167], v[140:143], v[60:63]
    v_mfma_f32_16x16x32_bf16 v[64:67], v[168:171], v[128:131], v[64:67]
    v_mfma_f32_16x16x32_bf16 v[68:71], v[168:171], v[132:135], v[68:71]
    s_add_u32 m0, s39, 115072
    s_nop 0
    buffer_load_dwordx4 v2, s[8:11], 0 offen offset:640 lds
    v_mfma_f32_16x16x32_bf16 v[72:75], v[168:171], v[136:139], v[72:75]
    v_mfma_f32_16x16x32_bf16 v[76:79], v[168:171], v[140:143], v[76:79]
    s_waitcnt lgkmcnt(0)
    v_mfma_f32_16x16x32_bf16 v[80:83], v[172:175], v[128:131], v[80:83]
    ds_read_b128 v[144:147], v11 offset:0
    ds_read_b64_tr_b16 v[160:161], v14 offset:30720
    s_add_u32 m0, s39, 116096
    s_nop 0
    buffer_load_dwordx4 v3, s[8:11], 0 offen offset:640 lds
    v_mfma_f32_16x16x32_bf16 v[84:87], v[172:175], v[132:135], v[84:87]
    ds_read_b64_tr_b16 v[162:163], v14 offset:31488
    v_mfma_f32_16x16x32_bf16 v[88:91], v[172:175], v[136:139], v[88:91]
    ds_read_b128 v[148:151], v11 offset:2048
    v_mfma_f32_16x16x32_bf16 v[92:95], v[172:175], v[140:143], v[92:95]
    ds_read_b128 v[152:155], v11 offset:4096
    v_mfma_f32_16x16x32_bf16 v[96:99], v[176:179], v[128:131], v[96:99]
    ds_read_b128 v[156:159], v11 offset:6144
    s_add_u32 m0, s39, 117120
    s_nop 0
    buffer_load_dwordx4 v4, s[8:11], 0 offen offset:640 lds
    v_mfma_f32_16x16x32_bf16 v[100:103], v[176:179], v[132:135], v[100:103]
    ds_read_b64_tr_b16 v[164:165], v15 offset:30752
    v_mfma_f32_16x16x32_bf16 v[104:107], v[176:179], v[136:139], v[104:107]
    ds_read_b64_tr_b16 v[166:167], v15 offset:31520
    v_mfma_f32_16x16x32_bf16 v[108:111], v[176:179], v[140:143], v[108:111]
    ds_read_b64_tr_b16 v[168:169], v14 offset:30784
    v_mfma_f32_16x16x32_bf16 v[112:115], v[180:183], v[128:131], v[112:115]
    ds_read_b64_tr_b16 v[170:171], v14 offset:31552
    s_add_u32 m0, s39, 130432
    s_nop 0
    buffer_load_dwordx4 v1, s[8:11], s3 offen offset:640 lds
    v_mfma_f32_16x16x32_bf16 v[116:119], v[180:183], v[132:135], v[116:119]
    v_mfma_f32_16x16x32_bf16 v[120:123], v[180:183], v[136:139], v[120:123]
    v_mfma_f32_16x16x32_bf16 v[124:127], v[180:183], v[140:143], v[124:127]
    s_waitcnt lgkmcnt(0)
    v_mfma_f32_16x16x32_bf16 v[32:35], v[160:163], v[144:147], v[32:35]
    ds_read_b64_tr_b16 v[172:173], v14 offset:43008
    s_add_u32 m0, s39, 131456
    s_nop 0
    buffer_load_dwordx4 v2, s[8:11], s3 offen offset:640 lds
    v_mfma_f32_16x16x32_bf16 v[36:39], v[160:163], v[148:151], v[36:39]
    ds_read_b64_tr_b16 v[174:175], v14 offset:43776
    v_mfma_f32_16x16x32_bf16 v[40:43], v[160:163], v[152:155], v[40:43]
    ds_read_b64_tr_b16 v[176:177], v15 offset:43040
    v_mfma_f32_16x16x32_bf16 v[44:47], v[160:163], v[156:159], v[44:47]
    ds_read_b64_tr_b16 v[178:179], v15 offset:43808
    v_mfma_f32_16x16x32_bf16 v[48:51], v[164:167], v[144:147], v[48:51]
    ds_read_b64_tr_b16 v[180:181], v14 offset:43072
    s_add_u32 m0, s39, 132480
    s_nop 0
    buffer_load_dwordx4 v3, s[8:11], s3 offen offset:640 lds
    v_mfma_f32_16x16x32_bf16 v[52:55], v[164:167], v[148:151], v[52:55]
    ds_read_b64_tr_b16 v[182:183], v14 offset:43840
    v_mfma_f32_16x16x32_bf16 v[56:59], v[164:167], v[152:155], v[56:59]
    v_mfma_f32_16x16x32_bf16 v[60:63], v[164:167], v[156:159], v[60:63]
    v_mfma_f32_16x16x32_bf16 v[64:67], v[168:171], v[144:147], v[64:67]
    s_add_u32 m0, s39, 133504
    s_nop 0
    buffer_load_dwordx4 v4, s[8:11], s3 offen offset:640 lds
    v_mfma_f32_16x16x32_bf16 v[68:71], v[168:171], v[148:151], v[68:71]
    v_mfma_f32_16x16x32_bf16 v[72:75], v[168:171], v[152:155], v[72:75]
    v_mfma_f32_16x16x32_bf16 v[76:79], v[168:171], v[156:159], v[76:79]
    s_waitcnt vmcnt(8) lgkmcnt(0)
    s_barrier
    v_mfma_f32_16x16x32_bf16 v[80:83], v[172:175], v[144:147], v[80:83]
    ds_read_b128 v[128:131], v10 offset:32768
    ds_read_b64_tr_b16 v[160:161], v14 offset:0
    s_add_u32 m0, s40, 36864
    s_nop 0
    buffer_load_dwordx4 v5, s[16:19], s41 offen lds
    v_mfma_f32_16x16x32_bf16 v[84:87], v[172:175], v[148:151], v[84:87]
    ds_read_b64_tr_b16 v[162:163], v14 offset:768
    v_mfma_f32_16x16x32_bf16 v[88:91], v[172:175], v[152:155], v[88:91]
    ds_read_b128 v[132:135], v10 offset:34816
    v_mfma_f32_16x16x32_bf16 v[92:95], v[172:175], v[156:159], v[92:95]
    ds_read_b128 v[136:139], v10 offset:36864
    s_add_u32 m0, s40, 37888
    s_nop 0
    buffer_load_dwordx4 v6, s[16:19], s41 offen lds
    v_mfma_f32_16x16x32_bf16 v[96:99], v[176:179], v[144:147], v[96:99]
    ds_read_b128 v[140:143], v10 offset:38912
    v_mfma_f32_16x16x32_bf16 v[100:103], v[176:179], v[148:151], v[100:103]
    ds_read_b64_tr_b16 v[164:165], v15 offset:32
    v_mfma_f32_16x16x32_bf16 v[104:107], v[176:179], v[152:155], v[104:107]
    ds_read_b64_tr_b16 v[166:167], v15 offset:800
    s_add_u32 m0, s40, 38912
    s_nop 0
    buffer_load_dwordx4 v7, s[16:19], s41 offen lds
    v_mfma_f32_16x16x32_bf16 v[108:111], v[176:179], v[156:159], v[108:111]
    ds_read_b64_tr_b16 v[168:169], v14 offset:64
    v_mfma_f32_16x16x32_bf16 v[112:115], v[180:183], v[144:147], v[112:115]
    ds_read_b64_tr_b16 v[170:171], v14 offset:832
    v_mfma_f32_16x16x32_bf16 v[116:119], v[180:183], v[148:151], v[116:119]
    s_add_u32 m0, s40, 24576
    s_nop 0
    buffer_load_dwordx4 v5, s[12:15], s41 offen lds
    v_mfma_f32_16x16x32_bf16 v[120:123], v[180:183], v[152:155], v[120:123]
    v_mfma_f32_16x16x32_bf16 v[124:127], v[180:183], v[156:159], v[124:127]
    s_waitcnt lgkmcnt(0)
    v_mfma_f32_16x16x32_bf16 v[32:35], v[160:163], v[128:131], v[32:35]
    ds_read_b64_tr_b16 v[172:173], v14 offset:12288
    v_and_b32 v30, 3, v0
    v_mfma_f32_16x16x32_bf16 v[36:39], v[160:163], v[132:135], v[36:39]
    ds_read_b64_tr_b16 v[174:175], v14 offset:13056
    v_mfma_f32_16x16x32_bf16 v[40:43], v[160:163], v[136:139], v[40:43]
    ds_read_b64_tr_b16 v[176:177], v15 offset:12320
    s_add_u32 m0, s40, 25600
    s_nop 0
    buffer_load_dwordx4 v6, s[12:15], s41 offen lds
    v_mfma_f32_16x16x32_bf16 v[44:47], v[160:163], v[140:143], v[44:47]
    ds_read_b64_tr_b16 v[178:179], v15 offset:13088
    v_mfma_f32_16x16x32_bf16 v[48:51], v[164:167], v[128:131], v[48:51]
    ds_read_b64_tr_b16 v[180:181], v14 offset:12352
    s_add_u32 m0, s40, 26624
    s_nop 0
    buffer_load_dwordx4 v7, s[12:15], s41 offen lds
    s_add_u32 s41, s41, s49
    v_mfma_f32_16x16x32_bf16 v[52:55], v[164:167], v[132:135], v[52:55]
    ds_read_b64_tr_b16 v[182:183], v14 offset:13120
    v_mfma_f32_16x16x32_bf16 v[56:59], v[164:167], v[136:139], v[56:59]
    v_mfma_f32_16x16x32_bf16 v[60:63], v[164:167], v[140:143], v[60:63]
    s_add_u32 m0, s39, 48384
    s_nop 0
    buffer_load_dwordx4 v1, s[8:11], 0 offen offset:768 lds
    v_mfma_f32_16x16x32_bf16 v[64:67], v[168:171], v[128:131], v[64:67]
    v_mfma_f32_16x16x32_bf16 v[68:71], v[168:171], v[132:135], v[68:71]
    s_add_u32 m0, s39, 49408
    s_nop 0
    buffer_load_dwordx4 v2, s[8:11], 0 offen offset:768 lds
    v_mfma_f32_16x16x32_bf16 v[72:75], v[168:171], v[136:139], v[72:75]
    v_mfma_f32_16x16x32_bf16 v[76:79], v[168:171], v[140:143], v[76:79]
    s_waitcnt lgkmcnt(0)
    v_mfma_f32_16x16x32_bf16 v[80:83], v[172:175], v[128:131], v[80:83]
    ds_read_b128 v[144:147], v11 offset:32768
    ds_read_b64_tr_b16 v[160:161], v14 offset:6144
    v_bfe_u32 v16, v0, 2, 2
    v_mfma_f32_16x16x32_bf16 v[84:87], v[172:175], v[132:135], v[84:87]
    ds_read_b64_tr_b16 v[162:163], v14 offset:6912
    v_mfma_f32_16x16x32_bf16 v[88:91], v[172:175], v[136:139], v[88:91]
    ds_read_b128 v[148:151], v11 offset:34816
    s_add_u32 m0, s39, 50432
    s_nop 0
    buffer_load_dwordx4 v3, s[8:11], 0 offen offset:768 lds
    v_mfma_f32_16x16x32_bf16 v[92:95], v[172:175], v[140:143], v[92:95]
    ds_read_b128 v[152:155], v11 offset:36864
    v_mfma_f32_16x16x32_bf16 v[96:99], v[176:179], v[128:131], v[96:99]
    ds_read_b128 v[156:159], v11 offset:38912
    s_add_u32 m0, s39, 51456
    s_nop 0
    buffer_load_dwordx4 v4, s[8:11], 0 offen offset:768 lds
    v_mfma_f32_16x16x32_bf16 v[100:103], v[176:179], v[132:135], v[100:103]
    ds_read_b64_tr_b16 v[164:165], v15 offset:6176
    v_mfma_f32_16x16x32_bf16 v[104:107], v[176:179], v[136:139], v[104:107]
    ds_read_b64_tr_b16 v[166:167], v15 offset:6944
    v_mfma_f32_16x16x32_bf16 v[108:111], v[176:179], v[140:143], v[108:111]
    ds_read_b64_tr_b16 v[168:169], v14 offset:6208
    v_lshl_add_u32 v30, v16, 3, v30
    v_mfma_f32_16x16x32_bf16 v[112:115], v[180:183], v[128:131], v[112:115]
    ds_read_b64_tr_b16 v[170:171], v14 offset:6976
    v_mfma_f32_16x16x32_bf16 v[116:119], v[180:183], v[132:135], v[116:119]
    s_add_u32 m0, s39, 64768
    s_nop 0
    buffer_load_dwordx4 v1, s[8:11], s3 offen offset:768 lds
    v_mfma_f32_16x16x32_bf16 v[120:123], v[180:183], v[136:139], v[120:123]
    v_mfma_f32_16x16x32_bf16 v[124:127], v[180:183], v[140:143], v[124:127]
    s_waitcnt lgkmcnt(0)
    v_mfma_f32_16x16x32_bf16 v[32:35], v[160:163], v[144:147], v[32:35]
    ds_read_b64_tr_b16 v[172:173], v14 offset:18432
    v_add_u32 v30, 228, v30
    v_mfma_f32_16x16x32_bf16 v[36:39], v[160:163], v[148:151], v[36:39]
    ds_read_b64_tr_b16 v[174:175], v14 offset:19200
    v_mfma_f32_16x16x32_bf16 v[40:43], v[160:163], v[152:155], v[40:43]
    ds_read_b64_tr_b16 v[176:177], v15 offset:18464
    s_add_u32 m0, s39, 65792
    s_nop 0
    buffer_load_dwordx4 v2, s[8:11], s3 offen offset:768 lds
    v_mfma_f32_16x16x32_bf16 v[44:47], v[160:163], v[156:159], v[44:47]
    ds_read_b64_tr_b16 v[178:179], v15 offset:19232
    v_mfma_f32_16x16x32_bf16 v[48:51], v[164:167], v[144:147], v[48:51]
    ds_read_b64_tr_b16 v[180:181], v14 offset:18496
    s_add_u32 m0, s39, 66816
    s_nop 0
    buffer_load_dwordx4 v3, s[8:11], s3 offen offset:768 lds
    v_mfma_f32_16x16x32_bf16 v[52:55], v[164:167], v[148:151], v[52:55]
    ds_read_b64_tr_b16 v[182:183], v14 offset:19264
    v_mfma_f32_16x16x32_bf16 v[56:59], v[164:167], v[152:155], v[56:59]
    v_mfma_f32_16x16x32_bf16 v[60:63], v[164:167], v[156:159], v[60:63]
    v_lshlrev_b32 v30, 7, v30
    v_mfma_f32_16x16x32_bf16 v[64:67], v[168:171], v[144:147], v[64:67]
    v_mfma_f32_16x16x32_bf16 v[68:71], v[168:171], v[148:151], v[68:71]
    s_add_u32 m0, s39, 67840
    s_nop 0
    buffer_load_dwordx4 v4, s[8:11], s3 offen offset:768 lds
    v_mfma_f32_16x16x32_bf16 v[72:75], v[168:171], v[152:155], v[72:75]
    v_mfma_f32_16x16x32_bf16 v[76:79], v[168:171], v[156:159], v[76:79]
    s_waitcnt vmcnt(8) lgkmcnt(0)
    s_barrier
    v_mfma_f32_16x16x32_bf16 v[80:83], v[172:175], v[144:147], v[80:83]
    ds_read_b128 v[128:131], v12 offset:0
    ds_read_b64_tr_b16 v[160:161], v14 offset:24576
    s_add_u32 m0, s40, 12288
    s_nop 0
    buffer_load_dwordx4 v5, s[16:19], s41 offen lds
    v_mfma_f32_16x16x32_bf16 v[84:87], v[172:175], v[148:151], v[84:87]
    ds_read_b64_tr_b16 v[162:163], v14 offset:25344
    v_mfma_f32_16x16x32_bf16 v[88:91], v[172:175], v[152:155], v[88:91]
    ds_read_b128 v[132:135], v12 offset:2048
    v_mfma_f32_16x16x32_bf16 v[92:95], v[172:175], v[156:159], v[92:95]
    ds_read_b128 v[136:139], v12 offset:4096
    s_add_u32 m0, s40, 13312
    s_nop 0
    buffer_load_dwordx4 v6, s[16:19], s41 offen lds
    v_mfma_f32_16x16x32_bf16 v[96:99], v[176:179], v[144:147], v[96:99]
    ds_read_b128 v[140:143], v12 offset:6144
    v_mfma_f32_16x16x32_bf16 v[100:103], v[176:179], v[148:151], v[100:103]
    ds_read_b64_tr_b16 v[164:165], v15 offset:24608
    v_mfma_f32_16x16x32_bf16 v[104:107], v[176:179], v[152:155], v[104:107]
    ds_read_b64_tr_b16 v[166:167], v15 offset:25376
    s_add_u32 m0, s40, 14336
    s_nop 0
    buffer_load_dwordx4 v7, s[16:19], s41 offen lds
    v_mfma_f32_16x16x32_bf16 v[108:111], v[176:179], v[156:159], v[108:111]
    ds_read_b64_tr_b16 v[168:169], v14 offset:24640
    v_mfma_f32_16x16x32_bf16 v[112:115], v[180:183], v[144:147], v[112:115]
    ds_read_b64_tr_b16 v[170:171], v14 offset:25408
    v_mfma_f32_16x16x32_bf16 v[116:119], v[180:183], v[148:151], v[116:119]
    s_add_u32 m0, s40, 0
    s_nop 0
    buffer_load_dwordx4 v5, s[12:15], s41 offen lds
    v_mfma_f32_16x16x32_bf16 v[120:123], v[180:183], v[152:155], v[120:123]
    v_mfma_f32_16x16x32_bf16 v[124:127], v[180:183], v[156:159], v[124:127]
    s_waitcnt lgkmcnt(0)
    v_mfma_f32_16x16x32_bf16 v[32:35], v[160:163], v[128:131], v[32:35]
    ds_read_b64_tr_b16 v[172:173], v14 offset:36864
    s_add_u32 m0, s40, 1024
    s_nop 0
    buffer_load_dwordx4 v6, s[12:15], s41 offen lds
    v_mfma_f32_16x16x32_bf16 v[36:39], v[160:163], v[132:135], v[36:39]
    ds_read_b64_tr_b16 v[174:175], v14 offset:37632
    v_mfma_f32_16x16x32_bf16 v[40:43], v[160:163], v[136:139], v[40:43]
    ds_read_b64_tr_b16 v[176:177], v15 offset:36896
    v_mfma_f32_16x16x32_bf16 v[44:47], v[160:163], v[140:143], v[44:47]
    ds_read_b64_tr_b16 v[178:179], v15 offset:37664
    s_add_u32 m0, s40, 2048
    s_nop 0
    buffer_load_dwordx4 v7, s[12:15], s41 offen lds
    s_add_u32 s41, s41, s49
    v_mfma_f32_16x16x32_bf16 v[48:51], v[164:167], v[128:131], v[48:51]
    ds_read_b64_tr_b16 v[180:181], v14 offset:36928
    v_mfma_f32_16x16x32_bf16 v[52:55], v[164:167], v[132:135], v[52:55]
    ds_read_b64_tr_b16 v[182:183], v14 offset:37696
    v_mfma_f32_16x16x32_bf16 v[56:59], v[164:167], v[136:139], v[56:59]
    s_add_u32 m0, s39, 81024
    s_nop 0
    buffer_load_dwordx4 v1, s[8:11], 0 offen offset:896 lds
    v_mfma_f32_16x16x32_bf16 v[60:63], v[164:167], v[140:143], v[60:63]
    v_mfma_f32_16x16x32_bf16 v[64:67], v[168:171], v[128:131], v[64:67]
    v_mfma_f32_16x16x32_bf16 v[68:71], v[168:171], v[132:135], v[68:71]
    s_add_u32 m0, s39, 82048
    s_nop 0
    buffer_load_dwordx4 v2, s[8:11], 0 offen offset:896 lds
    v_mfma_f32_16x16x32_bf16 v[72:75], v[168:171], v[136:139], v[72:75]
    v_mfma_f32_16x16x32_bf16 v[76:79], v[168:171], v[140:143], v[76:79]
    s_waitcnt lgkmcnt(0)
    v_mfma_f32_16x16x32_bf16 v[80:83], v[172:175], v[128:131], v[80:83]
    ds_read_b128 v[144:147], v13 offset:0
    ds_read_b64_tr_b16 v[160:161], v14 offset:30720
    s_add_u32 m0, s39, 83072
    s_nop 0
    buffer_load_dwordx4 v3, s[8:11], 0 offen offset:896 lds
    v_mfma_f32_16x16x32_bf16 v[84:87], v[172:175], v[132:135], v[84:87]
    ds_read_b64_tr_b16 v[162:163], v14 offset:31488
    v_mfma_f32_16x16x32_bf16 v[88:91], v[172:175], v[136:139], v[88:91]
    ds_read_b128 v[148:151], v13 offset:2048
    v_mfma_f32_16x16x32_bf16 v[92:95], v[172:175], v[140:143], v[92:95]
    ds_read_b128 v[152:155], v13 offset:4096
    v_mfma_f32_16x16x32_bf16 v[96:99], v[176:179], v[128:131], v[96:99]
    ds_read_b128 v[156:159], v13 offset:6144
    s_add_u32 m0, s39, 84096
    s_nop 0
    buffer_load_dwordx4 v4, s[8:11], 0 offen offset:896 lds
    v_mfma_f32_16x16x32_bf16 v[100:103], v[176:179], v[132:135], v[100:103]
    ds_read_b64_tr_b16 v[164:165], v15 offset:30752
    v_mfma_f32_16x16x32_bf16 v[104:107], v[176:179], v[136:139], v[104:107]
    ds_read_b64_tr_b16 v[166:167], v15 offset:31520
    v_mfma_f32_16x16x32_bf16 v[108:111], v[176:179], v[140:143], v[108:111]
    ds_read_b64_tr_b16 v[168:169], v14 offset:30784
    v_mfma_f32_16x16x32_bf16 v[112:115], v[180:183], v[128:131], v[112:115]
    ds_read_b64_tr_b16 v[170:171], v14 offset:31552
    s_add_u32 m0, s39, 97408
    s_nop 0
    buffer_load_dwordx4 v1, s[8:11], s3 offen offset:896 lds
    v_mfma_f32_16x16x32_bf16 v[116:119], v[180:183], v[132:135], v[116:119]
    v_mfma_f32_16x16x32_bf16 v[120:123], v[180:183], v[136:139], v[120:123]
    v_mfma_f32_16x16x32_bf16 v[124:127], v[180:183], v[140:143], v[124:127]
    s_waitcnt lgkmcnt(0)
    v_mfma_f32_16x16x32_bf16 v[32:35], v[160:163], v[144:147], v[32:35]
    ds_read_b64_tr_b16 v[172:173], v14 offset:43008
    s_add_u32 m0, s39, 98432
    s_nop 0
    buffer_load_dwordx4 v2, s[8:11], s3 offen offset:896 lds
    v_mfma_f32_16x16x32_bf16 v[36:39], v[160:163], v[148:151], v[36:39]
    ds_read_b64_tr_b16 v[174:175], v14 offset:43776
    v_mfma_f32_16x16x32_bf16 v[40:43], v[160:163], v[152:155], v[40:43]
    ds_read_b64_tr_b16 v[176:177], v15 offset:43040
    v_mfma_f32_16x16x32_bf16 v[44:47], v[160:163], v[156:159], v[44:47]
    ds_read_b64_tr_b16 v[178:179], v15 offset:43808
    v_mfma_f32_16x16x32_bf16 v[48:51], v[164:167], v[144:147], v[48:51]
    ds_read_b64_tr_b16 v[180:181], v14 offset:43072
    s_add_u32 m0, s39, 99456
    s_nop 0
    buffer_load_dwordx4 v3, s[8:11], s3 offen offset:896 lds
    v_mfma_f32_16x16x32_bf16 v[52:55], v[164:167], v[148:151], v[52:55]
    ds_read_b64_tr_b16 v[182:183], v14 offset:43840
    v_mfma_f32_16x16x32_bf16 v[56:59], v[164:167], v[152:155], v[56:59]
    v_mfma_f32_16x16x32_bf16 v[60:63], v[164:167], v[156:159], v[60:63]
    v_mfma_f32_16x16x32_bf16 v[64:67], v[168:171], v[144:147], v[64:67]
    s_add_u32 m0, s39, 100480
    s_nop 0
    buffer_load_dwordx4 v4, s[8:11], s3 offen offset:896 lds
    v_mfma_f32_16x16x32_bf16 v[68:71], v[168:171], v[148:151], v[68:71]
    v_mfma_f32_16x16x32_bf16 v[72:75], v[168:171], v[152:155], v[72:75]
    v_mfma_f32_16x16x32_bf16 v[76:79], v[168:171], v[156:159], v[76:79]
    s_waitcnt vmcnt(8) lgkmcnt(0)
    s_barrier
    v_mfma_f32_16x16x32_bf16 v[80:83], v[172:175], v[144:147], v[80:83]
    ds_read_b128 v[128:131], v10 offset:0
    ds_read_b64_tr_b16 v[160:161], v14 offset:0
    v_lshlrev_b32 v8, 4, v0
    v_mfma_f32_16x16x32_bf16 v[84:87], v[172:175], v[148:151], v[84:87]
    ds_read_b64_tr_b16 v[162:163], v14 offset:768
    v_mfma_f32_16x16x32_bf16 v[88:91], v[172:175], v[152:155], v[88:91]
    ds_read_b128 v[132:135], v10 offset:2048
    s_add_u32 m0, s40, 36864
    s_nop 0
    buffer_load_dwordx4 v5, s[16:19], s41 offen lds
    v_mfma_f32_16x16x32_bf16 v[92:95], v[172:175], v[156:159], v[92:95]
    ds_read_b128 v[136:139], v10 offset:4096
    v_mfma_f32_16x16x32_bf16 v[96:99], v[176:179], v[144:147], v[96:99]
    ds_read_b128 v[140:143], v10 offset:6144
    s_add_u32 m0, s40, 37888
    s_nop 0
    buffer_load_dwordx4 v6, s[16:19], s41 offen lds
    v_mfma_f32_16x16x32_bf16 v[100:103], v[176:179], v[148:151], v[100:103]
    ds_read_b64_tr_b16 v[164:165], v15 offset:32
    v_mfma_f32_16x16x32_bf16 v[104:107], v[176:179], v[152:155], v[104:107]
    ds_read_b64_tr_b16 v[166:167], v15 offset:800
    v_add_u32 v9, 4096, v8
    v_mfma_f32_16x16x32_bf16 v[108:111], v[176:179], v[156:159], v[108:111]
    ds_read_b64_tr_b16 v[168:169], v14 offset:64
    v_mfma_f32_16x16x32_bf16 v[112:115], v[180:183], v[144:147], v[112:115]
    ds_read_b64_tr_b16 v[170:171], v14 offset:832
    s_add_u32 m0, s40, 38912
    s_nop 0
    buffer_load_dwordx4 v7, s[16:19], s41 offen lds
    v_mfma_f32_16x16x32_bf16 v[116:119], v[180:183], v[148:151], v[116:119]
    v_mfma_f32_16x16x32_bf16 v[120:123], v[180:183], v[152:155], v[120:123]
    s_add_u32 m0, s40, 24576
    s_nop 0
    buffer_load_dwordx4 v5, s[12:15], s41 offen lds
    v_mfma_f32_16x16x32_bf16 v[124:127], v[180:183], v[156:159], v[124:127]
    s_waitcnt lgkmcnt(0)
    v_mfma_f32_16x16x32_bf16 v[32:35], v[160:163], v[128:131], v[32:35]
    ds_read_b64_tr_b16 v[172:173], v14 offset:12288
    s_mul_i32 s29, s32, 10240
    v_mfma_f32_16x16x32_bf16 v[36:39], v[160:163], v[132:135], v[36:39]
    ds_read_b64_tr_b16 v[174:175], v14 offset:13056
    v_mfma_f32_16x16x32_bf16 v[40:43], v[160:163], v[136:139], v[40:43]
    ds_read_b64_tr_b16 v[176:177], v15 offset:12320
    s_add_u32 m0, s40, 25600
    s_nop 0
    buffer_load_dwordx4 v6, s[12:15], s41 offen lds
    v_mfma_f32_16x16x32_bf16 v[44:47], v[160:163], v[140:143], v[44:47]
    ds_read_b64_tr_b16 v[178:179], v15 offset:13088
    v_mfma_f32_16x16x32_bf16 v[48:51], v[164:167], v[128:131], v[48:51]
    ds_read_b64_tr_b16 v[180:181], v14 offset:12352
    s_add_u32 m0, s40, 26624
    s_nop 0
    buffer_load_dwordx4 v7, s[12:15], s41 offen lds
    s_add_u32 s41, s41, s49
    v_mfma_f32_16x16x32_bf16 v[52:55], v[164:167], v[132:135], v[52:55]
    ds_read_b64_tr_b16 v[182:183], v14 offset:13120
    v_mfma_f32_16x16x32_bf16 v[56:59], v[164:167], v[136:139], v[56:59]
    s_add_u32 s30, s29, 81920
    v_mfma_f32_16x16x32_bf16 v[60:63], v[164:167], v[140:143], v[60:63]
    v_mfma_f32_16x16x32_bf16 v[64:67], v[168:171], v[128:131], v[64:67]
    s_add_u32 m0, s39, 113664
    s_nop 0
    buffer_load_dwordx4 v1, s[8:11], 0 offen offset:1024 lds
    v_mfma_f32_16x16x32_bf16 v[68:71], v[168:171], v[132:135], v[68:71]
    v_mfma_f32_16x16x32_bf16 v[72:75], v[168:171], v[136:139], v[72:75]
    s_add_u32 m0, s39, 114688
    s_nop 0
    buffer_load_dwordx4 v2, s[8:11], 0 offen offset:1024 lds
    v_mfma_f32_16x16x32_bf16 v[76:79], v[168:171], v[140:143], v[76:79]
    s_waitcnt lgkmcnt(0)
    v_mfma_f32_16x16x32_bf16 v[80:83], v[172:175], v[128:131], v[80:83]
    ds_read_b128 v[144:147], v11 offset:0
    ds_read_b64_tr_b16 v[160:161], v14 offset:6144
    s_lshl_b32 s45, s32, 3
    s_cmp_eq_u32 s32, 5
    s_cselect_b32 s45, 38, s45
    s_cmp_eq_u32 s32, 6
    s_cselect_b32 s45, 44, s45
    s_cmp_eq_u32 s32, 7
    s_cselect_b32 s45, 49, s45
    s_bfe_u32 s46, s2, 0x30003
    s_mul_i32 s46, s46, 74
    s_add_u32 s28, s45, s46
    s_mul_i32 s28, s28, 5120
    s_add_u32 s28, s28, 10485760
    v_mfma_f32_16x16x32_bf16 v[84:87], v[172:175], v[132:135], v[84:87]
    ds_read_b64_tr_b16 v[162:163], v14 offset:6912
    v_mfma_f32_16x16x32_bf16 v[88:91], v[172:175], v[136:139], v[88:91]
    ds_read_b128 v[148:151], v11 offset:2048
    s_add_u32 m0, s39, 115712
    s_nop 0
    buffer_load_dwordx4 v3, s[8:11], 0 offen offset:1024 lds
    v_mfma_f32_16x16x32_bf16 v[92:95], v[172:175], v[140:143], v[92:95]
    ds_read_b128 v[152:155], v11 offset:4096
    v_mfma_f32_16x16x32_bf16 v[96:99], v[176:179], v[128:131], v[96:99]
    ds_read_b128 v[156:159], v11 offset:6144
    s_add_u32 m0, s39, 116736
    s_nop 0
    buffer_load_dwordx4 v4, s[8:11], 0 offen offset:1024 lds
    v_mfma_f32_16x16x32_bf16 v[100:103], v[176:179], v[132:135], v[100:103]
    ds_read_b64_tr_b16 v[164:165], v15 offset:6176
    v_mfma_f32_16x16x32_bf16 v[104:107], v[176:179], v[136:139], v[104:107]
    ds_read_b64_tr_b16 v[166:167], v15 offset:6944
    v_mfma_f32_16x16x32_bf16 v[108:111], v[176:179], v[140:143], v[108:111]
    ds_read_b64_tr_b16 v[168:169], v14 offset:6208
    s_mov_b32 s31, 0
    v_mfma_f32_16x16x32_bf16 v[112:115], v[180:183], v[128:131], v[112:115]
    ds_read_b64_tr_b16 v[170:171], v14 offset:6976
    v_mfma_f32_16x16x32_bf16 v[116:119], v[180:183], v[132:135], v[116:119]
    s_add_u32 m0, s39, 130048
    s_nop 0
    buffer_load_dwordx4 v1, s[8:11], s3 offen offset:1024 lds
    v_mfma_f32_16x16x32_bf16 v[120:123], v[180:183], v[136:139], v[120:123]
    v_mfma_f32_16x16x32_bf16 v[124:127], v[180:183], v[140:143], v[124:127]
    s_waitcnt lgkmcnt(0)
    v_mfma_f32_16x16x32_bf16 v[32:35], v[160:163], v[144:147], v[32:35]
    ds_read_b64_tr_b16 v[172:173], v14 offset:18432
    buffer_load_dwordx2 v[28:29], v30, s[20:23], 0 offen sc1
    v_mfma_f32_16x16x32_bf16 v[36:39], v[160:163], v[148:151], v[36:39]
    ds_read_b64_tr_b16 v[174:175], v14 offset:19200
    v_mfma_f32_16x16x32_bf16 v[40:43], v[160:163], v[152:155], v[40:43]
    ds_read_b64_tr_b16 v[176:177], v15 offset:18464
    v_mfma_f32_16x16x32_bf16 v[44:47], v[160:163], v[156:159], v[44:47]
    ds_read_b64_tr_b16 v[178:179], v15 offset:19232
    s_add_u32 m0, s39, 131072
    s_nop 0
    buffer_load_dwordx4 v2, s[8:11], s3 offen offset:1024 lds
    v_mfma_f32_16x16x32_bf16 v[48:51], v[164:167], v[144:147], v[48:51]
    ds_read_b64_tr_b16 v[180:181], v14 offset:18496
    v_mfma_f32_16x16x32_bf16 v[52:55], v[164:167], v[148:151], v[52:55]
    ds_read_b64_tr_b16 v[182:183], v14 offset:19264
    v_mfma_f32_16x16x32_bf16 v[56:59], v[164:167], v[152:155], v[56:59]
    s_add_u32 m0, s39, 132096
    s_nop 0
    buffer_load_dwordx4 v3, s[8:11], s3 offen offset:1024 lds
    v_mfma_f32_16x16x32_bf16 v[60:63], v[164:167], v[156:159], v[60:63]
    v_mfma_f32_16x16x32_bf16 v[64:67], v[168:171], v[144:147], v[64:67]
    v_mfma_f32_16x16x32_bf16 v[68:71], v[168:171], v[148:151], v[68:71]
    s_add_u32 m0, s39, 133120
    s_nop 0
    buffer_load_dwordx4 v4, s[8:11], s3 offen offset:1024 lds
    v_mfma_f32_16x16x32_bf16 v[72:75], v[168:171], v[152:155], v[72:75]
    v_mfma_f32_16x16x32_bf16 v[76:79], v[168:171], v[156:159], v[76:79]
    s_waitcnt vmcnt(9) lgkmcnt(0)
    s_barrier
    v_mfma_f32_16x16x32_bf16 v[80:83], v[172:175], v[144:147], v[80:83]
    ds_read_b128 v[128:131], v10 offset:32768
    ds_read_b64_tr_b16 v[160:161], v14 offset:24576
    s_add_u32 m0, s40, 12288
    s_nop 0
    buffer_load_dwordx4 v5, s[16:19], s41 offen lds
    v_mfma_f32_16x16x32_bf16 v[84:87], v[172:175], v[148:151], v[84:87]
    ds_read_b64_tr_b16 v[162:163], v14 offset:25344
    v_mfma_f32_16x16x32_bf16 v[88:91], v[172:175], v[152:155], v[88:91]
    ds_read_b128 v[132:135], v10 offset:34816
    v_mfma_f32_16x16x32_bf16 v[92:95], v[172:175], v[156:159], v[92:95]
    ds_read_b128 v[136:139], v10 offset:36864
    s_add_u32 m0, s40, 13312
    s_nop 0
    buffer_load_dwordx4 v6, s[16:19], s41 offen lds
    v_mfma_f32_16x16x32_bf16 v[96:99], v[176:179], v[144:147], v[96:99]
    ds_read_b128 v[140:143], v10 offset:38912
    v_mfma_f32_16x16x32_bf16 v[100:103], v[176:179], v[148:151], v[100:103]
    ds_read_b64_tr_b16 v[164:165], v15 offset:24608
    v_mfma_f32_16x16x32_bf16 v[104:107], v[176:179], v[152:155], v[104:107]
    ds_read_b64_tr_b16 v[166:167], v15 offset:25376
    s_add_u32 m0, s40, 14336
    s_nop 0
    buffer_load_dwordx4 v7, s[16:19], s41 offen lds
    v_mfma_f32_16x16x32_bf16 v[108:111], v[176:179], v[156:159], v[108:111]
    ds_read_b64_tr_b16 v[168:169], v14 offset:24640
    v_mfma_f32_16x16x32_bf16 v[112:115], v[180:183], v[144:147], v[112:115]
    ds_read_b64_tr_b16 v[170:171], v14 offset:25408
    v_mfma_f32_16x16x32_bf16 v[116:119], v[180:183], v[148:151], v[116:119]
    s_add_u32 m0, s40, 0
    s_nop 0
    buffer_load_dwordx4 v5, s[12:15], s41 offen lds
    v_mfma_f32_16x16x32_bf16 v[120:123], v[180:183], v[152:155], v[120:123]
    v_mfma_f32_16x16x32_bf16 v[124:127], v[180:183], v[156:159], v[124:127]
    s_waitcnt lgkmcnt(0)
    v_mfma_f32_16x16x32_bf16 v[32:35], v[160:163], v[128:131], v[32:35]
    ds_read_b64_tr_b16 v[172:173], v14 offset:36864
    s_add_u32 m0, s40, 1024
    s_nop 0
    buffer_load_dwordx4 v6, s[12:15], s41 offen lds
    v_mfma_f32_16x16x32_bf16 v[36:39], v[160:163], v[132:135], v[36:39]
    ds_read_b64_tr_b16 v[174:175], v14 offset:37632
    v_mfma_f32_16x16x32_bf16 v[40:43], v[160:163], v[136:139], v[40:43]
    ds_read_b64_tr_b16 v[176:177], v15 offset:36896
    v_mfma_f32_16x16x32_bf16 v[44:47], v[160:163], v[140:143], v[44:47]
    ds_read_b64_tr_b16 v[178:179], v15 offset:37664
    s_add_u32 m0, s40, 2048
    s_nop 0
    buffer_load_dwordx4 v7, s[12:15], s41 offen lds
    s_add_u32 s41, s41, s49
    v_mfma_f32_16x16x32_bf16 v[48:51], v[164:167], v[128:131], v[48:51]
    ds_read_b64_tr_b16 v[180:181], v14 offset:36928
    v_mfma_f32_16x16x32_bf16 v[52:55], v[164:167], v[132:135], v[52:55]
    ds_read_b64_tr_b16 v[182:183], v14 offset:37696
    v_mfma_f32_16x16x32_bf16 v[56:59], v[164:167], v[136:139], v[56:59]
    s_add_u32 m0, s39, 48000
    s_nop 0
    buffer_load_dwordx4 v1, s[8:11], 0 offen offset:1152 lds
    v_mfma_f32_16x16x32_bf16 v[60:63], v[164:167], v[140:143], v[60:63]
    v_mfma_f32_16x16x32_bf16 v[64:67], v[168:171], v[128:131], v[64:67]
    v_mfma_f32_16x16x32_bf16 v[68:71], v[168:171], v[132:135], v[68:71]
    s_add_u32 m0, s39, 49024
    s_nop 0
    buffer_load_dwordx4 v2, s[8:11], 0 offen offset:1152 lds
    v_mfma_f32_16x16x32_bf16 v[72:75], v[168:171], v[136:139], v[72:75]
    v_mfma_f32_16x16x32_bf16 v[76:79], v[168:171], v[140:143], v[76:79]
    s_waitcnt lgkmcnt(0)
    v_mfma_f32_16x16x32_bf16 v[80:83], v[172:175], v[128:131], v[80:83]
    ds_read_b128 v[144:147], v11 offset:32768
    ds_read_b64_tr_b16 v[160:161], v14 offset:30720
    s_add_u32 m0, s39, 50048
    s_nop 0
    buffer_load_dwordx4 v3, s[8:11], 0 offen offset:1152 lds
    v_mfma_f32_16x16x32_bf16 v[84:87], v[172:175], v[132:135], v[84:87]
    ds_read_b64_tr_b16 v[162:163], v14 offset:31488
    v_mfma_f32_16x16x32_bf16 v[88:91], v[172:175], v[136:139], v[88:91]
    ds_read_b128 v[148:151], v11 offset:34816
    v_mfma_f32_16x16x32_bf16 v[92:95], v[172:175], v[140:143], v[92:95]
    ds_read_b128 v[152:155], v11 offset:36864
    v_mfma_f32_16x16x32_bf16 v[96:99], v[176:179], v[128:131], v[96:99]
    ds_read_b128 v[156:159], v11 offset:38912
    s_add_u32 m0, s39, 51072
    s_nop 0
    buffer_load_dwordx4 v4, s[8:11], 0 offen offset:1152 lds
    v_mfma_f32_16x16x32_bf16 v[100:103], v[176:179], v[132:135], v[100:103]
    ds_read_b64_tr_b16 v[164:165], v15 offset:30752
    v_mfma_f32_16x16x32_bf16 v[104:107], v[176:179], v[136:139], v[104:107]
    ds_read_b64_tr_b16 v[166:167], v15 offset:31520
    v_mfma_f32_16x16x32_bf16 v[108:111], v[176:179], v[140:143], v[108:111]
    ds_read_b64_tr_b16 v[168:169], v14 offset:30784
    v_mfma_f32_16x16x32_bf16 v[112:115], v[180:183], v[128:131], v[112:115]
    ds_read_b64_tr_b16 v[170:171], v14 offset:31552
    s_add_u32 m0, s39, 64384
    s_nop 0
    buffer_load_dwordx4 v1, s[8:11], s3 offen offset:1152 lds
    v_mfma_f32_16x16x32_bf16 v[116:119], v[180:183], v[132:135], v[116:119]
    v_mfma_f32_16x16x32_bf16 v[120:123], v[180:183], v[136:139], v[120:123]
    v_mfma_f32_16x16x32_bf16 v[124:127], v[180:183], v[140:143], v[124:127]
    s_waitcnt lgkmcnt(0)
    v_mfma_f32_16x16x32_bf16 v[32:35], v[160:163], v[144:147], v[32:35]
    ds_read_b64_tr_b16 v[172:173], v14 offset:43008
    s_add_u32 m0, s39, 65408
    s_nop 0
    buffer_load_dwordx4 v2, s[8:11], s3 offen offset:1152 lds
    v_mfma_f32_16x16x32_bf16 v[36:39], v[160:163], v[148:151], v[36:39]
    ds_read_b64_tr_b16 v[174:175], v14 offset:43776
    v_mfma_f32_16x16x32_bf16 v[40:43], v[160:163], v[152:155], v[40:43]
    ds_read_b64_tr_b16 v[176:177], v15 offset:43040
    v_mfma_f32_16x16x32_bf16 v[44:47], v[160:163], v[156:159], v[44:47]
    ds_read_b64_tr_b16 v[178:179], v15 offset:43808
    v_mfma_f32_16x16x32_bf16 v[48:51], v[164:167], v[144:147], v[48:51]
    ds_read_b64_tr_b16 v[180:181], v14 offset:43072
    s_add_u32 m0, s39, 66432
    s_nop 0
    buffer_load_dwordx4 v3, s[8:11], s3 offen offset:1152 lds
    v_mfma_f32_16x16x32_bf16 v[52:55], v[164:167], v[148:151], v[52:55]
    ds_read_b64_tr_b16 v[182:183], v14 offset:43840
    v_mfma_f32_16x16x32_bf16 v[56:59], v[164:167], v[152:155], v[56:59]
    v_mfma_f32_16x16x32_bf16 v[60:63], v[164:167], v[156:159], v[60:63]
    v_mfma_f32_16x16x32_bf16 v[64:67], v[168:171], v[144:147], v[64:67]
    s_add_u32 m0, s39, 67456
    s_nop 0
    buffer_load_dwordx4 v4, s[8:11], s3 offen offset:1152 lds
    v_mfma_f32_16x16x32_bf16 v[68:71], v[168:171], v[148:151], v[68:71]
    v_mfma_f32_16x16x32_bf16 v[72:75], v[168:171], v[152:155], v[72:75]
    v_mfma_f32_16x16x32_bf16 v[76:79], v[168:171], v[156:159], v[76:79]
    s_waitcnt vmcnt(8) lgkmcnt(0)
    s_barrier
    s_lshl_b32 s45, s33, 8
    s_lshl_b32 s46, s37, 6
    s_add_u32 s45, s45, s46
    s_lshl_b32 s45, s45, 3
    s_add_u32 s45, s45, 32768
    v_and_b32 v16, 15, v0
    v_lshlrev_b32 v16, 3, v16
    buffer_load_dwordx2 v[244:245], v16, s[20:23], s45 offen offset:0 sc1
    buffer_load_dwordx2 v[246:247], v16, s[20:23], s45 offen offset:128 sc1
    buffer_load_dwordx2 v[248:249], v16, s[20:23], s45 offen offset:256 sc1
    buffer_load_dwordx2 v[250:251], v16, s[20:23], s45 offen offset:384 sc1
    v_mfma_f32_16x16x32_bf16 v[80:83], v[172:175], v[144:147], v[80:83]
    ds_read_b128 v[128:131], v12 offset:0
    ds_read_b64_tr_b16 v[160:161], v14 offset:0
    s_add_u32 m0, s40, 36864
    s_nop 0
    buffer_load_dwordx4 v5, s[16:19], s41 offen lds
    v_mfma_f32_16x16x32_bf16 v[84:87], v[172:175], v[148:151], v[84:87]
    ds_read_b64_tr_b16 v[162:163], v14 offset:768
    v_mfma_f32_16x16x32_bf16 v[88:91], v[172:175], v[152:155], v[88:91]
    ds_read_b128 v[132:135], v12 offset:2048
    v_mfma_f32_16x16x32_bf16 v[92:95], v[172:175], v[156:159], v[92:95]
    ds_read_b128 v[136:139], v12 offset:4096
    s_add_u32 m0, s40, 37888
    s_nop 0
    buffer_load_dwordx4 v6, s[16:19], s41 offen lds
    v_mfma_f32_16x16x32_bf16 v[96:99], v[176:179], v[144:147], v[96:99]
    ds_read_b128 v[140:143], v12 offset:6144
    v_mfma_f32_16x16x32_bf16 v[100:103], v[176:179], v[148:151], v[100:103]
    ds_read_b64_tr_b16 v[164:165], v15 offset:32
    v_mfma_f32_16x16x32_bf16 v[104:107], v[176:179], v[152:155], v[104:107]
    ds_read_b64_tr_b16 v[166:167], v15 offset:800
    s_add_u32 m0, s40, 38912
    s_nop 0
    buffer_load_dwordx4 v7, s[16:19], s41 offen lds
    v_mfma_f32_16x16x32_bf16 v[108:111], v[176:179], v[156:159], v[108:111]
    ds_read_b64_tr_b16 v[168:169], v14 offset:64
    v_mfma_f32_16x16x32_bf16 v[112:115], v[180:183], v[144:147], v[112:115]
    ds_read_b64_tr_b16 v[170:171], v14 offset:832
    v_mfma_f32_16x16x32_bf16 v[116:119], v[180:183], v[148:151], v[116:119]
    s_add_u32 m0, s40, 24576
    s_nop 0
    buffer_load_dwordx4 v5, s[12:15], s41 offen lds
    v_mfma_f32_16x16x32_bf16 v[120:123], v[180:183], v[152:155], v[120:123]
    v_mfma_f32_16x16x32_bf16 v[124:127], v[180:183], v[156:159], v[124:127]
    s_waitcnt lgkmcnt(0)
    v_mfma_f32_16x16x32_bf16 v[32:35], v[160:163], v[128:131], v[32:35]
    ds_read_b64_tr_b16 v[172:173], v14 offset:12288
    s_waitcnt vmcnt(25)
    v_mfma_f32_16x16x32_bf16 v[36:39], v[160:163], v[132:135], v[36:39]
    ds_read_b64_tr_b16 v[174:175], v14 offset:13056
    s_add_u32 m0, s40, 25600
    s_nop 0
    buffer_load_dwordx4 v6, s[12:15], s41 offen lds
    v_mfma_f32_16x16x32_bf16 v[40:43], v[160:163], v[136:139], v[40:43]
    ds_read_b64_tr_b16 v[176:177], v15 offset:12320
    v_mfma_f32_16x16x32_bf16 v[44:47], v[160:163], v[140:143], v[44:47]
    ds_read_b64_tr_b16 v[178:179], v15 offset:13088
    v_subrev_u32 v16, s82, v28
    v_mfma_f32_16x16x32_bf16 v[48:51], v[164:167], v[128:131], v[48:51]
    ds_read_b64_tr_b16 v[180:181], v14 offset:12352
    v_mfma_f32_16x16x32_bf16 v[52:55], v[164:167], v[132:135], v[52:55]
    ds_read_b64_tr_b16 v[182:183], v14 offset:13120
    v_subrev_u32 v16, 1, v16
    v_mfma_f32_16x16x32_bf16 v[56:59], v[164:167], v[136:139], v[56:59]
    s_add_u32 m0, s40, 26624
    s_nop 0
    buffer_load_dwordx4 v7, s[12:15], s41 offen lds
    s_add_u32 s41, s41, s49
    v_mfma_f32_16x16x32_bf16 v[60:63], v[164:167], v[140:143], v[60:63]
    v_mfma_f32_16x16x32_bf16 v[64:67], v[168:171], v[128:131], v[64:67]
    v_xor_b32 v17, s83, v29
    v_mfma_f32_16x16x32_bf16 v[68:71], v[168:171], v[132:135], v[68:71]
    v_mfma_f32_16x16x32_bf16 v[72:75], v[168:171], v[136:139], v[72:75]
    v_cmp_ne_u32 s[74:75], 0, v17
    v_cmp_lt_u32 vcc, 2, v16
    s_nop 1
    s_or_b64 vcc, vcc, s[74:75]
    s_cmp_eq_u64 vcc, 0
    s_cselect_b32 s31, 1, s31
    v_mfma_f32_16x16x32_bf16 v[76:79], v[168:171], v[140:143], v[76:79]
    s_waitcnt lgkmcnt(0)
    v_mfma_f32_16x16x32_bf16 v[80:83], v[172:175], v[128:131], v[80:83]
    ds_read_b128 v[144:147], v13 offset:0
    ds_read_b64_tr_b16 v[160:161], v14 offset:6144
    s_cmp_eq_u32 s31, 1
    s_cbranch_scc0 GUL_B0_0
    s_add_u32 s48, s28, 0
    buffer_load_dwordx4 v[184:187], v8, s[20:23], s48 offen offset:0 sc1
    buffer_load_dwordx4 v[188:191], v8, s[20:23], s48 offen offset:1024 sc1
    buffer_load_dwordx4 v[192:195], v8, s[20:23], s48 offen offset:2048 sc1
    GUL_B0_0:
    v_mfma_f32_16x16x32_bf16 v[84:87], v[172:175], v[132:135], v[84:87]
    ds_read_b64_tr_b16 v[162:163], v14 offset:6912
    v_mfma_f32_16x16x32_bf16 v[88:91], v[172:175], v[136:139], v[88:91]
    ds_read_b128 v[148:151], v13 offset:2048
    v_mfma_f32_16x16x32_bf16 v[92:95], v[172:175], v[140:143], v[92:95]
    ds_read_b128 v[152:155], v13 offset:4096
    v_mfma_f32_16x16x32_bf16 v[96:99], v[176:179], v[128:131], v[96:99]
    ds_read_b128 v[156:159], v13 offset:6144
    v_mfma_f32_16x16x32_bf16 v[100:103], v[176:179], v[132:135], v[100:103]
    ds_read_b64_tr_b16 v[164:165], v15 offset:6176
    v_mfma_f32_16x16x32_bf16 v[104:107], v[176:179], v[136:139], v[104:107]
    ds_read_b64_tr_b16 v[166:167], v15 offset:6944
    s_cmp_eq_u32 s31, 1
    s_cbranch_scc0 GUL_B0_3
    buffer_load_dwordx4 v[196:199], v8, s[20:23], s48 offen offset:3072 sc1
    buffer_load_dwordx4 v[200:203], v9, s[20:23], s48 offen offset:0 sc1
    GUL_B0_3:
    v_mfma_f32_16x16x32_bf16 v[108:111], v[176:179], v[140:143], v[108:111]
    ds_read_b64_tr_b16 v[168:169], v14 offset:6208
    v_mfma_f32_16x16x32_bf16 v[112:115], v[180:183], v[128:131], v[112:115]
    ds_read_b64_tr_b16 v[170:171], v14 offset:6976
    v_mfma_f32_16x16x32_bf16 v[116:119], v[180:183], v[132:135], v[116:119]
    v_mfma_f32_16x16x32_bf16 v[120:123], v[180:183], v[136:139], v[120:123]
    v_mfma_f32_16x16x32_bf16 v[124:127], v[180:183], v[140:143], v[124:127]
    s_waitcnt lgkmcnt(0)
    v_mfma_f32_16x16x32_bf16 v[32:35], v[160:163], v[144:147], v[32:35]
    ds_read_b64_tr_b16 v[172:173], v14 offset:18432
    s_cmp_eq_u32 s31, 1
    s_cbranch_scc0 GUL_B1_0
    s_add_u32 s48, s28, 5120
    buffer_load_dwordx4 v[204:207], v8, s[20:23], s48 offen offset:0 sc1
    buffer_load_dwordx4 v[208:211], v8, s[20:23], s48 offen offset:1024 sc1
    buffer_load_dwordx4 v[212:215], v8, s[20:23], s48 offen offset:2048 sc1
    GUL_B1_0:
    v_mfma_f32_16x16x32_bf16 v[36:39], v[160:163], v[148:151], v[36:39]
    ds_read_b64_tr_b16 v[174:175], v14 offset:19200
    v_mfma_f32_16x16x32_bf16 v[40:43], v[160:163], v[152:155], v[40:43]
    ds_read_b64_tr_b16 v[176:177], v15 offset:18464
    v_mfma_f32_16x16x32_bf16 v[44:47], v[160:163], v[156:159], v[44:47]
    ds_read_b64_tr_b16 v[178:179], v15 offset:19232
    v_mfma_f32_16x16x32_bf16 v[48:51], v[164:167], v[144:147], v[48:51]
    ds_read_b64_tr_b16 v[180:181], v14 offset:18496
    v_mfma_f32_16x16x32_bf16 v[52:55], v[164:167], v[148:151], v[52:55]
    ds_read_b64_tr_b16 v[182:183], v14 offset:19264
    v_mfma_f32_16x16x32_bf16 v[56:59], v[164:167], v[152:155], v[56:59]
    s_cmp_eq_u32 s31, 1
    s_cbranch_scc0 GUL_B1_3
    buffer_load_dwordx4 v[216:219], v8, s[20:23], s48 offen offset:3072 sc1
    buffer_load_dwordx4 v[220:223], v9, s[20:23], s48 offen offset:0 sc1
    GUL_B1_3:
    v_mfma_f32_16x16x32_bf16 v[60:63], v[164:167], v[156:159], v[60:63]
    v_mfma_f32_16x16x32_bf16 v[64:67], v[168:171], v[144:147], v[64:67]
    v_mfma_f32_16x16x32_bf16 v[68:71], v[168:171], v[148:151], v[68:71]
    v_mfma_f32_16x16x32_bf16 v[72:75], v[168:171], v[152:155], v[72:75]
    v_mfma_f32_16x16x32_bf16 v[76:79], v[168:171], v[156:159], v[76:79]
    s_waitcnt vmcnt(0) lgkmcnt(0)
    s_barrier
    v_mfma_f32_16x16x32_bf16 v[80:83], v[172:175], v[144:147], v[80:83]
    ds_read_b128 v[128:131], v10 offset:0
    ds_read_b64_tr_b16 v[160:161], v14 offset:24576
    buffer_load_dwordx2 v[28:29], v30, s[20:23], 0 offen sc1
    v_mfma_f32_16x16x32_bf16 v[84:87], v[172:175], v[148:151], v[84:87]
    ds_read_b64_tr_b16 v[162:163], v14 offset:25344
    v_mfma_f32_16x16x32_bf16 v[88:91], v[172:175], v[152:155], v[88:91]
    ds_read_b128 v[132:135], v10 offset:2048
    v_mfma_f32_16x16x32_bf16 v[92:95], v[172:175], v[156:159], v[92:95]
    ds_read_b128 v[136:139], v10 offset:4096
    v_mfma_f32_16x16x32_bf16 v[96:99], v[176:179], v[144:147], v[96:99]
    ds_read_b128 v[140:143], v10 offset:6144
    v_mfma_f32_16x16x32_bf16 v[100:103], v[176:179], v[148:151], v[100:103]
    ds_read_b64_tr_b16 v[164:165], v15 offset:24608
    v_mfma_f32_16x16x32_bf16 v[104:107], v[176:179], v[152:155], v[104:107]
    ds_read_b64_tr_b16 v[166:167], v15 offset:25376
    v_mfma_f32_16x16x32_bf16 v[108:111], v[176:179], v[156:159], v[108:111]
    ds_read_b64_tr_b16 v[168:169], v14 offset:24640
    v_mfma_f32_16x16x32_bf16 v[112:115], v[180:183], v[144:147], v[112:115]
    ds_read_b64_tr_b16 v[170:171], v14 offset:25408
    v_mfma_f32_16x16x32_bf16 v[116:119], v[180:183], v[148:151], v[116:119]
    v_mfma_f32_16x16x32_bf16 v[120:123], v[180:183], v[152:155], v[120:123]
    v_mfma_f32_16x16x32_bf16 v[124:127], v[180:183], v[156:159], v[124:127]
    s_waitcnt lgkmcnt(0)
    v_mfma_f32_16x16x32_bf16 v[32:35], v[160:163], v[128:131], v[32:35]
    ds_read_b64_tr_b16 v[172:173], v14 offset:36864
    s_cmp_eq_u32 s31, 1
    s_cbranch_scc0 GUL_B2_0
    s_add_u32 s48, s28, 10240
    s_add_u32 m0, s30, 0
    s_nop 0
    buffer_load_dwordx4 v8, s[20:23], s48 offen offset:0 sc1 lds
    s_add_u32 m0, s30, 0
    s_nop 0
    buffer_load_dwordx4 v8, s[20:23], s48 offen offset:1024 sc1 lds
    s_add_u32 m0, s30, 0
    s_nop 0
    buffer_load_dwordx4 v8, s[20:23], s48 offen offset:2048 sc1 lds
    GUL_B2_0:
    v_mfma_f32_16x16x32_bf16 v[36:39], v[160:163], v[132:135], v[36:39]
    ds_read_b64_tr_b16 v[174:175], v14 offset:37632
    v_mfma_f32_16x16x32_bf16 v[40:43], v[160:163], v[136:139], v[40:43]
    ds_read_b64_tr_b16 v[176:177], v15 offset:36896
    v_mfma_f32_16x16x32_bf16 v[44:47], v[160:163], v[140:143], v[44:47]
    ds_read_b64_tr_b16 v[178:179], v15 offset:37664
    v_mfma_f32_16x16x32_bf16 v[48:51], v[164:167], v[128:131], v[48:51]
    ds_read_b64_tr_b16 v[180:181], v14 offset:36928
    v_mfma_f32_16x16x32_bf16 v[52:55], v[164:167], v[132:135], v[52:55]
    ds_read_b64_tr_b16 v[182:183], v14 offset:37696
    v_mfma_f32_16x16x32_bf16 v[56:59], v[164:167], v[136:139], v[56:59]
    s_cmp_eq_u32 s31, 1
    s_cbranch_scc0 GUL_B2_3
    s_add_u32 m0, s30, 0
    s_nop 0
    buffer_load_dwordx4 v8, s[20:23], s48 offen offset:3072 sc1 lds
    s_add_u32 m0, s30, 4096
    s_nop 0
    buffer_load_dwordx4 v9, s[20:23], s48 offen offset:0 sc1 lds
    GUL_B2_3:
    v_mfma_f32_16x16x32_bf16 v[60:63], v[164:167], v[140:143], v[60:63]
    v_mfma_f32_16x16x32_bf16 v[64:67], v[168:171], v[128:131], v[64:67]
    v_mfma_f32_16x16x32_bf16 v[68:71], v[168:171], v[132:135], v[68:71]
    v_mfma_f32_16x16x32_bf16 v[72:75], v[168:171], v[136:139], v[72:75]
    v_mfma_f32_16x16x32_bf16 v[76:79], v[168:171], v[140:143], v[76:79]
    s_waitcnt lgkmcnt(0)
    v_mfma_f32_16x16x32_bf16 v[80:83], v[172:175], v[128:131], v[80:83]
    ds_read_b128 v[144:147], v11 offset:0
    ds_read_b64_tr_b16 v[160:161], v14 offset:30720
    s_cmp_eq_u32 s31, 1
    s_cbranch_scc0 GUL_B3_0
    s_add_u32 s48, s28, 15360
    s_add_u32 m0, s30, 5120
    s_nop 0
    buffer_load_dwordx4 v8, s[20:23], s48 offen offset:0 sc1 lds
    s_add_u32 m0, s30, 5120
    s_nop 0
    buffer_load_dwordx4 v8, s[20:23], s48 offen offset:1024 sc1 lds
    s_add_u32 m0, s30, 5120
    s_nop 0
    buffer_load_dwordx4 v8, s[20:23], s48 offen offset:2048 sc1 lds
    GUL_B3_0:
    v_mfma_f32_16x16x32_bf16 v[84:87], v[172:175], v[132:135], v[84:87]
    ds_read_b64_tr_b16 v[162:163], v14 offset:31488
    v_mfma_f32_16x16x32_bf16 v[88:91], v[172:175], v[136:139], v[88:91]
    ds_read_b128 v[148:151], v11 offset:2048
    v_mfma_f32_16x16x32_bf16 v[92:95], v[172:175], v[140:143], v[92:95]
    ds_read_b128 v[152:155], v11 offset:4096
    v_mfma_f32_16x16x32_bf16 v[96:99], v[176:179], v[128:131], v[96:99]
    ds_read_b128 v[156:159], v11 offset:6144
    v_mfma_f32_16x16x32_bf16 v[100:103], v[176:179], v[132:135], v[100:103]
    ds_read_b64_tr_b16 v[164:165], v15 offset:30752
    v_mfma_f32_16x16x32_bf16 v[104:107], v[176:179], v[136:139], v[104:107]
    ds_read_b64_tr_b16 v[166:167], v15 offset:31520
    s_cmp_eq_u32 s31, 1
    s_cbranch_scc0 GUL_B3_3
    s_add_u32 m0, s30, 5120
    s_nop 0
    buffer_load_dwordx4 v8, s[20:23], s48 offen offset:3072 sc1 lds
    s_add_u32 m0, s30, 9216
    s_nop 0
    buffer_load_dwordx4 v9, s[20:23], s48 offen offset:0 sc1 lds
    GUL_B3_3:
    v_mfma_f32_16x16x32_bf16 v[108:111], v[176:179], v[140:143], v[108:111]
    ds_read_b64_tr_b16 v[168:169], v14 offset:30784
    v_mfma_f32_16x16x32_bf16 v[112:115], v[180:183], v[128:131], v[112:115]
    ds_read_b64_tr_b16 v[170:171], v14 offset:31552
    v_mfma_f32_16x16x32_bf16 v[116:119], v[180:183], v[132:135], v[116:119]
    v_mfma_f32_16x16x32_bf16 v[120:123], v[180:183], v[136:139], v[120:123]
    v_mfma_f32_16x16x32_bf16 v[124:127], v[180:183], v[140:143], v[124:127]
    s_waitcnt lgkmcnt(0)
    v_mfma_f32_16x16x32_bf16 v[32:35], v[160:163], v[144:147], v[32:35]
    ds_read_b64_tr_b16 v[172:173], v14 offset:43008
    v_mfma_f32_16x16x32_bf16 v[36:39], v[160:163], v[148:151], v[36:39]
    ds_read_b64_tr_b16 v[174:175], v14 offset:43776
    v_mfma_f32_16x16x32_bf16 v[40:43], v[160:163], v[152:155], v[40:43]
    ds_read_b64_tr_b16 v[176:177], v15 offset:43040
    v_mfma_f32_16x16x32_bf16 v[44:47], v[160:163], v[156:159], v[44:47]
    ds_read_b64_tr_b16 v[178:179], v15 offset:43808
    v_mfma_f32_16x16x32_bf16 v[48:51], v[164:167], v[144:147], v[48:51]
    ds_read_b64_tr_b16 v[180:181], v14 offset:43072
    v_mfma_f32_16x16x32_bf16 v[52:55], v[164:167], v[148:151], v[52:55]
    ds_read_b64_tr_b16 v[182:183], v14 offset:43840
    v_mfma_f32_16x16x32_bf16 v[56:59], v[164:167], v[152:155], v[56:59]
    v_mfma_f32_16x16x32_bf16 v[60:63], v[164:167], v[156:159], v[60:63]
    v_mfma_f32_16x16x32_bf16 v[64:67], v[168:171], v[144:147], v[64:67]
    v_mfma_f32_16x16x32_bf16 v[68:71], v[168:171], v[148:151], v[68:71]
    v_mfma_f32_16x16x32_bf16 v[72:75], v[168:171], v[152:155], v[72:75]
    v_mfma_f32_16x16x32_bf16 v[76:79], v[168:171], v[156:159], v[76:79]
    s_waitcnt lgkmcnt(0)
    v_mfma_f32_16x16x32_bf16 v[80:83], v[172:175], v[144:147], v[80:83]
    v_mfma_f32_16x16x32_bf16 v[84:87], v[172:175], v[148:151], v[84:87]
    v_mfma_f32_16x16x32_bf16 v[88:91], v[172:175], v[152:155], v[88:91]
    v_mfma_f32_16x16x32_bf16 v[92:95], v[172:175], v[156:159], v[92:95]
    v_mfma_f32_16x16x32_bf16 v[96:99], v[176:179], v[144:147], v[96:99]
    v_mfma_f32_16x16x32_bf16 v[100:103], v[176:179], v[148:151], v[100:103]
    v_mfma_f32_16x16x32_bf16 v[104:107], v[176:179], v[152:155], v[104:107]
    v_mfma_f32_16x16x32_bf16 v[108:111], v[176:179], v[156:159], v[108:111]
    v_mfma_f32_16x16x32_bf16 v[112:115], v[180:183], v[144:147], v[112:115]
    v_mfma_f32_16x16x32_bf16 v[116:119], v[180:183], v[148:151], v[116:119]
    v_mfma_f32_16x16x32_bf16 v[120:123], v[180:183], v[152:155], v[120:123]
    v_mfma_f32_16x16x32_bf16 v[124:127], v[180:183], v[156:159], v[124:127]
    s_cmp_eq_u32 s31, 1
    s_cbranch_scc1 GUL_WB
    s_waitcnt vmcnt(0)
GUL_WB:
    s_waitcnt vmcnt(10)
    s_setprio 0
    s_branch GU_LOOPEND
GU_ROLEP:
    s_and_b32 s45, s2, 1
    s_lshl_b32 s45, s45, 7
    s_bfe_u32 s46, s2, 0x20001
    s_lshl_b32 s46, s46, 5
    s_add_u32 s45, s45, s46
    s_lshr_b32 s46, s2, 3
    s_add_u32 s45, s45, s46
    s_lshl_b32 s45, s45, 3
    s_add_u32 s50, s45, s32
    s_mul_i32 s45, s50, 1280
    v_lshlrev_b32 v16, 4, v0
    v_lshlrev_b32 v17, 2, v0
    buffer_load_dwordx4 v[244:247], v16, s[24:27], s45 offen
    buffer_load_dword v248, v17, s[24:27], s45 offen offset:1024
    v_and_b32 v17, 15, v0
    v_cmp_le_u32 vcc, 6, v17
    s_nop 1
    v_cndmask_b32 v18, 0, 2, vcc
    v_cmp_le_u32 vcc, 10, v17
    s_nop 1
    v_cndmask_b32 v18, v18, -4, vcc
    v_add_u32 v17, v17, v18
    v_lshrrev_b32 v16, 4, v0
    v_mul_u32_u24 v16, 3456, v16
    v_lshl_add_u32 v16, v17, 4, v16
    s_mul_i32 s45, s33, 13824
    v_add_u32 v8, s45, v16
    v_mov_b32 v9, v8
    s_mov_b32 s42, 0x0fff0fff
    s_mov_b32 s43, 0x0fff0fff
    s_mul_i32 s44, s37, 110592
    s_mov_b64 exec, s[42:43]
    buffer_load_dwordx4 v[184:187], v8, s[12:15], s44 offen
    buffer_load_dwordx4 v[188:191], v9, s[16:19], s44 offen
    s_mov_b64 exec, -1
    s_add_u32 m0, s40, 0
    s_nop 0
    buffer_load_dwordx4 v5, s[76:79], s41 offen lds
    s_add_u32 m0, s40, 1024
    s_nop 0
    buffer_load_dwordx4 v6, s[76:79], s41 offen lds
    s_add_u32 m0, s40, 2048
    s_nop 0
    buffer_load_dwordx4 v7, s[76:79], s41 offen lds
    s_add_u32 s41, s41, s49
    s_add_u32 m0, s39, 49152
    s_nop 0
    buffer_load_dwordx4 v1, s[8:11], 0 offen offset:0 lds
    s_add_u32 m0, s39, 50176
    s_nop 0
    buffer_load_dwordx4 v2, s[8:11], 0 offen offset:0 lds
    s_add_u32 m0, s39, 51200
    s_nop 0
    buffer_load_dwordx4 v3, s[8:11], 0 offen offset:0 lds
    s_add_u32 m0, s39, 52224
    s_nop 0
    buffer_load_dwordx4 v4, s[8:11], 0 offen offset:0 lds
    s_mov_b32 s4, s70
    s_and_b32 s5, s71, 0xffff
    s_mov_b32 s6, 256
    s_mov_b32 s7, 0x20000
    v_and_b32 v16, 15, v0
    v_lshlrev_b32 v16, 7, v16
    v_bfe_u32 v17, v0, 1, 3
    v_lshrrev_b32 v18, 4, v0
    v_xor_b32 v17, v17, v18
    v_lshl_add_u32 v16, v17, 4, v16
    s_lshl_b32 s45, s37, 13
    s_add_u32 s45, s45, 49152
    v_add_u32 v10, s45, v16
    v_xor_b32 v11, 64, v10
    v_add_u32 v12, 65536, v10
    v_add_u32 v13, 65536, v11
    v_mul_u32_u24 v16, 1536, v18
    v_bfe_u32 v17, v0, 2, 2
    v_mul_u32_u24 v17, 192, v17
    v_add_u32 v16, v16, v17
    v_and_b32 v17, 3, v0
    v_mul_u32_u24 v17, 8, v17
    v_add_u32 v16, v16, v17
    s_mul_i32 s45, s38, 96
    v_add_u32 v14, s45, v16
    v_and_b32 v18, 1, v18
    s_cmp_eq_u32 s38, 0
    s_cselect_b32 s45, 32, -32
    v_mul_i32_i24 v18, s45, v18
    v_sub_u32 v15, v14, v18
    v_add_u32 v14, v14, v18
    s_lshl_b32 s45, s49, 1
    s_add_u32 s44, s44, s45
    s_mov_b64 exec, s[42:43]
    buffer_load_dwordx4 v[192:195], v8, s[12:15], s44 offen
    buffer_load_dwordx4 v[196:199], v9, s[16:19], s44 offen
    s_mov_b64 exec, -1
    s_waitcnt vmcnt(2) lgkmcnt(0)
    s_barrier
    ds_read_b128 v[128:131], v10 offset:0
    ds_read_b64_tr_b16 v[160:161], v14 offset:0
    ds_read_b64_tr_b16 v[162:163], v14 offset:768
    ds_read_b128 v[132:135], v10 offset:2048
    ds_read_b128 v[136:139], v10 offset:4096
    ds_read_b128 v[140:143], v10 offset:6144
    ds_read_b64_tr_b16 v[164:165], v15 offset:32
    ds_read_b64_tr_b16 v[166:167], v15 offset:800
    ds_read_b64_tr_b16 v[168:169], v14 offset:64
    ds_read_b64_tr_b16 v[170:171], v14 offset:832
    s_waitcnt lgkmcnt(0)
    v_mfma_f32_16x16x32_bf16 v[32:35], v[160:163], v[128:131], 0
    ds_read_b64_tr_b16 v[172:173], v14 offset:12288
    v_mfma_f32_16x16x32_bf16 v[36:39], v[160:163], v[132:135], 0
    ds_read_b64_tr_b16 v[174:175], v14 offset:13056
    v_mfma_f32_16x16x32_bf16 v[40:43], v[160:163], v[136:139], 0
    ds_read_b64_tr_b16 v[176:177], v15 offset:12320
    v_mfma_f32_16x16x32_bf16 v[44:47], v[160:163], v[140:143], 0
    ds_read_b64_tr_b16 v[178:179], v15 offset:13088
    v_mfma_f32_16x16x32_bf16 v[48:51], v[164:167], v[128:131], 0
    ds_read_b64_tr_b16 v[180:181], v14 offset:12352
    v_mfma_f32_16x16x32_bf16 v[52:55], v[164:167], v[132:135], 0
    ds_read_b64_tr_b16 v[182:183], v14 offset:13120
    v_mfma_f32_16x16x32_bf16 v[56:59], v[164:167], v[136:139], 0
    v_mfma_f32_16x16x32_bf16 v[60:63], v[164:167], v[140:143], 0
    v_mfma_f32_16x16x32_bf16 v[64:67], v[168:171], v[128:131], 0
    v_mfma_f32_16x16x32_bf16 v[68:71], v[168:171], v[132:135], 0
    v_mfma_f32_16x16x32_bf16 v[72:75], v[168:171], v[136:139], 0
    v_mfma_f32_16x16x32_bf16 v[76:79], v[168:171], v[140:143], 0
    s_waitcnt lgkmcnt(0)
    v_mfma_f32_16x16x32_bf16 v[80:83], v[172:175], v[128:131], 0
    ds_read_b128 v[144:147], v11 offset:0
    ds_read_b64_tr_b16 v[160:161], v14 offset:6144
    v_mfma_f32_16x16x32_bf16 v[84:87], v[172:175], v[132:135], 0
    ds_read_b64_tr_b16 v[162:163], v14 offset:6912
    v_mfma_f32_16x16x32_bf16 v[88:91], v[172:175], v[136:139], 0
    ds_read_b128 v[148:151], v11 offset:2048
    v_mfma_f32_16x16x32_bf16 v[92:95], v[172:175], v[140:143], 0
    ds_read_b128 v[152:155], v11 offset:4096
    v_mfma_f32_16x16x32_bf16 v[96:99], v[176:179], v[128:131], 0
    ds_read_b128 v[156:159], v11 offset:6144
    v_mfma_f32_16x16x32_bf16 v[100:103], v[176:179], v[132:135], 0
    ds_read_b64_tr_b16 v[164:165], v15 offset:6176
    v_mfma_f32_16x16x32_bf16 v[104:107], v[176:179], v[136:139], 0
    ds_read_b64_tr_b16 v[166:167], v15 offset:6944
    v_mfma_f32_16x16x32_bf16 v[108:111], v[176:179], v[140:143], 0
    ds_read_b64_tr_b16 v[168:169], v14 offset:6208
    v_mfma_f32_16x16x32_bf16 v[112:115], v[180:183], v[128:131], 0
    ds_read_b64_tr_b16 v[170:171], v14 offset:6976
    v_mfma_f32_16x16x32_bf16 v[116:119], v[180:183], v[132:135], 0
    v_mfma_f32_16x16x32_bf16 v[120:123], v[180:183], v[136:139], 0
    v_mfma_f32_16x16x32_bf16 v[124:127], v[180:183], v[140:143], 0
    s_waitcnt lgkmcnt(0)
    v_mfma_f32_16x16x32_bf16 v[32:35], v[160:163], v[144:147], v[32:35]
    ds_read_b64_tr_b16 v[172:173], v14 offset:18432
    v_mfma_f32_16x16x32_bf16 v[36:39], v[160:163], v[148:151], v[36:39]
    ds_read_b64_tr_b16 v[174:175], v14 offset:19200
    v_mfma_f32_16x16x32_bf16 v[40:43], v[160:163], v[152:155], v[40:43]
    ds_read_b64_tr_b16 v[176:177], v15 offset:18464
    v_mfma_f32_16x16x32_bf16 v[44:47], v[160:163], v[156:159], v[44:47]
    ds_read_b64_tr_b16 v[178:179], v15 offset:19232
    v_mfma_f32_16x16x32_bf16 v[48:51], v[164:167], v[144:147], v[48:51]
    ds_read_b64_tr_b16 v[180:181], v14 offset:18496
    v_mfma_f32_16x16x32_bf16 v[52:55], v[164:167], v[148:151], v[52:55]
    ds_read_b64_tr_b16 v[182:183], v14 offset:19264
    v_mfma_f32_16x16x32_bf16 v[56:59], v[164:167], v[152:155], v[56:59]
    v_mfma_f32_16x16x32_bf16 v[60:63], v[164:167], v[156:159], v[60:63]
    v_mfma_f32_16x16x32_bf16 v[64:67], v[168:171], v[144:147], v[64:67]
    v_mfma_f32_16x16x32_bf16 v[68:71], v[168:171], v[148:151], v[68:71]
    v_mfma_f32_16x16x32_bf16 v[72:75], v[168:171], v[152:155], v[72:75]
    v_mfma_f32_16x16x32_bf16 v[76:79], v[168:171], v[156:159], v[76:79]
    s_waitcnt lgkmcnt(0)
    s_barrier
    v_mfma_f32_16x16x32_bf16 v[80:83], v[172:175], v[144:147], v[80:83]
    ds_read_b128 v[128:131], v10 offset:32768
    ds_read_b64_tr_b16 v[160:161], v14 offset:24576
    s_lshl_b32 s45, s49, 1
    s_add_u32 s44, s44, s45
    s_mov_b64 exec, s[42:43]
    buffer_load_dwordx4 v[216:219], v8, s[12:15], s44 offen
    buffer_load_dwordx4 v[220:223], v9, s[16:19], s44 offen
    s_mov_b64 exec, -1
    s_waitcnt vmcnt(13)
    v_mfma_f32_16x16x32_bf16 v[84:87], v[172:175], v[148:151], v[84:87]
    ds_read_b64_tr_b16 v[162:163], v14 offset:25344
    v_lshlrev_b32 v200, 16, v244
    v_mfma_f32_16x16x32_bf16 v[88:91], v[172:175], v[152:155], v[88:91]
    ds_read_b128 v[132:135], v10 offset:34816
    v_and_b32 v201, 0xffff0000, v244
    v_lshlrev_b32 v202, 16, v245
    v_mfma_f32_16x16x32_bf16 v[92:95], v[172:175], v[156:159], v[92:95]
    ds_read_b128 v[136:139], v10 offset:36864
    v_and_b32 v203, 0xffff0000, v245
    v_mfma_f32_16x16x32_bf16 v[96:99], v[176:179], v[144:147], v[96:99]
    ds_read_b128 v[140:143], v10 offset:38912
    v_lshlrev_b32 v204, 16, v246
    v_and_b32 v205, 0xffff0000, v246
    v_mfma_f32_16x16x32_bf16 v[100:103], v[176:179], v[148:151], v[100:103]
    ds_read_b64_tr_b16 v[164:165], v15 offset:24608
    v_lshlrev_b32 v206, 16, v247
    v_mfma_f32_16x16x32_bf16 v[104:107], v[176:179], v[152:155], v[104:107]
    ds_read_b64_tr_b16 v[166:167], v15 offset:25376
    v_and_b32 v207, 0xffff0000, v247
    v_lshlrev_b32 v208, 16, v248
    v_mfma_f32_16x16x32_bf16 v[108:111], v[176:179], v[156:159], v[108:111]
    ds_read_b64_tr_b16 v[168:169], v14 offset:24640
    v_and_b32 v209, 0xffff0000, v248
    v_mfma_f32_16x16x32_bf16 v[112:115], v[180:183], v[144:147], v[112:115]
    ds_read_b64_tr_b16 v[170:171], v14 offset:25408
    v_add_f32 v210, v200, v201
    v_add_f32 v210, v210, v202
    v_mfma_f32_16x16x32_bf16 v[116:119], v[180:183], v[148:151], v[116:119]
    v_add_f32 v210, v210, v203
    v_mfma_f32_16x16x32_bf16 v[120:123], v[180:183], v[152:155], v[120:123]
    v_add_f32 v210, v210, v204
    v_add_f32 v210, v210, v205
    v_mfma_f32_16x16x32_bf16 v[124:127], v[180:183], v[156:159], v[124:127]
    v_add_f32 v210, v210, v206
    s_waitcnt lgkmcnt(0)
    v_mfma_f32_16x16x32_bf16 v[32:35], v[160:163], v[128:131], v[32:35]
    ds_read_b64_tr_b16 v[172:173], v14 offset:36864
    s_lshl_b32 s45, s49, 1
    s_add_u32 s44, s44, s45
    s_mov_b64 exec, s[42:43]
    buffer_load_dwordx4 v[224:227], v8, s[12:15], s44 offen
    buffer_load_dwordx4 v[228:231], v9, s[16:19], s44 offen
    s_mov_b64 exec, -1
    v_add_f32 v210, v210, v207
    v_mfma_f32_16x16x32_bf16 v[36:39], v[160:163], v[132:135], v[36:39]
    ds_read_b64_tr_b16 v[174:175], v14 offset:37632
    v_add_f32 v210, v210, v208
    v_add_f32 v210, v210, v209
    v_mfma_f32_16x16x32_bf16 v[40:43], v[160:163], v[136:139], v[40:43]
    ds_read_b64_tr_b16 v[176:177], v15 offset:36896
    v_add_f32_dpp v210, v210, v210 row_shr:1 row_mask:0xf bank_mask:0xf bound_ctrl:0
    v_mfma_f32_16x16x32_bf16 v[44:47], v[160:163], v[140:143], v[44:47]
    ds_read_b64_tr_b16 v[178:179], v15 offset:37664
    v_add_f32_dpp v210, v210, v210 row_shr:2 row_mask:0xf bank_mask:0xf bound_ctrl:0
    s_nop 1
    v_add_f32_dpp v210, v210, v210 row_shr:4 row_mask:0xf bank_mask:0xf bound_ctrl:0
    v_mfma_f32_16x16x32_bf16 v[48:51], v[164:167], v[128:131], v[48:51]
    ds_read_b64_tr_b16 v[180:181], v14 offset:36928
    v_add_f32_dpp v210, v210, v210 row_shr:8 row_mask:0xf bank_mask:0xf bound_ctrl:0
    v_mfma_f32_16x16x32_bf16 v[52:55], v[164:167], v[132:135], v[52:55]
    ds_read_b64_tr_b16 v[182:183], v14 offset:37696
    v_add_f32_dpp v210, v210, v210 row_bcast:15 row_mask:0xa bank_mask:0xf
    s_nop 1
    v_add_f32_dpp v210, v210, v210 row_bcast:31 row_mask:0xc bank_mask:0xf
    v_mfma_f32_16x16x32_bf16 v[56:59], v[164:167], v[136:139], v[56:59]
    v_readlane_b32 s51, v210, 63
    v_mov_b32 v211, 0x3acccccd
    v_mfma_f32_16x16x32_bf16 v[60:63], v[164:167], v[140:143], v[60:63]
    v_mul_f32 v211, s51, v211
    v_mfma_f32_16x16x32_bf16 v[64:67], v[168:171], v[128:131], v[64:67]
    v_sub_f32 v200, v200, v211
    v_sub_f32 v201, v201, v211
    v_mfma_f32_16x16x32_bf16 v[68:71], v[168:171], v[132:135], v[68:71]
    v_sub_f32 v202, v202, v211
    v_mfma_f32_16x16x32_bf16 v[72:75], v[168:171], v[136:139], v[72:75]
    v_sub_f32 v203, v203, v211
    v_sub_f32 v204, v204, v211
    v_mfma_f32_16x16x32_bf16 v[76:79], v[168:171], v[140:143], v[76:79]
    v_sub_f32 v205, v205, v211
    s_waitcnt lgkmcnt(0)
    v_mfma_f32_16x16x32_bf16 v[80:83], v[172:175], v[128:131], v[80:83]
    ds_read_b128 v[144:147], v11 offset:32768
    ds_read_b64_tr_b16 v[160:161], v14 offset:30720
    s_lshl_b32 s45, s49, 1
    s_add_u32 s44, s44, s45
    s_mov_b64 exec, s[42:43]
    buffer_load_dwordx4 v[232:235], v8, s[12:15], s44 offen
    buffer_load_dwordx4 v[236:239], v9, s[16:19], s44 offen
    s_mov_b64 exec, -1
    v_sub_f32 v206, v206, v211
    v_mfma_f32_16x16x32_bf16 v[84:87], v[172:175], v[132:135], v[84:87]
    ds_read_b64_tr_b16 v[162:163], v14 offset:31488
    v_sub_f32 v207, v207, v211
    v_sub_f32 v208, v208, v211
    v_mfma_f32_16x16x32_bf16 v[88:91], v[172:175], v[136:139], v[88:91]
    ds_read_b128 v[148:151], v11 offset:34816
    v_sub_f32 v209, v209, v211
    v_mfma_f32_16x16x32_bf16 v[92:95], v[172:175], v[140:143], v[92:95]
    ds_read_b128 v[152:155], v11 offset:36864
    v_mul_f32 v210, v200, v200
    v_fmac_f32 v210, v201, v201
    v_mfma_f32_16x16x32_bf16 v[96:99], v[176:179], v[128:131], v[96:99]
    ds_read_b128 v[156:159], v11 offset:38912
    v_fmac_f32 v210, v202, v202
    v_mfma_f32_16x16x32_bf16 v[100:103], v[176:179], v[132:135], v[100:103]
    ds_read_b64_tr_b16 v[164:165], v15 offset:30752
    v_fmac_f32 v210, v203, v203
    v_fmac_f32 v210, v204, v204
    v_mfma_f32_16x16x32_bf16 v[104:107], v[176:179], v[136:139], v[104:107]
    ds_read_b64_tr_b16 v[166:167], v15 offset:31520
    v_fmac_f32 v210, v205, v205
    v_fmac_f32 v210, v206, v206
    v_mfma_f32_16x16x32_bf16 v[108:111], v[176:179], v[140:143], v[108:111]
    ds_read_b64_tr_b16 v[168:169], v14 offset:30784
    v_fmac_f32 v210, v207, v207
    v_mfma_f32_16x16x32_bf16 v[112:115], v[180:183], v[128:131], v[112:115]
    ds_read_b64_tr_b16 v[170:171], v14 offset:31552
    v_fmac_f32 v210, v208, v208
    v_fmac_f32 v210, v209, v209
    v_mfma_f32_16x16x32_bf16 v[116:119], v[180:183], v[132:135], v[116:119]
    s_nop 0
    v_add_f32_dpp v210, v210, v210 row_shr:1 row_mask:0xf bank_mask:0xf bound_ctrl:0
    v_mfma_f32_16x16x32_bf16 v[120:123], v[180:183], v[136:139], v[120:123]
    s_nop 0
    v_add_f32_dpp v210, v210, v210 row_shr:2 row_mask:0xf bank_mask:0xf bound_ctrl:0
    s_nop 1
    v_add_f32_dpp v210, v210, v210 row_shr:4 row_mask:0xf bank_mask:0xf bound_ctrl:0
    v_mfma_f32_16x16x32_bf16 v[124:127], v[180:183], v[140:143], v[124:127]
    s_nop 0
    v_add_f32_dpp v210, v210, v210 row_shr:8 row_mask:0xf bank_mask:0xf bound_ctrl:0
    s_waitcnt lgkmcnt(0)
    v_mfma_f32_16x16x32_bf16 v[32:35], v[160:163], v[144:147], v[32:35]
    ds_read_b64_tr_b16 v[172:173], v14 offset:43008
    v_add_f32_dpp v210, v210, v210 row_bcast:15 row_mask:0xa bank_mask:0xf
    s_nop 1
    v_add_f32_dpp v210, v210, v210 row_bcast:31 row_mask:0xc bank_mask:0xf
    v_mfma_f32_16x16x32_bf16 v[36:39], v[160:163], v[148:151], v[36:39]
    ds_read_b64_tr_b16 v[174:175], v14 offset:43776
    v_readlane_b32 s51, v210, 63
    v_mov_b32 v210, 0x3acccccd
    v_mfma_f32_16x16x32_bf16 v[40:43], v[160:163], v[152:155], v[40:43]
    ds_read_b64_tr_b16 v[176:177], v15 offset:43040
    v_mul_f32 v210, s51, v210
    v_mfma_f32_16x16x32_bf16 v[44:47], v[160:163], v[156:159], v[44:47]
    ds_read_b64_tr_b16 v[178:179], v15 offset:43808
    v_cvt_pk_bf16_f32 v210, v210, v211
    v_and_b32 v200, 0xffff0000, v210
    v_mfma_f32_16x16x32_bf16 v[48:51], v[164:167], v[144:147], v[48:51]
    ds_read_b64_tr_b16 v[180:181], v14 offset:43072
    v_lshlrev_b32 v210, 16, v210
    v_mfma_f32_16x16x32_bf16 v[52:55], v[164:167], v[148:151], v[52:55]
    ds_read_b64_tr_b16 v[182:183], v14 offset:43840
    v_add_f32 v210, 0x3727c5ac, v210
    v_cvt_pk_bf16_f32 v210, v210, v210
    v_mfma_f32_16x16x32_bf16 v[56:59], v[164:167], v[152:155], v[56:59]
    v_lshlrev_b32 v210, 16, v210
    v_sqrt_f32 v210, v210
    v_mfma_f32_16x16x32_bf16 v[60:63], v[164:167], v[156:159], v[60:63]
    v_cvt_pk_bf16_f32 v210, v210, v210
    v_mfma_f32_16x16x32_bf16 v[64:67], v[168:171], v[144:147], v[64:67]
    v_lshlrev_b32 v201, 16, v210
    s_lshl_b32 s51, s50, 3
    v_mfma_f32_16x16x32_bf16 v[68:71], v[168:171], v[148:151], v[68:71]
    s_add_u32 s51, s51, 32768
    v_mfma_f32_16x16x32_bf16 v[72:75], v[168:171], v[152:155], v[72:75]
    v_mov_b32 v210, 0
    s_mov_b64 exec, 1
    buffer_store_dwordx2 v[200:201], v210, s[20:23], s51 offen sc1
    s_mov_b64 exec, -1
    v_mfma_f32_16x16x32_bf16 v[76:79], v[168:171], v[156:159], v[76:79]
    v_mov_b32 v242, 0
    buffer_load_dwordx2 v[242:243], v242, s[4:7], 0 offen sc1
    s_waitcnt lgkmcnt(0)
    s_barrier
    v_mfma_f32_16x16x32_bf16 v[80:83], v[172:175], v[144:147], v[80:83]
    ds_read_b128 v[128:131], v12 offset:0
    ds_read_b64_tr_b16 v[160:161], v14 offset:0
    s_waitcnt vmcnt(17)
    v_lshlrev_b32 v200, 16, v184
    v_mfma_f32_16x16x32_bf16 v[84:87], v[172:175], v[148:151], v[84:87]
    ds_read_b64_tr_b16 v[162:163], v14 offset:768
    v_and_b32 v201, 0xffff0000, v184
    v_lshlrev_b32 v202, 16, v185
    v_mfma_f32_16x16x32_bf16 v[88:91], v[172:175], v[152:155], v[88:91]
    ds_read_b128 v[132:135], v12 offset:2048
    v_and_b32 v203, 0xffff0000, v185
    v_lshlrev_b32 v204, 16, v186
    v_mfma_f32_16x16x32_bf16 v[92:95], v[172:175], v[156:159], v[92:95]
    ds_read_b128 v[136:139], v12 offset:4096
    v_and_b32 v205, 0xffff0000, v186
    v_lshlrev_b32 v206, 16, v187
    v_mfma_f32_16x16x32_bf16 v[96:99], v[176:179], v[144:147], v[96:99]
    ds_read_b128 v[140:143], v12 offset:6144
    v_and_b32 v207, 0xffff0000, v187
    v_lshlrev_b32 v208, 16, v188
    v_mfma_f32_16x16x32_bf16 v[100:103], v[176:179], v[148:151], v[100:103]
    ds_read_b64_tr_b16 v[164:165], v15 offset:32
    v_and_b32 v209, 0xffff0000, v188
    v_lshlrev_b32 v210, 16, v189
    v_mfma_f32_16x16x32_bf16 v[104:107], v[176:179], v[152:155], v[104:107]
    ds_read_b64_tr_b16 v[166:167], v15 offset:800
    v_and_b32 v211, 0xffff0000, v189
    v_lshlrev_b32 v212, 16, v190
    v_mfma_f32_16x16x32_bf16 v[108:111], v[176:179], v[156:159], v[108:111]
    ds_read_b64_tr_b16 v[168:169], v14 offset:64
    v_and_b32 v213, 0xffff0000, v190
    v_lshlrev_b32 v214, 16, v191
    v_mfma_f32_16x16x32_bf16 v[112:115], v[180:183], v[144:147], v[112:115]
    ds_read_b64_tr_b16 v[170:171], v14 offset:832
    v_and_b32 v215, 0xffff0000, v191
    s_waitcnt vmcnt(8)
    v_mfma_f32_16x16x32_bf16 v[116:119], v[180:183], v[148:151], v[116:119]
    v_lshlrev_b32 v16, 16, v192
    v_and_b32 v17, 0xffff0000, v192
    v_mfma_f32_16x16x32_bf16 v[120:123], v[180:183], v[152:155], v[120:123]
    v_add_f32 v200, v200, v16
    v_add_f32 v201, v201, v17
    v_mfma_f32_16x16x32_bf16 v[124:127], v[180:183], v[156:159], v[124:127]
    v_lshlrev_b32 v16, 16, v193
    s_waitcnt lgkmcnt(0)
    v_mfma_f32_16x16x32_bf16 v[32:35], v[160:163], v[128:131], v[32:35]
    ds_read_b64_tr_b16 v[172:173], v14 offset:12288
    v_and_b32 v17, 0xffff0000, v193
    v_add_f32 v202, v202, v16
    v_mfma_f32_16x16x32_bf16 v[36:39], v[160:163], v[132:135], v[36:39]
    ds_read_b64_tr_b16 v[174:175], v14 offset:13056
    v_add_f32 v203, v203, v17
    v_lshlrev_b32 v16, 16, v194
    v_mfma_f32_16x16x32_bf16 v[40:43], v[160:163], v[136:139], v[40:43]
    ds_read_b64_tr_b16 v[176:177], v15 offset:12320
    v_and_b32 v17, 0xffff0000, v194
    v_add_f32 v204, v204, v16
    v_mfma_f32_16x16x32_bf16 v[44:47], v[160:163], v[140:143], v[44:47]
    ds_read_b64_tr_b16 v[178:179], v15 offset:13088
    v_add_f32 v205, v205, v17
    v_lshlrev_b32 v16, 16, v195
    v_mfma_f32_16x16x32_bf16 v[48:51], v[164:167], v[128:131], v[48:51]
    ds_read_b64_tr_b16 v[180:181], v14 offset:12352
    v_and_b32 v17, 0xffff0000, v195
    v_add_f32 v206, v206, v16
    v_mfma_f32_16x16x32_bf16 v[52:55], v[164:167], v[132:135], v[52:55]
    ds_read_b64_tr_b16 v[182:183], v14 offset:13120
    v_add_f32 v207, v207, v17
    v_lshlrev_b32 v16, 16, v196
    v_mfma_f32_16x16x32_bf16 v[56:59], v[164:167], v[136:139], v[56:59]
    v_and_b32 v17, 0xffff0000, v196
    v_add_f32 v208, v208, v16
    v_mfma_f32_16x16x32_bf16 v[60:63], v[164:167], v[140:143], v[60:63]
    v_add_f32 v209, v209, v17
    v_lshlrev_b32 v16, 16, v197
    v_mfma_f32_16x16x32_bf16 v[64:67], v[168:171], v[128:131], v[64:67]
    v_and_b32 v17, 0xffff0000, v197
    v_add_f32 v210, v210, v16
    v_mfma_f32_16x16x32_bf16 v[68:71], v[168:171], v[132:135], v[68:71]
    v_add_f32 v211, v211, v17
    v_lshlrev_b32 v16, 16, v198
    v_mfma_f32_16x16x32_bf16 v[72:75], v[168:171], v[136:139], v[72:75]
    v_and_b32 v17, 0xffff0000, v198
    v_add_f32 v212, v212, v16
    v_mfma_f32_16x16x32_bf16 v[76:79], v[168:171], v[140:143], v[76:79]
    v_add_f32 v213, v213, v17
    s_waitcnt lgkmcnt(0)
    v_mfma_f32_16x16x32_bf16 v[80:83], v[172:175], v[128:131], v[80:83]
    ds_read_b128 v[144:147], v13 offset:0
    ds_read_b64_tr_b16 v[160:161], v14 offset:6144
    v_lshlrev_b32 v16, 16, v199
    v_and_b32 v17, 0xffff0000, v199
    v_mfma_f32_16x16x32_bf16 v[84:87], v[172:175], v[132:135], v[84:87]
    ds_read_b64_tr_b16 v[162:163], v14 offset:6912
    v_add_f32 v214, v214, v16
    v_add_f32 v215, v215, v17
    v_mfma_f32_16x16x32_bf16 v[88:91], v[172:175], v[136:139], v[88:91]
    ds_read_b128 v[148:151], v13 offset:2048
    s_waitcnt vmcnt(6)
    v_lshlrev_b32 v16, 16, v216
    v_mfma_f32_16x16x32_bf16 v[92:95], v[172:175], v[140:143], v[92:95]
    ds_read_b128 v[152:155], v13 offset:4096
    v_and_b32 v17, 0xffff0000, v216
    v_add_f32 v200, v200, v16
    v_mfma_f32_16x16x32_bf16 v[96:99], v[176:179], v[128:131], v[96:99]
    ds_read_b128 v[156:159], v13 offset:6144
    v_add_f32 v201, v201, v17
    v_lshlrev_b32 v16, 16, v217
    v_mfma_f32_16x16x32_bf16 v[100:103], v[176:179], v[132:135], v[100:103]
    ds_read_b64_tr_b16 v[164:165], v15 offset:6176
    v_and_b32 v17, 0xffff0000, v217
    v_add_f32 v202, v202, v16
    v_mfma_f32_16x16x32_bf16 v[104:107], v[176:179], v[136:139], v[104:107]
    ds_read_b64_tr_b16 v[166:167], v15 offset:6944
    v_add_f32 v203, v203, v17
    v_lshlrev_b32 v16, 16, v218
    v_mfma_f32_16x16x32_bf16 v[108:111], v[176:179], v[140:143], v[108:111]
    ds_read_b64_tr_b16 v[168:169], v14 offset:6208
    v_and_b32 v17, 0xffff0000, v218
    v_add_f32 v204, v204, v16
    v_mfma_f32_16x16x32_bf16 v[112:115], v[180:183], v[128:131], v[112:115]
    ds_read_b64_tr_b16 v[170:171], v14 offset:6976
    v_add_f32 v205, v205, v17
    v_lshlrev_b32 v16, 16, v219
    v_mfma_f32_16x16x32_bf16 v[116:119], v[180:183], v[132:135], v[116:119]
    v_and_b32 v17, 0xffff0000, v219
    v_add_f32 v206, v206, v16
    v_mfma_f32_16x16x32_bf16 v[120:123], v[180:183], v[136:139], v[120:123]
    v_add_f32 v207, v207, v17
    v_lshlrev_b32 v16, 16, v220
    v_mfma_f32_16x16x32_bf16 v[124:127], v[180:183], v[140:143], v[124:127]
    v_and_b32 v17, 0xffff0000, v220
    s_waitcnt lgkmcnt(0)
    v_mfma_f32_16x16x32_bf16 v[32:35], v[160:163], v[144:147], v[32:35]
    ds_read_b64_tr_b16 v[172:173], v14 offset:18432
    v_add_f32 v208, v208, v16
    v_add_f32 v209, v209, v17
    v_mfma_f32_16x16x32_bf16 v[36:39], v[160:163], v[148:151], v[36:39]
    ds_read_b64_tr_b16 v[174:175], v14 offset:19200
    v_lshlrev_b32 v16, 16, v221
    v_and_b32 v17, 0xffff0000, v221
    v_mfma_f32_16x16x32_bf16 v[40:43], v[160:163], v[152:155], v[40:43]
    ds_read_b64_tr_b16 v[176:177], v15 offset:18464
    v_add_f32 v210, v210, v16
    v_add_f32 v211, v211, v17
    v_mfma_f32_16x16x32_bf16 v[44:47], v[160:163], v[156:159], v[44:47]
    ds_read_b64_tr_b16 v[178:179], v15 offset:19232
    v_lshlrev_b32 v16, 16, v222
    v_and_b32 v17, 0xffff0000, v222
    v_mfma_f32_16x16x32_bf16 v[48:51], v[164:167], v[144:147], v[48:51]
    ds_read_b64_tr_b16 v[180:181], v14 offset:18496
    v_add_f32 v212, v212, v16
    v_add_f32 v213, v213, v17
    v_mfma_f32_16x16x32_bf16 v[52:55], v[164:167], v[148:151], v[52:55]
    ds_read_b64_tr_b16 v[182:183], v14 offset:19264
    v_lshlrev_b32 v16, 16, v223
    v_and_b32 v17, 0xffff0000, v223
    v_mfma_f32_16x16x32_bf16 v[56:59], v[164:167], v[152:155], v[56:59]
    v_add_f32 v214, v214, v16
    v_add_f32 v215, v215, v17
    v_mfma_f32_16x16x32_bf16 v[60:63], v[164:167], v[156:159], v[60:63]
    s_waitcnt vmcnt(4)
    v_lshlrev_b32 v16, 16, v224
    v_mfma_f32_16x16x32_bf16 v[64:67], v[168:171], v[144:147], v[64:67]
    v_and_b32 v17, 0xffff0000, v224
    v_add_f32 v200, v200, v16
    v_mfma_f32_16x16x32_bf16 v[68:71], v[168:171], v[148:151], v[68:71]
    v_add_f32 v201, v201, v17
    v_lshlrev_b32 v16, 16, v225
    v_mfma_f32_16x16x32_bf16 v[72:75], v[168:171], v[152:155], v[72:75]
    v_and_b32 v17, 0xffff0000, v225
    v_add_f32 v202, v202, v16
    v_mfma_f32_16x16x32_bf16 v[76:79], v[168:171], v[156:159], v[76:79]
    v_add_f32 v203, v203, v17
    s_waitcnt lgkmcnt(0)
    s_barrier
    s_waitcnt vmcnt(0)
    v_readfirstlane_b32 s82, v242
    v_readfirstlane_b32 s83, v243
    s_cmp_lg_u32 s82, 0
    s_cbranch_scc1 GUP_NON_OK
    s_mov_b32 s81, 0
GUP_NON_SP:
    s_sleep 2
    v_mov_b32 v242, 0
    buffer_load_dwordx2 v[242:243], v242, s[4:7], 0 offen sc1
    s_waitcnt vmcnt(0)
    v_readfirstlane_b32 s82, v242
    v_readfirstlane_b32 s83, v243
    s_add_u32 s81, s81, 1
    s_cmp_ge_u32 s81, 200000
    s_cbranch_scc1 GUP_NON_OK
    s_cmp_eq_u32 s82, 0
    s_cbranch_scc1 GUP_NON_SP
GUP_NON_OK:
    v_mfma_f32_16x16x32_bf16 v[80:83], v[172:175], v[144:147], v[80:83]
    ds_read_b128 v[128:131], v10 offset:0
    ds_read_b64_tr_b16 v[160:161], v14 offset:24576
    v_lshlrev_b32 v16, 16, v226
    v_and_b32 v17, 0xffff0000, v226
    v_mfma_f32_16x16x32_bf16 v[84:87], v[172:175], v[148:151], v[84:87]
    ds_read_b64_tr_b16 v[162:163], v14 offset:25344
    v_add_f32 v204, v204, v16
    v_add_f32 v205, v205, v17
    v_mfma_f32_16x16x32_bf16 v[88:91], v[172:175], v[152:155], v[88:91]
    ds_read_b128 v[132:135], v10 offset:2048
    v_lshlrev_b32 v16, 16, v227
    v_and_b32 v17, 0xffff0000, v227
    v_mfma_f32_16x16x32_bf16 v[92:95], v[172:175], v[156:159], v[92:95]
    ds_read_b128 v[136:139], v10 offset:4096
    v_add_f32 v206, v206, v16
    v_add_f32 v207, v207, v17
    v_mfma_f32_16x16x32_bf16 v[96:99], v[176:179], v[144:147], v[96:99]
    ds_read_b128 v[140:143], v10 offset:6144
    v_lshlrev_b32 v16, 16, v228
    v_and_b32 v17, 0xffff0000, v228
    v_mfma_f32_16x16x32_bf16 v[100:103], v[176:179], v[148:151], v[100:103]
    ds_read_b64_tr_b16 v[164:165], v15 offset:24608
    v_add_f32 v208, v208, v16
    v_add_f32 v209, v209, v17
    v_mfma_f32_16x16x32_bf16 v[104:107], v[176:179], v[152:155], v[104:107]
    ds_read_b64_tr_b16 v[166:167], v15 offset:25376
    v_lshlrev_b32 v16, 16, v229
    v_and_b32 v17, 0xffff0000, v229
    v_mfma_f32_16x16x32_bf16 v[108:111], v[176:179], v[156:159], v[108:111]
    ds_read_b64_tr_b16 v[168:169], v14 offset:24640
    v_add_f32 v210, v210, v16
    v_add_f32 v211, v211, v17
    v_mfma_f32_16x16x32_bf16 v[112:115], v[180:183], v[144:147], v[112:115]
    ds_read_b64_tr_b16 v[170:171], v14 offset:25408
    v_lshlrev_b32 v16, 16, v230
    v_and_b32 v17, 0xffff0000, v230
    v_mfma_f32_16x16x32_bf16 v[116:119], v[180:183], v[148:151], v[116:119]
    v_add_f32 v212, v212, v16
    v_add_f32 v213, v213, v17
    v_mfma_f32_16x16x32_bf16 v[120:123], v[180:183], v[152:155], v[120:123]
    v_lshlrev_b32 v16, 16, v231
    v_and_b32 v17, 0xffff0000, v231
    v_mfma_f32_16x16x32_bf16 v[124:127], v[180:183], v[156:159], v[124:127]
    v_add_f32 v214, v214, v16
    s_waitcnt lgkmcnt(0)
    v_mfma_f32_16x16x32_bf16 v[32:35], v[160:163], v[128:131], v[32:35]
    ds_read_b64_tr_b16 v[172:173], v14 offset:36864
    v_add_f32 v215, v215, v17
    s_waitcnt vmcnt(2)
    v_mfma_f32_16x16x32_bf16 v[36:39], v[160:163], v[132:135], v[36:39]
    ds_read_b64_tr_b16 v[174:175], v14 offset:37632
    v_lshlrev_b32 v16, 16, v232
    v_and_b32 v17, 0xffff0000, v232
    v_mfma_f32_16x16x32_bf16 v[40:43], v[160:163], v[136:139], v[40:43]
    ds_read_b64_tr_b16 v[176:177], v15 offset:36896
    v_add_f32 v200, v200, v16
    v_add_f32 v201, v201, v17
    v_mfma_f32_16x16x32_bf16 v[44:47], v[160:163], v[140:143], v[44:47]
    ds_read_b64_tr_b16 v[178:179], v15 offset:37664
    v_lshlrev_b32 v16, 16, v233
    v_and_b32 v17, 0xffff0000, v233
    v_mfma_f32_16x16x32_bf16 v[48:51], v[164:167], v[128:131], v[48:51]
    ds_read_b64_tr_b16 v[180:181], v14 offset:36928
    v_add_f32 v202, v202, v16
    v_add_f32 v203, v203, v17
    v_mfma_f32_16x16x32_bf16 v[52:55], v[164:167], v[132:135], v[52:55]
    ds_read_b64_tr_b16 v[182:183], v14 offset:37696
    v_lshlrev_b32 v16, 16, v234
    v_and_b32 v17, 0xffff0000, v234
    v_mfma_f32_16x16x32_bf16 v[56:59], v[164:167], v[136:139], v[56:59]
    v_add_f32 v204, v204, v16
    v_add_f32 v205, v205, v17
    v_mfma_f32_16x16x32_bf16 v[60:63], v[164:167], v[140:143], v[60:63]
    v_lshlrev_b32 v16, 16, v235
    v_and_b32 v17, 0xffff0000, v235
    v_mfma_f32_16x16x32_bf16 v[64:67], v[168:171], v[128:131], v[64:67]
    v_add_f32 v206, v206, v16
    v_add_f32 v207, v207, v17
    v_mfma_f32_16x16x32_bf16 v[68:71], v[168:171], v[132:135], v[68:71]
    v_lshlrev_b32 v16, 16, v236
    v_and_b32 v17, 0xffff0000, v236
    v_mfma_f32_16x16x32_bf16 v[72:75], v[168:171], v[136:139], v[72:75]
    v_add_f32 v208, v208, v16
    v_add_f32 v209, v209, v17
    v_mfma_f32_16x16x32_bf16 v[76:79], v[168:171], v[140:143], v[76:79]
    v_lshlrev_b32 v16, 16, v237
    s_waitcnt lgkmcnt(0)
    v_mfma_f32_16x16x32_bf16 v[80:83], v[172:175], v[128:131], v[80:83]
    ds_read_b128 v[144:147], v11 offset:0
    ds_read_b64_tr_b16 v[160:161], v14 offset:30720
    v_and_b32 v17, 0xffff0000, v237
    v_add_f32 v210, v210, v16
    v_mfma_f32_16x16x32_bf16 v[84:87], v[172:175], v[132:135], v[84:87]
    ds_read_b64_tr_b16 v[162:163], v14 offset:31488
    v_add_f32 v211, v211, v17
    v_lshlrev_b32 v16, 16, v238
    v_mfma_f32_16x16x32_bf16 v[88:91], v[172:175], v[136:139], v[88:91]
    ds_read_b128 v[148:151], v11 offset:2048
    v_and_b32 v17, 0xffff0000, v238
    v_add_f32 v212, v212, v16
    v_mfma_f32_16x16x32_bf16 v[92:95], v[172:175], v[140:143], v[92:95]
    ds_read_b128 v[152:155], v11 offset:4096
    v_add_f32 v213, v213, v17
    v_lshlrev_b32 v16, 16, v239
    v_mfma_f32_16x16x32_bf16 v[96:99], v[176:179], v[128:131], v[96:99]
    ds_read_b128 v[156:159], v11 offset:6144
    v_and_b32 v17, 0xffff0000, v239
    v_add_f32 v214, v214, v16
    v_mfma_f32_16x16x32_bf16 v[100:103], v[176:179], v[132:135], v[100:103]
    ds_read_b64_tr_b16 v[164:165], v15 offset:30752
    v_add_f32 v215, v215, v17
    v_permlane32_swap_b32 v200, v208
    v_mfma_f32_16x16x32_bf16 v[104:107], v[176:179], v[136:139], v[104:107]
    ds_read_b64_tr_b16 v[166:167], v15 offset:31520
    v_permlane32_swap_b32 v201, v209
    v_permlane32_swap_b32 v202, v210
    v_mfma_f32_16x16x32_bf16 v[108:111], v[176:179], v[140:143], v[108:111]
    ds_read_b64_tr_b16 v[168:169], v14 offset:30784
    v_permlane32_swap_b32 v203, v211
    v_permlane32_swap_b32 v204, v212
    v_mfma_f32_16x16x32_bf16 v[112:115], v[180:183], v[128:131], v[112:115]
    ds_read_b64_tr_b16 v[170:171], v14 offset:31552
    v_permlane32_swap_b32 v205, v213
    v_permlane32_swap_b32 v206, v214
    v_mfma_f32_16x16x32_bf16 v[116:119], v[180:183], v[132:135], v[116:119]
    v_permlane32_swap_b32 v207, v215
    v_add_f32 v200, v200, v208
    v_mfma_f32_16x16x32_bf16 v[120:123], v[180:183], v[136:139], v[120:123]
    v_add_f32 v201, v201, v209
    v_add_f32 v202, v202, v210
    v_mfma_f32_16x16x32_bf16 v[124:127], v[180:183], v[140:143], v[124:127]
    v_add_f32 v203, v203, v211
    s_waitcnt lgkmcnt(0)
    v_mfma_f32_16x16x32_bf16 v[32:35], v[160:163], v[144:147], v[32:35]
    ds_read_b64_tr_b16 v[172:173], v14 offset:43008
    v_add_f32 v204, v204, v212
    v_add_f32 v205, v205, v213
    v_mfma_f32_16x16x32_bf16 v[36:39], v[160:163], v[148:151], v[36:39]
    ds_read_b64_tr_b16 v[174:175], v14 offset:43776
    v_add_f32 v206, v206, v214
    v_add_f32 v207, v207, v215
    v_mfma_f32_16x16x32_bf16 v[40:43], v[160:163], v[152:155], v[40:43]
    ds_read_b64_tr_b16 v[176:177], v15 offset:43040
    v_permlane16_swap_b32 v200, v204
    v_permlane16_swap_b32 v201, v205
    v_mfma_f32_16x16x32_bf16 v[44:47], v[160:163], v[156:159], v[44:47]
    ds_read_b64_tr_b16 v[178:179], v15 offset:43808
    v_permlane16_swap_b32 v202, v206
    v_permlane16_swap_b32 v203, v207
    v_mfma_f32_16x16x32_bf16 v[48:51], v[164:167], v[144:147], v[48:51]
    ds_read_b64_tr_b16 v[180:181], v14 offset:43072
    v_add_f32 v200, v200, v204
    v_add_f32 v201, v201, v205
    v_mfma_f32_16x16x32_bf16 v[52:55], v[164:167], v[148:151], v[52:55]
    ds_read_b64_tr_b16 v[182:183], v14 offset:43840
    v_add_f32 v202, v202, v206
    v_add_f32 v203, v203, v207
    v_mfma_f32_16x16x32_bf16 v[56:59], v[164:167], v[152:155], v[56:59]
    v_and_b32 v16, 15, v0
    v_lshlrev_b32 v16, 5, v16
    v_mfma_f32_16x16x32_bf16 v[60:63], v[164:167], v[156:159], v[60:63]
    v_bfe_u32 v17, v0, 4, 1
    v_lshl_add_u32 v16, v17, 4, v16
    v_mfma_f32_16x16x32_bf16 v[64:67], v[168:171], v[144:147], v[64:67]
    v_lshrrev_b32 v17, 5, v0
    v_mul_u32_u24 v17, 384, v17
    v_mfma_f32_16x16x32_bf16 v[68:71], v[168:171], v[148:151], v[68:71]
    v_add_u32 v16, v16, v17
    s_mul_i32 s45, s37, 768
    v_mfma_f32_16x16x32_bf16 v[72:75], v[168:171], v[152:155], v[72:75]
    s_add_u32 s45, s45, 154656
    v_add_u32 v16, s45, v16
    v_mfma_f32_16x16x32_bf16 v[76:79], v[168:171], v[156:159], v[76:79]
    s_mov_b64 exec, s[42:43]
    ds_write_b128 v16, v[200:203]
    s_mov_b64 exec, -1
    s_waitcnt vmcnt(1) lgkmcnt(0)
    s_barrier
    s_cmp_eq_u32 s32, 4
    s_cbranch_scc0 GUP_NCS
    v_lshlrev_b32 v16, 4, v0
    v_add_u32 v17, 154656, v16
    s_mov_b32 exec_hi, 0xffff
    ds_read_b128 v[184:187], v17 offset:0
    ds_read_b128 v[188:191], v17 offset:768
    ds_read_b128 v[192:195], v17 offset:1536
    ds_read_b128 v[196:199], v17 offset:2304
    s_lshl_b32 s45, s36, 3
    s_add_u32 s45, s45, s33
    s_mul_i32 s45, s45, 768
    s_add_u32 s45, s45, 65536
    s_waitcnt lgkmcnt(0)
    v_add_f32 v184, v184, v188
    v_add_f32 v185, v185, v189
    v_add_f32 v186, v186, v190
    v_add_f32 v187, v187, v191
    v_add_f32 v184, v184, v192
    v_add_f32 v185, v185, v193
    v_add_f32 v186, v186, v194
    v_add_f32 v187, v187, v195
    v_add_f32 v184, v184, v196
    v_add_f32 v185, v185, v197
    v_add_f32 v186, v186, v198
    v_add_f32 v187, v187, v199
    buffer_store_dwordx4 v[184:187], v16, s[20:23], s45 offen sc1
    s_mov_b64 exec, -1
GUP_NCS:
    v_mfma_f32_16x16x32_bf16 v[80:83], v[172:175], v[144:147], v[80:83]
    ds_read_b128 v[128:131], v10 offset:32768
    ds_read_b64_tr_b16 v[160:161], v14 offset:0
    v_mfma_f32_16x16x32_bf16 v[84:87], v[172:175], v[148:151], v[84:87]
    ds_read_b64_tr_b16 v[162:163], v14 offset:768
    v_mfma_f32_16x16x32_bf16 v[88:91], v[172:175], v[152:155], v[88:91]
    ds_read_b128 v[132:135], v10 offset:34816
    v_mfma_f32_16x16x32_bf16 v[92:95], v[172:175], v[156:159], v[92:95]
    ds_read_b128 v[136:139], v10 offset:36864
    v_mfma_f32_16x16x32_bf16 v[96:99], v[176:179], v[144:147], v[96:99]
    ds_read_b128 v[140:143], v10 offset:38912
    v_mfma_f32_16x16x32_bf16 v[100:103], v[176:179], v[148:151], v[100:103]
    ds_read_b64_tr_b16 v[164:165], v15 offset:32
    v_mfma_f32_16x16x32_bf16 v[104:107], v[176:179], v[152:155], v[104:107]
    ds_read_b64_tr_b16 v[166:167], v15 offset:800
    v_mfma_f32_16x16x32_bf16 v[108:111], v[176:179], v[156:159], v[108:111]
    ds_read_b64_tr_b16 v[168:169], v14 offset:64
    v_mfma_f32_16x16x32_bf16 v[112:115], v[180:183], v[144:147], v[112:115]
    ds_read_b64_tr_b16 v[170:171], v14 offset:832
    v_mfma_f32_16x16x32_bf16 v[116:119], v[180:183], v[148:151], v[116:119]
    v_mfma_f32_16x16x32_bf16 v[120:123], v[180:183], v[152:155], v[120:123]
    v_mfma_f32_16x16x32_bf16 v[124:127], v[180:183], v[156:159], v[124:127]
    s_waitcnt lgkmcnt(0)
    v_mfma_f32_16x16x32_bf16 v[32:35], v[160:163], v[128:131], v[32:35]
    ds_read_b64_tr_b16 v[172:173], v14 offset:12288
    v_and_b32 v30, 3, v0
    v_mfma_f32_16x16x32_bf16 v[36:39], v[160:163], v[132:135], v[36:39]
    ds_read_b64_tr_b16 v[174:175], v14 offset:13056
    v_mfma_f32_16x16x32_bf16 v[40:43], v[160:163], v[136:139], v[40:43]
    ds_read_b64_tr_b16 v[176:177], v15 offset:12320
    v_bfe_u32 v16, v0, 2, 2
    v_mfma_f32_16x16x32_bf16 v[44:47], v[160:163], v[140:143], v[44:47]
    ds_read_b64_tr_b16 v[178:179], v15 offset:13088
    v_mfma_f32_16x16x32_bf16 v[48:51], v[164:167], v[128:131], v[48:51]
    ds_read_b64_tr_b16 v[180:181], v14 offset:12352
    v_lshl_add_u32 v30, v16, 3, v30
    v_mfma_f32_16x16x32_bf16 v[52:55], v[164:167], v[132:135], v[52:55]
    ds_read_b64_tr_b16 v[182:183], v14 offset:13120
    v_mfma_f32_16x16x32_bf16 v[56:59], v[164:167], v[136:139], v[56:59]
    v_add_u32 v30, 228, v30
    v_mfma_f32_16x16x32_bf16 v[60:63], v[164:167], v[140:143], v[60:63]
    v_mfma_f32_16x16x32_bf16 v[64:67], v[168:171], v[128:131], v[64:67]
    v_lshlrev_b32 v30, 7, v30
    v_mfma_f32_16x16x32_bf16 v[68:71], v[168:171], v[132:135], v[68:71]
    v_mfma_f32_16x16x32_bf16 v[72:75], v[168:171], v[136:139], v[72:75]
    s_and_b32 s45, s33, 3
    v_mfma_f32_16x16x32_bf16 v[76:79], v[168:171], v[140:143], v[76:79]
    s_waitcnt lgkmcnt(0)
    v_mfma_f32_16x16x32_bf16 v[80:83], v[172:175], v[128:131], v[80:83]
    ds_read_b128 v[144:147], v11 offset:32768
    ds_read_b64_tr_b16 v[160:161], v14 offset:6144
    s_lshl_b32 s45, s45, 1
    v_mfma_f32_16x16x32_bf16 v[84:87], v[172:175], v[132:135], v[84:87]
    ds_read_b64_tr_b16 v[162:163], v14 offset:6912
    v_mfma_f32_16x16x32_bf16 v[88:91], v[172:175], v[136:139], v[88:91]
    ds_read_b128 v[148:151], v11 offset:34816
    s_lshr_b32 s46, s33, 2
    v_mfma_f32_16x16x32_bf16 v[92:95], v[172:175], v[140:143], v[92:95]
    ds_read_b128 v[152:155], v11 offset:36864
    v_mfma_f32_16x16x32_bf16 v[96:99], v[176:179], v[128:131], v[96:99]
    ds_read_b128 v[156:159], v11 offset:38912
    s_add_u32 s45, s45, s46
    v_mfma_f32_16x16x32_bf16 v[100:103], v[176:179], v[132:135], v[100:103]
    ds_read_b64_tr_b16 v[164:165], v15 offset:6176
    v_mfma_f32_16x16x32_bf16 v[104:107], v[176:179], v[136:139], v[104:107]
    ds_read_b64_tr_b16 v[166:167], v15 offset:6944
    v_lshlrev_b32 v31, 3, v0
    v_mfma_f32_16x16x32_bf16 v[108:111], v[176:179], v[140:143], v[108:111]
    ds_read_b64_tr_b16 v[168:169], v14 offset:6208
    v_mfma_f32_16x16x32_bf16 v[112:115], v[180:183], v[128:131], v[112:115]
    ds_read_b64_tr_b16 v[170:171], v14 offset:6976
    v_add_u32 v31, s45, v31
    v_mfma_f32_16x16x32_bf16 v[116:119], v[180:183], v[132:135], v[116:119]
    v_mfma_f32_16x16x32_bf16 v[120:123], v[180:183], v[136:139], v[120:123]
    s_andn2_b32 s45, s2, 25
    v_mfma_f32_16x16x32_bf16 v[124:127], v[180:183], v[140:143], v[124:127]
    s_waitcnt lgkmcnt(0)
    v_mfma_f32_16x16x32_bf16 v[32:35], v[160:163], v[144:147], v[32:35]
    ds_read_b64_tr_b16 v[172:173], v14 offset:18432
    v_and_b32 v16, 3, v0
    v_mfma_f32_16x16x32_bf16 v[36:39], v[160:163], v[148:151], v[36:39]
    ds_read_b64_tr_b16 v[174:175], v14 offset:19200
    v_lshlrev_b32 v16, 3, v16
    v_mfma_f32_16x16x32_bf16 v[40:43], v[160:163], v[152:155], v[40:43]
    ds_read_b64_tr_b16 v[176:177], v15 offset:18464
    v_mfma_f32_16x16x32_bf16 v[44:47], v[160:163], v[156:159], v[44:47]
    ds_read_b64_tr_b16 v[178:179], v15 offset:19232
    v_bfe_u32 v17, v0, 2, 1
    v_mfma_f32_16x16x32_bf16 v[48:51], v[164:167], v[144:147], v[48:51]
    ds_read_b64_tr_b16 v[180:181], v14 offset:18496
    v_mfma_f32_16x16x32_bf16 v[52:55], v[164:167], v[148:151], v[52:55]
    ds_read_b64_tr_b16 v[182:183], v14 offset:19264
    v_or3_b32 v16, s45, v16, v17
    v_mfma_f32_16x16x32_bf16 v[56:59], v[164:167], v[152:155], v[56:59]
    v_cmp_gt_u32 vcc, 32, v0
    v_mfma_f32_16x16x32_bf16 v[60:63], v[164:167], v[156:159], v[60:63]
    v_mfma_f32_16x16x32_bf16 v[64:67], v[168:171], v[144:147], v[64:67]
    v_cndmask_b32 v31, v16, v31, vcc
    v_mfma_f32_16x16x32_bf16 v[68:71], v[168:171], v[148:151], v[68:71]
    v_mfma_f32_16x16x32_bf16 v[72:75], v[168:171], v[152:155], v[72:75]
    v_lshlrev_b32 v31, 7, v31
    v_mfma_f32_16x16x32_bf16 v[76:79], v[168:171], v[156:159], v[76:79]
    s_waitcnt vmcnt(0) lgkmcnt(0)
    s_barrier
    s_cmp_eq_u32 s32, 5
    s_cbranch_scc0 GUP_NP1
    s_add_u32 s45, s82, 1
    v_mov_b32 v16, s45
    v_mov_b32 v17, s83
    v_mov_b32 v18, 0
    s_lshl_b32 s45, s2, 7
    s_mov_b64 exec, 1
    buffer_store_dwordx2 v[16:17], v18, s[20:23], s45 offen sc1
    s_mov_b64 exec, -1
GUP_NP1:
    v_mfma_f32_16x16x32_bf16 v[80:83], v[172:175], v[144:147], v[80:83]
    ds_read_b128 v[128:131], v12 offset:0
    ds_read_b64_tr_b16 v[160:161], v14 offset:24576
    v_mfma_f32_16x16x32_bf16 v[84:87], v[172:175], v[148:151], v[84:87]
    ds_read_b64_tr_b16 v[162:163], v14 offset:25344
    v_mfma_f32_16x16x32_bf16 v[88:91], v[172:175], v[152:155], v[88:91]
    ds_read_b128 v[132:135], v12 offset:2048
    v_mfma_f32_16x16x32_bf16 v[92:95], v[172:175], v[156:159], v[92:95]
    ds_read_b128 v[136:139], v12 offset:4096
    v_mfma_f32_16x16x32_bf16 v[96:99], v[176:179], v[144:147], v[96:99]
    ds_read_b128 v[140:143], v12 offset:6144
    v_mfma_f32_16x16x32_bf16 v[100:103], v[176:179], v[148:151], v[100:103]
    ds_read_b64_tr_b16 v[164:165], v15 offset:24608
    v_mfma_f32_16x16x32_bf16 v[104:107], v[176:179], v[152:155], v[104:107]
    ds_read_b64_tr_b16 v[166:167], v15 offset:25376
    v_mfma_f32_16x16x32_bf16 v[108:111], v[176:179], v[156:159], v[108:111]
    ds_read_b64_tr_b16 v[168:169], v14 offset:24640
    v_mfma_f32_16x16x32_bf16 v[112:115], v[180:183], v[144:147], v[112:115]
    ds_read_b64_tr_b16 v[170:171], v14 offset:25408
    v_mfma_f32_16x16x32_bf16 v[116:119], v[180:183], v[148:151], v[116:119]
    v_mfma_f32_16x16x32_bf16 v[120:123], v[180:183], v[152:155], v[120:123]
    v_mfma_f32_16x16x32_bf16 v[124:127], v[180:183], v[156:159], v[124:127]
    s_waitcnt lgkmcnt(0)
    v_mfma_f32_16x16x32_bf16 v[32:35], v[160:163], v[128:131], v[32:35]
    ds_read_b64_tr_b16 v[172:173], v14 offset:36864
    v_mfma_f32_16x16x32_bf16 v[36:39], v[160:163], v[132:135], v[36:39]
    ds_read_b64_tr_b16 v[174:175], v14 offset:37632
    v_mfma_f32_16x16x32_bf16 v[40:43], v[160:163], v[136:139], v[40:43]
    ds_read_b64_tr_b16 v[176:177], v15 offset:36896
    v_mfma_f32_16x16x32_bf16 v[44:47], v[160:163], v[140:143], v[44:47]
    ds_read_b64_tr_b16 v[178:179], v15 offset:37664
    v_mfma_f32_16x16x32_bf16 v[48:51], v[164:167], v[128:131], v[48:51]
    ds_read_b64_tr_b16 v[180:181], v14 offset:36928
    v_mfma_f32_16x16x32_bf16 v[52:55], v[164:167], v[132:135], v[52:55]
    ds_read_b64_tr_b16 v[182:183], v14 offset:37696
    v_mfma_f32_16x16x32_bf16 v[56:59], v[164:167], v[136:139], v[56:59]
    v_mfma_f32_16x16x32_bf16 v[60:63], v[164:167], v[140:143], v[60:63]
    v_mfma_f32_16x16x32_bf16 v[64:67], v[168:171], v[128:131], v[64:67]
    v_mfma_f32_16x16x32_bf16 v[68:71], v[168:171], v[132:135], v[68:71]
    v_mfma_f32_16x16x32_bf16 v[72:75], v[168:171], v[136:139], v[72:75]
    v_mfma_f32_16x16x32_bf16 v[76:79], v[168:171], v[140:143], v[76:79]
    s_waitcnt lgkmcnt(0)
    v_mfma_f32_16x16x32_bf16 v[80:83], v[172:175], v[128:131], v[80:83]
    ds_read_b128 v[144:147], v13 offset:0
    ds_read_b64_tr_b16 v[160:161], v14 offset:30720
    v_mfma_f32_16x16x32_bf16 v[84:87], v[172:175], v[132:135], v[84:87]
    ds_read_b64_tr_b16 v[162:163], v14 offset:31488
    v_mfma_f32_16x16x32_bf16 v[88:91], v[172:175], v[136:139], v[88:91]
    ds_read_b128 v[148:151], v13 offset:2048
    v_mfma_f32_16x16x32_bf16 v[92:95], v[172:175], v[140:143], v[92:95]
    ds_read_b128 v[152:155], v13 offset:4096
    v_mfma_f32_16x16x32_bf16 v[96:99], v[176:179], v[128:131], v[96:99]
    ds_read_b128 v[156:159], v13 offset:6144
    v_mfma_f32_16x16x32_bf16 v[100:103], v[176:179], v[132:135], v[100:103]
    ds_read_b64_tr_b16 v[164:165], v15 offset:30752
    v_mfma_f32_16x16x32_bf16 v[104:107], v[176:179], v[136:139], v[104:107]
    ds_read_b64_tr_b16 v[166:167], v15 offset:31520
    v_mfma_f32_16x16x32_bf16 v[108:111], v[176:179], v[140:143], v[108:111]
    ds_read_b64_tr_b16 v[168:169], v14 offset:30784
    v_mfma_f32_16x16x32_bf16 v[112:115], v[180:183], v[128:131], v[112:115]
    ds_read_b64_tr_b16 v[170:171], v14 offset:31552
    v_mfma_f32_16x16x32_bf16 v[116:119], v[180:183], v[132:135], v[116:119]
    v_mfma_f32_16x16x32_bf16 v[120:123], v[180:183], v[136:139], v[120:123]
    v_mfma_f32_16x16x32_bf16 v[124:127], v[180:183], v[140:143], v[124:127]
    s_waitcnt lgkmcnt(0)
    v_mfma_f32_16x16x32_bf16 v[32:35], v[160:163], v[144:147], v[32:35]
    ds_read_b64_tr_b16 v[172:173], v14 offset:43008
    v_mfma_f32_16x16x32_bf16 v[36:39], v[160:163], v[148:151], v[36:39]
    ds_read_b64_tr_b16 v[174:175], v14 offset:43776
    v_mfma_f32_16x16x32_bf16 v[40:43], v[160:163], v[152:155], v[40:43]
    ds_read_b64_tr_b16 v[176:177], v15 offset:43040
    v_mfma_f32_16x16x32_bf16 v[44:47], v[160:163], v[156:159], v[44:47]
    ds_read_b64_tr_b16 v[178:179], v15 offset:43808
    v_mfma_f32_16x16x32_bf16 v[48:51], v[164:167], v[144:147], v[48:51]
    ds_read_b64_tr_b16 v[180:181], v14 offset:43072
    v_mfma_f32_16x16x32_bf16 v[52:55], v[164:167], v[148:151], v[52:55]
    ds_read_b64_tr_b16 v[182:183], v14 offset:43840
    v_mfma_f32_16x16x32_bf16 v[56:59], v[164:167], v[152:155], v[56:59]
    v_mfma_f32_16x16x32_bf16 v[60:63], v[164:167], v[156:159], v[60:63]
    v_mfma_f32_16x16x32_bf16 v[64:67], v[168:171], v[144:147], v[64:67]
    v_mfma_f32_16x16x32_bf16 v[68:71], v[168:171], v[148:151], v[68:71]
    v_mfma_f32_16x16x32_bf16 v[72:75], v[168:171], v[152:155], v[72:75]
    v_mfma_f32_16x16x32_bf16 v[76:79], v[168:171], v[156:159], v[76:79]
    s_waitcnt lgkmcnt(0)
    s_barrier
    v_mfma_f32_16x16x32_bf16 v[80:83], v[172:175], v[144:147], v[80:83]
    ds_read_b128 v[128:131], v10 offset:0
    ds_read_b64_tr_b16 v[160:161], v14 offset:0
    v_lshlrev_b32 v8, 4, v0
    v_mfma_f32_16x16x32_bf16 v[84:87], v[172:175], v[148:151], v[84:87]
    ds_read_b64_tr_b16 v[162:163], v14 offset:768
    v_mfma_f32_16x16x32_bf16 v[88:91], v[172:175], v[152:155], v[88:91]
    ds_read_b128 v[132:135], v10 offset:2048
    v_mfma_f32_16x16x32_bf16 v[92:95], v[172:175], v[156:159], v[92:95]
    ds_read_b128 v[136:139], v10 offset:4096
    v_mfma_f32_16x16x32_bf16 v[96:99], v[176:179], v[144:147], v[96:99]
    ds_read_b128 v[140:143], v10 offset:6144
    v_mfma_f32_16x16x32_bf16 v[100:103], v[176:179], v[148:151], v[100:103]
    ds_read_b64_tr_b16 v[164:165], v15 offset:32
    v_mfma_f32_16x16x32_bf16 v[104:107], v[176:179], v[152:155], v[104:107]
    ds_read_b64_tr_b16 v[166:167], v15 offset:800
    v_add_u32 v9, 4096, v8
    v_mfma_f32_16x16x32_bf16 v[108:111], v[176:179], v[156:159], v[108:111]
    ds_read_b64_tr_b16 v[168:169], v14 offset:64
    v_mfma_f32_16x16x32_bf16 v[112:115], v[180:183], v[144:147], v[112:115]
    ds_read_b64_tr_b16 v[170:171], v14 offset:832
    v_mfma_f32_16x16x32_bf16 v[116:119], v[180:183], v[148:151], v[116:119]
    v_mfma_f32_16x16x32_bf16 v[120:123], v[180:183], v[152:155], v[120:123]
    v_mfma_f32_16x16x32_bf16 v[124:127], v[180:183], v[156:159], v[124:127]
    s_waitcnt lgkmcnt(0)
    v_mfma_f32_16x16x32_bf16 v[32:35], v[160:163], v[128:131], v[32:35]
    ds_read_b64_tr_b16 v[172:173], v14 offset:12288
    s_mul_i32 s29, s32, 10240
    v_mfma_f32_16x16x32_bf16 v[36:39], v[160:163], v[132:135], v[36:39]
    ds_read_b64_tr_b16 v[174:175], v14 offset:13056
    v_mfma_f32_16x16x32_bf16 v[40:43], v[160:163], v[136:139], v[40:43]
    ds_read_b64_tr_b16 v[176:177], v15 offset:12320
    v_mfma_f32_16x16x32_bf16 v[44:47], v[160:163], v[140:143], v[44:47]
    ds_read_b64_tr_b16 v[178:179], v15 offset:13088
    v_mfma_f32_16x16x32_bf16 v[48:51], v[164:167], v[128:131], v[48:51]
    ds_read_b64_tr_b16 v[180:181], v14 offset:12352
    s_add_u32 s30, s29, 81920
    v_mfma_f32_16x16x32_bf16 v[52:55], v[164:167], v[132:135], v[52:55]
    ds_read_b64_tr_b16 v[182:183], v14 offset:13120
    v_mfma_f32_16x16x32_bf16 v[56:59], v[164:167], v[136:139], v[56:59]
    v_mfma_f32_16x16x32_bf16 v[60:63], v[164:167], v[140:143], v[60:63]
    v_mfma_f32_16x16x32_bf16 v[64:67], v[168:171], v[128:131], v[64:67]
    s_cmp_eq_u32 s32, 6
    s_cbranch_scc0 GUP_NPS
    buffer_load_dwordx2 v[254:255], v31, s[20:23], 0 offen sc1
    GUP_NPS:
    v_mfma_f32_16x16x32_bf16 v[68:71], v[168:171], v[132:135], v[68:71]
    v_mfma_f32_16x16x32_bf16 v[72:75], v[168:171], v[136:139], v[72:75]
    v_mfma_f32_16x16x32_bf16 v[76:79], v[168:171], v[140:143], v[76:79]
    s_waitcnt lgkmcnt(0)
    v_mfma_f32_16x16x32_bf16 v[80:83], v[172:175], v[128:131], v[80:83]
    ds_read_b128 v[144:147], v11 offset:0
    ds_read_b64_tr_b16 v[160:161], v14 offset:6144
    s_lshl_b32 s45, s32, 3
    s_cmp_eq_u32 s32, 5
    s_cselect_b32 s45, 38, s45
    s_cmp_eq_u32 s32, 6
    s_cselect_b32 s45, 44, s45
    s_cmp_eq_u32 s32, 7
    s_cselect_b32 s45, 49, s45
    s_bfe_u32 s46, s2, 0x30003
    s_mul_i32 s46, s46, 74
    s_add_u32 s28, s45, s46
    s_mul_i32 s28, s28, 5120
    s_add_u32 s28, s28, 10485760
    v_mfma_f32_16x16x32_bf16 v[84:87], v[172:175], v[132:135], v[84:87]
    ds_read_b64_tr_b16 v[162:163], v14 offset:6912
    v_mfma_f32_16x16x32_bf16 v[88:91], v[172:175], v[136:139], v[88:91]
    ds_read_b128 v[148:151], v11 offset:2048
    v_mfma_f32_16x16x32_bf16 v[92:95], v[172:175], v[140:143], v[92:95]
    ds_read_b128 v[152:155], v11 offset:4096
    v_mfma_f32_16x16x32_bf16 v[96:99], v[176:179], v[128:131], v[96:99]
    ds_read_b128 v[156:159], v11 offset:6144
    v_mfma_f32_16x16x32_bf16 v[100:103], v[176:179], v[132:135], v[100:103]
    ds_read_b64_tr_b16 v[164:165], v15 offset:6176
    v_mfma_f32_16x16x32_bf16 v[104:107], v[176:179], v[136:139], v[104:107]
    ds_read_b64_tr_b16 v[166:167], v15 offset:6944
    s_mov_b32 s31, 0
    v_mfma_f32_16x16x32_bf16 v[108:111], v[176:179], v[140:143], v[108:111]
    ds_read_b64_tr_b16 v[168:169], v14 offset:6208
    v_mfma_f32_16x16x32_bf16 v[112:115], v[180:183], v[128:131], v[112:115]
    ds_read_b64_tr_b16 v[170:171], v14 offset:6976
    v_mfma_f32_16x16x32_bf16 v[116:119], v[180:183], v[132:135], v[116:119]
    v_mfma_f32_16x16x32_bf16 v[120:123], v[180:183], v[136:139], v[120:123]
    v_mfma_f32_16x16x32_bf16 v[124:127], v[180:183], v[140:143], v[124:127]
    s_waitcnt lgkmcnt(0)
    v_mfma_f32_16x16x32_bf16 v[32:35], v[160:163], v[144:147], v[32:35]
    ds_read_b64_tr_b16 v[172:173], v14 offset:18432
    buffer_load_dwordx2 v[28:29], v30, s[20:23], 0 offen sc1
    v_mfma_f32_16x16x32_bf16 v[36:39], v[160:163], v[148:151], v[36:39]
    ds_read_b64_tr_b16 v[174:175], v14 offset:19200
    v_mfma_f32_16x16x32_bf16 v[40:43], v[160:163], v[152:155], v[40:43]
    ds_read_b64_tr_b16 v[176:177], v15 offset:18464
    v_mfma_f32_16x16x32_bf16 v[44:47], v[160:163], v[156:159], v[44:47]
    ds_read_b64_tr_b16 v[178:179], v15 offset:19232
    v_mfma_f32_16x16x32_bf16 v[48:51], v[164:167], v[144:147], v[48:51]
    ds_read_b64_tr_b16 v[180:181], v14 offset:18496
    v_mfma_f32_16x16x32_bf16 v[52:55], v[164:167], v[148:151], v[52:55]
    ds_read_b64_tr_b16 v[182:183], v14 offset:19264
    v_mfma_f32_16x16x32_bf16 v[56:59], v[164:167], v[152:155], v[56:59]
    v_mfma_f32_16x16x32_bf16 v[60:63], v[164:167], v[156:159], v[60:63]
    v_mfma_f32_16x16x32_bf16 v[64:67], v[168:171], v[144:147], v[64:67]
    v_mfma_f32_16x16x32_bf16 v[68:71], v[168:171], v[148:151], v[68:71]
    v_mfma_f32_16x16x32_bf16 v[72:75], v[168:171], v[152:155], v[72:75]
    v_mfma_f32_16x16x32_bf16 v[76:79], v[168:171], v[156:159], v[76:79]
    s_waitcnt lgkmcnt(0)
    s_barrier
    s_cmp_eq_u32 s32, 6
    s_cbranch_scc0 GUP_NG
    s_waitcnt vmcnt(1)
    v_subrev_u32 v16, s82, v254
    v_subrev_u32 v16, 1, v16
    v_xor_b32 v17, s83, v255
    v_cmp_ne_u32 s[74:75], 0, v17
    v_cmp_lt_u32 vcc, 2, v16
    s_nop 0
    s_or_b64 vcc, vcc, s[74:75]
    s_cbranch_vccz GUP_PS_OK
    s_mov_b32 s81, 0
GUP_PS_SP:
    buffer_load_dwordx2 v[254:255], v31, s[20:23], 0 offen sc1
    s_waitcnt vmcnt(0)
    v_subrev_u32 v16, s82, v254
    v_subrev_u32 v16, 1, v16
    v_xor_b32 v17, s83, v255
    v_cmp_ne_u32 s[74:75], 0, v17
    v_cmp_lt_u32 vcc, 2, v16
    s_nop 0
    s_or_b64 vcc, vcc, s[74:75]
    s_add_u32 s81, s81, 1
    s_cmp_ge_u32 s81, 200000
    s_cbranch_scc1 GUP_PS_OK
    s_cbranch_vccz GUP_PS_OK
    s_sleep 2
    s_branch GUP_PS_SP
GUP_PS_OK:
    v_lshlrev_b32 v16, 4, v0
    s_mul_i32 s45, s36, 6144
    s_add_u32 s45, s45, 65536
    s_add_u32 s46, s45, 3072
    s_mov_b32 exec_hi, 0xffff
    buffer_load_dwordx4 v[184:187], v16, s[20:23], s45 offen offset:0 sc1
    buffer_load_dwordx4 v[188:191], v16, s[20:23], s45 offen offset:768 sc1
    buffer_load_dwordx4 v[192:195], v16, s[20:23], s45 offen offset:1536 sc1
    buffer_load_dwordx4 v[196:199], v16, s[20:23], s45 offen offset:2304 sc1
    buffer_load_dwordx4 v[200:203], v16, s[20:23], s46 offen offset:0 sc1
    buffer_load_dwordx4 v[204:207], v16, s[20:23], s46 offen offset:768 sc1
    buffer_load_dwordx4 v[208:211], v16, s[20:23], s46 offen offset:1536 sc1
    buffer_load_dwordx4 v[212:215], v16, s[20:23], s46 offen offset:2304 sc1
    s_mov_b64 exec, -1
GUP_NG:
    v_mfma_f32_16x16x32_bf16 v[80:83], v[172:175], v[144:147], v[80:83]
    ds_read_b128 v[128:131], v10 offset:32768
    ds_read_b64_tr_b16 v[160:161], v14 offset:24576
    v_mfma_f32_16x16x32_bf16 v[84:87], v[172:175], v[148:151], v[84:87]
    ds_read_b64_tr_b16 v[162:163], v14 offset:25344
    v_mfma_f32_16x16x32_bf16 v[88:91], v[172:175], v[152:155], v[88:91]
    ds_read_b128 v[132:135], v10 offset:34816
    v_mfma_f32_16x16x32_bf16 v[92:95], v[172:175], v[156:159], v[92:95]
    ds_read_b128 v[136:139], v10 offset:36864
    v_mfma_f32_16x16x32_bf16 v[96:99], v[176:179], v[144:147], v[96:99]
    ds_read_b128 v[140:143], v10 offset:38912
    v_mfma_f32_16x16x32_bf16 v[100:103], v[176:179], v[148:151], v[100:103]
    ds_read_b64_tr_b16 v[164:165], v15 offset:24608
    v_mfma_f32_16x16x32_bf16 v[104:107], v[176:179], v[152:155], v[104:107]
    ds_read_b64_tr_b16 v[166:167], v15 offset:25376
    v_mfma_f32_16x16x32_bf16 v[108:111], v[176:179], v[156:159], v[108:111]
    ds_read_b64_tr_b16 v[168:169], v14 offset:24640
    v_mfma_f32_16x16x32_bf16 v[112:115], v[180:183], v[144:147], v[112:115]
    ds_read_b64_tr_b16 v[170:171], v14 offset:25408
    v_mfma_f32_16x16x32_bf16 v[116:119], v[180:183], v[148:151], v[116:119]
    v_mfma_f32_16x16x32_bf16 v[120:123], v[180:183], v[152:155], v[120:123]
    v_mfma_f32_16x16x32_bf16 v[124:127], v[180:183], v[156:159], v[124:127]
    s_waitcnt lgkmcnt(0)
    v_mfma_f32_16x16x32_bf16 v[32:35], v[160:163], v[128:131], v[32:35]
    ds_read_b64_tr_b16 v[172:173], v14 offset:36864
    v_mfma_f32_16x16x32_bf16 v[36:39], v[160:163], v[132:135], v[36:39]
    ds_read_b64_tr_b16 v[174:175], v14 offset:37632
    v_mfma_f32_16x16x32_bf16 v[40:43], v[160:163], v[136:139], v[40:43]
    ds_read_b64_tr_b16 v[176:177], v15 offset:36896
    v_mfma_f32_16x16x32_bf16 v[44:47], v[160:163], v[140:143], v[44:47]
    ds_read_b64_tr_b16 v[178:179], v15 offset:37664
    v_mfma_f32_16x16x32_bf16 v[48:51], v[164:167], v[128:131], v[48:51]
    ds_read_b64_tr_b16 v[180:181], v14 offset:36928
    v_mfma_f32_16x16x32_bf16 v[52:55], v[164:167], v[132:135], v[52:55]
    ds_read_b64_tr_b16 v[182:183], v14 offset:37696
    v_mfma_f32_16x16x32_bf16 v[56:59], v[164:167], v[136:139], v[56:59]
    v_mfma_f32_16x16x32_bf16 v[60:63], v[164:167], v[140:143], v[60:63]
    v_mfma_f32_16x16x32_bf16 v[64:67], v[168:171], v[128:131], v[64:67]
    v_mfma_f32_16x16x32_bf16 v[68:71], v[168:171], v[132:135], v[68:71]
    v_mfma_f32_16x16x32_bf16 v[72:75], v[168:171], v[136:139], v[72:75]
    v_mfma_f32_16x16x32_bf16 v[76:79], v[168:171], v[140:143], v[76:79]
    s_waitcnt lgkmcnt(0)
    v_mfma_f32_16x16x32_bf16 v[80:83], v[172:175], v[128:131], v[80:83]
    ds_read_b128 v[144:147], v11 offset:32768
    ds_read_b64_tr_b16 v[160:161], v14 offset:30720
    v_mfma_f32_16x16x32_bf16 v[84:87], v[172:175], v[132:135], v[84:87]
    ds_read_b64_tr_b16 v[162:163], v14 offset:31488
    v_mfma_f32_16x16x32_bf16 v[88:91], v[172:175], v[136:139], v[88:91]
    ds_read_b128 v[148:151], v11 offset:34816
    v_mfma_f32_16x16x32_bf16 v[92:95], v[172:175], v[140:143], v[92:95]
    ds_read_b128 v[152:155], v11 offset:36864
    v_mfma_f32_16x16x32_bf16 v[96:99], v[176:179], v[128:131], v[96:99]
    ds_read_b128 v[156:159], v11 offset:38912
    v_mfma_f32_16x16x32_bf16 v[100:103], v[176:179], v[132:135], v[100:103]
    ds_read_b64_tr_b16 v[164:165], v15 offset:30752
    v_mfma_f32_16x16x32_bf16 v[104:107], v[176:179], v[136:139], v[104:107]
    ds_read_b64_tr_b16 v[166:167], v15 offset:31520
    v_mfma_f32_16x16x32_bf16 v[108:111], v[176:179], v[140:143], v[108:111]
    ds_read_b64_tr_b16 v[168:169], v14 offset:30784
    v_mfma_f32_16x16x32_bf16 v[112:115], v[180:183], v[128:131], v[112:115]
    ds_read_b64_tr_b16 v[170:171], v14 offset:31552
    v_mfma_f32_16x16x32_bf16 v[116:119], v[180:183], v[132:135], v[116:119]
    v_mfma_f32_16x16x32_bf16 v[120:123], v[180:183], v[136:139], v[120:123]
    v_mfma_f32_16x16x32_bf16 v[124:127], v[180:183], v[140:143], v[124:127]
    s_waitcnt lgkmcnt(0)
    v_mfma_f32_16x16x32_bf16 v[32:35], v[160:163], v[144:147], v[32:35]
    ds_read_b64_tr_b16 v[172:173], v14 offset:43008
    v_mfma_f32_16x16x32_bf16 v[36:39], v[160:163], v[148:151], v[36:39]
    ds_read_b64_tr_b16 v[174:175], v14 offset:43776
    v_mfma_f32_16x16x32_bf16 v[40:43], v[160:163], v[152:155], v[40:43]
    ds_read_b64_tr_b16 v[176:177], v15 offset:43040
    v_mfma_f32_16x16x32_bf16 v[44:47], v[160:163], v[156:159], v[44:47]
    ds_read_b64_tr_b16 v[178:179], v15 offset:43808
    v_mfma_f32_16x16x32_bf16 v[48:51], v[164:167], v[144:147], v[48:51]
    ds_read_b64_tr_b16 v[180:181], v14 offset:43072
    v_mfma_f32_16x16x32_bf16 v[52:55], v[164:167], v[148:151], v[52:55]
    ds_read_b64_tr_b16 v[182:183], v14 offset:43840
    v_mfma_f32_16x16x32_bf16 v[56:59], v[164:167], v[152:155], v[56:59]
    v_mfma_f32_16x16x32_bf16 v[60:63], v[164:167], v[156:159], v[60:63]
    v_mfma_f32_16x16x32_bf16 v[64:67], v[168:171], v[144:147], v[64:67]
    v_mfma_f32_16x16x32_bf16 v[68:71], v[168:171], v[148:151], v[68:71]
    v_mfma_f32_16x16x32_bf16 v[72:75], v[168:171], v[152:155], v[72:75]
    v_mfma_f32_16x16x32_bf16 v[76:79], v[168:171], v[156:159], v[76:79]
    s_waitcnt lgkmcnt(0)
    s_barrier
    s_lshl_b32 s45, s33, 8
    s_lshl_b32 s46, s37, 6
    s_add_u32 s45, s45, s46
    s_lshl_b32 s45, s45, 3
    s_add_u32 s45, s45, 32768
    v_and_b32 v16, 15, v0
    v_lshlrev_b32 v16, 3, v16
    buffer_load_dwordx2 v[244:245], v16, s[20:23], s45 offen offset:0 sc1
    buffer_load_dwordx2 v[246:247], v16, s[20:23], s45 offen offset:128 sc1
    buffer_load_dwordx2 v[248:249], v16, s[20:23], s45 offen offset:256 sc1
    buffer_load_dwordx2 v[250:251], v16, s[20:23], s45 offen offset:384 sc1
    s_cmp_eq_u32 s32, 6
    s_cbranch_scc0 GUP_NG2
    s_waitcnt vmcnt(4)
    v_lshlrev_b32 v16, 4, v0
    v_add_u32 v16, 163072, v16
    v_pk_add_f32 v[184:185], v[184:185], v[188:189]
    v_pk_add_f32 v[186:187], v[186:187], v[190:191]
    v_pk_add_f32 v[184:185], v[184:185], v[192:193]
    v_pk_add_f32 v[186:187], v[186:187], v[194:195]
    v_pk_add_f32 v[184:185], v[184:185], v[196:197]
    v_pk_add_f32 v[186:187], v[186:187], v[198:199]
    v_pk_add_f32 v[184:185], v[184:185], v[200:201]
    v_pk_add_f32 v[186:187], v[186:187], v[202:203]
    v_pk_add_f32 v[184:185], v[184:185], v[204:205]
    v_pk_add_f32 v[186:187], v[186:187], v[206:207]
    v_pk_add_f32 v[184:185], v[184:185], v[208:209]
    v_pk_add_f32 v[186:187], v[186:187], v[210:211]
    v_pk_add_f32 v[184:185], v[184:185], v[212:213]
    v_pk_add_f32 v[186:187], v[186:187], v[214:215]
    s_mov_b32 exec_hi, 0xffff
    ds_write_b128 v16, v[184:187]
    s_mov_b64 exec, -1
GUP_NG2:
    v_mfma_f32_16x16x32_bf16 v[80:83], v[172:175], v[144:147], v[80:83]
    ds_read_b128 v[128:131], v12 offset:0
    ds_read_b64_tr_b16 v[160:161], v14 offset:0
    v_mfma_f32_16x16x32_bf16 v[84:87], v[172:175], v[148:151], v[84:87]
    ds_read_b64_tr_b16 v[162:163], v14 offset:768
    v_mfma_f32_16x16x32_bf16 v[88:91], v[172:175], v[152:155], v[88:91]
    ds_read_b128 v[132:135], v12 offset:2048
    v_mfma_f32_16x16x32_bf16 v[92:95], v[172:175], v[156:159], v[92:95]
    ds_read_b128 v[136:139], v12 offset:4096
    v_mfma_f32_16x16x32_bf16 v[96:99], v[176:179], v[144:147], v[96:99]
    ds_read_b128 v[140:143], v12 offset:6144
    v_mfma_f32_16x16x32_bf16 v[100:103], v[176:179], v[148:151], v[100:103]
    ds_read_b64_tr_b16 v[164:165], v15 offset:32
    v_mfma_f32_16x16x32_bf16 v[104:107], v[176:179], v[152:155], v[104:107]
    ds_read_b64_tr_b16 v[166:167], v15 offset:800
    v_mfma_f32_16x16x32_bf16 v[108:111], v[176:179], v[156:159], v[108:111]
    ds_read_b64_tr_b16 v[168:169], v14 offset:64
    v_mfma_f32_16x16x32_bf16 v[112:115], v[180:183], v[144:147], v[112:115]
    ds_read_b64_tr_b16 v[170:171], v14 offset:832
    v_mfma_f32_16x16x32_bf16 v[116:119], v[180:183], v[148:151], v[116:119]
    v_mfma_f32_16x16x32_bf16 v[120:123], v[180:183], v[152:155], v[120:123]
    v_mfma_f32_16x16x32_bf16 v[124:127], v[180:183], v[156:159], v[124:127]
    s_waitcnt lgkmcnt(0)
    v_mfma_f32_16x16x32_bf16 v[32:35], v[160:163], v[128:131], v[32:35]
    ds_read_b64_tr_b16 v[172:173], v14 offset:12288
    s_waitcnt vmcnt(4)
    v_mfma_f32_16x16x32_bf16 v[36:39], v[160:163], v[132:135], v[36:39]
    ds_read_b64_tr_b16 v[174:175], v14 offset:13056
    v_mfma_f32_16x16x32_bf16 v[40:43], v[160:163], v[136:139], v[40:43]
    ds_read_b64_tr_b16 v[176:177], v15 offset:12320
    v_subrev_u32 v16, s82, v28
    v_mfma_f32_16x16x32_bf16 v[44:47], v[160:163], v[140:143], v[44:47]
    ds_read_b64_tr_b16 v[178:179], v15 offset:13088
    v_mfma_f32_16x16x32_bf16 v[48:51], v[164:167], v[128:131], v[48:51]
    ds_read_b64_tr_b16 v[180:181], v14 offset:12352
    v_subrev_u32 v16, 1, v16
    v_mfma_f32_16x16x32_bf16 v[52:55], v[164:167], v[132:135], v[52:55]
    ds_read_b64_tr_b16 v[182:183], v14 offset:13120
    v_mfma_f32_16x16x32_bf16 v[56:59], v[164:167], v[136:139], v[56:59]
    v_mfma_f32_16x16x32_bf16 v[60:63], v[164:167], v[140:143], v[60:63]
    v_xor_b32 v17, s83, v29
    v_mfma_f32_16x16x32_bf16 v[64:67], v[168:171], v[128:131], v[64:67]
    v_mfma_f32_16x16x32_bf16 v[68:71], v[168:171], v[132:135], v[68:71]
    v_cmp_ne_u32 s[74:75], 0, v17
    v_cmp_lt_u32 vcc, 2, v16
    s_nop 1
    s_or_b64 vcc, vcc, s[74:75]
    s_cmp_eq_u64 vcc, 0
    s_cselect_b32 s31, 1, s31
    v_mfma_f32_16x16x32_bf16 v[72:75], v[168:171], v[136:139], v[72:75]
    v_mfma_f32_16x16x32_bf16 v[76:79], v[168:171], v[140:143], v[76:79]
    s_waitcnt lgkmcnt(0)
    v_mfma_f32_16x16x32_bf16 v[80:83], v[172:175], v[128:131], v[80:83]
    ds_read_b128 v[144:147], v13 offset:0
    ds_read_b64_tr_b16 v[160:161], v14 offset:6144
    v_mfma_f32_16x16x32_bf16 v[84:87], v[172:175], v[132:135], v[84:87]
    ds_read_b64_tr_b16 v[162:163], v14 offset:6912
    v_mfma_f32_16x16x32_bf16 v[88:91], v[172:175], v[136:139], v[88:91]
    ds_read_b128 v[148:151], v13 offset:2048
    v_mfma_f32_16x16x32_bf16 v[92:95], v[172:175], v[140:143], v[92:95]
    ds_read_b128 v[152:155], v13 offset:4096
    v_mfma_f32_16x16x32_bf16 v[96:99], v[176:179], v[128:131], v[96:99]
    ds_read_b128 v[156:159], v13 offset:6144
    v_mfma_f32_16x16x32_bf16 v[100:103], v[176:179], v[132:135], v[100:103]
    ds_read_b64_tr_b16 v[164:165], v15 offset:6176
    v_mfma_f32_16x16x32_bf16 v[104:107], v[176:179], v[136:139], v[104:107]
    ds_read_b64_tr_b16 v[166:167], v15 offset:6944
    v_mfma_f32_16x16x32_bf16 v[108:111], v[176:179], v[140:143], v[108:111]
    ds_read_b64_tr_b16 v[168:169], v14 offset:6208
    v_mfma_f32_16x16x32_bf16 v[112:115], v[180:183], v[128:131], v[112:115]
    ds_read_b64_tr_b16 v[170:171], v14 offset:6976
    v_mfma_f32_16x16x32_bf16 v[116:119], v[180:183], v[132:135], v[116:119]
    v_mfma_f32_16x16x32_bf16 v[120:123], v[180:183], v[136:139], v[120:123]
    v_mfma_f32_16x16x32_bf16 v[124:127], v[180:183], v[140:143], v[124:127]
    s_waitcnt lgkmcnt(0)
    v_mfma_f32_16x16x32_bf16 v[32:35], v[160:163], v[144:147], v[32:35]
    ds_read_b64_tr_b16 v[172:173], v14 offset:18432
    v_mfma_f32_16x16x32_bf16 v[36:39], v[160:163], v[148:151], v[36:39]
    ds_read_b64_tr_b16 v[174:175], v14 offset:19200
    v_mfma_f32_16x16x32_bf16 v[40:43], v[160:163], v[152:155], v[40:43]
    ds_read_b64_tr_b16 v[176:177], v15 offset:18464
    v_mfma_f32_16x16x32_bf16 v[44:47], v[160:163], v[156:159], v[44:47]
    ds_read_b64_tr_b16 v[178:179], v15 offset:19232
    v_mfma_f32_16x16x32_bf16 v[48:51], v[164:167], v[144:147], v[48:51]
    ds_read_b64_tr_b16 v[180:181], v14 offset:18496
    v_mfma_f32_16x16x32_bf16 v[52:55], v[164:167], v[148:151], v[52:55]
    ds_read_b64_tr_b16 v[182:183], v14 offset:19264
    v_mfma_f32_16x16x32_bf16 v[56:59], v[164:167], v[152:155], v[56:59]
    v_mfma_f32_16x16x32_bf16 v[60:63], v[164:167], v[156:159], v[60:63]
    v_mfma_f32_16x16x32_bf16 v[64:67], v[168:171], v[144:147], v[64:67]
    v_mfma_f32_16x16x32_bf16 v[68:71], v[168:171], v[148:151], v[68:71]
    v_mfma_f32_16x16x32_bf16 v[72:75], v[168:171], v[152:155], v[72:75]
    v_mfma_f32_16x16x32_bf16 v[76:79], v[168:171], v[156:159], v[76:79]
    s_waitcnt lgkmcnt(0)
    s_barrier
    v_mfma_f32_16x16x32_bf16 v[80:83], v[172:175], v[144:147], v[80:83]
    ds_read_b128 v[128:131], v10 offset:0
    ds_read_b64_tr_b16 v[160:161], v14 offset:24576
    buffer_load_dwordx2 v[28:29], v30, s[20:23], 0 offen sc1
    v_mfma_f32_16x16x32_bf16 v[84:87], v[172:175], v[148:151], v[84:87]
    ds_read_b64_tr_b16 v[162:163], v14 offset:25344
    v_mfma_f32_16x16x32_bf16 v[88:91], v[172:175], v[152:155], v[88:91]
    ds_read_b128 v[132:135], v10 offset:2048
    v_mfma_f32_16x16x32_bf16 v[92:95], v[172:175], v[156:159], v[92:95]
    ds_read_b128 v[136:139], v10 offset:4096
    v_mfma_f32_16x16x32_bf16 v[96:99], v[176:179], v[144:147], v[96:99]
    ds_read_b128 v[140:143], v10 offset:6144
    v_mfma_f32_16x16x32_bf16 v[100:103], v[176:179], v[148:151], v[100:103]
    ds_read_b64_tr_b16 v[164:165], v15 offset:24608
    v_mfma_f32_16x16x32_bf16 v[104:107], v[176:179], v[152:155], v[104:107]
    ds_read_b64_tr_b16 v[166:167], v15 offset:25376
    v_mfma_f32_16x16x32_bf16 v[108:111], v[176:179], v[156:159], v[108:111]
    ds_read_b64_tr_b16 v[168:169], v14 offset:24640
    v_mfma_f32_16x16x32_bf16 v[112:115], v[180:183], v[144:147], v[112:115]
    ds_read_b64_tr_b16 v[170:171], v14 offset:25408
    v_mfma_f32_16x16x32_bf16 v[116:119], v[180:183], v[148:151], v[116:119]
    v_mfma_f32_16x16x32_bf16 v[120:123], v[180:183], v[152:155], v[120:123]
    v_mfma_f32_16x16x32_bf16 v[124:127], v[180:183], v[156:159], v[124:127]
    s_waitcnt lgkmcnt(0)
    v_mfma_f32_16x16x32_bf16 v[32:35], v[160:163], v[128:131], v[32:35]
    ds_read_b64_tr_b16 v[172:173], v14 offset:36864
    s_cmp_eq_u32 s31, 1
    s_cbranch_scc0 GUP_B2_0
    s_add_u32 s48, s28, 10240
    s_add_u32 m0, s30, 0
    s_nop 0
    buffer_load_dwordx4 v8, s[20:23], s48 offen offset:0 sc1 lds
    s_add_u32 m0, s30, 0
    s_nop 0
    buffer_load_dwordx4 v8, s[20:23], s48 offen offset:1024 sc1 lds
    s_add_u32 m0, s30, 0
    s_nop 0
    buffer_load_dwordx4 v8, s[20:23], s48 offen offset:2048 sc1 lds
    GUP_B2_0:
    v_mfma_f32_16x16x32_bf16 v[36:39], v[160:163], v[132:135], v[36:39]
    ds_read_b64_tr_b16 v[174:175], v14 offset:37632
    v_mfma_f32_16x16x32_bf16 v[40:43], v[160:163], v[136:139], v[40:43]
    ds_read_b64_tr_b16 v[176:177], v15 offset:36896
    v_mfma_f32_16x16x32_bf16 v[44:47], v[160:163], v[140:143], v[44:47]
    ds_read_b64_tr_b16 v[178:179], v15 offset:37664
    v_mfma_f32_16x16x32_bf16 v[48:51], v[164:167], v[128:131], v[48:51]
    ds_read_b64_tr_b16 v[180:181], v14 offset:36928
    v_mfma_f32_16x16x32_bf16 v[52:55], v[164:167], v[132:135], v[52:55]
    ds_read_b64_tr_b16 v[182:183], v14 offset:37696
    v_mfma_f32_16x16x32_bf16 v[56:59], v[164:167], v[136:139], v[56:59]
    s_cmp_eq_u32 s31, 1
    s_cbranch_scc0 GUP_B2_3
    s_add_u32 m0, s30, 0
    s_nop 0
    buffer_load_dwordx4 v8, s[20:23], s48 offen offset:3072 sc1 lds
    s_add_u32 m0, s30, 4096
    s_nop 0
    buffer_load_dwordx4 v9, s[20:23], s48 offen offset:0 sc1 lds
    GUP_B2_3:
    v_mfma_f32_16x16x32_bf16 v[60:63], v[164:167], v[140:143], v[60:63]
    v_mfma_f32_16x16x32_bf16 v[64:67], v[168:171], v[128:131], v[64:67]
    v_mfma_f32_16x16x32_bf16 v[68:71], v[168:171], v[132:135], v[68:71]
    v_mfma_f32_16x16x32_bf16 v[72:75], v[168:171], v[136:139], v[72:75]
    v_mfma_f32_16x16x32_bf16 v[76:79], v[168:171], v[140:143], v[76:79]
    s_waitcnt lgkmcnt(0)
    v_mfma_f32_16x16x32_bf16 v[80:83], v[172:175], v[128:131], v[80:83]
    ds_read_b128 v[144:147], v11 offset:0
    ds_read_b64_tr_b16 v[160:161], v14 offset:30720
    s_cmp_eq_u32 s31, 1
    s_cbranch_scc0 GUP_B3_0
    s_add_u32 s48, s28, 15360
    s_add_u32 m0, s30, 5120
    s_nop 0
    buffer_load_dwordx4 v8, s[20:23], s48 offen offset:0 sc1 lds
    s_add_u32 m0, s30, 5120
    s_nop 0
    buffer_load_dwordx4 v8, s[20:23], s48 offen offset:1024 sc1 lds
    s_add_u32 m0, s30, 5120
    s_nop 0
    buffer_load_dwordx4 v8, s[20:23], s48 offen offset:2048 sc1 lds
    GUP_B3_0:
    v_mfma_f32_16x16x32_bf16 v[84:87], v[172:175], v[132:135], v[84:87]
    ds_read_b64_tr_b16 v[162:163], v14 offset:31488
    v_mfma_f32_16x16x32_bf16 v[88:91], v[172:175], v[136:139], v[88:91]
    ds_read_b128 v[148:151], v11 offset:2048
    v_mfma_f32_16x16x32_bf16 v[92:95], v[172:175], v[140:143], v[92:95]
    ds_read_b128 v[152:155], v11 offset:4096
    v_mfma_f32_16x16x32_bf16 v[96:99], v[176:179], v[128:131], v[96:99]
    ds_read_b128 v[156:159], v11 offset:6144
    s_cmp_eq_u32 s31, 1
    s_cbranch_scc0 GUP_B3_3
    s_add_u32 m0, s30, 5120
    s_nop 0
    buffer_load_dwordx4 v8, s[20:23], s48 offen offset:3072 sc1 lds
    GUP_B3_3:
    v_mfma_f32_16x16x32_bf16 v[100:103], v[176:179], v[132:135], v[100:103]
    ds_read_b64_tr_b16 v[164:165], v15 offset:30752
    v_mfma_f32_16x16x32_bf16 v[104:107], v[176:179], v[136:139], v[104:107]
    ds_read_b64_tr_b16 v[166:167], v15 offset:31520
    v_mfma_f32_16x16x32_bf16 v[108:111], v[176:179], v[140:143], v[108:111]
    ds_read_b64_tr_b16 v[168:169], v14 offset:30784
    v_mfma_f32_16x16x32_bf16 v[112:115], v[180:183], v[128:131], v[112:115]
    ds_read_b64_tr_b16 v[170:171], v14 offset:31552
    s_cmp_eq_u32 s32, 7
    s_cbranch_scc1 GUP_W7
    s_cmp_eq_u32 s31, 1
    s_cbranch_scc0 GUP_B3_4
    s_add_u32 m0, s30, 9216
    s_nop 0
    buffer_load_dwordx4 v9, s[20:23], s48 offen offset:0 sc1 lds
    GUP_B3_4:
    GUP_W7:
    v_mfma_f32_16x16x32_bf16 v[116:119], v[180:183], v[132:135], v[116:119]
    v_mfma_f32_16x16x32_bf16 v[120:123], v[180:183], v[136:139], v[120:123]
    v_mfma_f32_16x16x32_bf16 v[124:127], v[180:183], v[140:143], v[124:127]
    s_waitcnt lgkmcnt(0)
    v_mfma_f32_16x16x32_bf16 v[32:35], v[160:163], v[144:147], v[32:35]
    ds_read_b64_tr_b16 v[172:173], v14 offset:43008
    s_cmp_eq_u32 s31, 1
    s_cbranch_scc0 GUP_B0_0
    s_add_u32 s48, s28, 0
    buffer_load_dwordx4 v[184:187], v8, s[20:23], s48 offen offset:0 sc1
    buffer_load_dwordx4 v[188:191], v8, s[20:23], s48 offen offset:1024 sc1
    buffer_load_dwordx4 v[192:195], v8, s[20:23], s48 offen offset:2048 sc1
    GUP_B0_0:
    v_mfma_f32_16x16x32_bf16 v[36:39], v[160:163], v[148:151], v[36:39]
    ds_read_b64_tr_b16 v[174:175], v14 offset:43776
    v_mfma_f32_16x16x32_bf16 v[40:43], v[160:163], v[152:155], v[40:43]
    ds_read_b64_tr_b16 v[176:177], v15 offset:43040
    v_mfma_f32_16x16x32_bf16 v[44:47], v[160:163], v[156:159], v[44:47]
    ds_read_b64_tr_b16 v[178:179], v15 offset:43808
    v_mfma_f32_16x16x32_bf16 v[48:51], v[164:167], v[144:147], v[48:51]
    ds_read_b64_tr_b16 v[180:181], v14 offset:43072
    v_mfma_f32_16x16x32_bf16 v[52:55], v[164:167], v[148:151], v[52:55]
    ds_read_b64_tr_b16 v[182:183], v14 offset:43840
    v_mfma_f32_16x16x32_bf16 v[56:59], v[164:167], v[152:155], v[56:59]
    s_cmp_eq_u32 s31, 1
    s_cbranch_scc0 GUP_B0_3
    buffer_load_dwordx4 v[196:199], v8, s[20:23], s48 offen offset:3072 sc1
    buffer_load_dwordx4 v[200:203], v9, s[20:23], s48 offen offset:0 sc1
    GUP_B0_3:
    v_mfma_f32_16x16x32_bf16 v[60:63], v[164:167], v[156:159], v[60:63]
    v_mfma_f32_16x16x32_bf16 v[64:67], v[168:171], v[144:147], v[64:67]
    v_mfma_f32_16x16x32_bf16 v[68:71], v[168:171], v[148:151], v[68:71]
    v_mfma_f32_16x16x32_bf16 v[72:75], v[168:171], v[152:155], v[72:75]
    v_mfma_f32_16x16x32_bf16 v[76:79], v[168:171], v[156:159], v[76:79]
    s_waitcnt lgkmcnt(0)
    v_mfma_f32_16x16x32_bf16 v[80:83], v[172:175], v[144:147], v[80:83]
    s_cmp_eq_u32 s31, 1
    s_cbranch_scc0 GUP_B1_0
    s_add_u32 s48, s28, 5120
    buffer_load_dwordx4 v[204:207], v8, s[20:23], s48 offen offset:0 sc1
    buffer_load_dwordx4 v[208:211], v8, s[20:23], s48 offen offset:1024 sc1
    buffer_load_dwordx4 v[212:215], v8, s[20:23], s48 offen offset:2048 sc1
    GUP_B1_0:
    v_mfma_f32_16x16x32_bf16 v[84:87], v[172:175], v[148:151], v[84:87]
    v_mfma_f32_16x16x32_bf16 v[88:91], v[172:175], v[152:155], v[88:91]
    v_mfma_f32_16x16x32_bf16 v[92:95], v[172:175], v[156:159], v[92:95]
    v_mfma_f32_16x16x32_bf16 v[96:99], v[176:179], v[144:147], v[96:99]
    v_mfma_f32_16x16x32_bf16 v[100:103], v[176:179], v[148:151], v[100:103]
    v_mfma_f32_16x16x32_bf16 v[104:107], v[176:179], v[152:155], v[104:107]
    s_cmp_eq_u32 s31, 1
    s_cbranch_scc0 GUP_B1_3
    buffer_load_dwordx4 v[216:219], v8, s[20:23], s48 offen offset:3072 sc1
    buffer_load_dwordx4 v[220:223], v9, s[20:23], s48 offen offset:0 sc1
    GUP_B1_3:
    v_mfma_f32_16x16x32_bf16 v[108:111], v[176:179], v[156:159], v[108:111]
    v_mfma_f32_16x16x32_bf16 v[112:115], v[180:183], v[144:147], v[112:115]
    v_mfma_f32_16x16x32_bf16 v[116:119], v[180:183], v[148:151], v[116:119]
    v_mfma_f32_16x16x32_bf16 v[120:123], v[180:183], v[152:155], v[120:123]
    v_mfma_f32_16x16x32_bf16 v[124:127], v[180:183], v[156:159], v[124:127]
    s_cmp_eq_u32 s31, 1
    s_cbranch_scc1 GUP_WB
    s_waitcnt vmcnt(0)
GUP_WB:
    s_waitcnt vmcnt(19)
GU_LOOPEND:
    s_nop 7
    v_lshrrev_b32 v16, 4, v0
    v_mul_u32_u24 v16, 16, v16
    s_mul_i32 s45, s38, 192
    s_add_u32 s45, s45, 163072
    v_add_u32 v16, s45, v16
    ds_read_b128 v[144:147], v16 offset:0
    ds_read_b128 v[148:151], v16 offset:64
    ds_read_b128 v[152:155], v16 offset:128
    ds_read_b128 v[156:159], v16 offset:384
    ds_read_b128 v[160:163], v16 offset:448
    ds_read_b128 v[164:167], v16 offset:512
    s_cmp_eq_u32 s31, 1
    s_cbranch_scc0 GU_NO3
    v_subrev_u32 v20, s82, v28
    v_subrev_u32 v20, 2, v20
    v_xor_b32 v21, s83, v29
    v_cmp_ne_u32 s[74:75], 0, v21
    v_cmp_lt_u32 vcc, 1, v20
    s_nop 1
    s_or_b64 vcc, vcc, s[74:75]
    s_cmp_eq_u64 vcc, 0
    s_cselect_b32 s31, 3, s31
GU_NO3:
    s_waitcnt lgkmcnt(0)
    v_rcp_f32 v136, v245
    v_mul_f32 v128, v245, v245
    v_rcp_f32 v138, v247
    v_mul_f32 v130, v247, v247
    v_rcp_f32 v140, v249
    v_mul_f32 v132, v249, v249
    v_rcp_f32 v142, v251
    v_mul_f32 v134, v251, v251
    v_mul_f32 v136, 3216550459, v136
    v_mul_f32 v138, 3216550459, v138
    v_mul_f32 v140, 3216550459, v140
    v_mul_f32 v142, 3216550459, v142
    v_lshlrev_b32 v16, 4, v0
    v_lshrrev_b32 v17, 5, v0
    v_mul_u32_u24 v17, 54784, v17
    v_add_u32 v17, v17, v16
    s_lshl_b32 s45, s38, 9
    v_add_u32 v17, s45, v17
    s_lshl_b32 s42, s33, 4
    s_lshl_b32 s46, s37, 2
    s_add_u32 s42, s42, s46
    s_mul_i32 s42, s42, 54
    s_mul_i32 s46, s34, 3
    s_add_u32 s42, s42, s46
    s_lshl_b32 s42, s42, 10
    s_add_u32 s42, s42, 16777216
    s_add_u32 s43, s42, 1024
    s_lshl_b32 s47, s38, 11
    s_add_u32 s42, s42, s47
    v_pk_fma_f32 v[32:33], v[244:245], v[144:145], v[32:33] op_sel:[0,0,0] op_sel_hi:[0,1,1] neg_lo:[1,0,0] neg_hi:[1,0,0]
    v_pk_fma_f32 v[34:35], v[244:245], v[146:147], v[34:35] op_sel:[0,0,0] op_sel_hi:[0,1,1] neg_lo:[1,0,0] neg_hi:[1,0,0]
    v_pk_fma_f32 v[48:49], v[244:245], v[148:149], v[48:49] op_sel:[0,0,0] op_sel_hi:[0,1,1] neg_lo:[1,0,0] neg_hi:[1,0,0]
    v_pk_fma_f32 v[50:51], v[244:245], v[150:151], v[50:51] op_sel:[0,0,0] op_sel_hi:[0,1,1] neg_lo:[1,0,0] neg_hi:[1,0,0]
    v_pk_mul_f32 v[168:169], v[32:33], v[136:137] op_sel:[0,0] op_sel_hi:[1,0]
    v_pk_mul_f32 v[170:171], v[34:35], v[136:137] op_sel:[0,0] op_sel_hi:[1,0]
    v_pk_mul_f32 v[172:173], v[48:49], v[136:137] op_sel:[0,0] op_sel_hi:[1,0]
    v_pk_mul_f32 v[174:175], v[50:51], v[136:137] op_sel:[0,0] op_sel_hi:[1,0]
    v_exp_f32 v168, v168
    v_exp_f32 v169, v169
    v_pk_fma_f32 v[80:81], v[244:245], v[156:157], v[80:81] op_sel:[0,0,0] op_sel_hi:[0,1,1] neg_lo:[1,0,0] neg_hi:[1,0,0]
    v_exp_f32 v170, v170
    v_exp_f32 v171, v171
    v_pk_fma_f32 v[82:83], v[244:245], v[158:159], v[82:83] op_sel:[0,0,0] op_sel_hi:[0,1,1] neg_lo:[1,0,0] neg_hi:[1,0,0]
    v_exp_f32 v172, v172
    v_exp_f32 v173, v173
    v_pk_fma_f32 v[96:97], v[244:245], v[160:161], v[96:97] op_sel:[0,0,0] op_sel_hi:[0,1,1] neg_lo:[1,0,0] neg_hi:[1,0,0]
    v_exp_f32 v174, v174
    v_exp_f32 v175, v175
    v_pk_fma_f32 v[98:99], v[244:245], v[162:163], v[98:99] op_sel:[0,0,0] op_sel_hi:[0,1,1] neg_lo:[1,0,0] neg_hi:[1,0,0]
    v_pk_fma_f32 v[168:169], v[168:169], v[128:129], v[128:129] op_sel:[0,0,0] op_sel_hi:[1,0,0]
    v_pk_fma_f32 v[170:171], v[170:171], v[128:129], v[128:129] op_sel:[0,0,0] op_sel_hi:[1,0,0]
    v_pk_fma_f32 v[172:173], v[172:173], v[128:129], v[128:129] op_sel:[0,0,0] op_sel_hi:[1,0,0]
    v_pk_fma_f32 v[174:175], v[174:175], v[128:129], v[128:129] op_sel:[0,0,0] op_sel_hi:[1,0,0]
    v_rcp_f32 v168, v168
    v_rcp_f32 v169, v169
    v_pk_mul_f32 v[32:33], v[32:33], v[80:81]
    v_rcp_f32 v170, v170
    v_rcp_f32 v171, v171
    v_pk_mul_f32 v[34:35], v[34:35], v[82:83]
    v_rcp_f32 v172, v172
    v_rcp_f32 v173, v173
    v_pk_mul_f32 v[48:49], v[48:49], v[96:97]
    v_rcp_f32 v174, v174
    v_rcp_f32 v175, v175
    v_pk_mul_f32 v[50:51], v[50:51], v[98:99]
    v_pk_mul_f32 v[32:33], v[32:33], v[168:169]
    v_pk_mul_f32 v[34:35], v[34:35], v[170:171]
    v_pk_mul_f32 v[48:49], v[48:49], v[172:173]
    v_pk_mul_f32 v[50:51], v[50:51], v[174:175]
    v_cvt_pk_bf16_f32 v176, v32, v33
    v_cvt_pk_bf16_f32 v177, v34, v35
    v_cvt_pk_bf16_f32 v178, v48, v49
    v_cvt_pk_bf16_f32 v179, v50, v51
    buffer_store_dwordx4 v[176:179], v16, s[20:23], s42 offen sc1
    s_add_u32 s42, s42, 55296
    s_cmp_eq_u32 s31, 3
    s_cbranch_scc0 GU_B4_0
    s_add_u32 s48, s28, 20480
    buffer_load_dwordx4 v[224:227], v8, s[20:23], s48 offen offset:0 sc1
    GU_B4_0:
    v_pk_fma_f32 v[36:37], v[246:247], v[144:145], v[36:37] op_sel:[0,0,0] op_sel_hi:[0,1,1] neg_lo:[1,0,0] neg_hi:[1,0,0]
    v_pk_fma_f32 v[38:39], v[246:247], v[146:147], v[38:39] op_sel:[0,0,0] op_sel_hi:[0,1,1] neg_lo:[1,0,0] neg_hi:[1,0,0]
    v_pk_fma_f32 v[52:53], v[246:247], v[148:149], v[52:53] op_sel:[0,0,0] op_sel_hi:[0,1,1] neg_lo:[1,0,0] neg_hi:[1,0,0]
    v_pk_fma_f32 v[54:55], v[246:247], v[150:151], v[54:55] op_sel:[0,0,0] op_sel_hi:[0,1,1] neg_lo:[1,0,0] neg_hi:[1,0,0]
    v_pk_mul_f32 v[168:169], v[36:37], v[138:139] op_sel:[0,0] op_sel_hi:[1,0]
    v_pk_mul_f32 v[170:171], v[38:39], v[138:139] op_sel:[0,0] op_sel_hi:[1,0]
    v_pk_mul_f32 v[172:173], v[52:53], v[138:139] op_sel:[0,0] op_sel_hi:[1,0]
    v_pk_mul_f32 v[174:175], v[54:55], v[138:139] op_sel:[0,0] op_sel_hi:[1,0]
    v_exp_f32 v168, v168
    v_exp_f32 v169, v169
    v_pk_fma_f32 v[84:85], v[246:247], v[156:157], v[84:85] op_sel:[0,0,0] op_sel_hi:[0,1,1] neg_lo:[1,0,0] neg_hi:[1,0,0]
    v_exp_f32 v170, v170
    v_exp_f32 v171, v171
    v_pk_fma_f32 v[86:87], v[246:247], v[158:159], v[86:87] op_sel:[0,0,0] op_sel_hi:[0,1,1] neg_lo:[1,0,0] neg_hi:[1,0,0]
    v_exp_f32 v172, v172
    v_exp_f32 v173, v173
    v_pk_fma_f32 v[100:101], v[246:247], v[160:161], v[100:101] op_sel:[0,0,0] op_sel_hi:[0,1,1] neg_lo:[1,0,0] neg_hi:[1,0,0]
    v_exp_f32 v174, v174
    v_exp_f32 v175, v175
    v_pk_fma_f32 v[102:103], v[246:247], v[162:163], v[102:103] op_sel:[0,0,0] op_sel_hi:[0,1,1] neg_lo:[1,0,0] neg_hi:[1,0,0]
    v_pk_fma_f32 v[168:169], v[168:169], v[130:131], v[130:131] op_sel:[0,0,0] op_sel_hi:[1,0,0]
    v_pk_fma_f32 v[170:171], v[170:171], v[130:131], v[130:131] op_sel:[0,0,0] op_sel_hi:[1,0,0]
    v_pk_fma_f32 v[172:173], v[172:173], v[130:131], v[130:131] op_sel:[0,0,0] op_sel_hi:[1,0,0]
    v_pk_fma_f32 v[174:175], v[174:175], v[130:131], v[130:131] op_sel:[0,0,0] op_sel_hi:[1,0,0]
    v_rcp_f32 v168, v168
    v_rcp_f32 v169, v169
    v_pk_mul_f32 v[36:37], v[36:37], v[84:85]
    v_rcp_f32 v170, v170
    v_rcp_f32 v171, v171
    v_pk_mul_f32 v[38:39], v[38:39], v[86:87]
    v_rcp_f32 v172, v172
    v_rcp_f32 v173, v173
    v_pk_mul_f32 v[52:53], v[52:53], v[100:101]
    v_rcp_f32 v174, v174
    v_rcp_f32 v175, v175
    v_pk_mul_f32 v[54:55], v[54:55], v[102:103]
    v_pk_mul_f32 v[36:37], v[36:37], v[168:169]
    v_pk_mul_f32 v[38:39], v[38:39], v[170:171]
    v_pk_mul_f32 v[52:53], v[52:53], v[172:173]
    v_pk_mul_f32 v[54:55], v[54:55], v[174:175]
    v_cvt_pk_bf16_f32 v180, v36, v37
    v_cvt_pk_bf16_f32 v181, v38, v39
    v_cvt_pk_bf16_f32 v182, v52, v53
    v_cvt_pk_bf16_f32 v183, v54, v55
    buffer_store_dwordx4 v[180:183], v16, s[20:23], s42 offen sc1
    s_add_u32 s42, s42, 55296
    s_cmp_eq_u32 s31, 3
    s_cbranch_scc0 GU_B4_1
    buffer_load_dwordx4 v[228:231], v8, s[20:23], s48 offen offset:1024 sc1
    GU_B4_1:
    v_pk_fma_f32 v[64:65], v[244:245], v[152:153], v[64:65] op_sel:[0,0,0] op_sel_hi:[0,1,1] neg_lo:[1,0,0] neg_hi:[1,0,0]
    v_pk_fma_f32 v[66:67], v[244:245], v[154:155], v[66:67] op_sel:[0,0,0] op_sel_hi:[0,1,1] neg_lo:[1,0,0] neg_hi:[1,0,0]
    v_pk_fma_f32 v[68:69], v[246:247], v[152:153], v[68:69] op_sel:[0,0,0] op_sel_hi:[0,1,1] neg_lo:[1,0,0] neg_hi:[1,0,0]
    v_pk_fma_f32 v[70:71], v[246:247], v[154:155], v[70:71] op_sel:[0,0,0] op_sel_hi:[0,1,1] neg_lo:[1,0,0] neg_hi:[1,0,0]
    v_pk_mul_f32 v[168:169], v[64:65], v[136:137] op_sel:[0,0] op_sel_hi:[1,0]
    v_pk_mul_f32 v[170:171], v[66:67], v[136:137] op_sel:[0,0] op_sel_hi:[1,0]
    v_pk_mul_f32 v[172:173], v[68:69], v[138:139] op_sel:[0,0] op_sel_hi:[1,0]
    v_pk_mul_f32 v[174:175], v[70:71], v[138:139] op_sel:[0,0] op_sel_hi:[1,0]
    v_exp_f32 v168, v168
    v_exp_f32 v169, v169
    v_pk_fma_f32 v[112:113], v[244:245], v[164:165], v[112:113] op_sel:[0,0,0] op_sel_hi:[0,1,1] neg_lo:[1,0,0] neg_hi:[1,0,0]
    v_exp_f32 v170, v170
    v_exp_f32 v171, v171
    v_pk_fma_f32 v[114:115], v[244:245], v[166:167], v[114:115] op_sel:[0,0,0] op_sel_hi:[0,1,1] neg_lo:[1,0,0] neg_hi:[1,0,0]
    v_exp_f32 v172, v172
    v_exp_f32 v173, v173
    v_pk_fma_f32 v[116:117], v[246:247], v[164:165], v[116:117] op_sel:[0,0,0] op_sel_hi:[0,1,1] neg_lo:[1,0,0] neg_hi:[1,0,0]
    v_exp_f32 v174, v174
    v_exp_f32 v175, v175
    v_pk_fma_f32 v[118:119], v[246:247], v[166:167], v[118:119] op_sel:[0,0,0] op_sel_hi:[0,1,1] neg_lo:[1,0,0] neg_hi:[1,0,0]
    v_pk_fma_f32 v[168:169], v[168:169], v[128:129], v[128:129] op_sel:[0,0,0] op_sel_hi:[1,0,0]
    v_pk_fma_f32 v[170:171], v[170:171], v[128:129], v[128:129] op_sel:[0,0,0] op_sel_hi:[1,0,0]
    v_pk_fma_f32 v[172:173], v[172:173], v[130:131], v[130:131] op_sel:[0,0,0] op_sel_hi:[1,0,0]
    v_pk_fma_f32 v[174:175], v[174:175], v[130:131], v[130:131] op_sel:[0,0,0] op_sel_hi:[1,0,0]
    v_rcp_f32 v168, v168
    v_rcp_f32 v169, v169
    v_pk_mul_f32 v[64:65], v[64:65], v[112:113]
    v_rcp_f32 v170, v170
    v_rcp_f32 v171, v171
    v_pk_mul_f32 v[66:67], v[66:67], v[114:115]
    v_rcp_f32 v172, v172
    v_rcp_f32 v173, v173
    v_pk_mul_f32 v[68:69], v[68:69], v[116:117]
    v_rcp_f32 v174, v174
    v_rcp_f32 v175, v175
    v_pk_mul_f32 v[70:71], v[70:71], v[118:119]
    v_pk_mul_f32 v[64:65], v[64:65], v[168:169]
    v_pk_mul_f32 v[66:67], v[66:67], v[170:171]
    v_pk_mul_f32 v[68:69], v[68:69], v[172:173]
    v_pk_mul_f32 v[70:71], v[70:71], v[174:175]
    v_cvt_pk_bf16_f32 v176, v64, v65
    v_cvt_pk_bf16_f32 v177, v66, v67
    v_cvt_pk_bf16_f32 v178, v68, v69
    v_cvt_pk_bf16_f32 v179, v70, v71
    s_nop 0
    v_permlane32_swap_b32 v176, v178
    v_permlane32_swap_b32 v177, v179
    buffer_store_dwordx4 v[176:179], v17, s[20:23], s43 offen sc1
    s_add_u32 s43, s43, 110592
    s_cmp_eq_u32 s31, 3
    s_cbranch_scc0 GU_B4_2
    buffer_load_dwordx4 v[232:235], v8, s[20:23], s48 offen offset:2048 sc1
    GU_B4_2:
    v_pk_fma_f32 v[40:41], v[248:249], v[144:145], v[40:41] op_sel:[0,0,0] op_sel_hi:[0,1,1] neg_lo:[1,0,0] neg_hi:[1,0,0]
    v_pk_fma_f32 v[42:43], v[248:249], v[146:147], v[42:43] op_sel:[0,0,0] op_sel_hi:[0,1,1] neg_lo:[1,0,0] neg_hi:[1,0,0]
    v_pk_fma_f32 v[56:57], v[248:249], v[148:149], v[56:57] op_sel:[0,0,0] op_sel_hi:[0,1,1] neg_lo:[1,0,0] neg_hi:[1,0,0]
    v_pk_fma_f32 v[58:59], v[248:249], v[150:151], v[58:59] op_sel:[0,0,0] op_sel_hi:[0,1,1] neg_lo:[1,0,0] neg_hi:[1,0,0]
    v_pk_mul_f32 v[168:169], v[40:41], v[140:141] op_sel:[0,0] op_sel_hi:[1,0]
    v_pk_mul_f32 v[170:171], v[42:43], v[140:141] op_sel:[0,0] op_sel_hi:[1,0]
    v_pk_mul_f32 v[172:173], v[56:57], v[140:141] op_sel:[0,0] op_sel_hi:[1,0]
    v_pk_mul_f32 v[174:175], v[58:59], v[140:141] op_sel:[0,0] op_sel_hi:[1,0]
    v_exp_f32 v168, v168
    v_exp_f32 v169, v169
    v_pk_fma_f32 v[88:89], v[248:249], v[156:157], v[88:89] op_sel:[0,0,0] op_sel_hi:[0,1,1] neg_lo:[1,0,0] neg_hi:[1,0,0]
    v_exp_f32 v170, v170
    v_exp_f32 v171, v171
    v_pk_fma_f32 v[90:91], v[248:249], v[158:159], v[90:91] op_sel:[0,0,0] op_sel_hi:[0,1,1] neg_lo:[1,0,0] neg_hi:[1,0,0]
    v_exp_f32 v172, v172
    v_exp_f32 v173, v173
    v_pk_fma_f32 v[104:105], v[248:249], v[160:161], v[104:105] op_sel:[0,0,0] op_sel_hi:[0,1,1] neg_lo:[1,0,0] neg_hi:[1,0,0]
    v_exp_f32 v174, v174
    v_exp_f32 v175, v175
    v_pk_fma_f32 v[106:107], v[248:249], v[162:163], v[106:107] op_sel:[0,0,0] op_sel_hi:[0,1,1] neg_lo:[1,0,0] neg_hi:[1,0,0]
    v_pk_fma_f32 v[168:169], v[168:169], v[132:133], v[132:133] op_sel:[0,0,0] op_sel_hi:[1,0,0]
    v_pk_fma_f32 v[170:171], v[170:171], v[132:133], v[132:133] op_sel:[0,0,0] op_sel_hi:[1,0,0]
    v_pk_fma_f32 v[172:173], v[172:173], v[132:133], v[132:133] op_sel:[0,0,0] op_sel_hi:[1,0,0]
    v_pk_fma_f32 v[174:175], v[174:175], v[132:133], v[132:133] op_sel:[0,0,0] op_sel_hi:[1,0,0]
    v_rcp_f32 v168, v168
    v_rcp_f32 v169, v169
    v_pk_mul_f32 v[40:41], v[40:41], v[88:89]
    v_rcp_f32 v170, v170
    v_rcp_f32 v171, v171
    v_pk_mul_f32 v[42:43], v[42:43], v[90:91]
    v_rcp_f32 v172, v172
    v_rcp_f32 v173, v173
    v_pk_mul_f32 v[56:57], v[56:57], v[104:105]
    v_rcp_f32 v174, v174
    v_rcp_f32 v175, v175
    v_pk_mul_f32 v[58:59], v[58:59], v[106:107]
    v_pk_mul_f32 v[40:41], v[40:41], v[168:169]
    v_pk_mul_f32 v[42:43], v[42:43], v[170:171]
    v_pk_mul_f32 v[56:57], v[56:57], v[172:173]
    v_pk_mul_f32 v[58:59], v[58:59], v[174:175]
    v_cvt_pk_bf16_f32 v180, v40, v41
    v_cvt_pk_bf16_f32 v181, v42, v43
    v_cvt_pk_bf16_f32 v182, v56, v57
    v_cvt_pk_bf16_f32 v183, v58, v59
    buffer_store_dwordx4 v[180:183], v16, s[20:23], s42 offen sc1
    s_add_u32 s42, s42, 55296
    s_cmp_eq_u32 s31, 3
    s_cbranch_scc0 GU_B4_3
    buffer_load_dwordx4 v[236:239], v8, s[20:23], s48 offen offset:3072 sc1
    GU_B4_3:
    v_pk_fma_f32 v[44:45], v[250:251], v[144:145], v[44:45] op_sel:[0,0,0] op_sel_hi:[0,1,1] neg_lo:[1,0,0] neg_hi:[1,0,0]
    v_pk_fma_f32 v[46:47], v[250:251], v[146:147], v[46:47] op_sel:[0,0,0] op_sel_hi:[0,1,1] neg_lo:[1,0,0] neg_hi:[1,0,0]
    v_pk_fma_f32 v[60:61], v[250:251], v[148:149], v[60:61] op_sel:[0,0,0] op_sel_hi:[0,1,1] neg_lo:[1,0,0] neg_hi:[1,0,0]
    v_pk_fma_f32 v[62:63], v[250:251], v[150:151], v[62:63] op_sel:[0,0,0] op_sel_hi:[0,1,1] neg_lo:[1,0,0] neg_hi:[1,0,0]
    v_pk_mul_f32 v[168:169], v[44:45], v[142:143] op_sel:[0,0] op_sel_hi:[1,0]
    v_pk_mul_f32 v[170:171], v[46:47], v[142:143] op_sel:[0,0] op_sel_hi:[1,0]
    v_pk_mul_f32 v[172:173], v[60:61], v[142:143] op_sel:[0,0] op_sel_hi:[1,0]
    v_pk_mul_f32 v[174:175], v[62:63], v[142:143] op_sel:[0,0] op_sel_hi:[1,0]
    v_exp_f32 v168, v168
    v_exp_f32 v169, v169
    v_pk_fma_f32 v[92:93], v[250:251], v[156:157], v[92:93] op_sel:[0,0,0] op_sel_hi:[0,1,1] neg_lo:[1,0,0] neg_hi:[1,0,0]
    v_exp_f32 v170, v170
    v_exp_f32 v171, v171
    v_pk_fma_f32 v[94:95], v[250:251], v[158:159], v[94:95] op_sel:[0,0,0] op_sel_hi:[0,1,1] neg_lo:[1,0,0] neg_hi:[1,0,0]
    v_exp_f32 v172, v172
    v_exp_f32 v173, v173
    v_pk_fma_f32 v[108:109], v[250:251], v[160:161], v[108:109] op_sel:[0,0,0] op_sel_hi:[0,1,1] neg_lo:[1,0,0] neg_hi:[1,0,0]
    v_exp_f32 v174, v174
    v_exp_f32 v175, v175
    v_pk_fma_f32 v[110:111], v[250:251], v[162:163], v[110:111] op_sel:[0,0,0] op_sel_hi:[0,1,1] neg_lo:[1,0,0] neg_hi:[1,0,0]
    v_pk_fma_f32 v[168:169], v[168:169], v[134:135], v[134:135] op_sel:[0,0,0] op_sel_hi:[1,0,0]
    v_pk_fma_f32 v[170:171], v[170:171], v[134:135], v[134:135] op_sel:[0,0,0] op_sel_hi:[1,0,0]
    v_pk_fma_f32 v[172:173], v[172:173], v[134:135], v[134:135] op_sel:[0,0,0] op_sel_hi:[1,0,0]
    v_pk_fma_f32 v[174:175], v[174:175], v[134:135], v[134:135] op_sel:[0,0,0] op_sel_hi:[1,0,0]
    v_rcp_f32 v168, v168
    v_rcp_f32 v169, v169
    v_pk_mul_f32 v[44:45], v[44:45], v[92:93]
    v_rcp_f32 v170, v170
    v_rcp_f32 v171, v171
    v_pk_mul_f32 v[46:47], v[46:47], v[94:95]
    v_rcp_f32 v172, v172
    v_rcp_f32 v173, v173
    v_pk_mul_f32 v[60:61], v[60:61], v[108:109]
    v_rcp_f32 v174, v174
    v_rcp_f32 v175, v175
    v_pk_mul_f32 v[62:63], v[62:63], v[110:111]
    v_pk_mul_f32 v[44:45], v[44:45], v[168:169]
    v_pk_mul_f32 v[46:47], v[46:47], v[170:171]
    v_pk_mul_f32 v[60:61], v[60:61], v[172:173]
    v_pk_mul_f32 v[62:63], v[62:63], v[174:175]
    v_cvt_pk_bf16_f32 v176, v44, v45
    v_cvt_pk_bf16_f32 v177, v46, v47
    v_cvt_pk_bf16_f32 v178, v60, v61
    v_cvt_pk_bf16_f32 v179, v62, v63
    buffer_store_dwordx4 v[176:179], v16, s[20:23], s42 offen sc1
    s_cmp_eq_u32 s31, 3
    s_cbranch_scc0 GU_B4_4
    buffer_load_dwordx4 v[240:243], v9, s[20:23], s48 offen offset:0 sc1
    GU_B4_4:
    v_pk_fma_f32 v[72:73], v[248:249], v[152:153], v[72:73] op_sel:[0,0,0] op_sel_hi:[0,1,1] neg_lo:[1,0,0] neg_hi:[1,0,0]
    v_pk_fma_f32 v[74:75], v[248:249], v[154:155], v[74:75] op_sel:[0,0,0] op_sel_hi:[0,1,1] neg_lo:[1,0,0] neg_hi:[1,0,0]
    v_pk_fma_f32 v[76:77], v[250:251], v[152:153], v[76:77] op_sel:[0,0,0] op_sel_hi:[0,1,1] neg_lo:[1,0,0] neg_hi:[1,0,0]
    v_pk_fma_f32 v[78:79], v[250:251], v[154:155], v[78:79] op_sel:[0,0,0] op_sel_hi:[0,1,1] neg_lo:[1,0,0] neg_hi:[1,0,0]
    v_pk_mul_f32 v[168:169], v[72:73], v[140:141] op_sel:[0,0] op_sel_hi:[1,0]
    v_pk_mul_f32 v[170:171], v[74:75], v[140:141] op_sel:[0,0] op_sel_hi:[1,0]
    v_pk_mul_f32 v[172:173], v[76:77], v[142:143] op_sel:[0,0] op_sel_hi:[1,0]
    v_pk_mul_f32 v[174:175], v[78:79], v[142:143] op_sel:[0,0] op_sel_hi:[1,0]
    v_exp_f32 v168, v168
    v_exp_f32 v169, v169
    v_pk_fma_f32 v[120:121], v[248:249], v[164:165], v[120:121] op_sel:[0,0,0] op_sel_hi:[0,1,1] neg_lo:[1,0,0] neg_hi:[1,0,0]
    v_exp_f32 v170, v170
    v_exp_f32 v171, v171
    v_pk_fma_f32 v[122:123], v[248:249], v[166:167], v[122:123] op_sel:[0,0,0] op_sel_hi:[0,1,1] neg_lo:[1,0,0] neg_hi:[1,0,0]
    v_exp_f32 v172, v172
    v_exp_f32 v173, v173
    v_pk_fma_f32 v[124:125], v[250:251], v[164:165], v[124:125] op_sel:[0,0,0] op_sel_hi:[0,1,1] neg_lo:[1,0,0] neg_hi:[1,0,0]
    v_exp_f32 v174, v174
    v_exp_f32 v175, v175
    v_pk_fma_f32 v[126:127], v[250:251], v[166:167], v[126:127] op_sel:[0,0,0] op_sel_hi:[0,1,1] neg_lo:[1,0,0] neg_hi:[1,0,0]
    v_pk_fma_f32 v[168:169], v[168:169], v[132:133], v[132:133] op_sel:[0,0,0] op_sel_hi:[1,0,0]
    v_pk_fma_f32 v[170:171], v[170:171], v[132:133], v[132:133] op_sel:[0,0,0] op_sel_hi:[1,0,0]
    v_pk_fma_f32 v[172:173], v[172:173], v[134:135], v[134:135] op_sel:[0,0,0] op_sel_hi:[1,0,0]
    v_pk_fma_f32 v[174:175], v[174:175], v[134:135], v[134:135] op_sel:[0,0,0] op_sel_hi:[1,0,0]
    v_rcp_f32 v168, v168
    v_rcp_f32 v169, v169
    v_pk_mul_f32 v[72:73], v[72:73], v[120:121]
    v_rcp_f32 v170, v170
    v_rcp_f32 v171, v171
    v_pk_mul_f32 v[74:75], v[74:75], v[122:123]
    v_rcp_f32 v172, v172
    v_rcp_f32 v173, v173
    v_pk_mul_f32 v[76:77], v[76:77], v[124:125]
    v_rcp_f32 v174, v174
    v_rcp_f32 v175, v175
    v_pk_mul_f32 v[78:79], v[78:79], v[126:127]
    v_pk_mul_f32 v[72:73], v[72:73], v[168:169]
    v_pk_mul_f32 v[74:75], v[74:75], v[170:171]
    v_pk_mul_f32 v[76:77], v[76:77], v[172:173]
    v_pk_mul_f32 v[78:79], v[78:79], v[174:175]
    v_cvt_pk_bf16_f32 v180, v72, v73
    v_cvt_pk_bf16_f32 v181, v74, v75
    v_cvt_pk_bf16_f32 v182, v76, v77
    v_cvt_pk_bf16_f32 v183, v78, v79
    s_nop 0
    v_permlane32_swap_b32 v180, v182
    v_permlane32_swap_b32 v181, v183
    buffer_store_dwordx4 v[180:183], v17, s[20:23], s43 offen sc1
    s_branch P1_FIN
P1_QKV:
    s_mul_i32 s45, s32, 30720
    v_add_u32 v19, 0, v0
    v_mul_u32_u24 v16, 205, v19
    v_lshrrev_b32 v16, 12, v16
    v_mul_u32_u24 v17, 20, v16
    v_sub_u32 v17, v19, v17
    v_mul_u32_u24 v16, 3840, v16
    v_lshl_add_u32 v16, v17, 4, v16
    s_cmp_eq_u32 s35, 1
    s_cselect_b32 s46, 1120, 0
    v_mov_b32 v18, s46
    v_cmp_le_u32 vcc, 10, v17
    s_nop 1
    v_cndmask_b32 v18, 0, v18, vcc
    v_add_u32 v16, v16, v18
    v_add_u32 v5, s45, v16
    v_add_u32 v19, 64, v0
    v_mul_u32_u24 v16, 205, v19
    v_lshrrev_b32 v16, 12, v16
    v_mul_u32_u24 v17, 20, v16
    v_sub_u32 v17, v19, v17
    v_mul_u32_u24 v16, 3840, v16
    v_lshl_add_u32 v16, v17, 4, v16
    s_cmp_eq_u32 s35, 1
    s_cselect_b32 s46, 1120, 0
    v_mov_b32 v18, s46
    v_cmp_le_u32 vcc, 10, v17
    s_nop 1
    v_cndmask_b32 v18, 0, v18, vcc
    v_add_u32 v16, v16, v18
    v_add_u32 v6, s45, v16
    v_add_u32 v19, 128, v0
    v_mul_u32_u24 v16, 205, v19
    v_lshrrev_b32 v16, 12, v16
    v_mul_u32_u24 v17, 20, v16
    v_sub_u32 v17, v19, v17
    v_mul_u32_u24 v16, 3840, v16
    v_lshl_add_u32 v16, v17, 4, v16
    s_cmp_eq_u32 s35, 1
    s_cselect_b32 s46, 1120, 0
    v_mov_b32 v18, s46
    v_cmp_le_u32 vcc, 10, v17
    s_nop 1
    v_cndmask_b32 v18, 0, v18, vcc
    v_add_u32 v16, v16, v18
    v_add_u32 v7, s45, v16
    s_mul_i32 s40, s32, 2592
    s_mov_b32 s49, 245760
    s_waitcnt lgkmcnt(0)
    s_mul_i32 s45, s33, 327680
    s_add_u32 s8, s52, s45
    s_addc_u32 s9, s53, 0
    s_and_b32 s9, s9, 0xffff
    s_mov_b32 s10, 327680
    s_mov_b32 s11, 0x20000
    s_mov_b32 s24, s52
    s_and_b32 s25, s53, 0xffff
    s_mov_b32 s26, 2621440
    s_mov_b32 s27, 0x20000
    s_mov_b32 s20, s72
    s_and_b32 s21, s73, 0xffff
    s_mov_b32 s22, 268435456
    s_mov_b32 s23, 0x20000
    s_mul_i32 s45, s34, 320
    s_mul_i32 s46, s34, 160
    s_add_u32 s46, s46, 1280
    s_cmp_eq_u32 s35, 1
    s_cselect_b32 s45, s46, s45
    s_add_u32 s12, s54, s45
    s_addc_u32 s13, s55, 0
    s_and_b32 s13, s13, 0xffff
    s_sub_u32 s14, 2457600, s45
    s_mov_b32 s15, 0x20000
    s_add_u32 s16, s54, s45
    s_addc_u32 s17, s55, 0
    s_and_b32 s17, s17, 0xffff
    s_sub_u32 s18, 2457600, s45
    s_mov_b32 s19, 0x20000
    s_add_u32 s76, s54, s45
    s_addc_u32 s77, s55, 0
    s_and_b32 s77, s77, 0xffff
    s_sub_u32 s78, 2457600, s45
    s_mov_b32 s79, 0x20000
    s_mul_i32 s45, s34, 6400
    s_mul_i32 s46, s34, 3200
    s_cmp_eq_u32 s35, 1
    s_cselect_b32 s45, s46, s45
    s_add_u32 s28, s56, s45
    s_addc_u32 s29, s57, 0
    s_and_b32 s29, s29, 0xffff
    s_sub_u32 s30, 25600, s45
    s_mov_b32 s31, 0x20000
    s_mov_b32 s3, 163840
    s_cmp_lg_u32 s38, 0
    s_cbranch_scc1 QKV_ROLEP
    s_and_b32 s45, s2, 1
    s_lshl_b32 s45, s45, 7
    s_bfe_u32 s46, s2, 0x20001
    s_lshl_b32 s46, s46, 5
    s_add_u32 s45, s45, s46
    s_lshr_b32 s46, s2, 3
    s_add_u32 s45, s45, s46
    s_lshl_b32 s45, s45, 3
    s_add_u32 s50, s45, s32
    s_mul_i32 s45, s50, 1280
    v_lshlrev_b32 v16, 4, v0
    v_lshlrev_b32 v17, 2, v0
    buffer_load_dwordx4 v[244:247], v16, s[24:27], s45 offen
    buffer_load_dword v248, v17, s[24:27], s45 offen offset:1024
    s_add_u32 m0, s40, 0
    s_nop 0
    buffer_load_dwordx4 v5, s[76:79], s41 offen lds
    s_add_u32 m0, s40, 1024
    s_nop 0
    buffer_load_dwordx4 v6, s[76:79], s41 offen lds
    s_add_u32 m0, s40, 2048
    s_mov_b32 exec_hi, 0
    buffer_load_dwordx4 v7, s[76:79], s41 offen lds
    s_mov_b32 exec_hi, -1
    s_add_u32 s41, s41, s49
    s_add_u32 m0, s39, 49152
    s_nop 0
    buffer_load_dwordx4 v1, s[8:11], 0 offen offset:0 lds
    s_add_u32 m0, s39, 50176
    s_nop 0
    buffer_load_dwordx4 v2, s[8:11], 0 offen offset:0 lds
    s_add_u32 m0, s39, 51200
    s_nop 0
    buffer_load_dwordx4 v3, s[8:11], 0 offen offset:0 lds
    s_add_u32 m0, s39, 52224
    s_nop 0
    buffer_load_dwordx4 v4, s[8:11], 0 offen offset:0 lds
    s_mov_b32 s4, s70
    s_and_b32 s5, s71, 0xffff
    s_mov_b32 s6, 256
    s_mov_b32 s7, 0x20000
    s_or_b32 s45, s2, s32
    s_cmp_eq_u32 s45, 0
    s_cbranch_scc0 NONCE_SKIP
    s_memrealtime s[74:75]
    s_waitcnt lgkmcnt(0)
    s_lshl_b64 s[74:75], s[74:75], 3
    s_or_b32 s74, s74, 4
    v_mov_b32 v16, s74
    v_mov_b32 v17, s75
    v_mov_b32 v18, 0
    s_mov_b64 exec, 1
    buffer_store_dwordx2 v[16:17], v18, s[4:7], 0 offen sc1
    s_mov_b64 exec, -1
NONCE_SKIP:
    s_lshl_b32 s45, s32, 10
    s_add_u32 m0, s45, 147456
    v_lshlrev_b32 v16, 4, v0
    v_add_u32 v16, s45, v16
    v_cmp_gt_u32 vcc, 6400, v16
    s_nop 0
    s_and_b64 exec, vcc, -1
    s_cbranch_execz PHI_SKIPQKVL
    buffer_load_dwordx4 v16, s[28:31], 0 offen lds
PHI_SKIPQKVL:
    s_mov_b64 exec, -1
    v_and_b32 v16, 15, v0
    v_lshlrev_b32 v16, 7, v16
    v_bfe_u32 v17, v0, 1, 3
    v_lshrrev_b32 v18, 4, v0
    v_xor_b32 v17, v17, v18
    v_lshl_add_u32 v16, v17, 4, v16
    s_lshl_b32 s45, s37, 13
    s_add_u32 s45, s45, 49152
    v_add_u32 v10, s45, v16
    v_xor_b32 v11, 64, v10
    v_add_u32 v12, 65536, v10
    v_add_u32 v13, 65536, v11
    v_mul_u32_u24 v16, 2592, v18
    v_bfe_u32 v17, v0, 2, 2
    v_mul_u32_u24 v17, 320, v17
    v_add_u32 v16, v16, v17
    v_and_b32 v17, 3, v0
    v_mul_u32_u24 v17, 40, v17
    v_add_u32 v16, v16, v17
    s_mul_i32 s45, s38, 160
    v_add_u32 v14, s45, v16
    s_waitcnt vmcnt(0) lgkmcnt(0)
    s_barrier
    s_setprio 1
    s_add_u32 s45, s41, 122880
    s_add_u32 m0, s40, 34944
    s_nop 0
    buffer_load_dwordx4 v5, s[76:79], s45 offen lds
    s_add_u32 s45, s41, 122880
    s_add_u32 m0, s40, 35968
    s_nop 0
    buffer_load_dwordx4 v6, s[76:79], s45 offen lds
    s_add_u32 s45, s41, 122880
    s_add_u32 m0, s40, 36992
    s_mov_b32 exec_hi, 0
    buffer_load_dwordx4 v7, s[76:79], s45 offen lds
    s_mov_b32 exec_hi, -1
    s_add_u32 m0, s40, 24576
    s_nop 0
    buffer_load_dwordx4 v5, s[76:79], s41 offen lds
    s_add_u32 m0, s40, 25600
    s_nop 0
    buffer_load_dwordx4 v6, s[76:79], s41 offen lds
    s_add_u32 m0, s40, 26624
    s_mov_b32 exec_hi, 0
    buffer_load_dwordx4 v7, s[76:79], s41 offen lds
    s_mov_b32 exec_hi, -1
    s_add_u32 s41, s41, s49
    s_add_u32 m0, s39, 81792
    s_nop 0
    buffer_load_dwordx4 v1, s[8:11], 0 offen offset:128 lds
    s_add_u32 m0, s39, 82816
    s_nop 0
    buffer_load_dwordx4 v2, s[8:11], 0 offen offset:128 lds
    s_add_u32 m0, s39, 83840
    s_nop 0
    buffer_load_dwordx4 v3, s[8:11], 0 offen offset:128 lds
    s_add_u32 m0, s39, 84864
    s_nop 0
    buffer_load_dwordx4 v4, s[8:11], 0 offen offset:128 lds
    s_add_u32 m0, s39, 98176
    s_nop 0
    buffer_load_dwordx4 v1, s[8:11], s3 offen offset:128 lds
    s_add_u32 m0, s39, 99200
    s_nop 0
    buffer_load_dwordx4 v2, s[8:11], s3 offen offset:128 lds
    s_add_u32 m0, s39, 100224
    s_nop 0
    buffer_load_dwordx4 v3, s[8:11], s3 offen offset:128 lds
    s_add_u32 m0, s39, 101248
    s_nop 0
    buffer_load_dwordx4 v4, s[8:11], s3 offen offset:128 lds
    ds_read_b128 v[128:131], v10 offset:0
    ds_read_b64_tr_b16 v[160:161], v14 offset:0
    ds_read_b64_tr_b16 v[162:163], v14 offset:1280
    ds_read_b128 v[132:135], v10 offset:2048
    ds_read_b128 v[136:139], v10 offset:4096
    ds_read_b128 v[140:143], v10 offset:6144
    ds_read_b64_tr_b16 v[164:165], v14 offset:8
    ds_read_b64_tr_b16 v[166:167], v14 offset:1288
    s_waitcnt lgkmcnt(0)
    v_mfma_f32_16x16x32_bf16 v[32:35], v[160:163], v[128:131], 0
    ds_read_b64_tr_b16 v[172:173], v14 offset:16
    v_mfma_f32_16x16x32_bf16 v[36:39], v[160:163], v[132:135], 0
    ds_read_b64_tr_b16 v[174:175], v14 offset:1296
    v_mfma_f32_16x16x32_bf16 v[40:43], v[160:163], v[136:139], 0
    ds_read_b64_tr_b16 v[176:177], v14 offset:24
    v_mfma_f32_16x16x32_bf16 v[44:47], v[160:163], v[140:143], 0
    ds_read_b64_tr_b16 v[178:179], v14 offset:1304
    v_mfma_f32_16x16x32_bf16 v[48:51], v[164:167], v[128:131], 0
    ds_read_b64_tr_b16 v[180:181], v14 offset:32
    v_mfma_f32_16x16x32_bf16 v[52:55], v[164:167], v[132:135], 0
    ds_read_b64_tr_b16 v[182:183], v14 offset:1312
    v_mfma_f32_16x16x32_bf16 v[56:59], v[164:167], v[136:139], 0
    v_mfma_f32_16x16x32_bf16 v[60:63], v[164:167], v[140:143], 0
    s_waitcnt lgkmcnt(0)
    v_mfma_f32_16x16x32_bf16 v[64:67], v[172:175], v[128:131], 0
    ds_read_b128 v[144:147], v11 offset:0
    s_add_u32 m0, s39, 114432
    s_nop 0
    buffer_load_dwordx4 v1, s[8:11], 0 offen offset:256 lds
    v_mfma_f32_16x16x32_bf16 v[68:71], v[172:175], v[132:135], 0
    ds_read_b64_tr_b16 v[160:161], v14 offset:10368
    v_mfma_f32_16x16x32_bf16 v[72:75], v[172:175], v[136:139], 0
    ds_read_b64_tr_b16 v[162:163], v14 offset:11648
    v_mfma_f32_16x16x32_bf16 v[76:79], v[172:175], v[140:143], 0
    ds_read_b128 v[148:151], v11 offset:2048
    s_add_u32 m0, s39, 115456
    s_nop 0
    buffer_load_dwordx4 v2, s[8:11], 0 offen offset:256 lds
    v_mfma_f32_16x16x32_bf16 v[80:83], v[176:179], v[128:131], 0
    ds_read_b128 v[152:155], v11 offset:4096
    v_mfma_f32_16x16x32_bf16 v[84:87], v[176:179], v[132:135], 0
    ds_read_b128 v[156:159], v11 offset:6144
    v_mfma_f32_16x16x32_bf16 v[88:91], v[176:179], v[136:139], 0
    ds_read_b64_tr_b16 v[164:165], v14 offset:10376
    s_add_u32 m0, s39, 116480
    s_nop 0
    buffer_load_dwordx4 v3, s[8:11], 0 offen offset:256 lds
    v_mfma_f32_16x16x32_bf16 v[92:95], v[176:179], v[140:143], 0
    ds_read_b64_tr_b16 v[166:167], v14 offset:11656
    v_mfma_f32_16x16x32_bf16 v[96:99], v[180:183], v[128:131], 0
    v_mfma_f32_16x16x32_bf16 v[100:103], v[180:183], v[132:135], 0
    s_add_u32 m0, s39, 117504
    s_nop 0
    buffer_load_dwordx4 v4, s[8:11], 0 offen offset:256 lds
    v_mfma_f32_16x16x32_bf16 v[104:107], v[180:183], v[136:139], 0
    v_mfma_f32_16x16x32_bf16 v[108:111], v[180:183], v[140:143], 0
    s_waitcnt lgkmcnt(0)
    v_mfma_f32_16x16x32_bf16 v[32:35], v[160:163], v[144:147], v[32:35]
    ds_read_b64_tr_b16 v[172:173], v14 offset:10384
    s_add_u32 m0, s39, 130816
    s_nop 0
    buffer_load_dwordx4 v1, s[8:11], s3 offen offset:256 lds
    v_mfma_f32_16x16x32_bf16 v[36:39], v[160:163], v[148:151], v[36:39]
    ds_read_b64_tr_b16 v[174:175], v14 offset:11664
    v_mfma_f32_16x16x32_bf16 v[40:43], v[160:163], v[152:155], v[40:43]
    ds_read_b64_tr_b16 v[176:177], v14 offset:10392
    s_add_u32 m0, s39, 131840
    s_nop 0
    buffer_load_dwordx4 v2, s[8:11], s3 offen offset:256 lds
    v_mfma_f32_16x16x32_bf16 v[44:47], v[160:163], v[156:159], v[44:47]
    ds_read_b64_tr_b16 v[178:179], v14 offset:11672
    v_mfma_f32_16x16x32_bf16 v[48:51], v[164:167], v[144:147], v[48:51]
    ds_read_b64_tr_b16 v[180:181], v14 offset:10400
    s_add_u32 m0, s39, 132864
    s_nop 0
    buffer_load_dwordx4 v3, s[8:11], s3 offen offset:256 lds
    v_mfma_f32_16x16x32_bf16 v[52:55], v[164:167], v[148:151], v[52:55]
    ds_read_b64_tr_b16 v[182:183], v14 offset:11680
    v_mfma_f32_16x16x32_bf16 v[56:59], v[164:167], v[152:155], v[56:59]
    s_add_u32 m0, s39, 133888
    s_nop 0
    buffer_load_dwordx4 v4, s[8:11], s3 offen offset:256 lds
    v_mfma_f32_16x16x32_bf16 v[60:63], v[164:167], v[156:159], v[60:63]
    s_waitcnt vmcnt(8) lgkmcnt(0)
    s_barrier
    v_mfma_f32_16x16x32_bf16 v[64:67], v[172:175], v[144:147], v[64:67]
    ds_read_b128 v[128:131], v10 offset:32768
    v_lshlrev_b32 v200, 16, v244
    s_add_u32 s45, s41, 122880
    s_add_u32 m0, s40, 10368
    s_nop 0
    buffer_load_dwordx4 v5, s[76:79], s45 offen lds
    v_mfma_f32_16x16x32_bf16 v[68:71], v[172:175], v[148:151], v[68:71]
    ds_read_b64_tr_b16 v[160:161], v14 offset:24576
    v_and_b32 v201, 0xffff0000, v244
    v_mfma_f32_16x16x32_bf16 v[72:75], v[172:175], v[152:155], v[72:75]
    ds_read_b64_tr_b16 v[162:163], v14 offset:25856
    v_lshlrev_b32 v202, 16, v245
    v_mfma_f32_16x16x32_bf16 v[76:79], v[172:175], v[156:159], v[76:79]
    ds_read_b128 v[132:135], v10 offset:34816
    s_add_u32 s45, s41, 122880
    s_add_u32 m0, s40, 11392
    s_nop 0
    buffer_load_dwordx4 v6, s[76:79], s45 offen lds
    v_mfma_f32_16x16x32_bf16 v[80:83], v[176:179], v[144:147], v[80:83]
    ds_read_b128 v[136:139], v10 offset:36864
    v_and_b32 v203, 0xffff0000, v245
    v_lshlrev_b32 v204, 16, v246
    v_mfma_f32_16x16x32_bf16 v[84:87], v[176:179], v[148:151], v[84:87]
    ds_read_b128 v[140:143], v10 offset:38912
    v_and_b32 v205, 0xffff0000, v246
    v_mfma_f32_16x16x32_bf16 v[88:91], v[176:179], v[152:155], v[88:91]
    ds_read_b64_tr_b16 v[164:165], v14 offset:24584
    s_add_u32 s45, s41, 122880
    s_add_u32 m0, s40, 12416
    s_mov_b32 exec_hi, 0
    buffer_load_dwordx4 v7, s[76:79], s45 offen lds
    s_mov_b32 exec_hi, -1
    v_mfma_f32_16x16x32_bf16 v[92:95], v[176:179], v[156:159], v[92:95]
    ds_read_b64_tr_b16 v[166:167], v14 offset:25864
    v_lshlrev_b32 v206, 16, v247
    v_mfma_f32_16x16x32_bf16 v[96:99], v[180:183], v[144:147], v[96:99]
    v_and_b32 v207, 0xffff0000, v247
    v_lshlrev_b32 v208, 16, v248
    v_mfma_f32_16x16x32_bf16 v[100:103], v[180:183], v[148:151], v[100:103]
    s_add_u32 m0, s40, 0
    s_nop 0
    buffer_load_dwordx4 v5, s[76:79], s41 offen lds
    v_mfma_f32_16x16x32_bf16 v[104:107], v[180:183], v[152:155], v[104:107]
    v_and_b32 v209, 0xffff0000, v248
    v_mfma_f32_16x16x32_bf16 v[108:111], v[180:183], v[156:159], v[108:111]
    v_add_f32 v210, v200, v201
    s_waitcnt lgkmcnt(0)
    v_mfma_f32_16x16x32_bf16 v[32:35], v[160:163], v[128:131], v[32:35]
    ds_read_b64_tr_b16 v[172:173], v14 offset:24592
    v_add_f32 v210, v210, v202
    s_add_u32 m0, s40, 1024
    s_nop 0
    buffer_load_dwordx4 v6, s[76:79], s41 offen lds
    v_mfma_f32_16x16x32_bf16 v[36:39], v[160:163], v[132:135], v[36:39]
    ds_read_b64_tr_b16 v[174:175], v14 offset:25872
    v_add_f32 v210, v210, v203
    v_add_f32 v210, v210, v204
    v_mfma_f32_16x16x32_bf16 v[40:43], v[160:163], v[136:139], v[40:43]
    ds_read_b64_tr_b16 v[176:177], v14 offset:24600
    v_add_f32 v210, v210, v205
    s_add_u32 m0, s40, 2048
    s_mov_b32 exec_hi, 0
    buffer_load_dwordx4 v7, s[76:79], s41 offen lds
    s_mov_b32 exec_hi, -1
    s_add_u32 s41, s41, s49
    v_mfma_f32_16x16x32_bf16 v[44:47], v[160:163], v[140:143], v[44:47]
    ds_read_b64_tr_b16 v[178:179], v14 offset:25880
    v_add_f32 v210, v210, v206
    v_add_f32 v210, v210, v207
    v_mfma_f32_16x16x32_bf16 v[48:51], v[164:167], v[128:131], v[48:51]
    ds_read_b64_tr_b16 v[180:181], v14 offset:24608
    v_add_f32 v210, v210, v208
    s_add_u32 m0, s39, 48768
    s_nop 0
    buffer_load_dwordx4 v1, s[8:11], 0 offen offset:384 lds
    v_mfma_f32_16x16x32_bf16 v[52:55], v[164:167], v[132:135], v[52:55]
    ds_read_b64_tr_b16 v[182:183], v14 offset:25888
    v_add_f32 v210, v210, v209
    s_nop 1
    v_add_f32_dpp v210, v210, v210 row_shr:1 row_mask:0xf bank_mask:0xf bound_ctrl:0
    v_mfma_f32_16x16x32_bf16 v[56:59], v[164:167], v[136:139], v[56:59]
    s_nop 0
    v_add_f32_dpp v210, v210, v210 row_shr:2 row_mask:0xf bank_mask:0xf bound_ctrl:0
    s_add_u32 m0, s39, 49792
    s_nop 0
    buffer_load_dwordx4 v2, s[8:11], 0 offen offset:384 lds
    v_mfma_f32_16x16x32_bf16 v[60:63], v[164:167], v[140:143], v[60:63]
    v_add_f32_dpp v210, v210, v210 row_shr:4 row_mask:0xf bank_mask:0xf bound_ctrl:0
    s_nop 1
    v_add_f32_dpp v210, v210, v210 row_shr:8 row_mask:0xf bank_mask:0xf bound_ctrl:0
    s_waitcnt lgkmcnt(0)
    v_mfma_f32_16x16x32_bf16 v[64:67], v[172:175], v[128:131], v[64:67]
    ds_read_b128 v[144:147], v11 offset:32768
    v_add_f32_dpp v210, v210, v210 row_bcast:15 row_mask:0xa bank_mask:0xf
    s_add_u32 m0, s39, 50816
    s_nop 0
    buffer_load_dwordx4 v3, s[8:11], 0 offen offset:384 lds
    v_mfma_f32_16x16x32_bf16 v[68:71], v[172:175], v[132:135], v[68:71]
    ds_read_b64_tr_b16 v[160:161], v14 offset:34944
    v_add_f32_dpp v210, v210, v210 row_bcast:31 row_mask:0xc bank_mask:0xf
    v_mfma_f32_16x16x32_bf16 v[72:75], v[172:175], v[136:139], v[72:75]
    ds_read_b64_tr_b16 v[162:163], v14 offset:36224
    v_readlane_b32 s51, v210, 63
    v_mfma_f32_16x16x32_bf16 v[76:79], v[172:175], v[140:143], v[76:79]
    ds_read_b128 v[148:151], v11 offset:34816
    v_mov_b32 v211, 0x3acccccd
    v_mfma_f32_16x16x32_bf16 v[80:83], v[176:179], v[128:131], v[80:83]
    ds_read_b128 v[152:155], v11 offset:36864
    v_mul_f32 v211, s51, v211
    s_add_u32 m0, s39, 51840
    s_nop 0
    buffer_load_dwordx4 v4, s[8:11], 0 offen offset:384 lds
    v_mfma_f32_16x16x32_bf16 v[84:87], v[176:179], v[132:135], v[84:87]
    ds_read_b128 v[156:159], v11 offset:38912
    v_sub_f32 v200, v200, v211
    v_mfma_f32_16x16x32_bf16 v[88:91], v[176:179], v[136:139], v[88:91]
    ds_read_b64_tr_b16 v[164:165], v14 offset:34952
    v_sub_f32 v201, v201, v211
    v_mfma_f32_16x16x32_bf16 v[92:95], v[176:179], v[140:143], v[92:95]
    ds_read_b64_tr_b16 v[166:167], v14 offset:36232
    v_sub_f32 v202, v202, v211
    v_mfma_f32_16x16x32_bf16 v[96:99], v[180:183], v[128:131], v[96:99]
    v_sub_f32 v203, v203, v211
    s_add_u32 m0, s39, 65152
    s_nop 0
    buffer_load_dwordx4 v1, s[8:11], s3 offen offset:384 lds
    v_mfma_f32_16x16x32_bf16 v[100:103], v[180:183], v[132:135], v[100:103]
    v_sub_f32 v204, v204, v211
    v_mfma_f32_16x16x32_bf16 v[104:107], v[180:183], v[136:139], v[104:107]
    v_sub_f32 v205, v205, v211
    v_mfma_f32_16x16x32_bf16 v[108:111], v[180:183], v[140:143], v[108:111]
    v_sub_f32 v206, v206, v211
    s_waitcnt lgkmcnt(0)
    v_mfma_f32_16x16x32_bf16 v[32:35], v[160:163], v[144:147], v[32:35]
    ds_read_b64_tr_b16 v[172:173], v14 offset:34960
    v_sub_f32 v207, v207, v211
    s_add_u32 m0, s39, 66176
    s_nop 0
    buffer_load_dwordx4 v2, s[8:11], s3 offen offset:384 lds
    v_mfma_f32_16x16x32_bf16 v[36:39], v[160:163], v[148:151], v[36:39]
    ds_read_b64_tr_b16 v[174:175], v14 offset:36240
    v_sub_f32 v208, v208, v211
    v_sub_f32 v209, v209, v211
    v_mfma_f32_16x16x32_bf16 v[40:43], v[160:163], v[152:155], v[40:43]
    ds_read_b64_tr_b16 v[176:177], v14 offset:34968
    v_mul_f32 v210, v200, v200
    v_fmac_f32 v210, v201, v201
    v_mfma_f32_16x16x32_bf16 v[44:47], v[160:163], v[156:159], v[44:47]
    ds_read_b64_tr_b16 v[178:179], v14 offset:36248
    s_add_u32 m0, s39, 67200
    s_nop 0
    buffer_load_dwordx4 v3, s[8:11], s3 offen offset:384 lds
    v_fmac_f32 v210, v202, v202
    v_mfma_f32_16x16x32_bf16 v[48:51], v[164:167], v[144:147], v[48:51]
    ds_read_b64_tr_b16 v[180:181], v14 offset:34976
    v_fmac_f32 v210, v203, v203
    v_fmac_f32 v210, v204, v204
    v_mfma_f32_16x16x32_bf16 v[52:55], v[164:167], v[148:151], v[52:55]
    ds_read_b64_tr_b16 v[182:183], v14 offset:36256
    v_fmac_f32 v210, v205, v205
    s_add_u32 m0, s39, 68224
    s_nop 0
    buffer_load_dwordx4 v4, s[8:11], s3 offen offset:384 lds
    v_mfma_f32_16x16x32_bf16 v[56:59], v[164:167], v[152:155], v[56:59]
    v_fmac_f32 v210, v206, v206
    v_fmac_f32 v210, v207, v207
    v_mfma_f32_16x16x32_bf16 v[60:63], v[164:167], v[156:159], v[60:63]
    v_mov_b32 v242, 0
    buffer_load_dwordx2 v[242:243], v242, s[4:7], 0 offen sc1
    s_waitcnt vmcnt(9) lgkmcnt(0)
    s_barrier
    v_mfma_f32_16x16x32_bf16 v[64:67], v[172:175], v[144:147], v[64:67]
    ds_read_b128 v[128:131], v12 offset:0
    v_fmac_f32 v210, v208, v208
    s_add_u32 s45, s41, 122880
    s_add_u32 m0, s40, 34944
    s_nop 0
    buffer_load_dwordx4 v5, s[76:79], s45 offen lds
    v_mfma_f32_16x16x32_bf16 v[68:71], v[172:175], v[148:151], v[68:71]
    ds_read_b64_tr_b16 v[160:161], v14 offset:0
    v_fmac_f32 v210, v209, v209
    v_mfma_f32_16x16x32_bf16 v[72:75], v[172:175], v[152:155], v[72:75]
    ds_read_b64_tr_b16 v[162:163], v14 offset:1280
    v_add_f32_dpp v210, v210, v210 row_shr:1 row_mask:0xf bank_mask:0xf bound_ctrl:0
    v_mfma_f32_16x16x32_bf16 v[76:79], v[172:175], v[156:159], v[76:79]
    ds_read_b128 v[132:135], v12 offset:2048
    v_add_f32_dpp v210, v210, v210 row_shr:2 row_mask:0xf bank_mask:0xf bound_ctrl:0
    s_add_u32 s45, s41, 122880
    s_add_u32 m0, s40, 35968
    s_nop 0
    buffer_load_dwordx4 v6, s[76:79], s45 offen lds
    v_mfma_f32_16x16x32_bf16 v[80:83], v[176:179], v[144:147], v[80:83]
    ds_read_b128 v[136:139], v12 offset:4096
    v_add_f32_dpp v210, v210, v210 row_shr:4 row_mask:0xf bank_mask:0xf bound_ctrl:0
    v_mfma_f32_16x16x32_bf16 v[84:87], v[176:179], v[148:151], v[84:87]
    ds_read_b128 v[140:143], v12 offset:6144
    v_add_f32_dpp v210, v210, v210 row_shr:8 row_mask:0xf bank_mask:0xf bound_ctrl:0
    v_mfma_f32_16x16x32_bf16 v[88:91], v[176:179], v[152:155], v[88:91]
    ds_read_b64_tr_b16 v[164:165], v14 offset:8
    v_add_f32_dpp v210, v210, v210 row_bcast:15 row_mask:0xa bank_mask:0xf
    s_add_u32 s45, s41, 122880
    s_add_u32 m0, s40, 36992
    s_mov_b32 exec_hi, 0
    buffer_load_dwordx4 v7, s[76:79], s45 offen lds
    s_mov_b32 exec_hi, -1
    v_mfma_f32_16x16x32_bf16 v[92:95], v[176:179], v[156:159], v[92:95]
    ds_read_b64_tr_b16 v[166:167], v14 offset:1288
    v_add_f32_dpp v210, v210, v210 row_bcast:31 row_mask:0xc bank_mask:0xf
    v_mfma_f32_16x16x32_bf16 v[96:99], v[180:183], v[144:147], v[96:99]
    v_readlane_b32 s51, v210, 63
    v_mfma_f32_16x16x32_bf16 v[100:103], v[180:183], v[148:151], v[100:103]
    v_mov_b32 v210, 0x3acccccd
    s_add_u32 m0, s40, 24576
    s_nop 0
    buffer_load_dwordx4 v5, s[76:79], s41 offen lds
    v_mfma_f32_16x16x32_bf16 v[104:107], v[180:183], v[152:155], v[104:107]
    v_mul_f32 v210, s51, v210
    v_mfma_f32_16x16x32_bf16 v[108:111], v[180:183], v[156:159], v[108:111]
    v_cvt_pk_bf16_f32 v210, v210, v211
    s_waitcnt lgkmcnt(0)
    v_mfma_f32_16x16x32_bf16 v[32:35], v[160:163], v[128:131], v[32:35]
    ds_read_b64_tr_b16 v[172:173], v14 offset:16
    v_and_b32 v200, 0xffff0000, v210
    s_add_u32 m0, s40, 25600
    s_nop 0
    buffer_load_dwordx4 v6, s[76:79], s41 offen lds
    v_mfma_f32_16x16x32_bf16 v[36:39], v[160:163], v[132:135], v[36:39]
    ds_read_b64_tr_b16 v[174:175], v14 offset:1296
    v_lshlrev_b32 v210, 16, v210
    v_add_f32 v210, 0x3727c5ac, v210
    v_mfma_f32_16x16x32_bf16 v[40:43], v[160:163], v[136:139], v[40:43]
    ds_read_b64_tr_b16 v[176:177], v14 offset:24
    v_cvt_pk_bf16_f32 v210, v210, v210
    s_add_u32 m0, s40, 26624
    s_mov_b32 exec_hi, 0
    buffer_load_dwordx4 v7, s[76:79], s41 offen lds
    s_mov_b32 exec_hi, -1
    s_add_u32 s41, s41, s49
    v_mfma_f32_16x16x32_bf16 v[44:47], v[160:163], v[140:143], v[44:47]
    ds_read_b64_tr_b16 v[178:179], v14 offset:1304
    v_lshlrev_b32 v210, 16, v210
    v_sqrt_f32 v210, v210
    v_mfma_f32_16x16x32_bf16 v[48:51], v[164:167], v[128:131], v[48:51]
    ds_read_b64_tr_b16 v[180:181], v14 offset:32
    v_cvt_pk_bf16_f32 v210, v210, v210
    s_add_u32 m0, s39, 81408
    s_nop 0
    buffer_load_dwordx4 v1, s[8:11], 0 offen offset:512 lds
    v_mfma_f32_16x16x32_bf16 v[52:55], v[164:167], v[132:135], v[52:55]
    ds_read_b64_tr_b16 v[182:183], v14 offset:1312
    v_lshlrev_b32 v201, 16, v210
    s_lshl_b32 s51, s50, 3
    v_mfma_f32_16x16x32_bf16 v[56:59], v[164:167], v[136:139], v[56:59]
    s_add_u32 s51, s51, 32768
    s_add_u32 m0, s39, 82432
    s_nop 0
    buffer_load_dwordx4 v2, s[8:11], 0 offen offset:512 lds
    v_mfma_f32_16x16x32_bf16 v[60:63], v[164:167], v[140:143], v[60:63]
    v_mov_b32 v210, 0
    s_mov_b64 exec, 1
    buffer_store_dwordx2 v[200:201], v210, s[20:23], s51 offen sc1
    s_mov_b64 exec, -1
    s_waitcnt lgkmcnt(0)
    v_mfma_f32_16x16x32_bf16 v[64:67], v[172:175], v[128:131], v[64:67]
    ds_read_b128 v[144:147], v13 offset:0
    s_add_u32 m0, s39, 83456
    s_nop 0
    buffer_load_dwordx4 v3, s[8:11], 0 offen offset:512 lds
    v_mfma_f32_16x16x32_bf16 v[68:71], v[172:175], v[132:135], v[68:71]
    ds_read_b64_tr_b16 v[160:161], v14 offset:10368
    v_mfma_f32_16x16x32_bf16 v[72:75], v[172:175], v[136:139], v[72:75]
    ds_read_b64_tr_b16 v[162:163], v14 offset:11648
    v_mfma_f32_16x16x32_bf16 v[76:79], v[172:175], v[140:143], v[76:79]
    ds_read_b128 v[148:151], v13 offset:2048
    v_mfma_f32_16x16x32_bf16 v[80:83], v[176:179], v[128:131], v[80:83]
    ds_read_b128 v[152:155], v13 offset:4096
    s_add_u32 m0, s39, 84480
    s_nop 0
    buffer_load_dwordx4 v4, s[8:11], 0 offen offset:512 lds
    v_mfma_f32_16x16x32_bf16 v[84:87], v[176:179], v[132:135], v[84:87]
    ds_read_b128 v[156:159], v13 offset:6144
    v_mfma_f32_16x16x32_bf16 v[88:91], v[176:179], v[136:139], v[88:91]
    ds_read_b64_tr_b16 v[164:165], v14 offset:10376
    v_mfma_f32_16x16x32_bf16 v[92:95], v[176:179], v[140:143], v[92:95]
    ds_read_b64_tr_b16 v[166:167], v14 offset:11656
    v_mfma_f32_16x16x32_bf16 v[96:99], v[180:183], v[128:131], v[96:99]
    s_add_u32 m0, s39, 97792
    s_nop 0
    buffer_load_dwordx4 v1, s[8:11], s3 offen offset:512 lds
    v_mfma_f32_16x16x32_bf16 v[100:103], v[180:183], v[132:135], v[100:103]
    v_mfma_f32_16x16x32_bf16 v[104:107], v[180:183], v[136:139], v[104:107]
    v_mfma_f32_16x16x32_bf16 v[108:111], v[180:183], v[140:143], v[108:111]
    s_waitcnt lgkmcnt(0)
    v_mfma_f32_16x16x32_bf16 v[32:35], v[160:163], v[144:147], v[32:35]
    ds_read_b64_tr_b16 v[172:173], v14 offset:10384
    s_add_u32 m0, s39, 98816
    s_nop 0
    buffer_load_dwordx4 v2, s[8:11], s3 offen offset:512 lds
    v_mfma_f32_16x16x32_bf16 v[36:39], v[160:163], v[148:151], v[36:39]
    ds_read_b64_tr_b16 v[174:175], v14 offset:11664
    v_mfma_f32_16x16x32_bf16 v[40:43], v[160:163], v[152:155], v[40:43]
    ds_read_b64_tr_b16 v[176:177], v14 offset:10392
    s_add_u32 m0, s39, 99840
    s_nop 0
    buffer_load_dwordx4 v3, s[8:11], s3 offen offset:512 lds
    v_mfma_f32_16x16x32_bf16 v[44:47], v[160:163], v[156:159], v[44:47]
    ds_read_b64_tr_b16 v[178:179], v14 offset:11672
    v_mfma_f32_16x16x32_bf16 v[48:51], v[164:167], v[144:147], v[48:51]
    ds_read_b64_tr_b16 v[180:181], v14 offset:10400
    v_mfma_f32_16x16x32_bf16 v[52:55], v[164:167], v[148:151], v[52:55]
    ds_read_b64_tr_b16 v[182:183], v14 offset:11680
    s_add_u32 m0, s39, 100864
    s_nop 0
    buffer_load_dwordx4 v4, s[8:11], s3 offen offset:512 lds
    v_mfma_f32_16x16x32_bf16 v[56:59], v[164:167], v[152:155], v[56:59]
    v_mfma_f32_16x16x32_bf16 v[60:63], v[164:167], v[156:159], v[60:63]
    s_waitcnt vmcnt(9) lgkmcnt(0)
    s_barrier
    s_waitcnt vmcnt(15)
    v_readfirstlane_b32 s82, v242
    v_readfirstlane_b32 s83, v243
    s_cmp_lg_u32 s82, 0
    s_cbranch_scc1 QKVL_NON_OK
    s_mov_b32 s81, 0
QKVL_NON_SP:
    s_sleep 2
    v_mov_b32 v242, 0
    buffer_load_dwordx2 v[242:243], v242, s[4:7], 0 offen sc1
    s_waitcnt vmcnt(0)
    v_readfirstlane_b32 s82, v242
    v_readfirstlane_b32 s83, v243
    s_add_u32 s81, s81, 1
    s_cmp_ge_u32 s81, 200000
    s_cbranch_scc1 QKVL_NON_OK
    s_cmp_eq_u32 s82, 0
    s_cbranch_scc1 QKVL_NON_SP
QKVL_NON_OK:
    v_mfma_f32_16x16x32_bf16 v[64:67], v[172:175], v[144:147], v[64:67]
    ds_read_b128 v[128:131], v10 offset:0
    s_add_u32 s45, s41, 122880
    s_add_u32 m0, s40, 10368
    s_nop 0
    buffer_load_dwordx4 v5, s[76:79], s45 offen lds
    v_mfma_f32_16x16x32_bf16 v[68:71], v[172:175], v[148:151], v[68:71]
    ds_read_b64_tr_b16 v[160:161], v14 offset:24576
    v_mfma_f32_16x16x32_bf16 v[72:75], v[172:175], v[152:155], v[72:75]
    ds_read_b64_tr_b16 v[162:163], v14 offset:25856
    v_mfma_f32_16x16x32_bf16 v[76:79], v[172:175], v[156:159], v[76:79]
    ds_read_b128 v[132:135], v10 offset:2048
    s_add_u32 s45, s41, 122880
    s_add_u32 m0, s40, 11392
    s_nop 0
    buffer_load_dwordx4 v6, s[76:79], s45 offen lds
    v_mfma_f32_16x16x32_bf16 v[80:83], v[176:179], v[144:147], v[80:83]
    ds_read_b128 v[136:139], v10 offset:4096
    v_mfma_f32_16x16x32_bf16 v[84:87], v[176:179], v[148:151], v[84:87]
    ds_read_b128 v[140:143], v10 offset:6144
    v_mfma_f32_16x16x32_bf16 v[88:91], v[176:179], v[152:155], v[88:91]
    ds_read_b64_tr_b16 v[164:165], v14 offset:24584
    s_add_u32 s45, s41, 122880
    s_add_u32 m0, s40, 12416
    s_mov_b32 exec_hi, 0
    buffer_load_dwordx4 v7, s[76:79], s45 offen lds
    s_mov_b32 exec_hi, -1
    v_mfma_f32_16x16x32_bf16 v[92:95], v[176:179], v[156:159], v[92:95]
    ds_read_b64_tr_b16 v[166:167], v14 offset:25864
    v_mfma_f32_16x16x32_bf16 v[96:99], v[180:183], v[144:147], v[96:99]
    v_mfma_f32_16x16x32_bf16 v[100:103], v[180:183], v[148:151], v[100:103]
    s_add_u32 m0, s40, 0
    s_nop 0
    buffer_load_dwordx4 v5, s[76:79], s41 offen lds
    v_mfma_f32_16x16x32_bf16 v[104:107], v[180:183], v[152:155], v[104:107]
    v_mfma_f32_16x16x32_bf16 v[108:111], v[180:183], v[156:159], v[108:111]
    s_waitcnt lgkmcnt(0)
    v_mfma_f32_16x16x32_bf16 v[32:35], v[160:163], v[128:131], v[32:35]
    ds_read_b64_tr_b16 v[172:173], v14 offset:24592
    s_add_u32 m0, s40, 1024
    s_nop 0
    buffer_load_dwordx4 v6, s[76:79], s41 offen lds
    v_mfma_f32_16x16x32_bf16 v[36:39], v[160:163], v[132:135], v[36:39]
    ds_read_b64_tr_b16 v[174:175], v14 offset:25872
    v_mfma_f32_16x16x32_bf16 v[40:43], v[160:163], v[136:139], v[40:43]
    ds_read_b64_tr_b16 v[176:177], v14 offset:24600
    s_add_u32 m0, s40, 2048
    s_mov_b32 exec_hi, 0
    buffer_load_dwordx4 v7, s[76:79], s41 offen lds
    s_mov_b32 exec_hi, -1
    s_add_u32 s41, s41, s49
    v_mfma_f32_16x16x32_bf16 v[44:47], v[160:163], v[140:143], v[44:47]
    ds_read_b64_tr_b16 v[178:179], v14 offset:25880
    v_mfma_f32_16x16x32_bf16 v[48:51], v[164:167], v[128:131], v[48:51]
    ds_read_b64_tr_b16 v[180:181], v14 offset:24608
    s_add_u32 m0, s39, 114048
    s_nop 0
    buffer_load_dwordx4 v1, s[8:11], 0 offen offset:640 lds
    v_mfma_f32_16x16x32_bf16 v[52:55], v[164:167], v[132:135], v[52:55]
    ds_read_b64_tr_b16 v[182:183], v14 offset:25888
    v_mfma_f32_16x16x32_bf16 v[56:59], v[164:167], v[136:139], v[56:59]
    s_add_u32 m0, s39, 115072
    s_nop 0
    buffer_load_dwordx4 v2, s[8:11], 0 offen offset:640 lds
    v_mfma_f32_16x16x32_bf16 v[60:63], v[164:167], v[140:143], v[60:63]
    s_waitcnt lgkmcnt(0)
    v_mfma_f32_16x16x32_bf16 v[64:67], v[172:175], v[128:131], v[64:67]
    ds_read_b128 v[144:147], v11 offset:0
    s_add_u32 m0, s39, 116096
    s_nop 0
    buffer_load_dwordx4 v3, s[8:11], 0 offen offset:640 lds
    v_mfma_f32_16x16x32_bf16 v[68:71], v[172:175], v[132:135], v[68:71]
    ds_read_b64_tr_b16 v[160:161], v14 offset:34944
    v_mfma_f32_16x16x32_bf16 v[72:75], v[172:175], v[136:139], v[72:75]
    ds_read_b64_tr_b16 v[162:163], v14 offset:36224
    v_mfma_f32_16x16x32_bf16 v[76:79], v[172:175], v[140:143], v[76:79]
    ds_read_b128 v[148:151], v11 offset:2048
    v_mfma_f32_16x16x32_bf16 v[80:83], v[176:179], v[128:131], v[80:83]
    ds_read_b128 v[152:155], v11 offset:4096
    s_add_u32 m0, s39, 117120
    s_nop 0
    buffer_load_dwordx4 v4, s[8:11], 0 offen offset:640 lds
    v_mfma_f32_16x16x32_bf16 v[84:87], v[176:179], v[132:135], v[84:87]
    ds_read_b128 v[156:159], v11 offset:6144
    v_mfma_f32_16x16x32_bf16 v[88:91], v[176:179], v[136:139], v[88:91]
    ds_read_b64_tr_b16 v[164:165], v14 offset:34952
    v_mfma_f32_16x16x32_bf16 v[92:95], v[176:179], v[140:143], v[92:95]
    ds_read_b64_tr_b16 v[166:167], v14 offset:36232
    v_mfma_f32_16x16x32_bf16 v[96:99], v[180:183], v[128:131], v[96:99]
    s_add_u32 m0, s39, 130432
    s_nop 0
    buffer_load_dwordx4 v1, s[8:11], s3 offen offset:640 lds
    v_mfma_f32_16x16x32_bf16 v[100:103], v[180:183], v[132:135], v[100:103]
    v_mfma_f32_16x16x32_bf16 v[104:107], v[180:183], v[136:139], v[104:107]
    v_mfma_f32_16x16x32_bf16 v[108:111], v[180:183], v[140:143], v[108:111]
    s_waitcnt lgkmcnt(0)
    v_mfma_f32_16x16x32_bf16 v[32:35], v[160:163], v[144:147], v[32:35]
    ds_read_b64_tr_b16 v[172:173], v14 offset:34960
    s_add_u32 m0, s39, 131456
    s_nop 0
    buffer_load_dwordx4 v2, s[8:11], s3 offen offset:640 lds
    v_mfma_f32_16x16x32_bf16 v[36:39], v[160:163], v[148:151], v[36:39]
    ds_read_b64_tr_b16 v[174:175], v14 offset:36240
    v_mfma_f32_16x16x32_bf16 v[40:43], v[160:163], v[152:155], v[40:43]
    ds_read_b64_tr_b16 v[176:177], v14 offset:34968
    s_add_u32 m0, s39, 132480
    s_nop 0
    buffer_load_dwordx4 v3, s[8:11], s3 offen offset:640 lds
    v_mfma_f32_16x16x32_bf16 v[44:47], v[160:163], v[156:159], v[44:47]
    ds_read_b64_tr_b16 v[178:179], v14 offset:36248
    v_mfma_f32_16x16x32_bf16 v[48:51], v[164:167], v[144:147], v[48:51]
    ds_read_b64_tr_b16 v[180:181], v14 offset:34976
    v_mfma_f32_16x16x32_bf16 v[52:55], v[164:167], v[148:151], v[52:55]
    ds_read_b64_tr_b16 v[182:183], v14 offset:36256
    s_add_u32 m0, s39, 133504
    s_nop 0
    buffer_load_dwordx4 v4, s[8:11], s3 offen offset:640 lds
    v_mfma_f32_16x16x32_bf16 v[56:59], v[164:167], v[152:155], v[56:59]
    v_mfma_f32_16x16x32_bf16 v[60:63], v[164:167], v[156:159], v[60:63]
    s_waitcnt vmcnt(8) lgkmcnt(0)
    s_barrier
    v_mfma_f32_16x16x32_bf16 v[64:67], v[172:175], v[144:147], v[64:67]
    ds_read_b128 v[128:131], v10 offset:32768
    s_add_u32 s45, s41, 122880
    s_add_u32 m0, s40, 34944
    s_nop 0
    buffer_load_dwordx4 v5, s[76:79], s45 offen lds
    v_mfma_f32_16x16x32_bf16 v[68:71], v[172:175], v[148:151], v[68:71]
    ds_read_b64_tr_b16 v[160:161], v14 offset:0
    v_mfma_f32_16x16x32_bf16 v[72:75], v[172:175], v[152:155], v[72:75]
    ds_read_b64_tr_b16 v[162:163], v14 offset:1280
    v_mfma_f32_16x16x32_bf16 v[76:79], v[172:175], v[156:159], v[76:79]
    ds_read_b128 v[132:135], v10 offset:34816
    s_add_u32 s45, s41, 122880
    s_add_u32 m0, s40, 35968
    s_nop 0
    buffer_load_dwordx4 v6, s[76:79], s45 offen lds
    v_mfma_f32_16x16x32_bf16 v[80:83], v[176:179], v[144:147], v[80:83]
    ds_read_b128 v[136:139], v10 offset:36864
    v_mfma_f32_16x16x32_bf16 v[84:87], v[176:179], v[148:151], v[84:87]
    ds_read_b128 v[140:143], v10 offset:38912
    v_mfma_f32_16x16x32_bf16 v[88:91], v[176:179], v[152:155], v[88:91]
    ds_read_b64_tr_b16 v[164:165], v14 offset:8
    s_add_u32 s45, s41, 122880
    s_add_u32 m0, s40, 36992
    s_mov_b32 exec_hi, 0
    buffer_load_dwordx4 v7, s[76:79], s45 offen lds
    s_mov_b32 exec_hi, -1
    v_mfma_f32_16x16x32_bf16 v[92:95], v[176:179], v[156:159], v[92:95]
    ds_read_b64_tr_b16 v[166:167], v14 offset:1288
    v_mfma_f32_16x16x32_bf16 v[96:99], v[180:183], v[144:147], v[96:99]
    v_mfma_f32_16x16x32_bf16 v[100:103], v[180:183], v[148:151], v[100:103]
    s_add_u32 m0, s40, 24576
    s_nop 0
    buffer_load_dwordx4 v5, s[76:79], s41 offen lds
    v_mfma_f32_16x16x32_bf16 v[104:107], v[180:183], v[152:155], v[104:107]
    v_mfma_f32_16x16x32_bf16 v[108:111], v[180:183], v[156:159], v[108:111]
    s_waitcnt lgkmcnt(0)
    v_mfma_f32_16x16x32_bf16 v[32:35], v[160:163], v[128:131], v[32:35]
    ds_read_b64_tr_b16 v[172:173], v14 offset:16
    v_and_b32 v30, 3, v0
    v_mfma_f32_16x16x32_bf16 v[36:39], v[160:163], v[132:135], v[36:39]
    ds_read_b64_tr_b16 v[174:175], v14 offset:1296
    s_add_u32 m0, s40, 25600
    s_nop 0
    buffer_load_dwordx4 v6, s[76:79], s41 offen lds
    v_mfma_f32_16x16x32_bf16 v[40:43], v[160:163], v[136:139], v[40:43]
    ds_read_b64_tr_b16 v[176:177], v14 offset:24
    v_mfma_f32_16x16x32_bf16 v[44:47], v[160:163], v[140:143], v[44:47]
    ds_read_b64_tr_b16 v[178:179], v14 offset:1304
    s_add_u32 m0, s40, 26624
    s_mov_b32 exec_hi, 0
    buffer_load_dwordx4 v7, s[76:79], s41 offen lds
    s_mov_b32 exec_hi, -1
    s_add_u32 s41, s41, s49
    v_mfma_f32_16x16x32_bf16 v[48:51], v[164:167], v[128:131], v[48:51]
    ds_read_b64_tr_b16 v[180:181], v14 offset:32
    s_add_u32 m0, s39, 48384
    s_nop 0
    buffer_load_dwordx4 v1, s[8:11], 0 offen offset:768 lds
    v_mfma_f32_16x16x32_bf16 v[52:55], v[164:167], v[132:135], v[52:55]
    ds_read_b64_tr_b16 v[182:183], v14 offset:1312
    v_mfma_f32_16x16x32_bf16 v[56:59], v[164:167], v[136:139], v[56:59]
    s_add_u32 m0, s39, 49408
    s_nop 0
    buffer_load_dwordx4 v2, s[8:11], 0 offen offset:768 lds
    v_mfma_f32_16x16x32_bf16 v[60:63], v[164:167], v[140:143], v[60:63]
    s_waitcnt lgkmcnt(0)
    v_mfma_f32_16x16x32_bf16 v[64:67], v[172:175], v[128:131], v[64:67]
    ds_read_b128 v[144:147], v11 offset:32768
    v_bfe_u32 v16, v0, 2, 2
    v_mfma_f32_16x16x32_bf16 v[68:71], v[172:175], v[132:135], v[68:71]
    ds_read_b64_tr_b16 v[160:161], v14 offset:10368
    v_mfma_f32_16x16x32_bf16 v[72:75], v[172:175], v[136:139], v[72:75]
    ds_read_b64_tr_b16 v[162:163], v14 offset:11648
    s_add_u32 m0, s39, 50432
    s_nop 0
    buffer_load_dwordx4 v3, s[8:11], 0 offen offset:768 lds
    v_mfma_f32_16x16x32_bf16 v[76:79], v[172:175], v[140:143], v[76:79]
    ds_read_b128 v[148:151], v11 offset:34816
    v_mfma_f32_16x16x32_bf16 v[80:83], v[176:179], v[128:131], v[80:83]
    ds_read_b128 v[152:155], v11 offset:36864
    s_add_u32 m0, s39, 51456
    s_nop 0
    buffer_load_dwordx4 v4, s[8:11], 0 offen offset:768 lds
    v_mfma_f32_16x16x32_bf16 v[84:87], v[176:179], v[132:135], v[84:87]
    ds_read_b128 v[156:159], v11 offset:38912
    v_mfma_f32_16x16x32_bf16 v[88:91], v[176:179], v[136:139], v[88:91]
    ds_read_b64_tr_b16 v[164:165], v14 offset:10376
    v_mfma_f32_16x16x32_bf16 v[92:95], v[176:179], v[140:143], v[92:95]
    ds_read_b64_tr_b16 v[166:167], v14 offset:11656
    v_lshl_add_u32 v30, v16, 3, v30
    v_mfma_f32_16x16x32_bf16 v[96:99], v[180:183], v[128:131], v[96:99]
    v_mfma_f32_16x16x32_bf16 v[100:103], v[180:183], v[132:135], v[100:103]
    s_add_u32 m0, s39, 64768
    s_nop 0
    buffer_load_dwordx4 v1, s[8:11], s3 offen offset:768 lds
    v_mfma_f32_16x16x32_bf16 v[104:107], v[180:183], v[136:139], v[104:107]
    v_mfma_f32_16x16x32_bf16 v[108:111], v[180:183], v[140:143], v[108:111]
    s_waitcnt lgkmcnt(0)
    v_mfma_f32_16x16x32_bf16 v[32:35], v[160:163], v[144:147], v[32:35]
    ds_read_b64_tr_b16 v[172:173], v14 offset:10384
    v_add_u32 v30, 228, v30
    v_mfma_f32_16x16x32_bf16 v[36:39], v[160:163], v[148:151], v[36:39]
    ds_read_b64_tr_b16 v[174:175], v14 offset:11664
    s_add_u32 m0, s39, 65792
    s_nop 0
    buffer_load_dwordx4 v2, s[8:11], s3 offen offset:768 lds
    v_mfma_f32_16x16x32_bf16 v[40:43], v[160:163], v[152:155], v[40:43]
    ds_read_b64_tr_b16 v[176:177], v14 offset:10392
    v_mfma_f32_16x16x32_bf16 v[44:47], v[160:163], v[156:159], v[44:47]
    ds_read_b64_tr_b16 v[178:179], v14 offset:11672
    s_add_u32 m0, s39, 66816
    s_nop 0
    buffer_load_dwordx4 v3, s[8:11], s3 offen offset:768 lds
    v_mfma_f32_16x16x32_bf16 v[48:51], v[164:167], v[144:147], v[48:51]
    ds_read_b64_tr_b16 v[180:181], v14 offset:10400
    v_lshlrev_b32 v30, 7, v30
    v_mfma_f32_16x16x32_bf16 v[52:55], v[164:167], v[148:151], v[52:55]
    ds_read_b64_tr_b16 v[182:183], v14 offset:11680
    v_mfma_f32_16x16x32_bf16 v[56:59], v[164:167], v[152:155], v[56:59]
    s_add_u32 m0, s39, 67840
    s_nop 0
    buffer_load_dwordx4 v4, s[8:11], s3 offen offset:768 lds
    v_mfma_f32_16x16x32_bf16 v[60:63], v[164:167], v[156:159], v[60:63]
    s_waitcnt vmcnt(8) lgkmcnt(0)
    s_barrier
    v_mfma_f32_16x16x32_bf16 v[64:67], v[172:175], v[144:147], v[64:67]
    ds_read_b128 v[128:131], v12 offset:0
    s_add_u32 s45, s41, 122880
    s_add_u32 m0, s40, 10368
    s_nop 0
    buffer_load_dwordx4 v5, s[76:79], s45 offen lds
    v_mfma_f32_16x16x32_bf16 v[68:71], v[172:175], v[148:151], v[68:71]
    ds_read_b64_tr_b16 v[160:161], v14 offset:24576
    v_mfma_f32_16x16x32_bf16 v[72:75], v[172:175], v[152:155], v[72:75]
    ds_read_b64_tr_b16 v[162:163], v14 offset:25856
    v_mfma_f32_16x16x32_bf16 v[76:79], v[172:175], v[156:159], v[76:79]
    ds_read_b128 v[132:135], v12 offset:2048
    s_add_u32 s45, s41, 122880
    s_add_u32 m0, s40, 11392
    s_nop 0
    buffer_load_dwordx4 v6, s[76:79], s45 offen lds
    v_mfma_f32_16x16x32_bf16 v[80:83], v[176:179], v[144:147], v[80:83]
    ds_read_b128 v[136:139], v12 offset:4096
    v_mfma_f32_16x16x32_bf16 v[84:87], v[176:179], v[148:151], v[84:87]
    ds_read_b128 v[140:143], v12 offset:6144
    v_mfma_f32_16x16x32_bf16 v[88:91], v[176:179], v[152:155], v[88:91]
    ds_read_b64_tr_b16 v[164:165], v14 offset:24584
    s_add_u32 s45, s41, 122880
    s_add_u32 m0, s40, 12416
    s_mov_b32 exec_hi, 0
    buffer_load_dwordx4 v7, s[76:79], s45 offen lds
    s_mov_b32 exec_hi, -1
    v_mfma_f32_16x16x32_bf16 v[92:95], v[176:179], v[156:159], v[92:95]
    ds_read_b64_tr_b16 v[166:167], v14 offset:25864
    v_mfma_f32_16x16x32_bf16 v[96:99], v[180:183], v[144:147], v[96:99]
    v_mfma_f32_16x16x32_bf16 v[100:103], v[180:183], v[148:151], v[100:103]
    s_add_u32 m0, s40, 0
    s_nop 0
    buffer_load_dwordx4 v5, s[76:79], s41 offen lds
    v_mfma_f32_16x16x32_bf16 v[104:107], v[180:183], v[152:155], v[104:107]
    v_mfma_f32_16x16x32_bf16 v[108:111], v[180:183], v[156:159], v[108:111]
    s_waitcnt lgkmcnt(0)
    v_mfma_f32_16x16x32_bf16 v[32:35], v[160:163], v[128:131], v[32:35]
    ds_read_b64_tr_b16 v[172:173], v14 offset:24592
    s_add_u32 m0, s40, 1024
    s_nop 0
    buffer_load_dwordx4 v6, s[76:79], s41 offen lds
    v_mfma_f32_16x16x32_bf16 v[36:39], v[160:163], v[132:135], v[36:39]
    ds_read_b64_tr_b16 v[174:175], v14 offset:25872
    v_mfma_f32_16x16x32_bf16 v[40:43], v[160:163], v[136:139], v[40:43]
    ds_read_b64_tr_b16 v[176:177], v14 offset:24600
    s_add_u32 m0, s40, 2048
    s_mov_b32 exec_hi, 0
    buffer_load_dwordx4 v7, s[76:79], s41 offen lds
    s_mov_b32 exec_hi, -1
    s_add_u32 s41, s41, s49
    v_mfma_f32_16x16x32_bf16 v[44:47], v[160:163], v[140:143], v[44:47]
    ds_read_b64_tr_b16 v[178:179], v14 offset:25880
    v_mfma_f32_16x16x32_bf16 v[48:51], v[164:167], v[128:131], v[48:51]
    ds_read_b64_tr_b16 v[180:181], v14 offset:24608
    s_add_u32 m0, s39, 81024
    s_nop 0
    buffer_load_dwordx4 v1, s[8:11], 0 offen offset:896 lds
    v_mfma_f32_16x16x32_bf16 v[52:55], v[164:167], v[132:135], v[52:55]
    ds_read_b64_tr_b16 v[182:183], v14 offset:25888
    v_mfma_f32_16x16x32_bf16 v[56:59], v[164:167], v[136:139], v[56:59]
    s_add_u32 m0, s39, 82048
    s_nop 0
    buffer_load_dwordx4 v2, s[8:11], 0 offen offset:896 lds
    v_mfma_f32_16x16x32_bf16 v[60:63], v[164:167], v[140:143], v[60:63]
    s_waitcnt lgkmcnt(0)
    v_mfma_f32_16x16x32_bf16 v[64:67], v[172:175], v[128:131], v[64:67]
    ds_read_b128 v[144:147], v13 offset:0
    s_add_u32 m0, s39, 83072
    s_nop 0
    buffer_load_dwordx4 v3, s[8:11], 0 offen offset:896 lds
    v_mfma_f32_16x16x32_bf16 v[68:71], v[172:175], v[132:135], v[68:71]
    ds_read_b64_tr_b16 v[160:161], v14 offset:34944
    v_mfma_f32_16x16x32_bf16 v[72:75], v[172:175], v[136:139], v[72:75]
    ds_read_b64_tr_b16 v[162:163], v14 offset:36224
    v_mfma_f32_16x16x32_bf16 v[76:79], v[172:175], v[140:143], v[76:79]
    ds_read_b128 v[148:151], v13 offset:2048
    v_mfma_f32_16x16x32_bf16 v[80:83], v[176:179], v[128:131], v[80:83]
    ds_read_b128 v[152:155], v13 offset:4096
    s_add_u32 m0, s39, 84096
    s_nop 0
    buffer_load_dwordx4 v4, s[8:11], 0 offen offset:896 lds
    v_mfma_f32_16x16x32_bf16 v[84:87], v[176:179], v[132:135], v[84:87]
    ds_read_b128 v[156:159], v13 offset:6144
    v_mfma_f32_16x16x32_bf16 v[88:91], v[176:179], v[136:139], v[88:91]
    ds_read_b64_tr_b16 v[164:165], v14 offset:34952
    v_mfma_f32_16x16x32_bf16 v[92:95], v[176:179], v[140:143], v[92:95]
    ds_read_b64_tr_b16 v[166:167], v14 offset:36232
    v_mfma_f32_16x16x32_bf16 v[96:99], v[180:183], v[128:131], v[96:99]
    s_add_u32 m0, s39, 97408
    s_nop 0
    buffer_load_dwordx4 v1, s[8:11], s3 offen offset:896 lds
    v_mfma_f32_16x16x32_bf16 v[100:103], v[180:183], v[132:135], v[100:103]
    v_mfma_f32_16x16x32_bf16 v[104:107], v[180:183], v[136:139], v[104:107]
    v_mfma_f32_16x16x32_bf16 v[108:111], v[180:183], v[140:143], v[108:111]
    s_waitcnt lgkmcnt(0)
    v_mfma_f32_16x16x32_bf16 v[32:35], v[160:163], v[144:147], v[32:35]
    ds_read_b64_tr_b16 v[172:173], v14 offset:34960
    s_add_u32 m0, s39, 98432
    s_nop 0
    buffer_load_dwordx4 v2, s[8:11], s3 offen offset:896 lds
    v_mfma_f32_16x16x32_bf16 v[36:39], v[160:163], v[148:151], v[36:39]
    ds_read_b64_tr_b16 v[174:175], v14 offset:36240
    v_mfma_f32_16x16x32_bf16 v[40:43], v[160:163], v[152:155], v[40:43]
    ds_read_b64_tr_b16 v[176:177], v14 offset:34968
    s_add_u32 m0, s39, 99456
    s_nop 0
    buffer_load_dwordx4 v3, s[8:11], s3 offen offset:896 lds
    v_mfma_f32_16x16x32_bf16 v[44:47], v[160:163], v[156:159], v[44:47]
    ds_read_b64_tr_b16 v[178:179], v14 offset:36248
    v_mfma_f32_16x16x32_bf16 v[48:51], v[164:167], v[144:147], v[48:51]
    ds_read_b64_tr_b16 v[180:181], v14 offset:34976
    v_mfma_f32_16x16x32_bf16 v[52:55], v[164:167], v[148:151], v[52:55]
    ds_read_b64_tr_b16 v[182:183], v14 offset:36256
    s_add_u32 m0, s39, 100480
    s_nop 0
    buffer_load_dwordx4 v4, s[8:11], s3 offen offset:896 lds
    v_mfma_f32_16x16x32_bf16 v[56:59], v[164:167], v[152:155], v[56:59]
    v_mfma_f32_16x16x32_bf16 v[60:63], v[164:167], v[156:159], v[60:63]
    s_waitcnt vmcnt(8) lgkmcnt(0)
    s_barrier
    v_mfma_f32_16x16x32_bf16 v[64:67], v[172:175], v[144:147], v[64:67]
    ds_read_b128 v[128:131], v10 offset:0
    v_lshlrev_b32 v8, 4, v0
    v_mfma_f32_16x16x32_bf16 v[68:71], v[172:175], v[148:151], v[68:71]
    ds_read_b64_tr_b16 v[160:161], v14 offset:0
    v_mfma_f32_16x16x32_bf16 v[72:75], v[172:175], v[152:155], v[72:75]
    ds_read_b64_tr_b16 v[162:163], v14 offset:1280
    s_add_u32 s45, s41, 122880
    s_add_u32 m0, s40, 34944
    s_nop 0
    buffer_load_dwordx4 v5, s[76:79], s45 offen lds
    v_mfma_f32_16x16x32_bf16 v[76:79], v[172:175], v[156:159], v[76:79]
    ds_read_b128 v[132:135], v10 offset:2048
    v_mfma_f32_16x16x32_bf16 v[80:83], v[176:179], v[144:147], v[80:83]
    ds_read_b128 v[136:139], v10 offset:4096
    s_add_u32 s45, s41, 122880
    s_add_u32 m0, s40, 35968
    s_nop 0
    buffer_load_dwordx4 v6, s[76:79], s45 offen lds
    v_mfma_f32_16x16x32_bf16 v[84:87], v[176:179], v[148:151], v[84:87]
    ds_read_b128 v[140:143], v10 offset:6144
    v_mfma_f32_16x16x32_bf16 v[88:91], v[176:179], v[152:155], v[88:91]
    ds_read_b64_tr_b16 v[164:165], v14 offset:8
    v_add_u32 v9, 4096, v8
    v_mfma_f32_16x16x32_bf16 v[92:95], v[176:179], v[156:159], v[92:95]
    ds_read_b64_tr_b16 v[166:167], v14 offset:1288
    v_mfma_f32_16x16x32_bf16 v[96:99], v[180:183], v[144:147], v[96:99]
    s_add_u32 s45, s41, 122880
    s_add_u32 m0, s40, 36992
    s_mov_b32 exec_hi, 0
    buffer_load_dwordx4 v7, s[76:79], s45 offen lds
    s_mov_b32 exec_hi, -1
    v_mfma_f32_16x16x32_bf16 v[100:103], v[180:183], v[148:151], v[100:103]
    v_mfma_f32_16x16x32_bf16 v[104:107], v[180:183], v[152:155], v[104:107]
    s_add_u32 m0, s40, 24576
    s_nop 0
    buffer_load_dwordx4 v5, s[76:79], s41 offen lds
    v_mfma_f32_16x16x32_bf16 v[108:111], v[180:183], v[156:159], v[108:111]
    s_waitcnt lgkmcnt(0)
    v_mfma_f32_16x16x32_bf16 v[32:35], v[160:163], v[128:131], v[32:35]
    ds_read_b64_tr_b16 v[172:173], v14 offset:16
    s_mul_i32 s29, s32, 10240
    v_mfma_f32_16x16x32_bf16 v[36:39], v[160:163], v[132:135], v[36:39]
    ds_read_b64_tr_b16 v[174:175], v14 offset:1296
    s_add_u32 m0, s40, 25600
    s_nop 0
    buffer_load_dwordx4 v6, s[76:79], s41 offen lds
    v_mfma_f32_16x16x32_bf16 v[40:43], v[160:163], v[136:139], v[40:43]
    ds_read_b64_tr_b16 v[176:177], v14 offset:24
    s_add_u32 m0, s40, 26624
    s_mov_b32 exec_hi, 0
    buffer_load_dwordx4 v7, s[76:79], s41 offen lds
    s_mov_b32 exec_hi, -1
    s_add_u32 s41, s41, s49
    v_mfma_f32_16x16x32_bf16 v[44:47], v[160:163], v[140:143], v[44:47]
    ds_read_b64_tr_b16 v[178:179], v14 offset:1304
    v_mfma_f32_16x16x32_bf16 v[48:51], v[164:167], v[128:131], v[48:51]
    ds_read_b64_tr_b16 v[180:181], v14 offset:32
    s_add_u32 s30, s29, 81920
    v_mfma_f32_16x16x32_bf16 v[52:55], v[164:167], v[132:135], v[52:55]
    ds_read_b64_tr_b16 v[182:183], v14 offset:1312
    s_add_u32 m0, s39, 113664
    s_nop 0
    buffer_load_dwordx4 v1, s[8:11], 0 offen offset:1024 lds
    v_mfma_f32_16x16x32_bf16 v[56:59], v[164:167], v[136:139], v[56:59]
    s_add_u32 m0, s39, 114688
    s_nop 0
    buffer_load_dwordx4 v2, s[8:11], 0 offen offset:1024 lds
    v_mfma_f32_16x16x32_bf16 v[60:63], v[164:167], v[140:143], v[60:63]
    s_waitcnt lgkmcnt(0)
    v_mfma_f32_16x16x32_bf16 v[64:67], v[172:175], v[128:131], v[64:67]
    ds_read_b128 v[144:147], v11 offset:0
    s_lshl_b32 s45, s32, 3
    s_cmp_eq_u32 s32, 5
    s_cselect_b32 s45, 38, s45
    s_cmp_eq_u32 s32, 6
    s_cselect_b32 s45, 44, s45
    s_cmp_eq_u32 s32, 7
    s_cselect_b32 s45, 49, s45
    s_bfe_u32 s46, s2, 0x30003
    s_mul_i32 s46, s46, 74
    s_add_u32 s28, s45, s46
    s_mul_i32 s28, s28, 5120
    s_add_u32 s28, s28, 10485760
    v_mfma_f32_16x16x32_bf16 v[68:71], v[172:175], v[132:135], v[68:71]
    ds_read_b64_tr_b16 v[160:161], v14 offset:10368
    v_mfma_f32_16x16x32_bf16 v[72:75], v[172:175], v[136:139], v[72:75]
    ds_read_b64_tr_b16 v[162:163], v14 offset:11648
    s_add_u32 m0, s39, 115712
    s_nop 0
    buffer_load_dwordx4 v3, s[8:11], 0 offen offset:1024 lds
    v_mfma_f32_16x16x32_bf16 v[76:79], v[172:175], v[140:143], v[76:79]
    ds_read_b128 v[148:151], v11 offset:2048
    v_mfma_f32_16x16x32_bf16 v[80:83], v[176:179], v[128:131], v[80:83]
    ds_read_b128 v[152:155], v11 offset:4096
    s_add_u32 m0, s39, 116736
    s_nop 0
    buffer_load_dwordx4 v4, s[8:11], 0 offen offset:1024 lds
    v_mfma_f32_16x16x32_bf16 v[84:87], v[176:179], v[132:135], v[84:87]
    ds_read_b128 v[156:159], v11 offset:6144
    v_mfma_f32_16x16x32_bf16 v[88:91], v[176:179], v[136:139], v[88:91]
    ds_read_b64_tr_b16 v[164:165], v14 offset:10376
    v_mfma_f32_16x16x32_bf16 v[92:95], v[176:179], v[140:143], v[92:95]
    ds_read_b64_tr_b16 v[166:167], v14 offset:11656
    s_mov_b32 s31, 0
    v_mfma_f32_16x16x32_bf16 v[96:99], v[180:183], v[128:131], v[96:99]
    v_mfma_f32_16x16x32_bf16 v[100:103], v[180:183], v[132:135], v[100:103]
    s_add_u32 m0, s39, 130048
    s_nop 0
    buffer_load_dwordx4 v1, s[8:11], s3 offen offset:1024 lds
    v_mfma_f32_16x16x32_bf16 v[104:107], v[180:183], v[136:139], v[104:107]
    v_mfma_f32_16x16x32_bf16 v[108:111], v[180:183], v[140:143], v[108:111]
    s_waitcnt lgkmcnt(0)
    v_mfma_f32_16x16x32_bf16 v[32:35], v[160:163], v[144:147], v[32:35]
    ds_read_b64_tr_b16 v[172:173], v14 offset:10384
    s_add_u32 m0, s39, 131072
    s_nop 0
    buffer_load_dwordx4 v2, s[8:11], s3 offen offset:1024 lds
    v_mfma_f32_16x16x32_bf16 v[36:39], v[160:163], v[148:151], v[36:39]
    ds_read_b64_tr_b16 v[174:175], v14 offset:11664
    v_mfma_f32_16x16x32_bf16 v[40:43], v[160:163], v[152:155], v[40:43]
    ds_read_b64_tr_b16 v[176:177], v14 offset:10392
    s_add_u32 m0, s39, 132096
    s_nop 0
    buffer_load_dwordx4 v3, s[8:11], s3 offen offset:1024 lds
    v_mfma_f32_16x16x32_bf16 v[44:47], v[160:163], v[156:159], v[44:47]
    ds_read_b64_tr_b16 v[178:179], v14 offset:11672
    v_mfma_f32_16x16x32_bf16 v[48:51], v[164:167], v[144:147], v[48:51]
    ds_read_b64_tr_b16 v[180:181], v14 offset:10400
    v_mfma_f32_16x16x32_bf16 v[52:55], v[164:167], v[148:151], v[52:55]
    ds_read_b64_tr_b16 v[182:183], v14 offset:11680
    s_add_u32 m0, s39, 133120
    s_nop 0
    buffer_load_dwordx4 v4, s[8:11], s3 offen offset:1024 lds
    v_mfma_f32_16x16x32_bf16 v[56:59], v[164:167], v[152:155], v[56:59]
    v_mfma_f32_16x16x32_bf16 v[60:63], v[164:167], v[156:159], v[60:63]
    s_waitcnt vmcnt(8) lgkmcnt(0)
    s_barrier
    v_mfma_f32_16x16x32_bf16 v[64:67], v[172:175], v[144:147], v[64:67]
    ds_read_b128 v[128:131], v10 offset:32768
    s_add_u32 s45, s41, 122880
    s_add_u32 m0, s40, 10368
    s_nop 0
    buffer_load_dwordx4 v5, s[76:79], s45 offen lds
    v_mfma_f32_16x16x32_bf16 v[68:71], v[172:175], v[148:151], v[68:71]
    ds_read_b64_tr_b16 v[160:161], v14 offset:24576
    v_mfma_f32_16x16x32_bf16 v[72:75], v[172:175], v[152:155], v[72:75]
    ds_read_b64_tr_b16 v[162:163], v14 offset:25856
    v_mfma_f32_16x16x32_bf16 v[76:79], v[172:175], v[156:159], v[76:79]
    ds_read_b128 v[132:135], v10 offset:34816
    s_add_u32 s45, s41, 122880
    s_add_u32 m0, s40, 11392
    s_nop 0
    buffer_load_dwordx4 v6, s[76:79], s45 offen lds
    v_mfma_f32_16x16x32_bf16 v[80:83], v[176:179], v[144:147], v[80:83]
    ds_read_b128 v[136:139], v10 offset:36864
    v_mfma_f32_16x16x32_bf16 v[84:87], v[176:179], v[148:151], v[84:87]
    ds_read_b128 v[140:143], v10 offset:38912
    v_mfma_f32_16x16x32_bf16 v[88:91], v[176:179], v[152:155], v[88:91]
    ds_read_b64_tr_b16 v[164:165], v14 offset:24584
    s_add_u32 s45, s41, 122880
    s_add_u32 m0, s40, 12416
    s_mov_b32 exec_hi, 0
    buffer_load_dwordx4 v7, s[76:79], s45 offen lds
    s_mov_b32 exec_hi, -1
    v_mfma_f32_16x16x32_bf16 v[92:95], v[176:179], v[156:159], v[92:95]
    ds_read_b64_tr_b16 v[166:167], v14 offset:25864
    v_mfma_f32_16x16x32_bf16 v[96:99], v[180:183], v[144:147], v[96:99]
    v_mfma_f32_16x16x32_bf16 v[100:103], v[180:183], v[148:151], v[100:103]
    s_add_u32 m0, s40, 0
    s_nop 0
    buffer_load_dwordx4 v5, s[76:79], s41 offen lds
    v_mfma_f32_16x16x32_bf16 v[104:107], v[180:183], v[152:155], v[104:107]
    v_mfma_f32_16x16x32_bf16 v[108:111], v[180:183], v[156:159], v[108:111]
    s_waitcnt lgkmcnt(0)
    v_mfma_f32_16x16x32_bf16 v[32:35], v[160:163], v[128:131], v[32:35]
    ds_read_b64_tr_b16 v[172:173], v14 offset:24592
    s_add_u32 m0, s40, 1024
    s_nop 0
    buffer_load_dwordx4 v6, s[76:79], s41 offen lds
    v_mfma_f32_16x16x32_bf16 v[36:39], v[160:163], v[132:135], v[36:39]
    ds_read_b64_tr_b16 v[174:175], v14 offset:25872
    v_mfma_f32_16x16x32_bf16 v[40:43], v[160:163], v[136:139], v[40:43]
    ds_read_b64_tr_b16 v[176:177], v14 offset:24600
    s_add_u32 m0, s40, 2048
    s_mov_b32 exec_hi, 0
    buffer_load_dwordx4 v7, s[76:79], s41 offen lds
    s_mov_b32 exec_hi, -1
    s_add_u32 s41, s41, s49
    v_mfma_f32_16x16x32_bf16 v[44:47], v[160:163], v[140:143], v[44:47]
    ds_read_b64_tr_b16 v[178:179], v14 offset:25880
    v_mfma_f32_16x16x32_bf16 v[48:51], v[164:167], v[128:131], v[48:51]
    ds_read_b64_tr_b16 v[180:181], v14 offset:24608
    s_add_u32 m0, s39, 48000
    s_nop 0
    buffer_load_dwordx4 v1, s[8:11], 0 offen offset:1152 lds
    v_mfma_f32_16x16x32_bf16 v[52:55], v[164:167], v[132:135], v[52:55]
    ds_read_b64_tr_b16 v[182:183], v14 offset:25888
    v_mfma_f32_16x16x32_bf16 v[56:59], v[164:167], v[136:139], v[56:59]
    s_add_u32 m0, s39, 49024
    s_nop 0
    buffer_load_dwordx4 v2, s[8:11], 0 offen offset:1152 lds
    v_mfma_f32_16x16x32_bf16 v[60:63], v[164:167], v[140:143], v[60:63]
    s_waitcnt lgkmcnt(0)
    v_mfma_f32_16x16x32_bf16 v[64:67], v[172:175], v[128:131], v[64:67]
    ds_read_b128 v[144:147], v11 offset:32768
    s_add_u32 m0, s39, 50048
    s_nop 0
    buffer_load_dwordx4 v3, s[8:11], 0 offen offset:1152 lds
    v_mfma_f32_16x16x32_bf16 v[68:71], v[172:175], v[132:135], v[68:71]
    ds_read_b64_tr_b16 v[160:161], v14 offset:34944
    v_mfma_f32_16x16x32_bf16 v[72:75], v[172:175], v[136:139], v[72:75]
    ds_read_b64_tr_b16 v[162:163], v14 offset:36224
    v_mfma_f32_16x16x32_bf16 v[76:79], v[172:175], v[140:143], v[76:79]
    ds_read_b128 v[148:151], v11 offset:34816
    v_mfma_f32_16x16x32_bf16 v[80:83], v[176:179], v[128:131], v[80:83]
    ds_read_b128 v[152:155], v11 offset:36864
    s_add_u32 m0, s39, 51072
    s_nop 0
    buffer_load_dwordx4 v4, s[8:11], 0 offen offset:1152 lds
    v_mfma_f32_16x16x32_bf16 v[84:87], v[176:179], v[132:135], v[84:87]
    ds_read_b128 v[156:159], v11 offset:38912
    v_mfma_f32_16x16x32_bf16 v[88:91], v[176:179], v[136:139], v[88:91]
    ds_read_b64_tr_b16 v[164:165], v14 offset:34952
    v_mfma_f32_16x16x32_bf16 v[92:95], v[176:179], v[140:143], v[92:95]
    ds_read_b64_tr_b16 v[166:167], v14 offset:36232
    v_mfma_f32_16x16x32_bf16 v[96:99], v[180:183], v[128:131], v[96:99]
    s_add_u32 m0, s39, 64384
    s_nop 0
    buffer_load_dwordx4 v1, s[8:11], s3 offen offset:1152 lds
    v_mfma_f32_16x16x32_bf16 v[100:103], v[180:183], v[132:135], v[100:103]
    v_mfma_f32_16x16x32_bf16 v[104:107], v[180:183], v[136:139], v[104:107]
    v_mfma_f32_16x16x32_bf16 v[108:111], v[180:183], v[140:143], v[108:111]
    s_waitcnt lgkmcnt(0)
    v_mfma_f32_16x16x32_bf16 v[32:35], v[160:163], v[144:147], v[32:35]
    ds_read_b64_tr_b16 v[172:173], v14 offset:34960
    s_add_u32 m0, s39, 65408
    s_nop 0
    buffer_load_dwordx4 v2, s[8:11], s3 offen offset:1152 lds
    v_mfma_f32_16x16x32_bf16 v[36:39], v[160:163], v[148:151], v[36:39]
    ds_read_b64_tr_b16 v[174:175], v14 offset:36240
    v_mfma_f32_16x16x32_bf16 v[40:43], v[160:163], v[152:155], v[40:43]
    ds_read_b64_tr_b16 v[176:177], v14 offset:34968
    s_add_u32 m0, s39, 66432
    s_nop 0
    buffer_load_dwordx4 v3, s[8:11], s3 offen offset:1152 lds
    v_mfma_f32_16x16x32_bf16 v[44:47], v[160:163], v[156:159], v[44:47]
    ds_read_b64_tr_b16 v[178:179], v14 offset:36248
    v_mfma_f32_16x16x32_bf16 v[48:51], v[164:167], v[144:147], v[48:51]
    ds_read_b64_tr_b16 v[180:181], v14 offset:34976
    v_mfma_f32_16x16x32_bf16 v[52:55], v[164:167], v[148:151], v[52:55]
    ds_read_b64_tr_b16 v[182:183], v14 offset:36256
    s_add_u32 m0, s39, 67456
    s_nop 0
    buffer_load_dwordx4 v4, s[8:11], s3 offen offset:1152 lds
    v_mfma_f32_16x16x32_bf16 v[56:59], v[164:167], v[152:155], v[56:59]
    v_mfma_f32_16x16x32_bf16 v[60:63], v[164:167], v[156:159], v[60:63]
    s_waitcnt vmcnt(8) lgkmcnt(0)
    s_barrier
    s_lshl_b32 s45, s33, 8
    s_lshl_b32 s46, s37, 6
    s_add_u32 s45, s45, s46
    s_lshl_b32 s45, s45, 3
    s_add_u32 s45, s45, 32768
    v_and_b32 v16, 15, v0
    v_lshlrev_b32 v16, 3, v16
    buffer_load_dwordx2 v[244:245], v16, s[20:23], s45 offen offset:0 sc1
    buffer_load_dwordx2 v[246:247], v16, s[20:23], s45 offen offset:128 sc1
    buffer_load_dwordx2 v[248:249], v16, s[20:23], s45 offen offset:256 sc1
    buffer_load_dwordx2 v[250:251], v16, s[20:23], s45 offen offset:384 sc1
    v_mfma_f32_16x16x32_bf16 v[64:67], v[172:175], v[144:147], v[64:67]
    ds_read_b128 v[128:131], v12 offset:0
    buffer_load_dwordx2 v[28:29], v30, s[20:23], 0 offen sc1
    s_add_u32 s45, s41, 122880
    s_add_u32 m0, s40, 34944
    s_nop 0
    buffer_load_dwordx4 v5, s[76:79], s45 offen lds
    v_lshrrev_b32 v22, 4, v0
    v_mfma_f32_16x16x32_bf16 v[68:71], v[172:175], v[148:151], v[68:71]
    ds_read_b64_tr_b16 v[160:161], v14 offset:0
    v_and_b32 v23, 3, v0
    v_cmp_eq_u32 vcc, v22, v23
    v_mul_u32_u24 v22, 800, v22
    v_mfma_f32_16x16x32_bf16 v[72:75], v[172:175], v[152:155], v[72:75]
    ds_read_b64_tr_b16 v[162:163], v14 offset:1280
    v_bfe_u32 v23, v0, 2, 2
    v_mul_u32_u24 v23, 40, v23
    v_add_u32 v22, v22, v23
    v_mfma_f32_16x16x32_bf16 v[76:79], v[172:175], v[156:159], v[76:79]
    ds_read_b128 v[132:135], v12 offset:2048
    s_add_u32 s45, s41, 122880
    s_add_u32 m0, s40, 35968
    s_nop 0
    buffer_load_dwordx4 v6, s[76:79], s45 offen lds
    s_mul_i32 s45, s38, 3200
    s_cmp_eq_u32 s35, 1
    v_mfma_f32_16x16x32_bf16 v[80:83], v[176:179], v[144:147], v[80:83]
    ds_read_b128 v[136:139], v12 offset:4096
    s_cselect_b32 s45, 0, s45
    s_add_u32 s45, s45, 147456
    v_add_u32 v22, s45, v22
    v_mfma_f32_16x16x32_bf16 v[84:87], v[176:179], v[148:151], v[84:87]
    ds_read_b128 v[140:143], v12 offset:6144
    v_mov_b32 v23, 153856
    v_cndmask_b32 v22, v23, v22, vcc
    v_mov_b32 v194, 0
    v_mfma_f32_16x16x32_bf16 v[88:91], v[176:179], v[152:155], v[88:91]
    ds_read_b64_tr_b16 v[164:165], v14 offset:8
    s_add_u32 s45, s41, 122880
    s_add_u32 m0, s40, 36992
    s_mov_b32 exec_hi, 0
    buffer_load_dwordx4 v7, s[76:79], s45 offen lds
    s_mov_b32 exec_hi, -1
    v_mov_b32 v195, 0
    v_mov_b32 v206, 0
    v_mfma_f32_16x16x32_bf16 v[92:95], v[176:179], v[156:159], v[92:95]
    ds_read_b64_tr_b16 v[166:167], v14 offset:1288
    v_mov_b32 v207, 0
    v_mov_b32 v218, 0
    v_mov_b32 v219, 0
    v_mfma_f32_16x16x32_bf16 v[96:99], v[180:183], v[144:147], v[96:99]
    v_mov_b32 v230, 0
    v_mov_b32 v231, 0
    v_mov_b32 v242, 0
    v_mfma_f32_16x16x32_bf16 v[100:103], v[180:183], v[148:151], v[100:103]
    s_add_u32 m0, s40, 24576
    s_nop 0
    buffer_load_dwordx4 v5, s[76:79], s41 offen lds
    v_mov_b32 v243, 0
    ds_read_b64_tr_b16 v[184:185], v22 offset:0
    v_mfma_f32_16x16x32_bf16 v[104:107], v[180:183], v[152:155], v[104:107]
    ds_read_b64_tr_b16 v[186:187], v22 offset:160
    ds_read_b64_tr_b16 v[188:189], v22 offset:320
    ds_read_b64_tr_b16 v[190:191], v22 offset:480
    v_mfma_f32_16x16x32_bf16 v[108:111], v[180:183], v[156:159], v[108:111]
    ds_read_b64_tr_b16 v[192:193], v22 offset:640
    ds_read_b64_tr_b16 v[196:197], v22 offset:8
    s_waitcnt lgkmcnt(0)
    v_mfma_f32_16x16x32_bf16 v[32:35], v[160:163], v[128:131], v[32:35]
    ds_read_b64_tr_b16 v[172:173], v14 offset:16
    ds_read_b64_tr_b16 v[198:199], v22 offset:168
    v_mfma_f32_16x16x32_bf16 v[36:39], v[160:163], v[132:135], v[36:39]
    ds_read_b64_tr_b16 v[174:175], v14 offset:1296
    s_add_u32 m0, s40, 25600
    s_nop 0
    buffer_load_dwordx4 v6, s[76:79], s41 offen lds
    v_mfma_f32_16x16x32_bf16 v[40:43], v[160:163], v[136:139], v[40:43]
    ds_read_b64_tr_b16 v[176:177], v14 offset:24
    ds_read_b64_tr_b16 v[200:201], v22 offset:328
    v_mfma_f32_16x16x32_bf16 v[44:47], v[160:163], v[140:143], v[44:47]
    ds_read_b64_tr_b16 v[178:179], v14 offset:1304
    ds_read_b64_tr_b16 v[202:203], v22 offset:488
    v_mfma_f32_16x16x32_bf16 v[48:51], v[164:167], v[128:131], v[48:51]
    ds_read_b64_tr_b16 v[180:181], v14 offset:32
    ds_read_b64_tr_b16 v[204:205], v22 offset:648
    v_mfma_f32_16x16x32_bf16 v[52:55], v[164:167], v[132:135], v[52:55]
    ds_read_b64_tr_b16 v[182:183], v14 offset:1312
    s_add_u32 m0, s40, 26624
    s_mov_b32 exec_hi, 0
    buffer_load_dwordx4 v7, s[76:79], s41 offen lds
    s_mov_b32 exec_hi, -1
    s_add_u32 s41, s41, s49
    v_mfma_f32_16x16x32_bf16 v[56:59], v[164:167], v[136:139], v[56:59]
    ds_read_b64_tr_b16 v[208:209], v22 offset:16
    v_mfma_f32_16x16x32_bf16 v[60:63], v[164:167], v[140:143], v[60:63]
    ds_read_b64_tr_b16 v[210:211], v22 offset:176
    s_waitcnt lgkmcnt(0)
    v_mfma_f32_16x16x32_bf16 v[64:67], v[172:175], v[128:131], v[64:67]
    ds_read_b128 v[144:147], v13 offset:0
    ds_read_b64_tr_b16 v[212:213], v22 offset:336
    v_mfma_f32_16x16x32_bf16 v[68:71], v[172:175], v[132:135], v[68:71]
    ds_read_b64_tr_b16 v[160:161], v14 offset:10368
    v_mfma_f32_16x16x32_bf16 v[72:75], v[172:175], v[136:139], v[72:75]
    ds_read_b64_tr_b16 v[162:163], v14 offset:11648
    ds_read_b64_tr_b16 v[214:215], v22 offset:496
    v_mfma_f32_16x16x32_bf16 v[76:79], v[172:175], v[140:143], v[76:79]
    ds_read_b128 v[148:151], v13 offset:2048
    v_mfma_f32_16x16x32_bf16 v[80:83], v[176:179], v[128:131], v[80:83]
    ds_read_b128 v[152:155], v13 offset:4096
    ds_read_b64_tr_b16 v[216:217], v22 offset:656
    v_mfma_f32_16x16x32_bf16 v[84:87], v[176:179], v[132:135], v[84:87]
    ds_read_b128 v[156:159], v13 offset:6144
    v_mfma_f32_16x16x32_bf16 v[88:91], v[176:179], v[136:139], v[88:91]
    ds_read_b64_tr_b16 v[164:165], v14 offset:10376
    ds_read_b64_tr_b16 v[220:221], v22 offset:24
    v_mfma_f32_16x16x32_bf16 v[92:95], v[176:179], v[140:143], v[92:95]
    ds_read_b64_tr_b16 v[166:167], v14 offset:11656
    v_mfma_f32_16x16x32_bf16 v[96:99], v[180:183], v[128:131], v[96:99]
    ds_read_b64_tr_b16 v[222:223], v22 offset:184
    v_mfma_f32_16x16x32_bf16 v[100:103], v[180:183], v[132:135], v[100:103]
    v_mfma_f32_16x16x32_bf16 v[104:107], v[180:183], v[136:139], v[104:107]
    ds_read_b64_tr_b16 v[224:225], v22 offset:344
    v_mfma_f32_16x16x32_bf16 v[108:111], v[180:183], v[140:143], v[108:111]
    s_waitcnt lgkmcnt(0)
    v_mfma_f32_16x16x32_bf16 v[32:35], v[160:163], v[144:147], v[32:35]
    ds_read_b64_tr_b16 v[172:173], v14 offset:10384
    ds_read_b64_tr_b16 v[226:227], v22 offset:504
    ds_read_b64_tr_b16 v[228:229], v22 offset:664
    v_mfma_f32_16x16x32_bf16 v[36:39], v[160:163], v[148:151], v[36:39]
    ds_read_b64_tr_b16 v[174:175], v14 offset:11664
    ds_read_b64_tr_b16 v[232:233], v22 offset:32
    v_mfma_f32_16x16x32_bf16 v[40:43], v[160:163], v[152:155], v[40:43]
    ds_read_b64_tr_b16 v[176:177], v14 offset:10392
    ds_read_b64_tr_b16 v[234:235], v22 offset:192
    ds_read_b64_tr_b16 v[236:237], v22 offset:352
    v_mfma_f32_16x16x32_bf16 v[44:47], v[160:163], v[156:159], v[44:47]
    ds_read_b64_tr_b16 v[178:179], v14 offset:11672
    ds_read_b64_tr_b16 v[238:239], v22 offset:512
    v_mfma_f32_16x16x32_bf16 v[48:51], v[164:167], v[144:147], v[48:51]
    ds_read_b64_tr_b16 v[180:181], v14 offset:10400
    ds_read_b64_tr_b16 v[240:241], v22 offset:672
    s_waitcnt vmcnt(6)
    v_mfma_f32_16x16x32_bf16 v[52:55], v[164:167], v[148:151], v[52:55]
    ds_read_b64_tr_b16 v[182:183], v14 offset:11680
    v_subrev_u32 v16, s82, v28
    v_mfma_f32_16x16x32_bf16 v[56:59], v[164:167], v[152:155], v[56:59]
    v_subrev_u32 v16, 2, v16
    v_xor_b32 v17, s83, v29
    v_mfma_f32_16x16x32_bf16 v[60:63], v[164:167], v[156:159], v[60:63]
    v_cmp_ne_u32 s[74:75], 0, v17
    v_cmp_lt_u32 vcc, 1, v16
    s_nop 1
    s_or_b64 vcc, vcc, s[74:75]
    s_cmp_eq_u64 vcc, 0
    s_cselect_b32 s31, 3, s31
    s_waitcnt vmcnt(0) lgkmcnt(0)
    s_barrier
    v_mfma_f32_16x16x32_bf16 v[64:67], v[172:175], v[144:147], v[64:67]
    ds_read_b128 v[128:131], v10 offset:0
    v_mfma_f32_16x16x32_bf16 v[68:71], v[172:175], v[148:151], v[68:71]
    ds_read_b64_tr_b16 v[160:161], v14 offset:24576
    v_mfma_f32_16x16x32_bf16 v[72:75], v[172:175], v[152:155], v[72:75]
    ds_read_b64_tr_b16 v[162:163], v14 offset:25856
    v_mfma_f32_16x16x32_bf16 v[76:79], v[172:175], v[156:159], v[76:79]
    ds_read_b128 v[132:135], v10 offset:2048
    v_mfma_f32_16x16x32_bf16 v[80:83], v[176:179], v[144:147], v[80:83]
    ds_read_b128 v[136:139], v10 offset:4096
    v_mfma_f32_16x16x32_bf16 v[84:87], v[176:179], v[148:151], v[84:87]
    ds_read_b128 v[140:143], v10 offset:6144
    v_mfma_f32_16x16x32_bf16 v[88:91], v[176:179], v[152:155], v[88:91]
    ds_read_b64_tr_b16 v[164:165], v14 offset:24584
    v_mfma_f32_16x16x32_bf16 v[92:95], v[176:179], v[156:159], v[92:95]
    ds_read_b64_tr_b16 v[166:167], v14 offset:25864
    v_mfma_f32_16x16x32_bf16 v[96:99], v[180:183], v[144:147], v[96:99]
    v_mfma_f32_16x16x32_bf16 v[100:103], v[180:183], v[148:151], v[100:103]
    v_mfma_f32_16x16x32_bf16 v[104:107], v[180:183], v[152:155], v[104:107]
    v_mfma_f32_16x16x32_bf16 v[108:111], v[180:183], v[156:159], v[108:111]
    s_waitcnt lgkmcnt(0)
    v_mfma_f32_16x16x32_bf16 v[32:35], v[160:163], v[128:131], v[32:35]
    ds_read_b64_tr_b16 v[172:173], v14 offset:24592
    s_cmp_eq_u32 s35, 0
    s_cbranch_scc0 QKVL_Q20
    s_cmp_eq_u32 s31, 3
    s_cbranch_scc0 QKVL_QB20
    s_add_u32 s48, s28, 10240
    s_add_u32 m0, s30, 0
    s_nop 0
    buffer_load_dwordx4 v8, s[20:23], s48 offen offset:0 sc1 lds
    s_add_u32 m0, s30, 0
    s_nop 0
    buffer_load_dwordx4 v8, s[20:23], s48 offen offset:1024 sc1 lds
    s_add_u32 m0, s30, 0
    s_nop 0
    buffer_load_dwordx4 v8, s[20:23], s48 offen offset:2048 sc1 lds
    QKVL_QB20:
    QKVL_Q20:
    v_mfma_f32_16x16x32_bf16 v[36:39], v[160:163], v[132:135], v[36:39]
    ds_read_b64_tr_b16 v[174:175], v14 offset:25872
    v_mfma_f32_16x16x32_bf16 v[40:43], v[160:163], v[136:139], v[40:43]
    ds_read_b64_tr_b16 v[176:177], v14 offset:24600
    v_mfma_f32_16x16x32_bf16 v[44:47], v[160:163], v[140:143], v[44:47]
    ds_read_b64_tr_b16 v[178:179], v14 offset:25880
    v_mfma_f32_16x16x32_bf16 v[48:51], v[164:167], v[128:131], v[48:51]
    ds_read_b64_tr_b16 v[180:181], v14 offset:24608
    s_cmp_eq_u32 s35, 0
    s_cbranch_scc0 QKVL_Q23
    s_cmp_eq_u32 s31, 3
    s_cbranch_scc0 QKVL_QB23
    s_add_u32 m0, s30, 0
    s_nop 0
    buffer_load_dwordx4 v8, s[20:23], s48 offen offset:3072 sc1 lds
    s_add_u32 m0, s30, 4096
    s_nop 0
    buffer_load_dwordx4 v9, s[20:23], s48 offen offset:0 sc1 lds
    QKVL_QB23:
    QKVL_Q23:
    v_mfma_f32_16x16x32_bf16 v[52:55], v[164:167], v[132:135], v[52:55]
    ds_read_b64_tr_b16 v[182:183], v14 offset:25888
    v_mfma_f32_16x16x32_bf16 v[56:59], v[164:167], v[136:139], v[56:59]
    v_mfma_f32_16x16x32_bf16 v[60:63], v[164:167], v[140:143], v[60:63]
    s_waitcnt lgkmcnt(0)
    v_mfma_f32_16x16x32_bf16 v[64:67], v[172:175], v[128:131], v[64:67]
    ds_read_b128 v[144:147], v11 offset:0
    s_cmp_eq_u32 s35, 0
    s_cbranch_scc0 QKVL_Q30
    s_cmp_eq_u32 s31, 3
    s_cbranch_scc0 QKVL_QB30
    s_add_u32 s48, s28, 15360
    s_add_u32 m0, s30, 5120
    s_nop 0
    buffer_load_dwordx4 v8, s[20:23], s48 offen offset:0 sc1 lds
    s_add_u32 m0, s30, 5120
    s_nop 0
    buffer_load_dwordx4 v8, s[20:23], s48 offen offset:1024 sc1 lds
    s_add_u32 m0, s30, 5120
    s_nop 0
    buffer_load_dwordx4 v8, s[20:23], s48 offen offset:2048 sc1 lds
    QKVL_QB30:
    QKVL_Q30:
    v_mfma_f32_16x16x32_bf16 v[68:71], v[172:175], v[132:135], v[68:71]
    ds_read_b64_tr_b16 v[160:161], v14 offset:34944
    v_mfma_f32_16x16x32_bf16 v[72:75], v[172:175], v[136:139], v[72:75]
    ds_read_b64_tr_b16 v[162:163], v14 offset:36224
    v_mfma_f32_16x16x32_bf16 v[76:79], v[172:175], v[140:143], v[76:79]
    ds_read_b128 v[148:151], v11 offset:2048
    v_mfma_f32_16x16x32_bf16 v[80:83], v[176:179], v[128:131], v[80:83]
    ds_read_b128 v[152:155], v11 offset:4096
    s_cmp_eq_u32 s35, 0
    s_cbranch_scc0 QKVL_Q33
    s_cmp_eq_u32 s31, 3
    s_cbranch_scc0 QKVL_QB33
    s_add_u32 m0, s30, 5120
    s_nop 0
    buffer_load_dwordx4 v8, s[20:23], s48 offen offset:3072 sc1 lds
    QKVL_QB33:
    QKVL_Q33:
    v_mfma_f32_16x16x32_bf16 v[84:87], v[176:179], v[132:135], v[84:87]
    ds_read_b128 v[156:159], v11 offset:6144
    v_mfma_f32_16x16x32_bf16 v[88:91], v[176:179], v[136:139], v[88:91]
    ds_read_b64_tr_b16 v[164:165], v14 offset:34952
    v_mfma_f32_16x16x32_bf16 v[92:95], v[176:179], v[140:143], v[92:95]
    ds_read_b64_tr_b16 v[166:167], v14 offset:36232
    v_mfma_f32_16x16x32_bf16 v[96:99], v[180:183], v[128:131], v[96:99]
    s_cmp_eq_u32 s35, 0
    s_cbranch_scc0 QKVL_Q34
    s_cmp_eq_u32 s32, 7
    s_cbranch_scc1 QKVL_Q34
    s_cmp_eq_u32 s31, 3
    s_cbranch_scc0 QKVL_QB34
    s_add_u32 m0, s30, 9216
    s_nop 0
    buffer_load_dwordx4 v9, s[20:23], s48 offen offset:0 sc1 lds
    QKVL_QB34:
    QKVL_Q34:
    v_mfma_f32_16x16x32_bf16 v[100:103], v[180:183], v[132:135], v[100:103]
    v_mfma_f32_16x16x32_bf16 v[104:107], v[180:183], v[136:139], v[104:107]
    v_mfma_f32_16x16x32_bf16 v[108:111], v[180:183], v[140:143], v[108:111]
    s_waitcnt lgkmcnt(0)
    v_mfma_f32_16x16x32_bf16 v[32:35], v[160:163], v[144:147], v[32:35]
    ds_read_b64_tr_b16 v[172:173], v14 offset:34960
    v_mfma_f32_16x16x32_bf16 v[36:39], v[160:163], v[148:151], v[36:39]
    ds_read_b64_tr_b16 v[174:175], v14 offset:36240
    v_mfma_f32_16x16x32_bf16 v[40:43], v[160:163], v[152:155], v[40:43]
    ds_read_b64_tr_b16 v[176:177], v14 offset:34968
    v_mfma_f32_16x16x32_bf16 v[44:47], v[160:163], v[156:159], v[44:47]
    ds_read_b64_tr_b16 v[178:179], v14 offset:36248
    v_mfma_f32_16x16x32_bf16 v[48:51], v[164:167], v[144:147], v[48:51]
    ds_read_b64_tr_b16 v[180:181], v14 offset:34976
    v_mfma_f32_16x16x32_bf16 v[52:55], v[164:167], v[148:151], v[52:55]
    ds_read_b64_tr_b16 v[182:183], v14 offset:36256
    v_mfma_f32_16x16x32_bf16 v[56:59], v[164:167], v[152:155], v[56:59]
    v_mfma_f32_16x16x32_bf16 v[60:63], v[164:167], v[156:159], v[60:63]
    s_waitcnt lgkmcnt(0)
    v_mfma_f32_16x16x32_bf16 v[64:67], v[172:175], v[144:147], v[64:67]
    v_mfma_f32_16x16x32_bf16 v[68:71], v[172:175], v[148:151], v[68:71]
    v_mfma_f32_16x16x32_bf16 v[72:75], v[172:175], v[152:155], v[72:75]
    v_mfma_f32_16x16x32_bf16 v[76:79], v[172:175], v[156:159], v[76:79]
    v_mfma_f32_16x16x32_bf16 v[80:83], v[176:179], v[144:147], v[80:83]
    v_mfma_f32_16x16x32_bf16 v[84:87], v[176:179], v[148:151], v[84:87]
    v_mfma_f32_16x16x32_bf16 v[88:91], v[176:179], v[152:155], v[88:91]
    v_mfma_f32_16x16x32_bf16 v[92:95], v[176:179], v[156:159], v[92:95]
    v_mfma_f32_16x16x32_bf16 v[96:99], v[180:183], v[144:147], v[96:99]
    v_mfma_f32_16x16x32_bf16 v[100:103], v[180:183], v[148:151], v[100:103]
    v_mfma_f32_16x16x32_bf16 v[104:107], v[180:183], v[152:155], v[104:107]
    v_mfma_f32_16x16x32_bf16 v[108:111], v[180:183], v[156:159], v[108:111]
    s_setprio 0
    s_branch QKV_LOOPEND
QKV_ROLEP:
    s_and_b32 s45, s2, 1
    s_lshl_b32 s45, s45, 7
    s_bfe_u32 s46, s2, 0x20001
    s_lshl_b32 s46, s46, 5
    s_add_u32 s45, s45, s46
    s_lshr_b32 s46, s2, 3
    s_add_u32 s45, s45, s46
    s_lshl_b32 s45, s45, 3
    s_add_u32 s50, s45, s32
    s_mul_i32 s45, s50, 1280
    v_lshlrev_b32 v16, 4, v0
    v_lshlrev_b32 v17, 2, v0
    buffer_load_dwordx4 v[244:247], v16, s[24:27], s45 offen
    buffer_load_dword v248, v17, s[24:27], s45 offen offset:1024
    v_and_b32 v17, 31, v0
    v_lshrrev_b32 v16, 5, v0
    v_mul_u32_u24 v16, 3840, v16
    v_lshl_add_u32 v16, v17, 4, v16
    s_cmp_eq_u32 s35, 1
    s_cselect_b32 s46, 1120, 0
    v_mov_b32 v18, s46
    v_cmp_le_u32 vcc, 10, v17
    s_nop 1
    v_cndmask_b32 v18, 0, v18, vcc
    v_add_u32 v16, v16, v18
    s_mul_i32 s45, s33, 15360
    v_add_u32 v8, s45, v16
    v_add_u32 v9, 7680, v8
    s_mov_b32 s42, 0xfffff
    s_mov_b32 s43, 0xfffff
    s_mul_i32 s44, s37, 122880
    s_mov_b64 exec, s[42:43]
    buffer_load_dwordx4 v[184:187], v8, s[12:15], s44 offen
    buffer_load_dwordx4 v[188:191], v9, s[16:19], s44 offen
    s_mov_b64 exec, -1
    s_add_u32 m0, s40, 0
    s_nop 0
    buffer_load_dwordx4 v5, s[76:79], s41 offen lds
    s_add_u32 m0, s40, 1024
    s_nop 0
    buffer_load_dwordx4 v6, s[76:79], s41 offen lds
    s_add_u32 m0, s40, 2048
    s_mov_b32 exec_hi, 0
    buffer_load_dwordx4 v7, s[76:79], s41 offen lds
    s_mov_b32 exec_hi, -1
    s_add_u32 s41, s41, s49
    s_add_u32 m0, s39, 49152
    s_nop 0
    buffer_load_dwordx4 v1, s[8:11], 0 offen offset:0 lds
    s_add_u32 m0, s39, 50176
    s_nop 0
    buffer_load_dwordx4 v2, s[8:11], 0 offen offset:0 lds
    s_add_u32 m0, s39, 51200
    s_nop 0
    buffer_load_dwordx4 v3, s[8:11], 0 offen offset:0 lds
    s_add_u32 m0, s39, 52224
    s_nop 0
    buffer_load_dwordx4 v4, s[8:11], 0 offen offset:0 lds
    s_mov_b32 s4, s70
    s_and_b32 s5, s71, 0xffff
    s_mov_b32 s6, 256
    s_mov_b32 s7, 0x20000
    s_lshl_b32 s45, s32, 10
    s_add_u32 m0, s45, 147456
    v_lshlrev_b32 v16, 4, v0
    v_add_u32 v16, s45, v16
    v_cmp_gt_u32 vcc, 6400, v16
    s_nop 0
    s_and_b64 exec, vcc, -1
    s_cbranch_execz PHI_SKIPQKVP
    buffer_load_dwordx4 v16, s[28:31], 0 offen lds
PHI_SKIPQKVP:
    s_mov_b64 exec, -1
    v_and_b32 v16, 15, v0
    v_lshlrev_b32 v16, 7, v16
    v_bfe_u32 v17, v0, 1, 3
    v_lshrrev_b32 v18, 4, v0
    v_xor_b32 v17, v17, v18
    v_lshl_add_u32 v16, v17, 4, v16
    s_lshl_b32 s45, s37, 13
    s_add_u32 s45, s45, 49152
    v_add_u32 v10, s45, v16
    v_xor_b32 v11, 64, v10
    v_add_u32 v12, 65536, v10
    v_add_u32 v13, 65536, v11
    v_mul_u32_u24 v16, 2592, v18
    v_bfe_u32 v17, v0, 2, 2
    v_mul_u32_u24 v17, 320, v17
    v_add_u32 v16, v16, v17
    v_and_b32 v17, 3, v0
    v_mul_u32_u24 v17, 40, v17
    v_add_u32 v16, v16, v17
    s_mul_i32 s45, s38, 160
    v_add_u32 v14, s45, v16
    s_lshl_b32 s45, s32, 6
    v_add_u32 v20, s45, v0
    v_subrev_u32 v20, 448, v20
    v_mov_b32 v16, 0
    v_mov_b32 v17, 0
    v_mov_b32 v18, 0
    v_mov_b32 v19, 0
    v_cmp_gt_u32 vcc, 50, v20
    v_lshlrev_b32 v20, 4, v20
    v_add_u32 v20, 153856, v20
    s_and_b64 exec, vcc, -1
    ds_write_b128 v20, v[16:19]
    s_mov_b64 exec, -1
    s_lshl_b32 s45, s49, 1
    s_add_u32 s44, s44, s45
    s_mov_b64 exec, s[42:43]
    buffer_load_dwordx4 v[192:195], v8, s[12:15], s44 offen
    buffer_load_dwordx4 v[196:199], v9, s[16:19], s44 offen
    s_mov_b64 exec, -1
    s_waitcnt vmcnt(2) lgkmcnt(0)
    s_barrier
    ds_read_b128 v[128:131], v10 offset:0
    ds_read_b64_tr_b16 v[160:161], v14 offset:0
    ds_read_b64_tr_b16 v[162:163], v14 offset:1280
    ds_read_b128 v[132:135], v10 offset:2048
    ds_read_b128 v[136:139], v10 offset:4096
    ds_read_b128 v[140:143], v10 offset:6144
    ds_read_b64_tr_b16 v[164:165], v14 offset:8
    ds_read_b64_tr_b16 v[166:167], v14 offset:1288
    s_waitcnt lgkmcnt(0)
    v_mfma_f32_16x16x32_bf16 v[32:35], v[160:163], v[128:131], 0
    ds_read_b64_tr_b16 v[172:173], v14 offset:16
    v_mfma_f32_16x16x32_bf16 v[36:39], v[160:163], v[132:135], 0
    ds_read_b64_tr_b16 v[174:175], v14 offset:1296
    v_mfma_f32_16x16x32_bf16 v[40:43], v[160:163], v[136:139], 0
    ds_read_b64_tr_b16 v[176:177], v14 offset:24
    v_mfma_f32_16x16x32_bf16 v[44:47], v[160:163], v[140:143], 0
    ds_read_b64_tr_b16 v[178:179], v14 offset:1304
    v_mfma_f32_16x16x32_bf16 v[48:51], v[164:167], v[128:131], 0
    ds_read_b64_tr_b16 v[180:181], v14 offset:32
    v_mfma_f32_16x16x32_bf16 v[52:55], v[164:167], v[132:135], 0
    ds_read_b64_tr_b16 v[182:183], v14 offset:1312
    v_mfma_f32_16x16x32_bf16 v[56:59], v[164:167], v[136:139], 0
    v_mfma_f32_16x16x32_bf16 v[60:63], v[164:167], v[140:143], 0
    s_waitcnt lgkmcnt(0)
    v_mfma_f32_16x16x32_bf16 v[64:67], v[172:175], v[128:131], 0
    ds_read_b128 v[144:147], v11 offset:0
    v_mfma_f32_16x16x32_bf16 v[68:71], v[172:175], v[132:135], 0
    ds_read_b64_tr_b16 v[160:161], v14 offset:10368
    v_mfma_f32_16x16x32_bf16 v[72:75], v[172:175], v[136:139], 0
    ds_read_b64_tr_b16 v[162:163], v14 offset:11648
    v_mfma_f32_16x16x32_bf16 v[76:79], v[172:175], v[140:143], 0
    ds_read_b128 v[148:151], v11 offset:2048
    v_mfma_f32_16x16x32_bf16 v[80:83], v[176:179], v[128:131], 0
    ds_read_b128 v[152:155], v11 offset:4096
    v_mfma_f32_16x16x32_bf16 v[84:87], v[176:179], v[132:135], 0
    ds_read_b128 v[156:159], v11 offset:6144
    v_mfma_f32_16x16x32_bf16 v[88:91], v[176:179], v[136:139], 0
    ds_read_b64_tr_b16 v[164:165], v14 offset:10376
    v_mfma_f32_16x16x32_bf16 v[92:95], v[176:179], v[140:143], 0
    ds_read_b64_tr_b16 v[166:167], v14 offset:11656
    v_mfma_f32_16x16x32_bf16 v[96:99], v[180:183], v[128:131], 0
    v_mfma_f32_16x16x32_bf16 v[100:103], v[180:183], v[132:135], 0
    v_mfma_f32_16x16x32_bf16 v[104:107], v[180:183], v[136:139], 0
    v_mfma_f32_16x16x32_bf16 v[108:111], v[180:183], v[140:143], 0
    s_waitcnt lgkmcnt(0)
    v_mfma_f32_16x16x32_bf16 v[32:35], v[160:163], v[144:147], v[32:35]
    ds_read_b64_tr_b16 v[172:173], v14 offset:10384
    v_mfma_f32_16x16x32_bf16 v[36:39], v[160:163], v[148:151], v[36:39]
    ds_read_b64_tr_b16 v[174:175], v14 offset:11664
    v_mfma_f32_16x16x32_bf16 v[40:43], v[160:163], v[152:155], v[40:43]
    ds_read_b64_tr_b16 v[176:177], v14 offset:10392
    v_mfma_f32_16x16x32_bf16 v[44:47], v[160:163], v[156:159], v[44:47]
    ds_read_b64_tr_b16 v[178:179], v14 offset:11672
    v_mfma_f32_16x16x32_bf16 v[48:51], v[164:167], v[144:147], v[48:51]
    ds_read_b64_tr_b16 v[180:181], v14 offset:10400
    v_mfma_f32_16x16x32_bf16 v[52:55], v[164:167], v[148:151], v[52:55]
    ds_read_b64_tr_b16 v[182:183], v14 offset:11680
    v_mfma_f32_16x16x32_bf16 v[56:59], v[164:167], v[152:155], v[56:59]
    v_mfma_f32_16x16x32_bf16 v[60:63], v[164:167], v[156:159], v[60:63]
    s_waitcnt lgkmcnt(0)
    s_barrier
    v_mfma_f32_16x16x32_bf16 v[64:67], v[172:175], v[144:147], v[64:67]
    ds_read_b128 v[128:131], v10 offset:32768
    s_lshl_b32 s45, s49, 1
    s_add_u32 s44, s44, s45
    s_mov_b64 exec, s[42:43]
    buffer_load_dwordx4 v[216:219], v8, s[12:15], s44 offen
    buffer_load_dwordx4 v[220:223], v9, s[16:19], s44 offen
    s_mov_b64 exec, -1
    s_waitcnt vmcnt(13)
    v_mfma_f32_16x16x32_bf16 v[68:71], v[172:175], v[148:151], v[68:71]
    ds_read_b64_tr_b16 v[160:161], v14 offset:24576
    v_lshlrev_b32 v200, 16, v244
    v_mfma_f32_16x16x32_bf16 v[72:75], v[172:175], v[152:155], v[72:75]
    ds_read_b64_tr_b16 v[162:163], v14 offset:25856
    v_and_b32 v201, 0xffff0000, v244
    v_lshlrev_b32 v202, 16, v245
    v_mfma_f32_16x16x32_bf16 v[76:79], v[172:175], v[156:159], v[76:79]
    ds_read_b128 v[132:135], v10 offset:34816
    v_and_b32 v203, 0xffff0000, v245
    v_mfma_f32_16x16x32_bf16 v[80:83], v[176:179], v[144:147], v[80:83]
    ds_read_b128 v[136:139], v10 offset:36864
    v_lshlrev_b32 v204, 16, v246
    v_and_b32 v205, 0xffff0000, v246
    v_mfma_f32_16x16x32_bf16 v[84:87], v[176:179], v[148:151], v[84:87]
    ds_read_b128 v[140:143], v10 offset:38912
    v_lshlrev_b32 v206, 16, v247
    v_mfma_f32_16x16x32_bf16 v[88:91], v[176:179], v[152:155], v[88:91]
    ds_read_b64_tr_b16 v[164:165], v14 offset:24584
    v_and_b32 v207, 0xffff0000, v247
    v_lshlrev_b32 v208, 16, v248
    v_mfma_f32_16x16x32_bf16 v[92:95], v[176:179], v[156:159], v[92:95]
    ds_read_b64_tr_b16 v[166:167], v14 offset:25864
    v_and_b32 v209, 0xffff0000, v248
    v_mfma_f32_16x16x32_bf16 v[96:99], v[180:183], v[144:147], v[96:99]
    v_add_f32 v210, v200, v201
    v_add_f32 v210, v210, v202
    v_mfma_f32_16x16x32_bf16 v[100:103], v[180:183], v[148:151], v[100:103]
    v_add_f32 v210, v210, v203
    v_mfma_f32_16x16x32_bf16 v[104:107], v[180:183], v[152:155], v[104:107]
    v_add_f32 v210, v210, v204
    v_add_f32 v210, v210, v205
    v_mfma_f32_16x16x32_bf16 v[108:111], v[180:183], v[156:159], v[108:111]
    v_add_f32 v210, v210, v206
    s_waitcnt lgkmcnt(0)
    v_mfma_f32_16x16x32_bf16 v[32:35], v[160:163], v[128:131], v[32:35]
    ds_read_b64_tr_b16 v[172:173], v14 offset:24592
    s_lshl_b32 s45, s49, 1
    s_add_u32 s44, s44, s45
    s_mov_b64 exec, s[42:43]
    buffer_load_dwordx4 v[224:227], v8, s[12:15], s44 offen
    buffer_load_dwordx4 v[228:231], v9, s[16:19], s44 offen
    s_mov_b64 exec, -1
    v_add_f32 v210, v210, v207
    v_add_f32 v210, v210, v208
    v_mfma_f32_16x16x32_bf16 v[36:39], v[160:163], v[132:135], v[36:39]
    ds_read_b64_tr_b16 v[174:175], v14 offset:25872
    v_add_f32 v210, v210, v209
    s_nop 1
    v_add_f32_dpp v210, v210, v210 row_shr:1 row_mask:0xf bank_mask:0xf bound_ctrl:0
    v_mfma_f32_16x16x32_bf16 v[40:43], v[160:163], v[136:139], v[40:43]
    ds_read_b64_tr_b16 v[176:177], v14 offset:24600
    v_add_f32_dpp v210, v210, v210 row_shr:2 row_mask:0xf bank_mask:0xf bound_ctrl:0
    s_nop 1
    v_add_f32_dpp v210, v210, v210 row_shr:4 row_mask:0xf bank_mask:0xf bound_ctrl:0
    s_nop 1
    v_add_f32_dpp v210, v210, v210 row_shr:8 row_mask:0xf bank_mask:0xf bound_ctrl:0
    v_mfma_f32_16x16x32_bf16 v[44:47], v[160:163], v[140:143], v[44:47]
    ds_read_b64_tr_b16 v[178:179], v14 offset:25880
    v_add_f32_dpp v210, v210, v210 row_bcast:15 row_mask:0xa bank_mask:0xf
    s_nop 1
    v_add_f32_dpp v210, v210, v210 row_bcast:31 row_mask:0xc bank_mask:0xf
    v_mfma_f32_16x16x32_bf16 v[48:51], v[164:167], v[128:131], v[48:51]
    ds_read_b64_tr_b16 v[180:181], v14 offset:24608
    v_readlane_b32 s51, v210, 63
    v_mov_b32 v211, 0x3acccccd
    v_mfma_f32_16x16x32_bf16 v[52:55], v[164:167], v[132:135], v[52:55]
    ds_read_b64_tr_b16 v[182:183], v14 offset:25888
    v_mul_f32 v211, s51, v211
    v_sub_f32 v200, v200, v211
    v_sub_f32 v201, v201, v211
    v_mfma_f32_16x16x32_bf16 v[56:59], v[164:167], v[136:139], v[56:59]
    v_sub_f32 v202, v202, v211
    v_sub_f32 v203, v203, v211
    v_mfma_f32_16x16x32_bf16 v[60:63], v[164:167], v[140:143], v[60:63]
    v_sub_f32 v204, v204, v211
    v_sub_f32 v205, v205, v211
    s_waitcnt lgkmcnt(0)
    v_mfma_f32_16x16x32_bf16 v[64:67], v[172:175], v[128:131], v[64:67]
    ds_read_b128 v[144:147], v11 offset:32768
    s_lshl_b32 s45, s49, 1
    s_add_u32 s44, s44, s45
    s_mov_b64 exec, s[42:43]
    buffer_load_dwordx4 v[232:235], v8, s[12:15], s44 offen
    buffer_load_dwordx4 v[236:239], v9, s[16:19], s44 offen
    s_mov_b64 exec, -1
    v_sub_f32 v206, v206, v211
    v_mfma_f32_16x16x32_bf16 v[68:71], v[172:175], v[132:135], v[68:71]
    ds_read_b64_tr_b16 v[160:161], v14 offset:34944
    v_sub_f32 v207, v207, v211
    v_sub_f32 v208, v208, v211
    v_mfma_f32_16x16x32_bf16 v[72:75], v[172:175], v[136:139], v[72:75]
    ds_read_b64_tr_b16 v[162:163], v14 offset:36224
    v_sub_f32 v209, v209, v211
    v_mfma_f32_16x16x32_bf16 v[76:79], v[172:175], v[140:143], v[76:79]
    ds_read_b128 v[148:151], v11 offset:34816
    v_mul_f32 v210, v200, v200
    v_fmac_f32 v210, v201, v201
    v_mfma_f32_16x16x32_bf16 v[80:83], v[176:179], v[128:131], v[80:83]
    ds_read_b128 v[152:155], v11 offset:36864
    v_fmac_f32 v210, v202, v202
    v_mfma_f32_16x16x32_bf16 v[84:87], v[176:179], v[132:135], v[84:87]
    ds_read_b128 v[156:159], v11 offset:38912
    v_fmac_f32 v210, v203, v203
    v_fmac_f32 v210, v204, v204
    v_mfma_f32_16x16x32_bf16 v[88:91], v[176:179], v[136:139], v[88:91]
    ds_read_b64_tr_b16 v[164:165], v14 offset:34952
    v_fmac_f32 v210, v205, v205
    v_fmac_f32 v210, v206, v206
    v_mfma_f32_16x16x32_bf16 v[92:95], v[176:179], v[140:143], v[92:95]
    ds_read_b64_tr_b16 v[166:167], v14 offset:36232
    v_fmac_f32 v210, v207, v207
    v_mfma_f32_16x16x32_bf16 v[96:99], v[180:183], v[128:131], v[96:99]
    v_fmac_f32 v210, v208, v208
    v_fmac_f32 v210, v209, v209
    v_mfma_f32_16x16x32_bf16 v[100:103], v[180:183], v[132:135], v[100:103]
    s_nop 0
    v_add_f32_dpp v210, v210, v210 row_shr:1 row_mask:0xf bank_mask:0xf bound_ctrl:0
    v_mfma_f32_16x16x32_bf16 v[104:107], v[180:183], v[136:139], v[104:107]
    s_nop 0
    v_add_f32_dpp v210, v210, v210 row_shr:2 row_mask:0xf bank_mask:0xf bound_ctrl:0
    s_nop 1
    v_add_f32_dpp v210, v210, v210 row_shr:4 row_mask:0xf bank_mask:0xf bound_ctrl:0
    v_mfma_f32_16x16x32_bf16 v[108:111], v[180:183], v[140:143], v[108:111]
    s_nop 0
    v_add_f32_dpp v210, v210, v210 row_shr:8 row_mask:0xf bank_mask:0xf bound_ctrl:0
    s_waitcnt lgkmcnt(0)
    v_mfma_f32_16x16x32_bf16 v[32:35], v[160:163], v[144:147], v[32:35]
    ds_read_b64_tr_b16 v[172:173], v14 offset:34960
    v_add_f32_dpp v210, v210, v210 row_bcast:15 row_mask:0xa bank_mask:0xf
    s_nop 1
    v_add_f32_dpp v210, v210, v210 row_bcast:31 row_mask:0xc bank_mask:0xf
    s_nop 0
    v_readlane_b32 s51, v210, 63
    v_mfma_f32_16x16x32_bf16 v[36:39], v[160:163], v[148:151], v[36:39]
    ds_read_b64_tr_b16 v[174:175], v14 offset:36240
    v_mov_b32 v210, 0x3acccccd
    v_mul_f32 v210, s51, v210
    v_mfma_f32_16x16x32_bf16 v[40:43], v[160:163], v[152:155], v[40:43]
    ds_read_b64_tr_b16 v[176:177], v14 offset:34968
    v_cvt_pk_bf16_f32 v210, v210, v211
    v_and_b32 v200, 0xffff0000, v210
    v_lshlrev_b32 v210, 16, v210
    v_mfma_f32_16x16x32_bf16 v[44:47], v[160:163], v[156:159], v[44:47]
    ds_read_b64_tr_b16 v[178:179], v14 offset:36248
    v_add_f32 v210, 0x3727c5ac, v210
    v_cvt_pk_bf16_f32 v210, v210, v210
    v_mfma_f32_16x16x32_bf16 v[48:51], v[164:167], v[144:147], v[48:51]
    ds_read_b64_tr_b16 v[180:181], v14 offset:34976
    v_lshlrev_b32 v210, 16, v210
    v_sqrt_f32 v210, v210
    v_mfma_f32_16x16x32_bf16 v[52:55], v[164:167], v[148:151], v[52:55]
    ds_read_b64_tr_b16 v[182:183], v14 offset:36256
    v_cvt_pk_bf16_f32 v210, v210, v210
    v_lshlrev_b32 v201, 16, v210
    s_lshl_b32 s51, s50, 3
    v_mfma_f32_16x16x32_bf16 v[56:59], v[164:167], v[152:155], v[56:59]
    s_add_u32 s51, s51, 32768
    v_mov_b32 v210, 0
    v_mfma_f32_16x16x32_bf16 v[60:63], v[164:167], v[156:159], v[60:63]
    s_mov_b64 exec, 1
    buffer_store_dwordx2 v[200:201], v210, s[20:23], s51 offen sc1
    s_mov_b64 exec, -1
    v_mov_b32 v242, 0
    buffer_load_dwordx2 v[242:243], v242, s[4:7], 0 offen sc1
    s_waitcnt lgkmcnt(0)
    s_barrier
    v_mfma_f32_16x16x32_bf16 v[64:67], v[172:175], v[144:147], v[64:67]
    ds_read_b128 v[128:131], v12 offset:0
    s_waitcnt vmcnt(17)
    v_lshlrev_b32 v200, 16, v184
    v_mfma_f32_16x16x32_bf16 v[68:71], v[172:175], v[148:151], v[68:71]
    ds_read_b64_tr_b16 v[160:161], v14 offset:0
    v_and_b32 v201, 0xffff0000, v184
    v_lshlrev_b32 v202, 16, v185
    v_mfma_f32_16x16x32_bf16 v[72:75], v[172:175], v[152:155], v[72:75]
    ds_read_b64_tr_b16 v[162:163], v14 offset:1280
    v_and_b32 v203, 0xffff0000, v185
    v_lshlrev_b32 v204, 16, v186
    v_mfma_f32_16x16x32_bf16 v[76:79], v[172:175], v[156:159], v[76:79]
    ds_read_b128 v[132:135], v12 offset:2048
    v_and_b32 v205, 0xffff0000, v186
    v_mfma_f32_16x16x32_bf16 v[80:83], v[176:179], v[144:147], v[80:83]
    ds_read_b128 v[136:139], v12 offset:4096
    v_lshlrev_b32 v206, 16, v187
    v_and_b32 v207, 0xffff0000, v187
    v_mfma_f32_16x16x32_bf16 v[84:87], v[176:179], v[148:151], v[84:87]
    ds_read_b128 v[140:143], v12 offset:6144
    v_lshlrev_b32 v16, 16, v188
    v_and_b32 v17, 0xffff0000, v188
    v_mfma_f32_16x16x32_bf16 v[88:91], v[176:179], v[152:155], v[88:91]
    ds_read_b64_tr_b16 v[164:165], v14 offset:8
    v_add_f32 v200, v200, v16
    v_add_f32 v201, v201, v17
    v_mfma_f32_16x16x32_bf16 v[92:95], v[176:179], v[156:159], v[92:95]
    ds_read_b64_tr_b16 v[166:167], v14 offset:1288
    v_lshlrev_b32 v16, 16, v189
    v_mfma_f32_16x16x32_bf16 v[96:99], v[180:183], v[144:147], v[96:99]
    v_and_b32 v17, 0xffff0000, v189
    v_add_f32 v202, v202, v16
    v_mfma_f32_16x16x32_bf16 v[100:103], v[180:183], v[148:151], v[100:103]
    v_add_f32 v203, v203, v17
    v_lshlrev_b32 v16, 16, v190
    v_mfma_f32_16x16x32_bf16 v[104:107], v[180:183], v[152:155], v[104:107]
    v_and_b32 v17, 0xffff0000, v190
    v_add_f32 v204, v204, v16
    v_mfma_f32_16x16x32_bf16 v[108:111], v[180:183], v[156:159], v[108:111]
    v_add_f32 v205, v205, v17
    s_waitcnt lgkmcnt(0)
    v_mfma_f32_16x16x32_bf16 v[32:35], v[160:163], v[128:131], v[32:35]
    ds_read_b64_tr_b16 v[172:173], v14 offset:16
    v_lshlrev_b32 v16, 16, v191
    v_and_b32 v17, 0xffff0000, v191
    v_add_f32 v206, v206, v16
    v_mfma_f32_16x16x32_bf16 v[36:39], v[160:163], v[132:135], v[36:39]
    ds_read_b64_tr_b16 v[174:175], v14 offset:1296
    v_add_f32 v207, v207, v17
    s_waitcnt vmcnt(8)
    v_lshlrev_b32 v16, 16, v192
    v_mfma_f32_16x16x32_bf16 v[40:43], v[160:163], v[136:139], v[40:43]
    ds_read_b64_tr_b16 v[176:177], v14 offset:24
    v_and_b32 v17, 0xffff0000, v192
    v_add_f32 v200, v200, v16
    v_add_f32 v201, v201, v17
    v_mfma_f32_16x16x32_bf16 v[44:47], v[160:163], v[140:143], v[44:47]
    ds_read_b64_tr_b16 v[178:179], v14 offset:1304
    v_lshlrev_b32 v16, 16, v193
    v_and_b32 v17, 0xffff0000, v193
    v_mfma_f32_16x16x32_bf16 v[48:51], v[164:167], v[128:131], v[48:51]
    ds_read_b64_tr_b16 v[180:181], v14 offset:32
    v_add_f32 v202, v202, v16
    v_add_f32 v203, v203, v17
    v_lshlrev_b32 v16, 16, v194
    v_mfma_f32_16x16x32_bf16 v[52:55], v[164:167], v[132:135], v[52:55]
    ds_read_b64_tr_b16 v[182:183], v14 offset:1312
    v_and_b32 v17, 0xffff0000, v194
    v_add_f32 v204, v204, v16
    v_add_f32 v205, v205, v17
    v_mfma_f32_16x16x32_bf16 v[56:59], v[164:167], v[136:139], v[56:59]
    v_lshlrev_b32 v16, 16, v195
    v_and_b32 v17, 0xffff0000, v195
    v_add_f32 v206, v206, v16
    v_mfma_f32_16x16x32_bf16 v[60:63], v[164:167], v[140:143], v[60:63]
    v_add_f32 v207, v207, v17
    v_lshlrev_b32 v16, 16, v196
    s_waitcnt lgkmcnt(0)
    v_mfma_f32_16x16x32_bf16 v[64:67], v[172:175], v[128:131], v[64:67]
    ds_read_b128 v[144:147], v13 offset:0
    v_and_b32 v17, 0xffff0000, v196
    v_add_f32 v200, v200, v16
    v_mfma_f32_16x16x32_bf16 v[68:71], v[172:175], v[132:135], v[68:71]
    ds_read_b64_tr_b16 v[160:161], v14 offset:10368
    v_add_f32 v201, v201, v17
    v_lshlrev_b32 v16, 16, v197
    v_mfma_f32_16x16x32_bf16 v[72:75], v[172:175], v[136:139], v[72:75]
    ds_read_b64_tr_b16 v[162:163], v14 offset:11648
    v_and_b32 v17, 0xffff0000, v197
    v_add_f32 v202, v202, v16
    v_mfma_f32_16x16x32_bf16 v[76:79], v[172:175], v[140:143], v[76:79]
    ds_read_b128 v[148:151], v13 offset:2048
    v_add_f32 v203, v203, v17
    v_mfma_f32_16x16x32_bf16 v[80:83], v[176:179], v[128:131], v[80:83]
    ds_read_b128 v[152:155], v13 offset:4096
    v_lshlrev_b32 v16, 16, v198
    v_and_b32 v17, 0xffff0000, v198
    v_mfma_f32_16x16x32_bf16 v[84:87], v[176:179], v[132:135], v[84:87]
    ds_read_b128 v[156:159], v13 offset:6144
    v_add_f32 v204, v204, v16
    v_add_f32 v205, v205, v17
    v_mfma_f32_16x16x32_bf16 v[88:91], v[176:179], v[136:139], v[88:91]
    ds_read_b64_tr_b16 v[164:165], v14 offset:10376
    v_lshlrev_b32 v16, 16, v199
    v_and_b32 v17, 0xffff0000, v199
    v_mfma_f32_16x16x32_bf16 v[92:95], v[176:179], v[140:143], v[92:95]
    ds_read_b64_tr_b16 v[166:167], v14 offset:11656
    v_add_f32 v206, v206, v16
    v_mfma_f32_16x16x32_bf16 v[96:99], v[180:183], v[128:131], v[96:99]
    v_add_f32 v207, v207, v17
    s_waitcnt vmcnt(6)
    v_mfma_f32_16x16x32_bf16 v[100:103], v[180:183], v[132:135], v[100:103]
    v_lshlrev_b32 v16, 16, v216
    v_and_b32 v17, 0xffff0000, v216
    v_mfma_f32_16x16x32_bf16 v[104:107], v[180:183], v[136:139], v[104:107]
    v_add_f32 v200, v200, v16
    v_add_f32 v201, v201, v17
    v_mfma_f32_16x16x32_bf16 v[108:111], v[180:183], v[140:143], v[108:111]
    v_lshlrev_b32 v16, 16, v217
    s_waitcnt lgkmcnt(0)
    v_mfma_f32_16x16x32_bf16 v[32:35], v[160:163], v[144:147], v[32:35]
    ds_read_b64_tr_b16 v[172:173], v14 offset:10384
    v_and_b32 v17, 0xffff0000, v217
    v_add_f32 v202, v202, v16
    v_add_f32 v203, v203, v17
    v_mfma_f32_16x16x32_bf16 v[36:39], v[160:163], v[148:151], v[36:39]
    ds_read_b64_tr_b16 v[174:175], v14 offset:11664
    v_lshlrev_b32 v16, 16, v218
    v_and_b32 v17, 0xffff0000, v218
    v_add_f32 v204, v204, v16
    v_mfma_f32_16x16x32_bf16 v[40:43], v[160:163], v[152:155], v[40:43]
    ds_read_b64_tr_b16 v[176:177], v14 offset:10392
    v_add_f32 v205, v205, v17
    v_lshlrev_b32 v16, 16, v219
    v_and_b32 v17, 0xffff0000, v219
    v_mfma_f32_16x16x32_bf16 v[44:47], v[160:163], v[156:159], v[44:47]
    ds_read_b64_tr_b16 v[178:179], v14 offset:11672
    v_add_f32 v206, v206, v16
    v_add_f32 v207, v207, v17
    v_mfma_f32_16x16x32_bf16 v[48:51], v[164:167], v[144:147], v[48:51]
    ds_read_b64_tr_b16 v[180:181], v14 offset:10400
    v_lshlrev_b32 v16, 16, v220
    v_and_b32 v17, 0xffff0000, v220
    v_add_f32 v200, v200, v16
    v_mfma_f32_16x16x32_bf16 v[52:55], v[164:167], v[148:151], v[52:55]
    ds_read_b64_tr_b16 v[182:183], v14 offset:11680
    v_add_f32 v201, v201, v17
    v_lshlrev_b32 v16, 16, v221
    v_and_b32 v17, 0xffff0000, v221
    v_mfma_f32_16x16x32_bf16 v[56:59], v[164:167], v[152:155], v[56:59]
    v_add_f32 v202, v202, v16
    v_add_f32 v203, v203, v17
    v_lshlrev_b32 v16, 16, v222
    v_mfma_f32_16x16x32_bf16 v[60:63], v[164:167], v[156:159], v[60:63]
    v_and_b32 v17, 0xffff0000, v222
    v_add_f32 v204, v204, v16
    s_waitcnt lgkmcnt(0)
    s_barrier
    s_waitcnt vmcnt(0)
    v_readfirstlane_b32 s82, v242
    v_readfirstlane_b32 s83, v243
    s_cmp_lg_u32 s82, 0
    s_cbranch_scc1 QKVP_NON_OK
    s_mov_b32 s81, 0
QKVP_NON_SP:
    s_sleep 2
    v_mov_b32 v242, 0
    buffer_load_dwordx2 v[242:243], v242, s[4:7], 0 offen sc1
    s_waitcnt vmcnt(0)
    v_readfirstlane_b32 s82, v242
    v_readfirstlane_b32 s83, v243
    s_add_u32 s81, s81, 1
    s_cmp_ge_u32 s81, 200000
    s_cbranch_scc1 QKVP_NON_OK
    s_cmp_eq_u32 s82, 0
    s_cbranch_scc1 QKVP_NON_SP
QKVP_NON_OK:
    v_mfma_f32_16x16x32_bf16 v[64:67], v[172:175], v[144:147], v[64:67]
    ds_read_b128 v[128:131], v10 offset:0
    v_add_f32 v205, v205, v17
    v_lshlrev_b32 v16, 16, v223
    v_mfma_f32_16x16x32_bf16 v[68:71], v[172:175], v[148:151], v[68:71]
    ds_read_b64_tr_b16 v[160:161], v14 offset:24576
    v_and_b32 v17, 0xffff0000, v223
    v_add_f32 v206, v206, v16
    v_mfma_f32_16x16x32_bf16 v[72:75], v[172:175], v[152:155], v[72:75]
    ds_read_b64_tr_b16 v[162:163], v14 offset:25856
    v_add_f32 v207, v207, v17
    s_waitcnt vmcnt(4)
    v_mfma_f32_16x16x32_bf16 v[76:79], v[172:175], v[156:159], v[76:79]
    ds_read_b128 v[132:135], v10 offset:2048
    v_lshlrev_b32 v16, 16, v224
    v_and_b32 v17, 0xffff0000, v224
    v_mfma_f32_16x16x32_bf16 v[80:83], v[176:179], v[144:147], v[80:83]
    ds_read_b128 v[136:139], v10 offset:4096
    v_add_f32 v200, v200, v16
    v_add_f32 v201, v201, v17
    v_mfma_f32_16x16x32_bf16 v[84:87], v[176:179], v[148:151], v[84:87]
    ds_read_b128 v[140:143], v10 offset:6144
    v_lshlrev_b32 v16, 16, v225
    v_mfma_f32_16x16x32_bf16 v[88:91], v[176:179], v[152:155], v[88:91]
    ds_read_b64_tr_b16 v[164:165], v14 offset:24584
    v_and_b32 v17, 0xffff0000, v225
    v_add_f32 v202, v202, v16
    v_mfma_f32_16x16x32_bf16 v[92:95], v[176:179], v[156:159], v[92:95]
    ds_read_b64_tr_b16 v[166:167], v14 offset:25864
    v_add_f32 v203, v203, v17
    v_lshlrev_b32 v16, 16, v226
    v_mfma_f32_16x16x32_bf16 v[96:99], v[180:183], v[144:147], v[96:99]
    v_and_b32 v17, 0xffff0000, v226
    v_add_f32 v204, v204, v16
    v_mfma_f32_16x16x32_bf16 v[100:103], v[180:183], v[148:151], v[100:103]
    v_add_f32 v205, v205, v17
    v_lshlrev_b32 v16, 16, v227
    v_mfma_f32_16x16x32_bf16 v[104:107], v[180:183], v[152:155], v[104:107]
    v_and_b32 v17, 0xffff0000, v227
    v_add_f32 v206, v206, v16
    v_mfma_f32_16x16x32_bf16 v[108:111], v[180:183], v[156:159], v[108:111]
    v_add_f32 v207, v207, v17
    s_waitcnt lgkmcnt(0)
    v_mfma_f32_16x16x32_bf16 v[32:35], v[160:163], v[128:131], v[32:35]
    ds_read_b64_tr_b16 v[172:173], v14 offset:24592
    v_lshlrev_b32 v16, 16, v228
    v_and_b32 v17, 0xffff0000, v228
    v_add_f32 v200, v200, v16
    v_mfma_f32_16x16x32_bf16 v[36:39], v[160:163], v[132:135], v[36:39]
    ds_read_b64_tr_b16 v[174:175], v14 offset:25872
    v_add_f32 v201, v201, v17
    v_lshlrev_b32 v16, 16, v229
    v_and_b32 v17, 0xffff0000, v229
    v_mfma_f32_16x16x32_bf16 v[40:43], v[160:163], v[136:139], v[40:43]
    ds_read_b64_tr_b16 v[176:177], v14 offset:24600
    v_add_f32 v202, v202, v16
    v_add_f32 v203, v203, v17
    v_mfma_f32_16x16x32_bf16 v[44:47], v[160:163], v[140:143], v[44:47]
    ds_read_b64_tr_b16 v[178:179], v14 offset:25880
    v_lshlrev_b32 v16, 16, v230
    v_and_b32 v17, 0xffff0000, v230
    v_add_f32 v204, v204, v16
    v_mfma_f32_16x16x32_bf16 v[48:51], v[164:167], v[128:131], v[48:51]
    ds_read_b64_tr_b16 v[180:181], v14 offset:24608
    v_add_f32 v205, v205, v17
    v_lshlrev_b32 v16, 16, v231
    v_and_b32 v17, 0xffff0000, v231
    v_mfma_f32_16x16x32_bf16 v[52:55], v[164:167], v[132:135], v[52:55]
    ds_read_b64_tr_b16 v[182:183], v14 offset:25888
    v_add_f32 v206, v206, v16
    v_add_f32 v207, v207, v17
    v_mfma_f32_16x16x32_bf16 v[56:59], v[164:167], v[136:139], v[56:59]
    s_waitcnt vmcnt(2)
    v_lshlrev_b32 v16, 16, v232
    v_and_b32 v17, 0xffff0000, v232
    v_mfma_f32_16x16x32_bf16 v[60:63], v[164:167], v[140:143], v[60:63]
    v_add_f32 v200, v200, v16
    v_add_f32 v201, v201, v17
    s_waitcnt lgkmcnt(0)
    v_mfma_f32_16x16x32_bf16 v[64:67], v[172:175], v[128:131], v[64:67]
    ds_read_b128 v[144:147], v11 offset:0
    v_lshlrev_b32 v16, 16, v233
    v_and_b32 v17, 0xffff0000, v233
    v_mfma_f32_16x16x32_bf16 v[68:71], v[172:175], v[132:135], v[68:71]
    ds_read_b64_tr_b16 v[160:161], v14 offset:34944
    v_add_f32 v202, v202, v16
    v_add_f32 v203, v203, v17
    v_mfma_f32_16x16x32_bf16 v[72:75], v[172:175], v[136:139], v[72:75]
    ds_read_b64_tr_b16 v[162:163], v14 offset:36224
    v_lshlrev_b32 v16, 16, v234
    v_and_b32 v17, 0xffff0000, v234
    v_mfma_f32_16x16x32_bf16 v[76:79], v[172:175], v[140:143], v[76:79]
    ds_read_b128 v[148:151], v11 offset:2048
    v_add_f32 v204, v204, v16
    v_add_f32 v205, v205, v17
    v_mfma_f32_16x16x32_bf16 v[80:83], v[176:179], v[128:131], v[80:83]
    ds_read_b128 v[152:155], v11 offset:4096
    v_lshlrev_b32 v16, 16, v235
    v_and_b32 v17, 0xffff0000, v235
    v_mfma_f32_16x16x32_bf16 v[84:87], v[176:179], v[132:135], v[84:87]
    ds_read_b128 v[156:159], v11 offset:6144
    v_add_f32 v206, v206, v16
    v_mfma_f32_16x16x32_bf16 v[88:91], v[176:179], v[136:139], v[88:91]
    ds_read_b64_tr_b16 v[164:165], v14 offset:34952
    v_add_f32 v207, v207, v17
    v_lshlrev_b32 v16, 16, v236
    v_mfma_f32_16x16x32_bf16 v[92:95], v[176:179], v[140:143], v[92:95]
    ds_read_b64_tr_b16 v[166:167], v14 offset:36232
    v_and_b32 v17, 0xffff0000, v236
    v_add_f32 v200, v200, v16
    v_mfma_f32_16x16x32_bf16 v[96:99], v[180:183], v[128:131], v[96:99]
    v_add_f32 v201, v201, v17
    v_lshlrev_b32 v16, 16, v237
    v_mfma_f32_16x16x32_bf16 v[100:103], v[180:183], v[132:135], v[100:103]
    v_and_b32 v17, 0xffff0000, v237
    v_add_f32 v202, v202, v16
    v_mfma_f32_16x16x32_bf16 v[104:107], v[180:183], v[136:139], v[104:107]
    v_add_f32 v203, v203, v17
    v_lshlrev_b32 v16, 16, v238
    v_mfma_f32_16x16x32_bf16 v[108:111], v[180:183], v[140:143], v[108:111]
    v_and_b32 v17, 0xffff0000, v238
    s_waitcnt lgkmcnt(0)
    v_mfma_f32_16x16x32_bf16 v[32:35], v[160:163], v[144:147], v[32:35]
    ds_read_b64_tr_b16 v[172:173], v14 offset:34960
    v_add_f32 v204, v204, v16
    v_add_f32 v205, v205, v17
    v_lshlrev_b32 v16, 16, v239
    v_mfma_f32_16x16x32_bf16 v[36:39], v[160:163], v[148:151], v[36:39]
    ds_read_b64_tr_b16 v[174:175], v14 offset:36240
    v_and_b32 v17, 0xffff0000, v239
    v_add_f32 v206, v206, v16
    v_add_f32 v207, v207, v17
    v_mfma_f32_16x16x32_bf16 v[40:43], v[160:163], v[152:155], v[40:43]
    ds_read_b64_tr_b16 v[176:177], v14 offset:34968
    v_permlane32_swap_b32 v200, v204
    v_permlane32_swap_b32 v201, v205
    v_permlane32_swap_b32 v202, v206
    v_mfma_f32_16x16x32_bf16 v[44:47], v[160:163], v[156:159], v[44:47]
    ds_read_b64_tr_b16 v[178:179], v14 offset:36248
    v_permlane32_swap_b32 v203, v207
    v_add_f32 v200, v200, v204
    v_mfma_f32_16x16x32_bf16 v[48:51], v[164:167], v[144:147], v[48:51]
    ds_read_b64_tr_b16 v[180:181], v14 offset:34976
    v_add_f32 v201, v201, v205
    v_add_f32 v202, v202, v206
    v_add_f32 v203, v203, v207
    v_mfma_f32_16x16x32_bf16 v[52:55], v[164:167], v[148:151], v[52:55]
    ds_read_b64_tr_b16 v[182:183], v14 offset:36256
    v_and_b32 v16, 31, v0
    v_lshlrev_b32 v16, 5, v16
    v_lshrrev_b32 v17, 5, v0
    v_mfma_f32_16x16x32_bf16 v[56:59], v[164:167], v[152:155], v[56:59]
    v_lshl_add_u32 v16, v17, 4, v16
    s_mul_i32 s45, s37, 768
    s_add_u32 s45, s45, 154656
    v_mfma_f32_16x16x32_bf16 v[60:63], v[164:167], v[156:159], v[60:63]
    v_add_u32 v16, s45, v16
    s_mov_b64 exec, s[42:43]
    ds_write_b128 v16, v[200:203]
    s_mov_b64 exec, -1
    s_waitcnt vmcnt(1) lgkmcnt(0)
    s_barrier
    s_cmp_eq_u32 s32, 4
    s_cbranch_scc0 QKVP_NCS
    v_lshlrev_b32 v16, 4, v0
    v_add_u32 v17, 154656, v16
    s_mov_b32 exec_hi, 0xffff
    ds_read_b128 v[184:187], v17 offset:0
    ds_read_b128 v[188:191], v17 offset:768
    ds_read_b128 v[192:195], v17 offset:1536
    ds_read_b128 v[196:199], v17 offset:2304
    s_lshl_b32 s45, s36, 3
    s_add_u32 s45, s45, s33
    s_mul_i32 s45, s45, 768
    s_add_u32 s45, s45, 65536
    s_waitcnt lgkmcnt(0)
    v_add_f32 v184, v184, v188
    v_add_f32 v185, v185, v189
    v_add_f32 v186, v186, v190
    v_add_f32 v187, v187, v191
    v_add_f32 v184, v184, v192
    v_add_f32 v185, v185, v193
    v_add_f32 v186, v186, v194
    v_add_f32 v187, v187, v195
    v_add_f32 v184, v184, v196
    v_add_f32 v185, v185, v197
    v_add_f32 v186, v186, v198
    v_add_f32 v187, v187, v199
    buffer_store_dwordx4 v[184:187], v16, s[20:23], s45 offen sc1
    s_mov_b64 exec, -1
QKVP_NCS:
    v_mfma_f32_16x16x32_bf16 v[64:67], v[172:175], v[144:147], v[64:67]
    ds_read_b128 v[128:131], v10 offset:32768
    v_mfma_f32_16x16x32_bf16 v[68:71], v[172:175], v[148:151], v[68:71]
    ds_read_b64_tr_b16 v[160:161], v14 offset:0
    v_mfma_f32_16x16x32_bf16 v[72:75], v[172:175], v[152:155], v[72:75]
    ds_read_b64_tr_b16 v[162:163], v14 offset:1280
    v_mfma_f32_16x16x32_bf16 v[76:79], v[172:175], v[156:159], v[76:79]
    ds_read_b128 v[132:135], v10 offset:34816
    v_mfma_f32_16x16x32_bf16 v[80:83], v[176:179], v[144:147], v[80:83]
    ds_read_b128 v[136:139], v10 offset:36864
    v_mfma_f32_16x16x32_bf16 v[84:87], v[176:179], v[148:151], v[84:87]
    ds_read_b128 v[140:143], v10 offset:38912
    v_mfma_f32_16x16x32_bf16 v[88:91], v[176:179], v[152:155], v[88:91]
    ds_read_b64_tr_b16 v[164:165], v14 offset:8
    v_mfma_f32_16x16x32_bf16 v[92:95], v[176:179], v[156:159], v[92:95]
    ds_read_b64_tr_b16 v[166:167], v14 offset:1288
    v_mfma_f32_16x16x32_bf16 v[96:99], v[180:183], v[144:147], v[96:99]
    v_mfma_f32_16x16x32_bf16 v[100:103], v[180:183], v[148:151], v[100:103]
    v_mfma_f32_16x16x32_bf16 v[104:107], v[180:183], v[152:155], v[104:107]
    v_mfma_f32_16x16x32_bf16 v[108:111], v[180:183], v[156:159], v[108:111]
    s_waitcnt lgkmcnt(0)
    v_mfma_f32_16x16x32_bf16 v[32:35], v[160:163], v[128:131], v[32:35]
    ds_read_b64_tr_b16 v[172:173], v14 offset:16
    v_and_b32 v30, 3, v0
    v_mfma_f32_16x16x32_bf16 v[36:39], v[160:163], v[132:135], v[36:39]
    ds_read_b64_tr_b16 v[174:175], v14 offset:1296
    v_bfe_u32 v16, v0, 2, 2
    v_mfma_f32_16x16x32_bf16 v[40:43], v[160:163], v[136:139], v[40:43]
    ds_read_b64_tr_b16 v[176:177], v14 offset:24
    v_lshl_add_u32 v30, v16, 3, v30
    v_mfma_f32_16x16x32_bf16 v[44:47], v[160:163], v[140:143], v[44:47]
    ds_read_b64_tr_b16 v[178:179], v14 offset:1304
    v_mfma_f32_16x16x32_bf16 v[48:51], v[164:167], v[128:131], v[48:51]
    ds_read_b64_tr_b16 v[180:181], v14 offset:32
    v_add_u32 v30, 228, v30
    v_mfma_f32_16x16x32_bf16 v[52:55], v[164:167], v[132:135], v[52:55]
    ds_read_b64_tr_b16 v[182:183], v14 offset:1312
    v_lshlrev_b32 v30, 7, v30
    v_mfma_f32_16x16x32_bf16 v[56:59], v[164:167], v[136:139], v[56:59]
    s_and_b32 s45, s33, 3
    v_mfma_f32_16x16x32_bf16 v[60:63], v[164:167], v[140:143], v[60:63]
    s_waitcnt lgkmcnt(0)
    v_mfma_f32_16x16x32_bf16 v[64:67], v[172:175], v[128:131], v[64:67]
    ds_read_b128 v[144:147], v11 offset:32768
    s_lshl_b32 s45, s45, 1
    v_mfma_f32_16x16x32_bf16 v[68:71], v[172:175], v[132:135], v[68:71]
    ds_read_b64_tr_b16 v[160:161], v14 offset:10368
    v_mfma_f32_16x16x32_bf16 v[72:75], v[172:175], v[136:139], v[72:75]
    ds_read_b64_tr_b16 v[162:163], v14 offset:11648
    s_lshr_b32 s46, s33, 2
    v_mfma_f32_16x16x32_bf16 v[76:79], v[172:175], v[140:143], v[76:79]
    ds_read_b128 v[148:151], v11 offset:34816
    v_mfma_f32_16x16x32_bf16 v[80:83], v[176:179], v[128:131], v[80:83]
    ds_read_b128 v[152:155], v11 offset:36864
    s_add_u32 s45, s45, s46
    v_mfma_f32_16x16x32_bf16 v[84:87], v[176:179], v[132:135], v[84:87]
    ds_read_b128 v[156:159], v11 offset:38912
    v_mfma_f32_16x16x32_bf16 v[88:91], v[176:179], v[136:139], v[88:91]
    ds_read_b64_tr_b16 v[164:165], v14 offset:10376
    v_lshlrev_b32 v31, 3, v0
    v_mfma_f32_16x16x32_bf16 v[92:95], v[176:179], v[140:143], v[92:95]
    ds_read_b64_tr_b16 v[166:167], v14 offset:11656
    v_mfma_f32_16x16x32_bf16 v[96:99], v[180:183], v[128:131], v[96:99]
    v_add_u32 v31, s45, v31
    v_mfma_f32_16x16x32_bf16 v[100:103], v[180:183], v[132:135], v[100:103]
    v_mfma_f32_16x16x32_bf16 v[104:107], v[180:183], v[136:139], v[104:107]
    s_andn2_b32 s45, s2, 25
    v_mfma_f32_16x16x32_bf16 v[108:111], v[180:183], v[140:143], v[108:111]
    s_waitcnt lgkmcnt(0)
    v_mfma_f32_16x16x32_bf16 v[32:35], v[160:163], v[144:147], v[32:35]
    ds_read_b64_tr_b16 v[172:173], v14 offset:10384
    v_and_b32 v16, 3, v0
    v_mfma_f32_16x16x32_bf16 v[36:39], v[160:163], v[148:151], v[36:39]
    ds_read_b64_tr_b16 v[174:175], v14 offset:11664
    v_lshlrev_b32 v16, 3, v16
    v_mfma_f32_16x16x32_bf16 v[40:43], v[160:163], v[152:155], v[40:43]
    ds_read_b64_tr_b16 v[176:177], v14 offset:10392
    v_bfe_u32 v17, v0, 2, 1
    v_mfma_f32_16x16x32_bf16 v[44:47], v[160:163], v[156:159], v[44:47]
    ds_read_b64_tr_b16 v[178:179], v14 offset:11672
    v_or3_b32 v16, s45, v16, v17
    v_mfma_f32_16x16x32_bf16 v[48:51], v[164:167], v[144:147], v[48:51]
    ds_read_b64_tr_b16 v[180:181], v14 offset:10400
    v_cmp_gt_u32 vcc, 32, v0
    v_mfma_f32_16x16x32_bf16 v[52:55], v[164:167], v[148:151], v[52:55]
    ds_read_b64_tr_b16 v[182:183], v14 offset:11680
    v_cndmask_b32 v31, v16, v31, vcc
    v_mfma_f32_16x16x32_bf16 v[56:59], v[164:167], v[152:155], v[56:59]
    v_lshlrev_b32 v31, 7, v31
    v_mfma_f32_16x16x32_bf16 v[60:63], v[164:167], v[156:159], v[60:63]
    s_waitcnt vmcnt(0) lgkmcnt(0)
    s_barrier
    s_cmp_eq_u32 s32, 5
    s_cbranch_scc0 QKVP_NP1
    s_add_u32 s45, s82, 1
    v_mov_b32 v16, s45
    v_mov_b32 v17, s83
    v_mov_b32 v18, 0
    s_lshl_b32 s45, s2, 7
    s_mov_b64 exec, 1
    buffer_store_dwordx2 v[16:17], v18, s[20:23], s45 offen sc1
    s_mov_b64 exec, -1
QKVP_NP1:
    v_mfma_f32_16x16x32_bf16 v[64:67], v[172:175], v[144:147], v[64:67]
    ds_read_b128 v[128:131], v12 offset:0
    v_mfma_f32_16x16x32_bf16 v[68:71], v[172:175], v[148:151], v[68:71]
    ds_read_b64_tr_b16 v[160:161], v14 offset:24576
    v_mfma_f32_16x16x32_bf16 v[72:75], v[172:175], v[152:155], v[72:75]
    ds_read_b64_tr_b16 v[162:163], v14 offset:25856
    v_mfma_f32_16x16x32_bf16 v[76:79], v[172:175], v[156:159], v[76:79]
    ds_read_b128 v[132:135], v12 offset:2048
    v_mfma_f32_16x16x32_bf16 v[80:83], v[176:179], v[144:147], v[80:83]
    ds_read_b128 v[136:139], v12 offset:4096
    v_mfma_f32_16x16x32_bf16 v[84:87], v[176:179], v[148:151], v[84:87]
    ds_read_b128 v[140:143], v12 offset:6144
    v_mfma_f32_16x16x32_bf16 v[88:91], v[176:179], v[152:155], v[88:91]
    ds_read_b64_tr_b16 v[164:165], v14 offset:24584
    v_mfma_f32_16x16x32_bf16 v[92:95], v[176:179], v[156:159], v[92:95]
    ds_read_b64_tr_b16 v[166:167], v14 offset:25864
    v_mfma_f32_16x16x32_bf16 v[96:99], v[180:183], v[144:147], v[96:99]
    v_mfma_f32_16x16x32_bf16 v[100:103], v[180:183], v[148:151], v[100:103]
    v_mfma_f32_16x16x32_bf16 v[104:107], v[180:183], v[152:155], v[104:107]
    v_mfma_f32_16x16x32_bf16 v[108:111], v[180:183], v[156:159], v[108:111]
    s_waitcnt lgkmcnt(0)
    v_mfma_f32_16x16x32_bf16 v[32:35], v[160:163], v[128:131], v[32:35]
    ds_read_b64_tr_b16 v[172:173], v14 offset:24592
    v_mfma_f32_16x16x32_bf16 v[36:39], v[160:163], v[132:135], v[36:39]
    ds_read_b64_tr_b16 v[174:175], v14 offset:25872
    v_mfma_f32_16x16x32_bf16 v[40:43], v[160:163], v[136:139], v[40:43]
    ds_read_b64_tr_b16 v[176:177], v14 offset:24600
    v_mfma_f32_16x16x32_bf16 v[44:47], v[160:163], v[140:143], v[44:47]
    ds_read_b64_tr_b16 v[178:179], v14 offset:25880
    v_mfma_f32_16x16x32_bf16 v[48:51], v[164:167], v[128:131], v[48:51]
    ds_read_b64_tr_b16 v[180:181], v14 offset:24608
    v_mfma_f32_16x16x32_bf16 v[52:55], v[164:167], v[132:135], v[52:55]
    ds_read_b64_tr_b16 v[182:183], v14 offset:25888
    v_mfma_f32_16x16x32_bf16 v[56:59], v[164:167], v[136:139], v[56:59]
    v_mfma_f32_16x16x32_bf16 v[60:63], v[164:167], v[140:143], v[60:63]
    s_waitcnt lgkmcnt(0)
    v_mfma_f32_16x16x32_bf16 v[64:67], v[172:175], v[128:131], v[64:67]
    ds_read_b128 v[144:147], v13 offset:0
    v_mfma_f32_16x16x32_bf16 v[68:71], v[172:175], v[132:135], v[68:71]
    ds_read_b64_tr_b16 v[160:161], v14 offset:34944
    v_mfma_f32_16x16x32_bf16 v[72:75], v[172:175], v[136:139], v[72:75]
    ds_read_b64_tr_b16 v[162:163], v14 offset:36224
    v_mfma_f32_16x16x32_bf16 v[76:79], v[172:175], v[140:143], v[76:79]
    ds_read_b128 v[148:151], v13 offset:2048
    v_mfma_f32_16x16x32_bf16 v[80:83], v[176:179], v[128:131], v[80:83]
    ds_read_b128 v[152:155], v13 offset:4096
    v_mfma_f32_16x16x32_bf16 v[84:87], v[176:179], v[132:135], v[84:87]
    ds_read_b128 v[156:159], v13 offset:6144
    v_mfma_f32_16x16x32_bf16 v[88:91], v[176:179], v[136:139], v[88:91]
    ds_read_b64_tr_b16 v[164:165], v14 offset:34952
    v_mfma_f32_16x16x32_bf16 v[92:95], v[176:179], v[140:143], v[92:95]
    ds_read_b64_tr_b16 v[166:167], v14 offset:36232
    v_mfma_f32_16x16x32_bf16 v[96:99], v[180:183], v[128:131], v[96:99]
    v_mfma_f32_16x16x32_bf16 v[100:103], v[180:183], v[132:135], v[100:103]
    v_mfma_f32_16x16x32_bf16 v[104:107], v[180:183], v[136:139], v[104:107]
    v_mfma_f32_16x16x32_bf16 v[108:111], v[180:183], v[140:143], v[108:111]
    s_waitcnt lgkmcnt(0)
    v_mfma_f32_16x16x32_bf16 v[32:35], v[160:163], v[144:147], v[32:35]
    ds_read_b64_tr_b16 v[172:173], v14 offset:34960
    v_mfma_f32_16x16x32_bf16 v[36:39], v[160:163], v[148:151], v[36:39]
    ds_read_b64_tr_b16 v[174:175], v14 offset:36240
    v_mfma_f32_16x16x32_bf16 v[40:43], v[160:163], v[152:155], v[40:43]
    ds_read_b64_tr_b16 v[176:177], v14 offset:34968
    v_mfma_f32_16x16x32_bf16 v[44:47], v[160:163], v[156:159], v[44:47]
    ds_read_b64_tr_b16 v[178:179], v14 offset:36248
    v_mfma_f32_16x16x32_bf16 v[48:51], v[164:167], v[144:147], v[48:51]
    ds_read_b64_tr_b16 v[180:181], v14 offset:34976
    v_mfma_f32_16x16x32_bf16 v[52:55], v[164:167], v[148:151], v[52:55]
    ds_read_b64_tr_b16 v[182:183], v14 offset:36256
    v_mfma_f32_16x16x32_bf16 v[56:59], v[164:167], v[152:155], v[56:59]
    v_mfma_f32_16x16x32_bf16 v[60:63], v[164:167], v[156:159], v[60:63]
    s_waitcnt lgkmcnt(0)
    s_barrier
    v_mfma_f32_16x16x32_bf16 v[64:67], v[172:175], v[144:147], v[64:67]
    ds_read_b128 v[128:131], v10 offset:0
    v_lshlrev_b32 v8, 4, v0
    v_mfma_f32_16x16x32_bf16 v[68:71], v[172:175], v[148:151], v[68:71]
    ds_read_b64_tr_b16 v[160:161], v14 offset:0
    v_mfma_f32_16x16x32_bf16 v[72:75], v[172:175], v[152:155], v[72:75]
    ds_read_b64_tr_b16 v[162:163], v14 offset:1280
    v_mfma_f32_16x16x32_bf16 v[76:79], v[172:175], v[156:159], v[76:79]
    ds_read_b128 v[132:135], v10 offset:2048
    v_mfma_f32_16x16x32_bf16 v[80:83], v[176:179], v[144:147], v[80:83]
    ds_read_b128 v[136:139], v10 offset:4096
    v_mfma_f32_16x16x32_bf16 v[84:87], v[176:179], v[148:151], v[84:87]
    ds_read_b128 v[140:143], v10 offset:6144
    v_mfma_f32_16x16x32_bf16 v[88:91], v[176:179], v[152:155], v[88:91]
    ds_read_b64_tr_b16 v[164:165], v14 offset:8
    v_add_u32 v9, 4096, v8
    v_mfma_f32_16x16x32_bf16 v[92:95], v[176:179], v[156:159], v[92:95]
    ds_read_b64_tr_b16 v[166:167], v14 offset:1288
    v_mfma_f32_16x16x32_bf16 v[96:99], v[180:183], v[144:147], v[96:99]
    v_mfma_f32_16x16x32_bf16 v[100:103], v[180:183], v[148:151], v[100:103]
    v_mfma_f32_16x16x32_bf16 v[104:107], v[180:183], v[152:155], v[104:107]
    v_mfma_f32_16x16x32_bf16 v[108:111], v[180:183], v[156:159], v[108:111]
    s_waitcnt lgkmcnt(0)
    v_mfma_f32_16x16x32_bf16 v[32:35], v[160:163], v[128:131], v[32:35]
    ds_read_b64_tr_b16 v[172:173], v14 offset:16
    s_mul_i32 s29, s32, 10240
    v_mfma_f32_16x16x32_bf16 v[36:39], v[160:163], v[132:135], v[36:39]
    ds_read_b64_tr_b16 v[174:175], v14 offset:1296
    v_mfma_f32_16x16x32_bf16 v[40:43], v[160:163], v[136:139], v[40:43]
    ds_read_b64_tr_b16 v[176:177], v14 offset:24
    s_add_u32 s30, s29, 81920
    v_mfma_f32_16x16x32_bf16 v[44:47], v[160:163], v[140:143], v[44:47]
    ds_read_b64_tr_b16 v[178:179], v14 offset:1304
    v_mfma_f32_16x16x32_bf16 v[48:51], v[164:167], v[128:131], v[48:51]
    ds_read_b64_tr_b16 v[180:181], v14 offset:32
    v_mfma_f32_16x16x32_bf16 v[52:55], v[164:167], v[132:135], v[52:55]
    ds_read_b64_tr_b16 v[182:183], v14 offset:1312
    s_cmp_eq_u32 s32, 6
    s_cbranch_scc0 QKVP_NPS
    buffer_load_dwordx2 v[254:255], v31, s[20:23], 0 offen sc1
    QKVP_NPS:
    v_mfma_f32_16x16x32_bf16 v[56:59], v[164:167], v[136:139], v[56:59]
    v_mfma_f32_16x16x32_bf16 v[60:63], v[164:167], v[140:143], v[60:63]
    s_waitcnt lgkmcnt(0)
    v_mfma_f32_16x16x32_bf16 v[64:67], v[172:175], v[128:131], v[64:67]
    ds_read_b128 v[144:147], v11 offset:0
    s_lshl_b32 s45, s32, 3
    s_cmp_eq_u32 s32, 5
    s_cselect_b32 s45, 38, s45
    s_cmp_eq_u32 s32, 6
    s_cselect_b32 s45, 44, s45
    s_cmp_eq_u32 s32, 7
    s_cselect_b32 s45, 49, s45
    s_bfe_u32 s46, s2, 0x30003
    s_mul_i32 s46, s46, 74
    s_add_u32 s28, s45, s46
    s_mul_i32 s28, s28, 5120
    s_add_u32 s28, s28, 10485760
    v_mfma_f32_16x16x32_bf16 v[68:71], v[172:175], v[132:135], v[68:71]
    ds_read_b64_tr_b16 v[160:161], v14 offset:10368
    v_mfma_f32_16x16x32_bf16 v[72:75], v[172:175], v[136:139], v[72:75]
    ds_read_b64_tr_b16 v[162:163], v14 offset:11648
    v_mfma_f32_16x16x32_bf16 v[76:79], v[172:175], v[140:143], v[76:79]
    ds_read_b128 v[148:151], v11 offset:2048
    v_mfma_f32_16x16x32_bf16 v[80:83], v[176:179], v[128:131], v[80:83]
    ds_read_b128 v[152:155], v11 offset:4096
    v_mfma_f32_16x16x32_bf16 v[84:87], v[176:179], v[132:135], v[84:87]
    ds_read_b128 v[156:159], v11 offset:6144
    v_mfma_f32_16x16x32_bf16 v[88:91], v[176:179], v[136:139], v[88:91]
    ds_read_b64_tr_b16 v[164:165], v14 offset:10376
    s_mov_b32 s31, 0
    v_mfma_f32_16x16x32_bf16 v[92:95], v[176:179], v[140:143], v[92:95]
    ds_read_b64_tr_b16 v[166:167], v14 offset:11656
    v_mfma_f32_16x16x32_bf16 v[96:99], v[180:183], v[128:131], v[96:99]
    v_mfma_f32_16x16x32_bf16 v[100:103], v[180:183], v[132:135], v[100:103]
    v_mfma_f32_16x16x32_bf16 v[104:107], v[180:183], v[136:139], v[104:107]
    v_mfma_f32_16x16x32_bf16 v[108:111], v[180:183], v[140:143], v[108:111]
    s_waitcnt lgkmcnt(0)
    v_mfma_f32_16x16x32_bf16 v[32:35], v[160:163], v[144:147], v[32:35]
    ds_read_b64_tr_b16 v[172:173], v14 offset:10384
    v_mfma_f32_16x16x32_bf16 v[36:39], v[160:163], v[148:151], v[36:39]
    ds_read_b64_tr_b16 v[174:175], v14 offset:11664
    v_mfma_f32_16x16x32_bf16 v[40:43], v[160:163], v[152:155], v[40:43]
    ds_read_b64_tr_b16 v[176:177], v14 offset:10392
    v_mfma_f32_16x16x32_bf16 v[44:47], v[160:163], v[156:159], v[44:47]
    ds_read_b64_tr_b16 v[178:179], v14 offset:11672
    v_mfma_f32_16x16x32_bf16 v[48:51], v[164:167], v[144:147], v[48:51]
    ds_read_b64_tr_b16 v[180:181], v14 offset:10400
    v_mfma_f32_16x16x32_bf16 v[52:55], v[164:167], v[148:151], v[52:55]
    ds_read_b64_tr_b16 v[182:183], v14 offset:11680
    v_mfma_f32_16x16x32_bf16 v[56:59], v[164:167], v[152:155], v[56:59]
    v_mfma_f32_16x16x32_bf16 v[60:63], v[164:167], v[156:159], v[60:63]
    s_waitcnt lgkmcnt(0)
    s_barrier
    s_cmp_eq_u32 s32, 6
    s_cbranch_scc0 QKVP_NG
    s_waitcnt vmcnt(0)
    v_subrev_u32 v16, s82, v254
    v_subrev_u32 v16, 1, v16
    v_xor_b32 v17, s83, v255
    v_cmp_ne_u32 s[74:75], 0, v17
    v_cmp_lt_u32 vcc, 2, v16
    s_nop 0
    s_or_b64 vcc, vcc, s[74:75]
    s_cbranch_vccz QKVP_PS_OK
    s_mov_b32 s81, 0
QKVP_PS_SP:
    buffer_load_dwordx2 v[254:255], v31, s[20:23], 0 offen sc1
    s_waitcnt vmcnt(0)
    v_subrev_u32 v16, s82, v254
    v_subrev_u32 v16, 1, v16
    v_xor_b32 v17, s83, v255
    v_cmp_ne_u32 s[74:75], 0, v17
    v_cmp_lt_u32 vcc, 2, v16
    s_nop 0
    s_or_b64 vcc, vcc, s[74:75]
    s_add_u32 s81, s81, 1
    s_cmp_ge_u32 s81, 200000
    s_cbranch_scc1 QKVP_PS_OK
    s_cbranch_vccz QKVP_PS_OK
    s_sleep 2
    s_branch QKVP_PS_SP
QKVP_PS_OK:
    v_lshlrev_b32 v16, 4, v0
    s_mul_i32 s45, s36, 6144
    s_add_u32 s45, s45, 65536
    s_add_u32 s46, s45, 3072
    s_mov_b32 exec_hi, 0xffff
    buffer_load_dwordx4 v[184:187], v16, s[20:23], s45 offen offset:0 sc1
    buffer_load_dwordx4 v[188:191], v16, s[20:23], s45 offen offset:768 sc1
    buffer_load_dwordx4 v[192:195], v16, s[20:23], s45 offen offset:1536 sc1
    buffer_load_dwordx4 v[196:199], v16, s[20:23], s45 offen offset:2304 sc1
    buffer_load_dwordx4 v[200:203], v16, s[20:23], s46 offen offset:0 sc1
    buffer_load_dwordx4 v[204:207], v16, s[20:23], s46 offen offset:768 sc1
    buffer_load_dwordx4 v[208:211], v16, s[20:23], s46 offen offset:1536 sc1
    buffer_load_dwordx4 v[212:215], v16, s[20:23], s46 offen offset:2304 sc1
    s_mov_b64 exec, -1
QKVP_NG:
    v_mfma_f32_16x16x32_bf16 v[64:67], v[172:175], v[144:147], v[64:67]
    ds_read_b128 v[128:131], v10 offset:32768
    v_mfma_f32_16x16x32_bf16 v[68:71], v[172:175], v[148:151], v[68:71]
    ds_read_b64_tr_b16 v[160:161], v14 offset:24576
    v_mfma_f32_16x16x32_bf16 v[72:75], v[172:175], v[152:155], v[72:75]
    ds_read_b64_tr_b16 v[162:163], v14 offset:25856
    v_mfma_f32_16x16x32_bf16 v[76:79], v[172:175], v[156:159], v[76:79]
    ds_read_b128 v[132:135], v10 offset:34816
    v_mfma_f32_16x16x32_bf16 v[80:83], v[176:179], v[144:147], v[80:83]
    ds_read_b128 v[136:139], v10 offset:36864
    v_mfma_f32_16x16x32_bf16 v[84:87], v[176:179], v[148:151], v[84:87]
    ds_read_b128 v[140:143], v10 offset:38912
    v_mfma_f32_16x16x32_bf16 v[88:91], v[176:179], v[152:155], v[88:91]
    ds_read_b64_tr_b16 v[164:165], v14 offset:24584
    v_mfma_f32_16x16x32_bf16 v[92:95], v[176:179], v[156:159], v[92:95]
    ds_read_b64_tr_b16 v[166:167], v14 offset:25864
    v_mfma_f32_16x16x32_bf16 v[96:99], v[180:183], v[144:147], v[96:99]
    v_mfma_f32_16x16x32_bf16 v[100:103], v[180:183], v[148:151], v[100:103]
    v_mfma_f32_16x16x32_bf16 v[104:107], v[180:183], v[152:155], v[104:107]
    v_mfma_f32_16x16x32_bf16 v[108:111], v[180:183], v[156:159], v[108:111]
    s_waitcnt lgkmcnt(0)
    v_mfma_f32_16x16x32_bf16 v[32:35], v[160:163], v[128:131], v[32:35]
    ds_read_b64_tr_b16 v[172:173], v14 offset:24592
    v_mfma_f32_16x16x32_bf16 v[36:39], v[160:163], v[132:135], v[36:39]
    ds_read_b64_tr_b16 v[174:175], v14 offset:25872
    v_mfma_f32_16x16x32_bf16 v[40:43], v[160:163], v[136:139], v[40:43]
    ds_read_b64_tr_b16 v[176:177], v14 offset:24600
    v_mfma_f32_16x16x32_bf16 v[44:47], v[160:163], v[140:143], v[44:47]
    ds_read_b64_tr_b16 v[178:179], v14 offset:25880
    v_mfma_f32_16x16x32_bf16 v[48:51], v[164:167], v[128:131], v[48:51]
    ds_read_b64_tr_b16 v[180:181], v14 offset:24608
    v_mfma_f32_16x16x32_bf16 v[52:55], v[164:167], v[132:135], v[52:55]
    ds_read_b64_tr_b16 v[182:183], v14 offset:25888
    v_mfma_f32_16x16x32_bf16 v[56:59], v[164:167], v[136:139], v[56:59]
    v_mfma_f32_16x16x32_bf16 v[60:63], v[164:167], v[140:143], v[60:63]
    s_waitcnt lgkmcnt(0)
    v_mfma_f32_16x16x32_bf16 v[64:67], v[172:175], v[128:131], v[64:67]
    ds_read_b128 v[144:147], v11 offset:32768
    v_mfma_f32_16x16x32_bf16 v[68:71], v[172:175], v[132:135], v[68:71]
    ds_read_b64_tr_b16 v[160:161], v14 offset:34944
    v_mfma_f32_16x16x32_bf16 v[72:75], v[172:175], v[136:139], v[72:75]
    ds_read_b64_tr_b16 v[162:163], v14 offset:36224
    v_mfma_f32_16x16x32_bf16 v[76:79], v[172:175], v[140:143], v[76:79]
    ds_read_b128 v[148:151], v11 offset:34816
    v_mfma_f32_16x16x32_bf16 v[80:83], v[176:179], v[128:131], v[80:83]
    ds_read_b128 v[152:155], v11 offset:36864
    v_mfma_f32_16x16x32_bf16 v[84:87], v[176:179], v[132:135], v[84:87]
    ds_read_b128 v[156:159], v11 offset:38912
    v_mfma_f32_16x16x32_bf16 v[88:91], v[176:179], v[136:139], v[88:91]
    ds_read_b64_tr_b16 v[164:165], v14 offset:34952
    v_mfma_f32_16x16x32_bf16 v[92:95], v[176:179], v[140:143], v[92:95]
    ds_read_b64_tr_b16 v[166:167], v14 offset:36232
    v_mfma_f32_16x16x32_bf16 v[96:99], v[180:183], v[128:131], v[96:99]
    v_mfma_f32_16x16x32_bf16 v[100:103], v[180:183], v[132:135], v[100:103]
    v_mfma_f32_16x16x32_bf16 v[104:107], v[180:183], v[136:139], v[104:107]
    v_mfma_f32_16x16x32_bf16 v[108:111], v[180:183], v[140:143], v[108:111]
    s_waitcnt lgkmcnt(0)
    v_mfma_f32_16x16x32_bf16 v[32:35], v[160:163], v[144:147], v[32:35]
    ds_read_b64_tr_b16 v[172:173], v14 offset:34960
    v_mfma_f32_16x16x32_bf16 v[36:39], v[160:163], v[148:151], v[36:39]
    ds_read_b64_tr_b16 v[174:175], v14 offset:36240
    v_mfma_f32_16x16x32_bf16 v[40:43], v[160:163], v[152:155], v[40:43]
    ds_read_b64_tr_b16 v[176:177], v14 offset:34968
    v_mfma_f32_16x16x32_bf16 v[44:47], v[160:163], v[156:159], v[44:47]
    ds_read_b64_tr_b16 v[178:179], v14 offset:36248
    v_mfma_f32_16x16x32_bf16 v[48:51], v[164:167], v[144:147], v[48:51]
    ds_read_b64_tr_b16 v[180:181], v14 offset:34976
    v_mfma_f32_16x16x32_bf16 v[52:55], v[164:167], v[148:151], v[52:55]
    ds_read_b64_tr_b16 v[182:183], v14 offset:36256
    v_mfma_f32_16x16x32_bf16 v[56:59], v[164:167], v[152:155], v[56:59]
    v_mfma_f32_16x16x32_bf16 v[60:63], v[164:167], v[156:159], v[60:63]
    s_waitcnt lgkmcnt(0)
    s_barrier
    s_lshl_b32 s45, s33, 8
    s_lshl_b32 s46, s37, 6
    s_add_u32 s45, s45, s46
    s_lshl_b32 s45, s45, 3
    s_add_u32 s45, s45, 32768
    v_and_b32 v16, 15, v0
    v_lshlrev_b32 v16, 3, v16
    buffer_load_dwordx2 v[244:245], v16, s[20:23], s45 offen offset:0 sc1
    buffer_load_dwordx2 v[246:247], v16, s[20:23], s45 offen offset:128 sc1
    buffer_load_dwordx2 v[248:249], v16, s[20:23], s45 offen offset:256 sc1
    buffer_load_dwordx2 v[250:251], v16, s[20:23], s45 offen offset:384 sc1
    s_cmp_eq_u32 s32, 6
    s_cbranch_scc0 QKVP_NG2
    s_waitcnt vmcnt(4)
    v_lshlrev_b32 v16, 4, v0
    v_add_u32 v16, 163072, v16
    v_pk_add_f32 v[184:185], v[184:185], v[188:189]
    v_pk_add_f32 v[186:187], v[186:187], v[190:191]
    v_pk_add_f32 v[184:185], v[184:185], v[192:193]
    v_pk_add_f32 v[186:187], v[186:187], v[194:195]
    v_pk_add_f32 v[184:185], v[184:185], v[196:197]
    v_pk_add_f32 v[186:187], v[186:187], v[198:199]
    v_pk_add_f32 v[184:185], v[184:185], v[200:201]
    v_pk_add_f32 v[186:187], v[186:187], v[202:203]
    v_pk_add_f32 v[184:185], v[184:185], v[204:205]
    v_pk_add_f32 v[186:187], v[186:187], v[206:207]
    v_pk_add_f32 v[184:185], v[184:185], v[208:209]
    v_pk_add_f32 v[186:187], v[186:187], v[210:211]
    v_pk_add_f32 v[184:185], v[184:185], v[212:213]
    v_pk_add_f32 v[186:187], v[186:187], v[214:215]
    s_mov_b32 exec_hi, 0xffff
    ds_write_b128 v16, v[184:187]
    s_mov_b64 exec, -1
QKVP_NG2:
    v_mfma_f32_16x16x32_bf16 v[64:67], v[172:175], v[144:147], v[64:67]
    ds_read_b128 v[128:131], v12 offset:0
    buffer_load_dwordx2 v[28:29], v30, s[20:23], 0 offen sc1
    v_lshrrev_b32 v22, 4, v0
    v_and_b32 v23, 3, v0
    v_mfma_f32_16x16x32_bf16 v[68:71], v[172:175], v[148:151], v[68:71]
    ds_read_b64_tr_b16 v[160:161], v14 offset:0
    v_cmp_eq_u32 vcc, v22, v23
    v_mul_u32_u24 v22, 800, v22
    v_bfe_u32 v23, v0, 2, 2
    v_mfma_f32_16x16x32_bf16 v[72:75], v[172:175], v[152:155], v[72:75]
    ds_read_b64_tr_b16 v[162:163], v14 offset:1280
    v_mul_u32_u24 v23, 40, v23
    v_add_u32 v22, v22, v23
    v_mfma_f32_16x16x32_bf16 v[76:79], v[172:175], v[156:159], v[76:79]
    ds_read_b128 v[132:135], v12 offset:2048
    s_mul_i32 s45, s38, 3200
    s_cmp_eq_u32 s35, 1
    s_cselect_b32 s45, 0, s45
    v_mfma_f32_16x16x32_bf16 v[80:83], v[176:179], v[144:147], v[80:83]
    ds_read_b128 v[136:139], v12 offset:4096
    s_add_u32 s45, s45, 147456
    v_add_u32 v22, s45, v22
    v_mfma_f32_16x16x32_bf16 v[84:87], v[176:179], v[148:151], v[84:87]
    ds_read_b128 v[140:143], v12 offset:6144
    v_mov_b32 v23, 153856
    v_cndmask_b32 v22, v23, v22, vcc
    v_mov_b32 v194, 0
    v_mfma_f32_16x16x32_bf16 v[88:91], v[176:179], v[152:155], v[88:91]
    ds_read_b64_tr_b16 v[164:165], v14 offset:8
    v_mov_b32 v195, 0
    v_mov_b32 v206, 0
    v_mov_b32 v207, 0
    v_mfma_f32_16x16x32_bf16 v[92:95], v[176:179], v[156:159], v[92:95]
    ds_read_b64_tr_b16 v[166:167], v14 offset:1288
    v_mov_b32 v218, 0
    v_mov_b32 v219, 0
    v_mfma_f32_16x16x32_bf16 v[96:99], v[180:183], v[144:147], v[96:99]
    v_mov_b32 v230, 0
    v_mov_b32 v231, 0
    v_mov_b32 v242, 0
    v_mfma_f32_16x16x32_bf16 v[100:103], v[180:183], v[148:151], v[100:103]
    v_mov_b32 v243, 0
    ds_read_b64_tr_b16 v[184:185], v22 offset:0
    v_mfma_f32_16x16x32_bf16 v[104:107], v[180:183], v[152:155], v[104:107]
    ds_read_b64_tr_b16 v[186:187], v22 offset:160
    ds_read_b64_tr_b16 v[188:189], v22 offset:320
    ds_read_b64_tr_b16 v[190:191], v22 offset:480
    v_mfma_f32_16x16x32_bf16 v[108:111], v[180:183], v[156:159], v[108:111]
    ds_read_b64_tr_b16 v[192:193], v22 offset:640
    ds_read_b64_tr_b16 v[196:197], v22 offset:8
    s_waitcnt lgkmcnt(0)
    v_mfma_f32_16x16x32_bf16 v[32:35], v[160:163], v[128:131], v[32:35]
    ds_read_b64_tr_b16 v[172:173], v14 offset:16
    ds_read_b64_tr_b16 v[198:199], v22 offset:168
    v_mfma_f32_16x16x32_bf16 v[36:39], v[160:163], v[132:135], v[36:39]
    ds_read_b64_tr_b16 v[174:175], v14 offset:1296
    ds_read_b64_tr_b16 v[200:201], v22 offset:328
    v_mfma_f32_16x16x32_bf16 v[40:43], v[160:163], v[136:139], v[40:43]
    ds_read_b64_tr_b16 v[176:177], v14 offset:24
    ds_read_b64_tr_b16 v[202:203], v22 offset:488
    v_mfma_f32_16x16x32_bf16 v[44:47], v[160:163], v[140:143], v[44:47]
    ds_read_b64_tr_b16 v[178:179], v14 offset:1304
    v_mfma_f32_16x16x32_bf16 v[48:51], v[164:167], v[128:131], v[48:51]
    ds_read_b64_tr_b16 v[180:181], v14 offset:32
    ds_read_b64_tr_b16 v[204:205], v22 offset:648
    v_mfma_f32_16x16x32_bf16 v[52:55], v[164:167], v[132:135], v[52:55]
    ds_read_b64_tr_b16 v[182:183], v14 offset:1312
    ds_read_b64_tr_b16 v[208:209], v22 offset:16
    v_mfma_f32_16x16x32_bf16 v[56:59], v[164:167], v[136:139], v[56:59]
    ds_read_b64_tr_b16 v[210:211], v22 offset:176
    v_mfma_f32_16x16x32_bf16 v[60:63], v[164:167], v[140:143], v[60:63]
    s_waitcnt lgkmcnt(0)
    v_mfma_f32_16x16x32_bf16 v[64:67], v[172:175], v[128:131], v[64:67]
    ds_read_b128 v[144:147], v13 offset:0
    ds_read_b64_tr_b16 v[212:213], v22 offset:336
    v_mfma_f32_16x16x32_bf16 v[68:71], v[172:175], v[132:135], v[68:71]
    ds_read_b64_tr_b16 v[160:161], v14 offset:10368
    v_mfma_f32_16x16x32_bf16 v[72:75], v[172:175], v[136:139], v[72:75]
    ds_read_b64_tr_b16 v[162:163], v14 offset:11648
    ds_read_b64_tr_b16 v[214:215], v22 offset:496
    v_mfma_f32_16x16x32_bf16 v[76:79], v[172:175], v[140:143], v[76:79]
    ds_read_b128 v[148:151], v13 offset:2048
    v_mfma_f32_16x16x32_bf16 v[80:83], v[176:179], v[128:131], v[80:83]
    ds_read_b128 v[152:155], v13 offset:4096
    ds_read_b64_tr_b16 v[216:217], v22 offset:656
    v_mfma_f32_16x16x32_bf16 v[84:87], v[176:179], v[132:135], v[84:87]
    ds_read_b128 v[156:159], v13 offset:6144
    v_mfma_f32_16x16x32_bf16 v[88:91], v[176:179], v[136:139], v[88:91]
    ds_read_b64_tr_b16 v[164:165], v14 offset:10376
    ds_read_b64_tr_b16 v[220:221], v22 offset:24
    v_mfma_f32_16x16x32_bf16 v[92:95], v[176:179], v[140:143], v[92:95]
    ds_read_b64_tr_b16 v[166:167], v14 offset:11656
    v_mfma_f32_16x16x32_bf16 v[96:99], v[180:183], v[128:131], v[96:99]
    ds_read_b64_tr_b16 v[222:223], v22 offset:184
    v_mfma_f32_16x16x32_bf16 v[100:103], v[180:183], v[132:135], v[100:103]
    v_mfma_f32_16x16x32_bf16 v[104:107], v[180:183], v[136:139], v[104:107]
    ds_read_b64_tr_b16 v[224:225], v22 offset:344
    v_mfma_f32_16x16x32_bf16 v[108:111], v[180:183], v[140:143], v[108:111]
    s_waitcnt lgkmcnt(0)
    v_mfma_f32_16x16x32_bf16 v[32:35], v[160:163], v[144:147], v[32:35]
    ds_read_b64_tr_b16 v[172:173], v14 offset:10384
    ds_read_b64_tr_b16 v[226:227], v22 offset:504
    ds_read_b64_tr_b16 v[228:229], v22 offset:664
    v_mfma_f32_16x16x32_bf16 v[36:39], v[160:163], v[148:151], v[36:39]
    ds_read_b64_tr_b16 v[174:175], v14 offset:11664
    ds_read_b64_tr_b16 v[232:233], v22 offset:32
    v_mfma_f32_16x16x32_bf16 v[40:43], v[160:163], v[152:155], v[40:43]
    ds_read_b64_tr_b16 v[176:177], v14 offset:10392
    ds_read_b64_tr_b16 v[234:235], v22 offset:192
    ds_read_b64_tr_b16 v[236:237], v22 offset:352
    v_mfma_f32_16x16x32_bf16 v[44:47], v[160:163], v[156:159], v[44:47]
    ds_read_b64_tr_b16 v[178:179], v14 offset:11672
    ds_read_b64_tr_b16 v[238:239], v22 offset:512
    v_mfma_f32_16x16x32_bf16 v[48:51], v[164:167], v[144:147], v[48:51]
    ds_read_b64_tr_b16 v[180:181], v14 offset:10400
    ds_read_b64_tr_b16 v[240:241], v22 offset:672
    s_waitcnt vmcnt(0)
    v_mfma_f32_16x16x32_bf16 v[52:55], v[164:167], v[148:151], v[52:55]
    ds_read_b64_tr_b16 v[182:183], v14 offset:11680
    v_subrev_u32 v16, s82, v28
    v_mfma_f32_16x16x32_bf16 v[56:59], v[164:167], v[152:155], v[56:59]
    v_subrev_u32 v16, 2, v16
    v_xor_b32 v17, s83, v29
    v_mfma_f32_16x16x32_bf16 v[60:63], v[164:167], v[156:159], v[60:63]
    v_cmp_ne_u32 s[74:75], 0, v17
    v_cmp_lt_u32 vcc, 1, v16
    s_nop 1
    s_or_b64 vcc, vcc, s[74:75]
    s_cmp_eq_u64 vcc, 0
    s_cselect_b32 s31, 3, s31
    s_waitcnt lgkmcnt(0)
    s_barrier
    v_mfma_f32_16x16x32_bf16 v[64:67], v[172:175], v[144:147], v[64:67]
    ds_read_b128 v[128:131], v10 offset:0
    v_mfma_f32_16x16x32_bf16 v[68:71], v[172:175], v[148:151], v[68:71]
    ds_read_b64_tr_b16 v[160:161], v14 offset:24576
    v_mfma_f32_16x16x32_bf16 v[72:75], v[172:175], v[152:155], v[72:75]
    ds_read_b64_tr_b16 v[162:163], v14 offset:25856
    v_mfma_f32_16x16x32_bf16 v[76:79], v[172:175], v[156:159], v[76:79]
    ds_read_b128 v[132:135], v10 offset:2048
    v_mfma_f32_16x16x32_bf16 v[80:83], v[176:179], v[144:147], v[80:83]
    ds_read_b128 v[136:139], v10 offset:4096
    v_mfma_f32_16x16x32_bf16 v[84:87], v[176:179], v[148:151], v[84:87]
    ds_read_b128 v[140:143], v10 offset:6144
    v_mfma_f32_16x16x32_bf16 v[88:91], v[176:179], v[152:155], v[88:91]
    ds_read_b64_tr_b16 v[164:165], v14 offset:24584
    v_mfma_f32_16x16x32_bf16 v[92:95], v[176:179], v[156:159], v[92:95]
    ds_read_b64_tr_b16 v[166:167], v14 offset:25864
    v_mfma_f32_16x16x32_bf16 v[96:99], v[180:183], v[144:147], v[96:99]
    v_mfma_f32_16x16x32_bf16 v[100:103], v[180:183], v[148:151], v[100:103]
    v_mfma_f32_16x16x32_bf16 v[104:107], v[180:183], v[152:155], v[104:107]
    v_mfma_f32_16x16x32_bf16 v[108:111], v[180:183], v[156:159], v[108:111]
    s_waitcnt lgkmcnt(0)
    v_mfma_f32_16x16x32_bf16 v[32:35], v[160:163], v[128:131], v[32:35]
    ds_read_b64_tr_b16 v[172:173], v14 offset:24592
    s_cmp_eq_u32 s35, 0
    s_cbranch_scc0 QKVP_Q20
    s_cmp_eq_u32 s31, 3
    s_cbranch_scc0 QKVP_QB20
    s_add_u32 s48, s28, 10240
    s_add_u32 m0, s30, 0
    s_nop 0
    buffer_load_dwordx4 v8, s[20:23], s48 offen offset:0 sc1 lds
    s_add_u32 m0, s30, 0
    s_nop 0
    buffer_load_dwordx4 v8, s[20:23], s48 offen offset:1024 sc1 lds
    s_add_u32 m0, s30, 0
    s_nop 0
    buffer_load_dwordx4 v8, s[20:23], s48 offen offset:2048 sc1 lds
    QKVP_QB20:
    QKVP_Q20:
    v_mfma_f32_16x16x32_bf16 v[36:39], v[160:163], v[132:135], v[36:39]
    ds_read_b64_tr_b16 v[174:175], v14 offset:25872
    v_mfma_f32_16x16x32_bf16 v[40:43], v[160:163], v[136:139], v[40:43]
    ds_read_b64_tr_b16 v[176:177], v14 offset:24600
    v_mfma_f32_16x16x32_bf16 v[44:47], v[160:163], v[140:143], v[44:47]
    ds_read_b64_tr_b16 v[178:179], v14 offset:25880
    v_mfma_f32_16x16x32_bf16 v[48:51], v[164:167], v[128:131], v[48:51]
    ds_read_b64_tr_b16 v[180:181], v14 offset:24608
    s_cmp_eq_u32 s35, 0
    s_cbranch_scc0 QKVP_Q23
    s_cmp_eq_u32 s31, 3
    s_cbranch_scc0 QKVP_QB23
    s_add_u32 m0, s30, 0
    s_nop 0
    buffer_load_dwordx4 v8, s[20:23], s48 offen offset:3072 sc1 lds
    s_add_u32 m0, s30, 4096
    s_nop 0
    buffer_load_dwordx4 v9, s[20:23], s48 offen offset:0 sc1 lds
    QKVP_QB23:
    QKVP_Q23:
    v_mfma_f32_16x16x32_bf16 v[52:55], v[164:167], v[132:135], v[52:55]
    ds_read_b64_tr_b16 v[182:183], v14 offset:25888
    v_mfma_f32_16x16x32_bf16 v[56:59], v[164:167], v[136:139], v[56:59]
    v_mfma_f32_16x16x32_bf16 v[60:63], v[164:167], v[140:143], v[60:63]
    s_waitcnt lgkmcnt(0)
    v_mfma_f32_16x16x32_bf16 v[64:67], v[172:175], v[128:131], v[64:67]
    ds_read_b128 v[144:147], v11 offset:0
    s_cmp_eq_u32 s35, 0
    s_cbranch_scc0 QKVP_Q30
    s_cmp_eq_u32 s31, 3
    s_cbranch_scc0 QKVP_QB30
    s_add_u32 s48, s28, 15360
    s_add_u32 m0, s30, 5120
    s_nop 0
    buffer_load_dwordx4 v8, s[20:23], s48 offen offset:0 sc1 lds
    s_add_u32 m0, s30, 5120
    s_nop 0
    buffer_load_dwordx4 v8, s[20:23], s48 offen offset:1024 sc1 lds
    s_add_u32 m0, s30, 5120
    s_nop 0
    buffer_load_dwordx4 v8, s[20:23], s48 offen offset:2048 sc1 lds
    QKVP_QB30:
    QKVP_Q30:
    v_mfma_f32_16x16x32_bf16 v[68:71], v[172:175], v[132:135], v[68:71]
    ds_read_b64_tr_b16 v[160:161], v14 offset:34944
    v_mfma_f32_16x16x32_bf16 v[72:75], v[172:175], v[136:139], v[72:75]
    ds_read_b64_tr_b16 v[162:163], v14 offset:36224
    v_mfma_f32_16x16x32_bf16 v[76:79], v[172:175], v[140:143], v[76:79]
    ds_read_b128 v[148:151], v11 offset:2048
    v_mfma_f32_16x16x32_bf16 v[80:83], v[176:179], v[128:131], v[80:83]
    ds_read_b128 v[152:155], v11 offset:4096
    s_cmp_eq_u32 s35, 0
    s_cbranch_scc0 QKVP_Q33
    s_cmp_eq_u32 s31, 3
    s_cbranch_scc0 QKVP_QB33
    s_add_u32 m0, s30, 5120
    s_nop 0
    buffer_load_dwordx4 v8, s[20:23], s48 offen offset:3072 sc1 lds
    QKVP_QB33:
    QKVP_Q33:
    v_mfma_f32_16x16x32_bf16 v[84:87], v[176:179], v[132:135], v[84:87]
    ds_read_b128 v[156:159], v11 offset:6144
    v_mfma_f32_16x16x32_bf16 v[88:91], v[176:179], v[136:139], v[88:91]
    ds_read_b64_tr_b16 v[164:165], v14 offset:34952
    v_mfma_f32_16x16x32_bf16 v[92:95], v[176:179], v[140:143], v[92:95]
    ds_read_b64_tr_b16 v[166:167], v14 offset:36232
    v_mfma_f32_16x16x32_bf16 v[96:99], v[180:183], v[128:131], v[96:99]
    s_cmp_eq_u32 s35, 0
    s_cbranch_scc0 QKVP_Q34
    s_cmp_eq_u32 s32, 7
    s_cbranch_scc1 QKVP_Q34
    s_cmp_eq_u32 s31, 3
    s_cbranch_scc0 QKVP_QB34
    s_add_u32 m0, s30, 9216
    s_nop 0
    buffer_load_dwordx4 v9, s[20:23], s48 offen offset:0 sc1 lds
    QKVP_QB34:
    QKVP_Q34:
    v_mfma_f32_16x16x32_bf16 v[100:103], v[180:183], v[132:135], v[100:103]
    v_mfma_f32_16x16x32_bf16 v[104:107], v[180:183], v[136:139], v[104:107]
    v_mfma_f32_16x16x32_bf16 v[108:111], v[180:183], v[140:143], v[108:111]
    s_waitcnt lgkmcnt(0)
    v_mfma_f32_16x16x32_bf16 v[32:35], v[160:163], v[144:147], v[32:35]
    ds_read_b64_tr_b16 v[172:173], v14 offset:34960
    v_mfma_f32_16x16x32_bf16 v[36:39], v[160:163], v[148:151], v[36:39]
    ds_read_b64_tr_b16 v[174:175], v14 offset:36240
    v_mfma_f32_16x16x32_bf16 v[40:43], v[160:163], v[152:155], v[40:43]
    ds_read_b64_tr_b16 v[176:177], v14 offset:34968
    v_mfma_f32_16x16x32_bf16 v[44:47], v[160:163], v[156:159], v[44:47]
    ds_read_b64_tr_b16 v[178:179], v14 offset:36248
    v_mfma_f32_16x16x32_bf16 v[48:51], v[164:167], v[144:147], v[48:51]
    ds_read_b64_tr_b16 v[180:181], v14 offset:34976
    v_mfma_f32_16x16x32_bf16 v[52:55], v[164:167], v[148:151], v[52:55]
    ds_read_b64_tr_b16 v[182:183], v14 offset:36256
    v_mfma_f32_16x16x32_bf16 v[56:59], v[164:167], v[152:155], v[56:59]
    v_mfma_f32_16x16x32_bf16 v[60:63], v[164:167], v[156:159], v[60:63]
    s_waitcnt lgkmcnt(0)
    v_mfma_f32_16x16x32_bf16 v[64:67], v[172:175], v[144:147], v[64:67]
    v_mfma_f32_16x16x32_bf16 v[68:71], v[172:175], v[148:151], v[68:71]
    v_mfma_f32_16x16x32_bf16 v[72:75], v[172:175], v[152:155], v[72:75]
    v_mfma_f32_16x16x32_bf16 v[76:79], v[172:175], v[156:159], v[76:79]
    v_mfma_f32_16x16x32_bf16 v[80:83], v[176:179], v[144:147], v[80:83]
    v_mfma_f32_16x16x32_bf16 v[84:87], v[176:179], v[148:151], v[84:87]
    v_mfma_f32_16x16x32_bf16 v[88:91], v[176:179], v[152:155], v[88:91]
    v_mfma_f32_16x16x32_bf16 v[92:95], v[176:179], v[156:159], v[92:95]
    v_mfma_f32_16x16x32_bf16 v[96:99], v[180:183], v[144:147], v[96:99]
    v_mfma_f32_16x16x32_bf16 v[100:103], v[180:183], v[148:151], v[100:103]
    v_mfma_f32_16x16x32_bf16 v[104:107], v[180:183], v[152:155], v[104:107]
    v_mfma_f32_16x16x32_bf16 v[108:111], v[180:183], v[156:159], v[108:111]
QKV_LOOPEND:
    s_nop 7
    v_lshrrev_b32 v16, 4, v0
    v_mul_u32_u24 v16, 80, v16
    s_mul_i32 s45, s38, 320
    s_add_u32 s45, s45, 163072
    v_add_u32 v16, s45, v16
    ds_read_b128 v[144:147], v16 offset:0
    ds_read_b128 v[148:151], v16 offset:16
    ds_read_b128 v[152:155], v16 offset:32
    ds_read_b128 v[156:159], v16 offset:48
    ds_read_b128 v[160:163], v16 offset:64
    s_cmp_eq_u32 s35, 1
    s_cbranch_scc1 EKV
    v_rcp_f32 v136, v245
    v_rcp_f32 v138, v247
    v_rcp_f32 v140, v249
    v_rcp_f32 v142, v251
    v_mov_b32 v178, 0
    v_mov_b32 v179, 0
    v_mov_b32 v122, 0
    v_mov_b32 v123, 0
    v_lshrrev_b32 v18, 4, v0
    v_mul_u32_u24 v18, 81920, v18
    v_and_b32 v17, 15, v0
    v_lshl_add_u32 v16, v17, 4, v18
    s_lshl_b32 s45, s34, 1
    s_add_u32 s45, s45, s38
    s_mul_i32 s45, s45, 327680
    s_add_u32 s45, s45, 1048576
    s_lshl_b32 s46, s33, 8
    s_lshl_b32 s47, s37, 6
    s_add_u32 s46, s46, s47
    s_lshl_b32 s47, s46, 3
    s_add_u32 s47, s47, s45
    s_add_u32 s47, s47, 65536
    s_lshl_b32 s46, s46, 4
    s_add_u32 s45, s45, s46
    s_add_u32 s46, s45, 32768
    s_waitcnt lgkmcnt(0)
    v_pk_fma_f32 v[32:33], v[244:245], v[144:145], v[32:33] op_sel:[0,0,0] op_sel_hi:[0,1,1] neg_lo:[1,0,0] neg_hi:[1,0,0]
    v_pk_fma_f32 v[34:35], v[244:245], v[146:147], v[34:35] op_sel:[0,0,0] op_sel_hi:[0,1,1] neg_lo:[1,0,0] neg_hi:[1,0,0]
    v_pk_fma_f32 v[48:49], v[244:245], v[148:149], v[48:49] op_sel:[0,0,0] op_sel_hi:[0,1,1] neg_lo:[1,0,0] neg_hi:[1,0,0]
    v_pk_fma_f32 v[50:51], v[244:245], v[150:151], v[50:51] op_sel:[0,0,0] op_sel_hi:[0,1,1] neg_lo:[1,0,0] neg_hi:[1,0,0]
    v_pk_fma_f32 v[64:65], v[244:245], v[152:153], v[64:65] op_sel:[0,0,0] op_sel_hi:[0,1,1] neg_lo:[1,0,0] neg_hi:[1,0,0]
    v_pk_fma_f32 v[66:67], v[244:245], v[154:155], v[66:67] op_sel:[0,0,0] op_sel_hi:[0,1,1] neg_lo:[1,0,0] neg_hi:[1,0,0]
    v_pk_fma_f32 v[80:81], v[244:245], v[156:157], v[80:81] op_sel:[0,0,0] op_sel_hi:[0,1,1] neg_lo:[1,0,0] neg_hi:[1,0,0]
    v_pk_fma_f32 v[82:83], v[244:245], v[158:159], v[82:83] op_sel:[0,0,0] op_sel_hi:[0,1,1] neg_lo:[1,0,0] neg_hi:[1,0,0]
    v_pk_fma_f32 v[96:97], v[244:245], v[160:161], v[96:97] op_sel:[0,0,0] op_sel_hi:[0,1,1] neg_lo:[1,0,0] neg_hi:[1,0,0]
    v_pk_fma_f32 v[98:99], v[244:245], v[162:163], v[98:99] op_sel:[0,0,0] op_sel_hi:[0,1,1] neg_lo:[1,0,0] neg_hi:[1,0,0]
    v_pk_mul_f32 v[32:33], v[32:33], v[136:137] op_sel:[0,0] op_sel_hi:[1,0]
    v_pk_mul_f32 v[34:35], v[34:35], v[136:137] op_sel:[0,0] op_sel_hi:[1,0]
    v_pk_mul_f32 v[48:49], v[48:49], v[136:137] op_sel:[0,0] op_sel_hi:[1,0]
    v_pk_mul_f32 v[50:51], v[50:51], v[136:137] op_sel:[0,0] op_sel_hi:[1,0]
    v_pk_mul_f32 v[64:65], v[64:65], v[136:137] op_sel:[0,0] op_sel_hi:[1,0]
    v_pk_mul_f32 v[66:67], v[66:67], v[136:137] op_sel:[0,0] op_sel_hi:[1,0]
    v_pk_mul_f32 v[80:81], v[80:81], v[136:137] op_sel:[0,0] op_sel_hi:[1,0]
    v_pk_mul_f32 v[82:83], v[82:83], v[136:137] op_sel:[0,0] op_sel_hi:[1,0]
    v_pk_mul_f32 v[96:97], v[96:97], v[136:137] op_sel:[0,0] op_sel_hi:[1,0]
    v_pk_mul_f32 v[98:99], v[98:99], v[136:137] op_sel:[0,0] op_sel_hi:[1,0]
    v_cvt_pk_bf16_f32 v168, v32, v33
    v_cvt_pk_bf16_f32 v169, v34, v35
    v_cvt_pk_bf16_f32 v170, v48, v49
    v_cvt_pk_bf16_f32 v171, v50, v51
    v_cvt_pk_bf16_f32 v172, v64, v65
    v_cvt_pk_bf16_f32 v173, v66, v67
    v_cvt_pk_bf16_f32 v174, v80, v81
    v_cvt_pk_bf16_f32 v175, v82, v83
    v_cvt_pk_bf16_f32 v176, v96, v97
    v_cvt_pk_bf16_f32 v177, v98, v99
    v_mfma_f32_16x16x32_bf16 v[32:35], v[184:187], v[168:171], 0
    v_pk_fma_f32 v[36:37], v[246:247], v[144:145], v[36:37] op_sel:[0,0,0] op_sel_hi:[0,1,1] neg_lo:[1,0,0] neg_hi:[1,0,0]
    v_pk_fma_f32 v[38:39], v[246:247], v[146:147], v[38:39] op_sel:[0,0,0] op_sel_hi:[0,1,1] neg_lo:[1,0,0] neg_hi:[1,0,0]
    v_mfma_f32_16x16x32_bf16 v[48:51], v[196:199], v[168:171], 0
    v_pk_fma_f32 v[52:53], v[246:247], v[148:149], v[52:53] op_sel:[0,0,0] op_sel_hi:[0,1,1] neg_lo:[1,0,0] neg_hi:[1,0,0]
    v_pk_fma_f32 v[54:55], v[246:247], v[150:151], v[54:55] op_sel:[0,0,0] op_sel_hi:[0,1,1] neg_lo:[1,0,0] neg_hi:[1,0,0]
    v_mfma_f32_16x16x32_bf16 v[64:67], v[208:211], v[168:171], 0
    v_pk_fma_f32 v[68:69], v[246:247], v[152:153], v[68:69] op_sel:[0,0,0] op_sel_hi:[0,1,1] neg_lo:[1,0,0] neg_hi:[1,0,0]
    v_pk_fma_f32 v[70:71], v[246:247], v[154:155], v[70:71] op_sel:[0,0,0] op_sel_hi:[0,1,1] neg_lo:[1,0,0] neg_hi:[1,0,0]
    v_mfma_f32_16x16x32_bf16 v[80:83], v[220:223], v[168:171], 0
    v_pk_fma_f32 v[84:85], v[246:247], v[156:157], v[84:85] op_sel:[0,0,0] op_sel_hi:[0,1,1] neg_lo:[1,0,0] neg_hi:[1,0,0]
    v_pk_fma_f32 v[86:87], v[246:247], v[158:159], v[86:87] op_sel:[0,0,0] op_sel_hi:[0,1,1] neg_lo:[1,0,0] neg_hi:[1,0,0]
    v_mfma_f32_16x16x32_bf16 v[96:99], v[232:235], v[168:171], 0
    v_pk_fma_f32 v[100:101], v[246:247], v[160:161], v[100:101] op_sel:[0,0,0] op_sel_hi:[0,1,1] neg_lo:[1,0,0] neg_hi:[1,0,0]
    v_pk_fma_f32 v[102:103], v[246:247], v[162:163], v[102:103] op_sel:[0,0,0] op_sel_hi:[0,1,1] neg_lo:[1,0,0] neg_hi:[1,0,0]
    v_mfma_f32_16x16x32_bf16 v[32:35], v[188:191], v[172:175], v[32:35]
    v_pk_mul_f32 v[36:37], v[36:37], v[138:139] op_sel:[0,0] op_sel_hi:[1,0]
    v_pk_mul_f32 v[38:39], v[38:39], v[138:139] op_sel:[0,0] op_sel_hi:[1,0]
    v_mfma_f32_16x16x32_bf16 v[48:51], v[200:203], v[172:175], v[48:51]
    v_pk_mul_f32 v[52:53], v[52:53], v[138:139] op_sel:[0,0] op_sel_hi:[1,0]
    v_pk_mul_f32 v[54:55], v[54:55], v[138:139] op_sel:[0,0] op_sel_hi:[1,0]
    v_mfma_f32_16x16x32_bf16 v[64:67], v[212:215], v[172:175], v[64:67]
    v_pk_mul_f32 v[68:69], v[68:69], v[138:139] op_sel:[0,0] op_sel_hi:[1,0]
    v_pk_mul_f32 v[70:71], v[70:71], v[138:139] op_sel:[0,0] op_sel_hi:[1,0]
    v_mfma_f32_16x16x32_bf16 v[80:83], v[224:227], v[172:175], v[80:83]
    v_pk_mul_f32 v[84:85], v[84:85], v[138:139] op_sel:[0,0] op_sel_hi:[1,0]
    v_pk_mul_f32 v[86:87], v[86:87], v[138:139] op_sel:[0,0] op_sel_hi:[1,0]
    v_mfma_f32_16x16x32_bf16 v[96:99], v[236:239], v[172:175], v[96:99]
    v_pk_mul_f32 v[100:101], v[100:101], v[138:139] op_sel:[0,0] op_sel_hi:[1,0]
    v_pk_mul_f32 v[102:103], v[102:103], v[138:139] op_sel:[0,0] op_sel_hi:[1,0]
    v_mfma_f32_16x16x32_bf16 v[32:35], v[192:195], v[176:179], v[32:35]
    v_cvt_pk_bf16_f32 v112, v36, v37
    v_cvt_pk_bf16_f32 v113, v38, v39
    v_mfma_f32_16x16x32_bf16 v[48:51], v[204:207], v[176:179], v[48:51]
    v_cvt_pk_bf16_f32 v114, v52, v53
    v_cvt_pk_bf16_f32 v115, v54, v55
    v_mfma_f32_16x16x32_bf16 v[64:67], v[216:219], v[176:179], v[64:67]
    v_cvt_pk_bf16_f32 v116, v68, v69
    v_cvt_pk_bf16_f32 v117, v70, v71
    v_mfma_f32_16x16x32_bf16 v[80:83], v[228:231], v[176:179], v[80:83]
    v_cvt_pk_bf16_f32 v118, v84, v85
    v_cvt_pk_bf16_f32 v119, v86, v87
    v_mfma_f32_16x16x32_bf16 v[96:99], v[240:243], v[176:179], v[96:99]
    v_cvt_pk_bf16_f32 v120, v100, v101
    v_cvt_pk_bf16_f32 v121, v102, v103
    v_mfma_f32_16x16x32_bf16 v[36:39], v[184:187], v[112:115], 0
    s_nop 4
    v_cvt_pk_bf16_f32 v124, v96, v97
    v_mfma_f32_16x16x32_bf16 v[52:55], v[196:199], v[112:115], 0
    v_cvt_pk_bf16_f32 v125, v98, v99
    v_mfma_f32_16x16x32_bf16 v[68:71], v[208:211], v[112:115], 0
    v_cvt_pk_bf16_f32 v32, v32, v33
    v_mfma_f32_16x16x32_bf16 v[84:87], v[220:223], v[112:115], 0
    v_cvt_pk_bf16_f32 v33, v34, v35
    v_mfma_f32_16x16x32_bf16 v[100:103], v[232:235], v[112:115], 0
    v_mfma_f32_16x16x32_bf16 v[36:39], v[188:191], v[116:119], v[36:39]
    v_cvt_pk_bf16_f32 v34, v48, v49
    v_mfma_f32_16x16x32_bf16 v[52:55], v[200:203], v[116:119], v[52:55]
    v_cvt_pk_bf16_f32 v35, v50, v51
    v_mfma_f32_16x16x32_bf16 v[68:71], v[212:215], v[116:119], v[68:71]
    buffer_store_dwordx4 v[32:35], v16, s[20:23], s45 offen offset:0 sc1
    v_mfma_f32_16x16x32_bf16 v[84:87], v[224:227], v[116:119], v[84:87]
    v_cvt_pk_bf16_f32 v48, v64, v65
    v_mfma_f32_16x16x32_bf16 v[100:103], v[236:239], v[116:119], v[100:103]
    v_mfma_f32_16x16x32_bf16 v[36:39], v[192:195], v[120:123], v[36:39]
    v_cvt_pk_bf16_f32 v49, v66, v67
    v_mfma_f32_16x16x32_bf16 v[52:55], v[204:207], v[120:123], v[52:55]
    v_cvt_pk_bf16_f32 v50, v80, v81
    v_mfma_f32_16x16x32_bf16 v[68:71], v[216:219], v[120:123], v[68:71]
    v_cvt_pk_bf16_f32 v51, v82, v83
    v_mfma_f32_16x16x32_bf16 v[84:87], v[228:231], v[120:123], v[84:87]
    buffer_store_dwordx4 v[48:51], v16, s[20:23], s46 offen offset:0 sc1
    v_mfma_f32_16x16x32_bf16 v[100:103], v[240:243], v[120:123], v[100:103]
    v_pk_fma_f32 v[40:41], v[248:249], v[144:145], v[40:41] op_sel:[0,0,0] op_sel_hi:[0,1,1] neg_lo:[1,0,0] neg_hi:[1,0,0]
    v_pk_fma_f32 v[42:43], v[248:249], v[146:147], v[42:43] op_sel:[0,0,0] op_sel_hi:[0,1,1] neg_lo:[1,0,0] neg_hi:[1,0,0]
    v_pk_fma_f32 v[56:57], v[248:249], v[148:149], v[56:57] op_sel:[0,0,0] op_sel_hi:[0,1,1] neg_lo:[1,0,0] neg_hi:[1,0,0]
    v_pk_fma_f32 v[58:59], v[248:249], v[150:151], v[58:59] op_sel:[0,0,0] op_sel_hi:[0,1,1] neg_lo:[1,0,0] neg_hi:[1,0,0]
    v_pk_fma_f32 v[72:73], v[248:249], v[152:153], v[72:73] op_sel:[0,0,0] op_sel_hi:[0,1,1] neg_lo:[1,0,0] neg_hi:[1,0,0]
    v_pk_fma_f32 v[74:75], v[248:249], v[154:155], v[74:75] op_sel:[0,0,0] op_sel_hi:[0,1,1] neg_lo:[1,0,0] neg_hi:[1,0,0]
    v_pk_fma_f32 v[88:89], v[248:249], v[156:157], v[88:89] op_sel:[0,0,0] op_sel_hi:[0,1,1] neg_lo:[1,0,0] neg_hi:[1,0,0]
    v_pk_fma_f32 v[90:91], v[248:249], v[158:159], v[90:91] op_sel:[0,0,0] op_sel_hi:[0,1,1] neg_lo:[1,0,0] neg_hi:[1,0,0]
    v_pk_fma_f32 v[104:105], v[248:249], v[160:161], v[104:105] op_sel:[0,0,0] op_sel_hi:[0,1,1] neg_lo:[1,0,0] neg_hi:[1,0,0]
    v_pk_fma_f32 v[106:107], v[248:249], v[162:163], v[106:107] op_sel:[0,0,0] op_sel_hi:[0,1,1] neg_lo:[1,0,0] neg_hi:[1,0,0]
    v_pk_mul_f32 v[40:41], v[40:41], v[140:141] op_sel:[0,0] op_sel_hi:[1,0]
    v_pk_mul_f32 v[42:43], v[42:43], v[140:141] op_sel:[0,0] op_sel_hi:[1,0]
    v_pk_mul_f32 v[56:57], v[56:57], v[140:141] op_sel:[0,0] op_sel_hi:[1,0]
    v_pk_mul_f32 v[58:59], v[58:59], v[140:141] op_sel:[0,0] op_sel_hi:[1,0]
    v_pk_mul_f32 v[72:73], v[72:73], v[140:141] op_sel:[0,0] op_sel_hi:[1,0]
    v_pk_mul_f32 v[74:75], v[74:75], v[140:141] op_sel:[0,0] op_sel_hi:[1,0]
    v_pk_mul_f32 v[88:89], v[88:89], v[140:141] op_sel:[0,0] op_sel_hi:[1,0]
    v_pk_mul_f32 v[90:91], v[90:91], v[140:141] op_sel:[0,0] op_sel_hi:[1,0]
    v_pk_mul_f32 v[104:105], v[104:105], v[140:141] op_sel:[0,0] op_sel_hi:[1,0]
    v_pk_mul_f32 v[106:107], v[106:107], v[140:141] op_sel:[0,0] op_sel_hi:[1,0]
    v_cvt_pk_bf16_f32 v168, v40, v41
    v_cvt_pk_bf16_f32 v169, v42, v43
    v_cvt_pk_bf16_f32 v170, v56, v57
    v_cvt_pk_bf16_f32 v171, v58, v59
    v_cvt_pk_bf16_f32 v172, v72, v73
    v_cvt_pk_bf16_f32 v173, v74, v75
    v_cvt_pk_bf16_f32 v174, v88, v89
    v_cvt_pk_bf16_f32 v175, v90, v91
    v_cvt_pk_bf16_f32 v176, v104, v105
    v_cvt_pk_bf16_f32 v177, v106, v107
    v_mfma_f32_16x16x32_bf16 v[40:43], v[184:187], v[168:171], 0
    v_cvt_pk_bf16_f32 v126, v100, v101
    v_mfma_f32_16x16x32_bf16 v[56:59], v[196:199], v[168:171], 0
    v_cvt_pk_bf16_f32 v127, v102, v103
    v_mfma_f32_16x16x32_bf16 v[72:75], v[208:211], v[168:171], 0
    v_cvt_pk_bf16_f32 v36, v36, v37
    v_mfma_f32_16x16x32_bf16 v[88:91], v[220:223], v[168:171], 0
    v_cvt_pk_bf16_f32 v37, v38, v39
    v_mfma_f32_16x16x32_bf16 v[104:107], v[232:235], v[168:171], 0
    v_cvt_pk_bf16_f32 v38, v52, v53
    v_mfma_f32_16x16x32_bf16 v[40:43], v[188:191], v[172:175], v[40:43]
    v_cvt_pk_bf16_f32 v39, v54, v55
    v_mfma_f32_16x16x32_bf16 v[56:59], v[200:203], v[172:175], v[56:59]
    buffer_store_dwordx4 v[36:39], v16, s[20:23], s45 offen offset:256 sc1
    v_mfma_f32_16x16x32_bf16 v[72:75], v[212:215], v[172:175], v[72:75]
    v_mfma_f32_16x16x32_bf16 v[88:91], v[224:227], v[172:175], v[88:91]
    v_cvt_pk_bf16_f32 v52, v68, v69
    v_mfma_f32_16x16x32_bf16 v[104:107], v[236:239], v[172:175], v[104:107]
    v_cvt_pk_bf16_f32 v53, v70, v71
    v_mfma_f32_16x16x32_bf16 v[40:43], v[192:195], v[176:179], v[40:43]
    v_cvt_pk_bf16_f32 v54, v84, v85
    v_mfma_f32_16x16x32_bf16 v[56:59], v[204:207], v[176:179], v[56:59]
    v_cvt_pk_bf16_f32 v55, v86, v87
    v_mfma_f32_16x16x32_bf16 v[72:75], v[216:219], v[176:179], v[72:75]
    buffer_store_dwordx4 v[52:55], v16, s[20:23], s46 offen offset:256 sc1
    v_mfma_f32_16x16x32_bf16 v[88:91], v[228:231], v[176:179], v[88:91]
    buffer_store_dwordx4 v[124:127], v16, s[20:23], s47 offen offset:0 sc1
    v_mfma_f32_16x16x32_bf16 v[104:107], v[240:243], v[176:179], v[104:107]
    v_pk_fma_f32 v[44:45], v[250:251], v[144:145], v[44:45] op_sel:[0,0,0] op_sel_hi:[0,1,1] neg_lo:[1,0,0] neg_hi:[1,0,0]
    v_pk_fma_f32 v[46:47], v[250:251], v[146:147], v[46:47] op_sel:[0,0,0] op_sel_hi:[0,1,1] neg_lo:[1,0,0] neg_hi:[1,0,0]
    v_pk_fma_f32 v[60:61], v[250:251], v[148:149], v[60:61] op_sel:[0,0,0] op_sel_hi:[0,1,1] neg_lo:[1,0,0] neg_hi:[1,0,0]
    v_pk_fma_f32 v[62:63], v[250:251], v[150:151], v[62:63] op_sel:[0,0,0] op_sel_hi:[0,1,1] neg_lo:[1,0,0] neg_hi:[1,0,0]
    v_pk_fma_f32 v[76:77], v[250:251], v[152:153], v[76:77] op_sel:[0,0,0] op_sel_hi:[0,1,1] neg_lo:[1,0,0] neg_hi:[1,0,0]
    v_pk_fma_f32 v[78:79], v[250:251], v[154:155], v[78:79] op_sel:[0,0,0] op_sel_hi:[0,1,1] neg_lo:[1,0,0] neg_hi:[1,0,0]
    v_pk_fma_f32 v[92:93], v[250:251], v[156:157], v[92:93] op_sel:[0,0,0] op_sel_hi:[0,1,1] neg_lo:[1,0,0] neg_hi:[1,0,0]
    v_pk_fma_f32 v[94:95], v[250:251], v[158:159], v[94:95] op_sel:[0,0,0] op_sel_hi:[0,1,1] neg_lo:[1,0,0] neg_hi:[1,0,0]
    v_pk_fma_f32 v[108:109], v[250:251], v[160:161], v[108:109] op_sel:[0,0,0] op_sel_hi:[0,1,1] neg_lo:[1,0,0] neg_hi:[1,0,0]
    v_pk_fma_f32 v[110:111], v[250:251], v[162:163], v[110:111] op_sel:[0,0,0] op_sel_hi:[0,1,1] neg_lo:[1,0,0] neg_hi:[1,0,0]
    v_pk_mul_f32 v[44:45], v[44:45], v[142:143] op_sel:[0,0] op_sel_hi:[1,0]
    v_pk_mul_f32 v[46:47], v[46:47], v[142:143] op_sel:[0,0] op_sel_hi:[1,0]
    v_pk_mul_f32 v[60:61], v[60:61], v[142:143] op_sel:[0,0] op_sel_hi:[1,0]
    v_pk_mul_f32 v[62:63], v[62:63], v[142:143] op_sel:[0,0] op_sel_hi:[1,0]
    v_pk_mul_f32 v[76:77], v[76:77], v[142:143] op_sel:[0,0] op_sel_hi:[1,0]
    v_pk_mul_f32 v[78:79], v[78:79], v[142:143] op_sel:[0,0] op_sel_hi:[1,0]
    v_pk_mul_f32 v[92:93], v[92:93], v[142:143] op_sel:[0,0] op_sel_hi:[1,0]
    v_pk_mul_f32 v[94:95], v[94:95], v[142:143] op_sel:[0,0] op_sel_hi:[1,0]
    v_pk_mul_f32 v[108:109], v[108:109], v[142:143] op_sel:[0,0] op_sel_hi:[1,0]
    v_pk_mul_f32 v[110:111], v[110:111], v[142:143] op_sel:[0,0] op_sel_hi:[1,0]
    v_cvt_pk_bf16_f32 v112, v44, v45
    v_cvt_pk_bf16_f32 v113, v46, v47
    v_cvt_pk_bf16_f32 v114, v60, v61
    v_cvt_pk_bf16_f32 v115, v62, v63
    v_cvt_pk_bf16_f32 v116, v76, v77
    v_cvt_pk_bf16_f32 v117, v78, v79
    v_cvt_pk_bf16_f32 v118, v92, v93
    v_cvt_pk_bf16_f32 v119, v94, v95
    v_cvt_pk_bf16_f32 v120, v108, v109
    v_cvt_pk_bf16_f32 v121, v110, v111
    v_mfma_f32_16x16x32_bf16 v[44:47], v[184:187], v[112:115], 0
    v_cvt_pk_bf16_f32 v128, v104, v105
    v_mfma_f32_16x16x32_bf16 v[60:63], v[196:199], v[112:115], 0
    v_cvt_pk_bf16_f32 v129, v106, v107
    v_mfma_f32_16x16x32_bf16 v[76:79], v[208:211], v[112:115], 0
    v_cvt_pk_bf16_f32 v40, v40, v41
    v_mfma_f32_16x16x32_bf16 v[92:95], v[220:223], v[112:115], 0
    v_cvt_pk_bf16_f32 v41, v42, v43
    v_mfma_f32_16x16x32_bf16 v[108:111], v[232:235], v[112:115], 0
    v_mfma_f32_16x16x32_bf16 v[44:47], v[188:191], v[116:119], v[44:47]
    v_cvt_pk_bf16_f32 v42, v56, v57
    v_mfma_f32_16x16x32_bf16 v[60:63], v[200:203], v[116:119], v[60:63]
    v_cvt_pk_bf16_f32 v43, v58, v59
    v_mfma_f32_16x16x32_bf16 v[76:79], v[212:215], v[116:119], v[76:79]
    buffer_store_dwordx4 v[40:43], v16, s[20:23], s45 offen offset:512 sc1
    v_mfma_f32_16x16x32_bf16 v[92:95], v[224:227], v[116:119], v[92:95]
    v_cvt_pk_bf16_f32 v56, v72, v73
    v_mfma_f32_16x16x32_bf16 v[108:111], v[236:239], v[116:119], v[108:111]
    v_mfma_f32_16x16x32_bf16 v[44:47], v[192:195], v[120:123], v[44:47]
    v_cvt_pk_bf16_f32 v57, v74, v75
    v_mfma_f32_16x16x32_bf16 v[60:63], v[204:207], v[120:123], v[60:63]
    v_cvt_pk_bf16_f32 v58, v88, v89
    v_mfma_f32_16x16x32_bf16 v[76:79], v[216:219], v[120:123], v[76:79]
    v_cvt_pk_bf16_f32 v59, v90, v91
    v_mfma_f32_16x16x32_bf16 v[92:95], v[228:231], v[120:123], v[92:95]
    buffer_store_dwordx4 v[56:59], v16, s[20:23], s46 offen offset:512 sc1
    v_mfma_f32_16x16x32_bf16 v[108:111], v[240:243], v[120:123], v[108:111]
    s_nop 7
    v_cvt_pk_bf16_f32 v130, v108, v109
    v_cvt_pk_bf16_f32 v131, v110, v111
    v_cvt_pk_bf16_f32 v44, v44, v45
    v_cvt_pk_bf16_f32 v45, v46, v47
    v_cvt_pk_bf16_f32 v46, v60, v61
    v_cvt_pk_bf16_f32 v47, v62, v63
    buffer_store_dwordx4 v[44:47], v16, s[20:23], s45 offen offset:768 sc1
    v_cvt_pk_bf16_f32 v60, v76, v77
    v_cvt_pk_bf16_f32 v61, v78, v79
    v_cvt_pk_bf16_f32 v62, v92, v93
    v_cvt_pk_bf16_f32 v63, v94, v95
    buffer_store_dwordx4 v[60:63], v16, s[20:23], s46 offen offset:768 sc1
    buffer_store_dwordx4 v[128:131], v16, s[20:23], s47 offen offset:256 sc1
    s_cmp_eq_u32 s31, 3
    s_cbranch_scc0 Q_NOB
    s_lshr_b32 s45, s2, 6
    s_lshl_b32 s45, s45, 1
    s_and_b32 s46, s2, 3
    s_lshl_b32 s46, s46, 3
    s_add_u32 s45, s45, s46
    s_bfe_u32 s46, s2, 0x10002
    s_add_u32 s45, s45, s46
    s_lshl_b32 s45, s45, 7
    v_mov_b32 v12, s45
    buffer_load_dwordx2 v[20:21], v12, s[20:23], 0 offen sc1
    s_add_u32 s48, s28, 0
    buffer_load_dwordx4 v[184:187], v8, s[20:23], s48 offen offset:0 sc1
    buffer_load_dwordx4 v[188:191], v8, s[20:23], s48 offen offset:1024 sc1
    buffer_load_dwordx4 v[192:195], v8, s[20:23], s48 offen offset:2048 sc1
    buffer_load_dwordx4 v[196:199], v8, s[20:23], s48 offen offset:3072 sc1
    buffer_load_dwordx4 v[200:203], v9, s[20:23], s48 offen offset:0 sc1
    s_add_u32 s48, s28, 5120
    buffer_load_dwordx4 v[204:207], v8, s[20:23], s48 offen offset:0 sc1
    buffer_load_dwordx4 v[208:211], v8, s[20:23], s48 offen offset:1024 sc1
    buffer_load_dwordx4 v[212:215], v8, s[20:23], s48 offen offset:2048 sc1
    buffer_load_dwordx4 v[216:219], v8, s[20:23], s48 offen offset:3072 sc1
    buffer_load_dwordx4 v[220:223], v9, s[20:23], s48 offen offset:0 sc1
    s_add_u32 s48, s28, 20480
    buffer_load_dwordx4 v[224:227], v8, s[20:23], s48 offen offset:0 sc1
    buffer_load_dwordx4 v[228:231], v8, s[20:23], s48 offen offset:1024 sc1
    buffer_load_dwordx4 v[232:235], v8, s[20:23], s48 offen offset:2048 sc1
    buffer_load_dwordx4 v[236:239], v8, s[20:23], s48 offen offset:3072 sc1
    buffer_load_dwordx4 v[240:243], v9, s[20:23], s48 offen offset:0 sc1
    s_waitcnt vmcnt(15)
    s_branch P1_FIN2
Q_NOB:
    s_branch P1_FIN
EKV:
    v_and_b32 v16, 15, v0
    v_mul_u32_u24 v16, 528, v16
    v_lshrrev_b32 v17, 4, v0
    v_lshl_add_u32 v16, v17, 7, v16
    s_mul_i32 s45, s37, 8448
    v_add_u32 v16, s45, v16
    s_cmp_eq_u32 s38, 0
    s_cbranch_scc1 KV_KWAVE
    s_waitcnt lgkmcnt(0)
    v_pk_fma_f32 v[32:33], v[244:245], v[144:145], v[32:33] op_sel:[0,0,0] op_sel_hi:[0,1,1] neg_lo:[1,0,0] neg_hi:[1,0,0]
    v_pk_fma_f32 v[34:35], v[244:245], v[146:147], v[34:35] op_sel:[0,0,0] op_sel_hi:[0,1,1] neg_lo:[1,0,0] neg_hi:[1,0,0]
    v_pk_fma_f32 v[48:49], v[244:245], v[148:149], v[48:49] op_sel:[0,0,0] op_sel_hi:[0,1,1] neg_lo:[1,0,0] neg_hi:[1,0,0]
    v_pk_fma_f32 v[50:51], v[244:245], v[150:151], v[50:51] op_sel:[0,0,0] op_sel_hi:[0,1,1] neg_lo:[1,0,0] neg_hi:[1,0,0]
    v_pk_fma_f32 v[64:65], v[244:245], v[152:153], v[64:65] op_sel:[0,0,0] op_sel_hi:[0,1,1] neg_lo:[1,0,0] neg_hi:[1,0,0]
    v_pk_fma_f32 v[66:67], v[244:245], v[154:155], v[66:67] op_sel:[0,0,0] op_sel_hi:[0,1,1] neg_lo:[1,0,0] neg_hi:[1,0,0]
    v_pk_fma_f32 v[80:81], v[244:245], v[156:157], v[80:81] op_sel:[0,0,0] op_sel_hi:[0,1,1] neg_lo:[1,0,0] neg_hi:[1,0,0]
    v_pk_fma_f32 v[82:83], v[244:245], v[158:159], v[82:83] op_sel:[0,0,0] op_sel_hi:[0,1,1] neg_lo:[1,0,0] neg_hi:[1,0,0]
    v_pk_fma_f32 v[96:97], v[244:245], v[160:161], v[96:97] op_sel:[0,0,0] op_sel_hi:[0,1,1] neg_lo:[1,0,0] neg_hi:[1,0,0]
    v_pk_fma_f32 v[98:99], v[244:245], v[162:163], v[98:99] op_sel:[0,0,0] op_sel_hi:[0,1,1] neg_lo:[1,0,0] neg_hi:[1,0,0]
    v_cvt_pk_bf16_f32 v112, v32, v33
    v_cvt_pk_bf16_f32 v113, v34, v35
    v_cvt_pk_bf16_f32 v114, v48, v49
    v_cvt_pk_bf16_f32 v115, v50, v51
    v_cvt_pk_bf16_f32 v116, v64, v65
    v_cvt_pk_bf16_f32 v117, v66, v67
    v_cvt_pk_bf16_f32 v118, v80, v81
    v_cvt_pk_bf16_f32 v119, v82, v83
    v_cvt_pk_bf16_f32 v120, v96, v97
    v_cvt_pk_bf16_f32 v121, v98, v99
    v_cvt_pk_bf16_f32 v122, v245, v245
    v_mov_b32 v123, 0
    v_pk_fma_f32 v[36:37], v[246:247], v[144:145], v[36:37] op_sel:[0,0,0] op_sel_hi:[0,1,1] neg_lo:[1,0,0] neg_hi:[1,0,0]
    v_pk_fma_f32 v[38:39], v[246:247], v[146:147], v[38:39] op_sel:[0,0,0] op_sel_hi:[0,1,1] neg_lo:[1,0,0] neg_hi:[1,0,0]
    v_pk_fma_f32 v[52:53], v[246:247], v[148:149], v[52:53] op_sel:[0,0,0] op_sel_hi:[0,1,1] neg_lo:[1,0,0] neg_hi:[1,0,0]
    v_pk_fma_f32 v[54:55], v[246:247], v[150:151], v[54:55] op_sel:[0,0,0] op_sel_hi:[0,1,1] neg_lo:[1,0,0] neg_hi:[1,0,0]
    v_pk_fma_f32 v[68:69], v[246:247], v[152:153], v[68:69] op_sel:[0,0,0] op_sel_hi:[0,1,1] neg_lo:[1,0,0] neg_hi:[1,0,0]
    v_pk_fma_f32 v[70:71], v[246:247], v[154:155], v[70:71] op_sel:[0,0,0] op_sel_hi:[0,1,1] neg_lo:[1,0,0] neg_hi:[1,0,0]
    v_pk_fma_f32 v[84:85], v[246:247], v[156:157], v[84:85] op_sel:[0,0,0] op_sel_hi:[0,1,1] neg_lo:[1,0,0] neg_hi:[1,0,0]
    v_pk_fma_f32 v[86:87], v[246:247], v[158:159], v[86:87] op_sel:[0,0,0] op_sel_hi:[0,1,1] neg_lo:[1,0,0] neg_hi:[1,0,0]
    v_pk_fma_f32 v[100:101], v[246:247], v[160:161], v[100:101] op_sel:[0,0,0] op_sel_hi:[0,1,1] neg_lo:[1,0,0] neg_hi:[1,0,0]
    v_pk_fma_f32 v[102:103], v[246:247], v[162:163], v[102:103] op_sel:[0,0,0] op_sel_hi:[0,1,1] neg_lo:[1,0,0] neg_hi:[1,0,0]
    v_cvt_pk_bf16_f32 v124, v36, v37
    v_cvt_pk_bf16_f32 v125, v38, v39
    v_cvt_pk_bf16_f32 v126, v52, v53
    v_cvt_pk_bf16_f32 v127, v54, v55
    v_cvt_pk_bf16_f32 v128, v68, v69
    v_cvt_pk_bf16_f32 v129, v70, v71
    v_cvt_pk_bf16_f32 v130, v84, v85
    v_cvt_pk_bf16_f32 v131, v86, v87
    v_cvt_pk_bf16_f32 v132, v100, v101
    v_cvt_pk_bf16_f32 v133, v102, v103
    v_cvt_pk_bf16_f32 v134, v247, v247
    v_mov_b32 v135, 0
    v_pk_fma_f32 v[40:41], v[248:249], v[144:145], v[40:41] op_sel:[0,0,0] op_sel_hi:[0,1,1] neg_lo:[1,0,0] neg_hi:[1,0,0]
    v_pk_fma_f32 v[42:43], v[248:249], v[146:147], v[42:43] op_sel:[0,0,0] op_sel_hi:[0,1,1] neg_lo:[1,0,0] neg_hi:[1,0,0]
    v_pk_fma_f32 v[56:57], v[248:249], v[148:149], v[56:57] op_sel:[0,0,0] op_sel_hi:[0,1,1] neg_lo:[1,0,0] neg_hi:[1,0,0]
    v_pk_fma_f32 v[58:59], v[248:249], v[150:151], v[58:59] op_sel:[0,0,0] op_sel_hi:[0,1,1] neg_lo:[1,0,0] neg_hi:[1,0,0]
    v_pk_fma_f32 v[72:73], v[248:249], v[152:153], v[72:73] op_sel:[0,0,0] op_sel_hi:[0,1,1] neg_lo:[1,0,0] neg_hi:[1,0,0]
    v_pk_fma_f32 v[74:75], v[248:249], v[154:155], v[74:75] op_sel:[0,0,0] op_sel_hi:[0,1,1] neg_lo:[1,0,0] neg_hi:[1,0,0]
    v_pk_fma_f32 v[88:89], v[248:249], v[156:157], v[88:89] op_sel:[0,0,0] op_sel_hi:[0,1,1] neg_lo:[1,0,0] neg_hi:[1,0,0]
    v_pk_fma_f32 v[90:91], v[248:249], v[158:159], v[90:91] op_sel:[0,0,0] op_sel_hi:[0,1,1] neg_lo:[1,0,0] neg_hi:[1,0,0]
    v_pk_fma_f32 v[104:105], v[248:249], v[160:161], v[104:105] op_sel:[0,0,0] op_sel_hi:[0,1,1] neg_lo:[1,0,0] neg_hi:[1,0,0]
    v_pk_fma_f32 v[106:107], v[248:249], v[162:163], v[106:107] op_sel:[0,0,0] op_sel_hi:[0,1,1] neg_lo:[1,0,0] neg_hi:[1,0,0]
    v_cvt_pk_bf16_f32 v168, v40, v41
    v_cvt_pk_bf16_f32 v169, v42, v43
    v_cvt_pk_bf16_f32 v170, v56, v57
    v_cvt_pk_bf16_f32 v171, v58, v59
    v_cvt_pk_bf16_f32 v172, v72, v73
    v_cvt_pk_bf16_f32 v173, v74, v75
    v_cvt_pk_bf16_f32 v174, v88, v89
    v_cvt_pk_bf16_f32 v175, v90, v91
    v_cvt_pk_bf16_f32 v176, v104, v105
    v_cvt_pk_bf16_f32 v177, v106, v107
    v_cvt_pk_bf16_f32 v178, v249, v249
    v_mov_b32 v179, 0
    v_pk_fma_f32 v[44:45], v[250:251], v[144:145], v[44:45] op_sel:[0,0,0] op_sel_hi:[0,1,1] neg_lo:[1,0,0] neg_hi:[1,0,0]
    v_pk_fma_f32 v[46:47], v[250:251], v[146:147], v[46:47] op_sel:[0,0,0] op_sel_hi:[0,1,1] neg_lo:[1,0,0] neg_hi:[1,0,0]
    v_pk_fma_f32 v[60:61], v[250:251], v[148:149], v[60:61] op_sel:[0,0,0] op_sel_hi:[0,1,1] neg_lo:[1,0,0] neg_hi:[1,0,0]
    v_pk_fma_f32 v[62:63], v[250:251], v[150:151], v[62:63] op_sel:[0,0,0] op_sel_hi:[0,1,1] neg_lo:[1,0,0] neg_hi:[1,0,0]
    v_pk_fma_f32 v[76:77], v[250:251], v[152:153], v[76:77] op_sel:[0,0,0] op_sel_hi:[0,1,1] neg_lo:[1,0,0] neg_hi:[1,0,0]
    v_pk_fma_f32 v[78:79], v[250:251], v[154:155], v[78:79] op_sel:[0,0,0] op_sel_hi:[0,1,1] neg_lo:[1,0,0] neg_hi:[1,0,0]
    v_pk_fma_f32 v[92:93], v[250:251], v[156:157], v[92:93] op_sel:[0,0,0] op_sel_hi:[0,1,1] neg_lo:[1,0,0] neg_hi:[1,0,0]
    v_pk_fma_f32 v[94:95], v[250:251], v[158:159], v[94:95] op_sel:[0,0,0] op_sel_hi:[0,1,1] neg_lo:[1,0,0] neg_hi:[1,0,0]
    v_pk_fma_f32 v[108:109], v[250:251], v[160:161], v[108:109] op_sel:[0,0,0] op_sel_hi:[0,1,1] neg_lo:[1,0,0] neg_hi:[1,0,0]
    v_pk_fma_f32 v[110:111], v[250:251], v[162:163], v[110:111] op_sel:[0,0,0] op_sel_hi:[0,1,1] neg_lo:[1,0,0] neg_hi:[1,0,0]
    v_cvt_pk_bf16_f32 v136, v44, v45
    v_cvt_pk_bf16_f32 v137, v46, v47
    v_cvt_pk_bf16_f32 v138, v60, v61
    v_cvt_pk_bf16_f32 v139, v62, v63
    v_cvt_pk_bf16_f32 v140, v76, v77
    v_cvt_pk_bf16_f32 v141, v78, v79
    v_cvt_pk_bf16_f32 v142, v92, v93
    v_cvt_pk_bf16_f32 v143, v94, v95
    v_cvt_pk_bf16_f32 v144, v108, v109
    v_cvt_pk_bf16_f32 v145, v110, v111
    v_cvt_pk_bf16_f32 v146, v251, v251
    v_mov_b32 v147, 0
    v_bfe_u32 v18, v0, 2, 3
    v_lshrrev_b32 v19, 5, v0
    v_lshl_add_u32 v18, v19, 3, v18
    v_mul_u32_u24 v18, 1056, v18
    v_and_b32 v19, 3, v0
    v_lshl_add_u32 v18, v19, 3, v18
    s_lshl_b32 s45, s37, 7
    v_add_u32 v18, s45, v18
    v_add_u32 v19, 16896, v18
    s_barrier
    ds_write_b128 v16, v[112:115] offset:80
    ds_write_b128 v16, v[116:119] offset:96
    ds_write_b128 v16, v[120:123] offset:112
    ds_write_b128 v16, v[124:127] offset:33872
    ds_write_b128 v16, v[128:131] offset:33888
    ds_write_b128 v16, v[132:135] offset:33904
    s_cmp_eq_u32 s31, 3
    s_cbranch_scc0 KVV_0_0
    s_add_u32 s48, s28, 0
    buffer_load_dwordx4 v[184:187], v8, s[20:23], s48 offen offset:0 sc1
    KVV_0_0:
    s_cmp_eq_u32 s31, 3
    s_cbranch_scc0 KVV_0_1
    buffer_load_dwordx4 v[188:191], v8, s[20:23], s48 offen offset:1024 sc1
    KVV_0_1:
    s_cmp_eq_u32 s31, 3
    s_cbranch_scc0 KVV_0_2
    buffer_load_dwordx4 v[192:195], v8, s[20:23], s48 offen offset:2048 sc1
    KVV_0_2:
    s_cmp_eq_u32 s31, 3
    s_cbranch_scc0 KVV_0_3
    buffer_load_dwordx4 v[196:199], v8, s[20:23], s48 offen offset:3072 sc1
    KVV_0_3:
    s_cmp_eq_u32 s31, 3
    s_cbranch_scc0 KVV_0_4
    buffer_load_dwordx4 v[200:203], v9, s[20:23], s48 offen offset:0 sc1
    KVV_0_4:
    s_cmp_eq_u32 s31, 3
    s_cbranch_scc0 KVV_1_0
    s_add_u32 s48, s28, 5120
    buffer_load_dwordx4 v[204:207], v8, s[20:23], s48 offen offset:0 sc1
    KVV_1_0:
    s_cmp_eq_u32 s31, 3
    s_cbranch_scc0 KVV_1_1
    buffer_load_dwordx4 v[208:211], v8, s[20:23], s48 offen offset:1024 sc1
    KVV_1_1:
    s_cmp_eq_u32 s31, 3
    s_cbranch_scc0 KVV_1_2
    buffer_load_dwordx4 v[212:215], v8, s[20:23], s48 offen offset:2048 sc1
    KVV_1_2:
    s_cmp_eq_u32 s31, 3
    s_cbranch_scc0 KVV_1_3
    buffer_load_dwordx4 v[216:219], v8, s[20:23], s48 offen offset:3072 sc1
    KVV_1_3:
    s_cmp_eq_u32 s31, 3
    s_cbranch_scc0 KVV_1_4
    buffer_load_dwordx4 v[220:223], v9, s[20:23], s48 offen offset:0 sc1
    KVV_1_4:
    v_and_b32 v20, 15, v0
    v_cmp_gt_u32 vcc, 5, v20
    v_lshrrev_b32 v21, 4, v0
    v_mul_u32_u24 v21, 21, v21
    v_add_u32 v20, v20, v21
    v_lshlrev_b32 v20, 4, v20
    s_lshl_b32 s45, s33, 5
    s_lshl_b32 s46, s34, 2
    s_add_u32 s45, s45, s46
    s_add_u32 s45, s45, s37
    s_mul_i32 s45, s45, 3360
    s_add_u32 s45, s45, 4194304
    s_waitcnt lgkmcnt(0)
    s_barrier
    ds_read_b64_tr_b16 v[76:77], v18 offset:80
    ds_read_b64_tr_b16 v[78:79], v18 offset:608
    ds_read_b64_tr_b16 v[80:81], v18 offset:112
    ds_read_b64_tr_b16 v[82:83], v18 offset:640
    ds_read_b64_tr_b16 v[64:65], v18 offset:0
    ds_read_b64_tr_b16 v[66:67], v18 offset:528
    ds_read_b64_tr_b16 v[68:69], v18 offset:32
    ds_read_b64_tr_b16 v[70:71], v18 offset:560
    ds_read_b64_tr_b16 v[72:73], v18 offset:64
    ds_read_b64_tr_b16 v[74:75], v18 offset:592
    ds_read_b64_tr_b16 v[96:97], v19 offset:80
    ds_read_b64_tr_b16 v[98:99], v19 offset:608
    ds_read_b64_tr_b16 v[100:101], v19 offset:112
    ds_read_b64_tr_b16 v[102:103], v19 offset:640
    ds_read_b64_tr_b16 v[84:85], v19 offset:0
    ds_read_b64_tr_b16 v[86:87], v19 offset:528
    ds_read_b64_tr_b16 v[88:89], v19 offset:32
    ds_read_b64_tr_b16 v[90:91], v19 offset:560
    ds_read_b64_tr_b16 v[92:93], v19 offset:64
    ds_read_b64_tr_b16 v[94:95], v19 offset:592
    s_waitcnt lgkmcnt(10)
    v_mfma_f32_16x16x32_bf16 v[32:35], v[64:67], v[76:79], 0
    v_mfma_f32_16x16x32_bf16 v[36:39], v[64:67], v[80:83], 0
    v_mfma_f32_16x16x32_bf16 v[40:43], v[68:71], v[76:79], 0
    v_mfma_f32_16x16x32_bf16 v[44:47], v[68:71], v[80:83], 0
    v_mfma_f32_16x16x32_bf16 v[48:51], v[72:75], v[76:79], 0
    v_mfma_f32_16x16x32_bf16 v[52:55], v[72:75], v[80:83], 0
    s_waitcnt lgkmcnt(0)
    v_mfma_f32_16x16x32_bf16 v[32:35], v[84:87], v[96:99], v[32:35]
    v_mfma_f32_16x16x32_bf16 v[36:39], v[84:87], v[100:103], v[36:39]
    v_mfma_f32_16x16x32_bf16 v[40:43], v[88:91], v[96:99], v[40:43]
    v_mfma_f32_16x16x32_bf16 v[44:47], v[88:91], v[100:103], v[44:47]
    v_mfma_f32_16x16x32_bf16 v[48:51], v[92:95], v[96:99], v[48:51]
    v_mfma_f32_16x16x32_bf16 v[52:55], v[92:95], v[100:103], v[52:55]
    s_cmp_eq_u32 s31, 3
    s_cbranch_scc0 KVV_4_0
    s_add_u32 s48, s28, 20480
    buffer_load_dwordx4 v[224:227], v8, s[20:23], s48 offen offset:0 sc1
    KVV_4_0:
    s_cmp_eq_u32 s31, 3
    s_cbranch_scc0 KVV_4_1
    buffer_load_dwordx4 v[228:231], v8, s[20:23], s48 offen offset:1024 sc1
    KVV_4_1:
    s_cmp_eq_u32 s31, 3
    s_cbranch_scc0 KVV_4_2
    buffer_load_dwordx4 v[232:235], v8, s[20:23], s48 offen offset:2048 sc1
    KVV_4_2:
    s_cmp_eq_u32 s31, 3
    s_cbranch_scc0 KVV_4_3
    buffer_load_dwordx4 v[236:239], v8, s[20:23], s48 offen offset:3072 sc1
    KVV_4_3:
    s_cmp_eq_u32 s31, 3
    s_cbranch_scc0 KVV_4_4
    buffer_load_dwordx4 v[240:243], v9, s[20:23], s48 offen offset:0 sc1
    KVV_4_4:
    s_waitcnt lgkmcnt(0)
    s_barrier
    ds_write_b128 v16, v[168:171] offset:80
    ds_write_b128 v16, v[172:175] offset:96
    ds_write_b128 v16, v[176:179] offset:112
    ds_read_b64_tr_b16 v[76:77], v18 offset:33872
    ds_read_b64_tr_b16 v[78:79], v18 offset:34400
    ds_read_b64_tr_b16 v[80:81], v18 offset:33904
    ds_read_b64_tr_b16 v[82:83], v18 offset:34432
    ds_read_b64_tr_b16 v[64:65], v18 offset:33792
    ds_read_b64_tr_b16 v[66:67], v18 offset:34320
    ds_read_b64_tr_b16 v[68:69], v18 offset:33824
    ds_read_b64_tr_b16 v[70:71], v18 offset:34352
    ds_read_b64_tr_b16 v[72:73], v18 offset:33856
    ds_read_b64_tr_b16 v[74:75], v18 offset:34384
    ds_read_b64_tr_b16 v[96:97], v19 offset:33872
    ds_read_b64_tr_b16 v[98:99], v19 offset:34400
    ds_read_b64_tr_b16 v[100:101], v19 offset:33904
    ds_read_b64_tr_b16 v[102:103], v19 offset:34432
    ds_read_b64_tr_b16 v[84:85], v19 offset:33792
    ds_read_b64_tr_b16 v[86:87], v19 offset:34320
    ds_read_b64_tr_b16 v[88:89], v19 offset:33824
    ds_read_b64_tr_b16 v[90:91], v19 offset:34352
    ds_read_b64_tr_b16 v[92:93], v19 offset:33856
    ds_read_b64_tr_b16 v[94:95], v19 offset:34384
    s_waitcnt lgkmcnt(10)
    v_mfma_f32_16x16x32_bf16 v[32:35], v[64:67], v[76:79], v[32:35]
    v_mfma_f32_16x16x32_bf16 v[36:39], v[64:67], v[80:83], v[36:39]
    v_mfma_f32_16x16x32_bf16 v[40:43], v[68:71], v[76:79], v[40:43]
    v_mfma_f32_16x16x32_bf16 v[44:47], v[68:71], v[80:83], v[44:47]
    v_mfma_f32_16x16x32_bf16 v[48:51], v[72:75], v[76:79], v[48:51]
    v_mfma_f32_16x16x32_bf16 v[52:55], v[72:75], v[80:83], v[52:55]
    s_waitcnt lgkmcnt(0)
    v_mfma_f32_16x16x32_bf16 v[32:35], v[84:87], v[96:99], v[32:35]
    v_mfma_f32_16x16x32_bf16 v[36:39], v[84:87], v[100:103], v[36:39]
    v_mfma_f32_16x16x32_bf16 v[40:43], v[88:91], v[96:99], v[40:43]
    v_mfma_f32_16x16x32_bf16 v[44:47], v[88:91], v[100:103], v[44:47]
    v_mfma_f32_16x16x32_bf16 v[48:51], v[92:95], v[96:99], v[48:51]
    v_mfma_f32_16x16x32_bf16 v[52:55], v[92:95], v[100:103], v[52:55]
    s_cmp_eq_u32 s31, 3
    s_cbranch_scc0 KVV_2_0
    s_add_u32 s48, s28, 10240
    s_add_u32 m0, s30, 0
    s_nop 0
    buffer_load_dwordx4 v8, s[20:23], s48 offen offset:0 sc1 lds
    KVV_2_0:
    s_cmp_eq_u32 s31, 3
    s_cbranch_scc0 KVV_2_1
    s_add_u32 m0, s30, 0
    s_nop 0
    buffer_load_dwordx4 v8, s[20:23], s48 offen offset:1024 sc1 lds
    KVV_2_1:
    s_cmp_eq_u32 s31, 3
    s_cbranch_scc0 KVV_2_2
    s_add_u32 m0, s30, 0
    s_nop 0
    buffer_load_dwordx4 v8, s[20:23], s48 offen offset:2048 sc1 lds
    KVV_2_2:
    s_cmp_eq_u32 s31, 3
    s_cbranch_scc0 KVV_2_3
    s_add_u32 m0, s30, 0
    s_nop 0
    buffer_load_dwordx4 v8, s[20:23], s48 offen offset:3072 sc1 lds
    KVV_2_3:
    s_cmp_eq_u32 s31, 3
    s_cbranch_scc0 KVV_2_4
    s_add_u32 m0, s30, 4096
    s_nop 0
    buffer_load_dwordx4 v9, s[20:23], s48 offen offset:0 sc1 lds
    KVV_2_4:
    s_waitcnt lgkmcnt(0)
    s_barrier
    ds_write_b128 v16, v[136:139] offset:33872
    ds_write_b128 v16, v[140:143] offset:33888
    ds_write_b128 v16, v[144:147] offset:33904
    ds_read_b64_tr_b16 v[76:77], v18 offset:80
    ds_read_b64_tr_b16 v[78:79], v18 offset:608
    ds_read_b64_tr_b16 v[80:81], v18 offset:112
    ds_read_b64_tr_b16 v[82:83], v18 offset:640
    ds_read_b64_tr_b16 v[64:65], v18 offset:0
    ds_read_b64_tr_b16 v[66:67], v18 offset:528
    ds_read_b64_tr_b16 v[68:69], v18 offset:32
    ds_read_b64_tr_b16 v[70:71], v18 offset:560
    ds_read_b64_tr_b16 v[72:73], v18 offset:64
    ds_read_b64_tr_b16 v[74:75], v18 offset:592
    ds_read_b64_tr_b16 v[96:97], v19 offset:80
    ds_read_b64_tr_b16 v[98:99], v19 offset:608
    ds_read_b64_tr_b16 v[100:101], v19 offset:112
    ds_read_b64_tr_b16 v[102:103], v19 offset:640
    ds_read_b64_tr_b16 v[84:85], v19 offset:0
    ds_read_b64_tr_b16 v[86:87], v19 offset:528
    ds_read_b64_tr_b16 v[88:89], v19 offset:32
    ds_read_b64_tr_b16 v[90:91], v19 offset:560
    ds_read_b64_tr_b16 v[92:93], v19 offset:64
    ds_read_b64_tr_b16 v[94:95], v19 offset:592
    s_waitcnt lgkmcnt(10)
    v_mfma_f32_16x16x32_bf16 v[32:35], v[64:67], v[76:79], v[32:35]
    v_mfma_f32_16x16x32_bf16 v[36:39], v[64:67], v[80:83], v[36:39]
    v_mfma_f32_16x16x32_bf16 v[40:43], v[68:71], v[76:79], v[40:43]
    v_mfma_f32_16x16x32_bf16 v[44:47], v[68:71], v[80:83], v[44:47]
    v_mfma_f32_16x16x32_bf16 v[48:51], v[72:75], v[76:79], v[48:51]
    v_mfma_f32_16x16x32_bf16 v[52:55], v[72:75], v[80:83], v[52:55]
    s_waitcnt lgkmcnt(0)
    v_mfma_f32_16x16x32_bf16 v[32:35], v[84:87], v[96:99], v[32:35]
    v_mfma_f32_16x16x32_bf16 v[36:39], v[84:87], v[100:103], v[36:39]
    v_mfma_f32_16x16x32_bf16 v[40:43], v[88:91], v[96:99], v[40:43]
    v_mfma_f32_16x16x32_bf16 v[44:47], v[88:91], v[100:103], v[44:47]
    v_mfma_f32_16x16x32_bf16 v[48:51], v[92:95], v[96:99], v[48:51]
    v_mfma_f32_16x16x32_bf16 v[52:55], v[92:95], v[100:103], v[52:55]
    s_cmp_eq_u32 s31, 3
    s_cbranch_scc0 KVV_3_0
    s_add_u32 s48, s28, 15360
    s_add_u32 m0, s30, 5120
    s_nop 0
    buffer_load_dwordx4 v8, s[20:23], s48 offen offset:0 sc1 lds
    KVV_3_0:
    s_cmp_eq_u32 s31, 3
    s_cbranch_scc0 KVV_3_1
    s_add_u32 m0, s30, 5120
    s_nop 0
    buffer_load_dwordx4 v8, s[20:23], s48 offen offset:1024 sc1 lds
    KVV_3_1:
    s_cmp_eq_u32 s31, 3
    s_cbranch_scc0 KVV_3_2
    s_add_u32 m0, s30, 5120
    s_nop 0
    buffer_load_dwordx4 v8, s[20:23], s48 offen offset:2048 sc1 lds
    KVV_3_2:
    s_cmp_eq_u32 s31, 3
    s_cbranch_scc0 KVV_3_3
    s_add_u32 m0, s30, 5120
    s_nop 0
    buffer_load_dwordx4 v8, s[20:23], s48 offen offset:3072 sc1 lds
    KVV_3_3:
    s_cmp_eq_u32 s31, 3
    s_cbranch_scc0 KVV_3_4
    s_add_u32 m0, s30, 9216
    s_nop 0
    buffer_load_dwordx4 v9, s[20:23], s48 offen offset:0 sc1 lds
    KVV_3_4:
    s_waitcnt lgkmcnt(0)
    s_barrier
    ds_read_b64_tr_b16 v[76:77], v18 offset:33872
    ds_read_b64_tr_b16 v[78:79], v18 offset:34400
    ds_read_b64_tr_b16 v[80:81], v18 offset:33904
    ds_read_b64_tr_b16 v[82:83], v18 offset:34432
    ds_read_b64_tr_b16 v[64:65], v18 offset:33792
    ds_read_b64_tr_b16 v[66:67], v18 offset:34320
    ds_read_b64_tr_b16 v[68:69], v18 offset:33824
    ds_read_b64_tr_b16 v[70:71], v18 offset:34352
    ds_read_b64_tr_b16 v[72:73], v18 offset:33856
    ds_read_b64_tr_b16 v[74:75], v18 offset:34384
    ds_read_b64_tr_b16 v[96:97], v19 offset:33872
    ds_read_b64_tr_b16 v[98:99], v19 offset:34400
    ds_read_b64_tr_b16 v[100:101], v19 offset:33904
    ds_read_b64_tr_b16 v[102:103], v19 offset:34432
    ds_read_b64_tr_b16 v[84:85], v19 offset:33792
    ds_read_b64_tr_b16 v[86:87], v19 offset:34320
    ds_read_b64_tr_b16 v[88:89], v19 offset:33824
    ds_read_b64_tr_b16 v[90:91], v19 offset:34352
    ds_read_b64_tr_b16 v[92:93], v19 offset:33856
    ds_read_b64_tr_b16 v[94:95], v19 offset:34384
    s_waitcnt lgkmcnt(10)
    v_mfma_f32_16x16x32_bf16 v[32:35], v[64:67], v[76:79], v[32:35]
    v_mfma_f32_16x16x32_bf16 v[36:39], v[64:67], v[80:83], v[36:39]
    v_mfma_f32_16x16x32_bf16 v[40:43], v[68:71], v[76:79], v[40:43]
    v_mfma_f32_16x16x32_bf16 v[44:47], v[68:71], v[80:83], v[44:47]
    v_mfma_f32_16x16x32_bf16 v[48:51], v[72:75], v[76:79], v[48:51]
    v_mfma_f32_16x16x32_bf16 v[52:55], v[72:75], v[80:83], v[52:55]
    s_waitcnt lgkmcnt(0)
    v_mfma_f32_16x16x32_bf16 v[32:35], v[84:87], v[96:99], v[32:35]
    v_mfma_f32_16x16x32_bf16 v[36:39], v[84:87], v[100:103], v[36:39]
    v_mfma_f32_16x16x32_bf16 v[40:43], v[88:91], v[96:99], v[40:43]
    v_mfma_f32_16x16x32_bf16 v[44:47], v[88:91], v[100:103], v[44:47]
    v_mfma_f32_16x16x32_bf16 v[48:51], v[92:95], v[96:99], v[48:51]
    v_mfma_f32_16x16x32_bf16 v[52:55], v[92:95], v[100:103], v[52:55]
    s_nop 2
    buffer_store_dwordx4 v[32:35], v20, s[20:23], s45 offen offset:0 sc1
    s_nop 0
    buffer_store_dwordx4 v[40:43], v20, s[20:23], s45 offen offset:1344 sc1
    s_mov_b32 exec_hi, 0
    buffer_store_dwordx4 v[48:51], v20, s[20:23], s45 offen offset:2688 sc1
    s_mov_b64 exec, -1
    s_mov_b64 exec, vcc
    buffer_store_dwordx4 v[36:39], v20, s[20:23], s45 offen offset:256 sc1
    buffer_store_dwordx4 v[44:47], v20, s[20:23], s45 offen offset:1600 sc1
    s_mov_b32 exec_hi, 0
    buffer_store_dwordx4 v[52:55], v20, s[20:23], s45 offen offset:2944 sc1
    s_mov_b64 exec, -1
    s_branch KV_DONE
KV_KWAVE:
    v_rcp_f32 v137, v245
    v_rcp_f32 v139, v247
    v_rcp_f32 v141, v249
    v_rcp_f32 v143, v251
    v_mov_b32 v178, 0
    v_mov_b32 v179, 0
    v_mov_b32 v122, 0
    v_mov_b32 v123, 0
    v_mov_b32 v134, 0
    v_mov_b32 v135, 0
    v_mul_f32 v136, 1069066811, v137
    v_mul_f32 v138, 1069066811, v139
    v_mul_f32 v140, 1069066811, v141
    v_mul_f32 v142, 1069066811, v143
    s_waitcnt lgkmcnt(0)
    v_pk_fma_f32 v[32:33], v[244:245], v[144:145], v[32:33] op_sel:[0,0,0] op_sel_hi:[0,1,1] neg_lo:[1,0,0] neg_hi:[1,0,0]
    v_pk_fma_f32 v[34:35], v[244:245], v[146:147], v[34:35] op_sel:[0,0,0] op_sel_hi:[0,1,1] neg_lo:[1,0,0] neg_hi:[1,0,0]
    v_pk_fma_f32 v[48:49], v[244:245], v[148:149], v[48:49] op_sel:[0,0,0] op_sel_hi:[0,1,1] neg_lo:[1,0,0] neg_hi:[1,0,0]
    v_pk_fma_f32 v[50:51], v[244:245], v[150:151], v[50:51] op_sel:[0,0,0] op_sel_hi:[0,1,1] neg_lo:[1,0,0] neg_hi:[1,0,0]
    v_pk_fma_f32 v[64:65], v[244:245], v[152:153], v[64:65] op_sel:[0,0,0] op_sel_hi:[0,1,1] neg_lo:[1,0,0] neg_hi:[1,0,0]
    v_pk_fma_f32 v[66:67], v[244:245], v[154:155], v[66:67] op_sel:[0,0,0] op_sel_hi:[0,1,1] neg_lo:[1,0,0] neg_hi:[1,0,0]
    v_pk_fma_f32 v[80:81], v[244:245], v[156:157], v[80:81] op_sel:[0,0,0] op_sel_hi:[0,1,1] neg_lo:[1,0,0] neg_hi:[1,0,0]
    v_pk_fma_f32 v[82:83], v[244:245], v[158:159], v[82:83] op_sel:[0,0,0] op_sel_hi:[0,1,1] neg_lo:[1,0,0] neg_hi:[1,0,0]
    v_pk_fma_f32 v[96:97], v[244:245], v[160:161], v[96:97] op_sel:[0,0,0] op_sel_hi:[0,1,1] neg_lo:[1,0,0] neg_hi:[1,0,0]
    v_pk_fma_f32 v[98:99], v[244:245], v[162:163], v[98:99] op_sel:[0,0,0] op_sel_hi:[0,1,1] neg_lo:[1,0,0] neg_hi:[1,0,0]
    v_cvt_pk_bf16_f32 v168, v32, v33
    v_cvt_pk_bf16_f32 v169, v34, v35
    v_cvt_pk_bf16_f32 v170, v48, v49
    v_cvt_pk_bf16_f32 v171, v50, v51
    v_cvt_pk_bf16_f32 v172, v64, v65
    v_cvt_pk_bf16_f32 v173, v66, v67
    v_cvt_pk_bf16_f32 v174, v80, v81
    v_cvt_pk_bf16_f32 v175, v82, v83
    v_cvt_pk_bf16_f32 v176, v96, v97
    v_cvt_pk_bf16_f32 v177, v98, v99
    v_mfma_f32_16x16x32_bf16 v[32:35], v[184:187], v[168:171], 0
    v_pk_fma_f32 v[36:37], v[246:247], v[144:145], v[36:37] op_sel:[0,0,0] op_sel_hi:[0,1,1] neg_lo:[1,0,0] neg_hi:[1,0,0]
    v_pk_fma_f32 v[38:39], v[246:247], v[146:147], v[38:39] op_sel:[0,0,0] op_sel_hi:[0,1,1] neg_lo:[1,0,0] neg_hi:[1,0,0]
    v_mfma_f32_16x16x32_bf16 v[48:51], v[196:199], v[168:171], 0
    v_pk_fma_f32 v[52:53], v[246:247], v[148:149], v[52:53] op_sel:[0,0,0] op_sel_hi:[0,1,1] neg_lo:[1,0,0] neg_hi:[1,0,0]
    v_mfma_f32_16x16x32_bf16 v[64:67], v[208:211], v[168:171], 0
    v_pk_fma_f32 v[54:55], v[246:247], v[150:151], v[54:55] op_sel:[0,0,0] op_sel_hi:[0,1,1] neg_lo:[1,0,0] neg_hi:[1,0,0]
    v_mfma_f32_16x16x32_bf16 v[80:83], v[220:223], v[168:171], 0
    v_pk_fma_f32 v[68:69], v[246:247], v[152:153], v[68:69] op_sel:[0,0,0] op_sel_hi:[0,1,1] neg_lo:[1,0,0] neg_hi:[1,0,0]
    v_pk_fma_f32 v[70:71], v[246:247], v[154:155], v[70:71] op_sel:[0,0,0] op_sel_hi:[0,1,1] neg_lo:[1,0,0] neg_hi:[1,0,0]
    v_mfma_f32_16x16x32_bf16 v[96:99], v[232:235], v[168:171], 0
    v_pk_fma_f32 v[84:85], v[246:247], v[156:157], v[84:85] op_sel:[0,0,0] op_sel_hi:[0,1,1] neg_lo:[1,0,0] neg_hi:[1,0,0]
    v_mfma_f32_16x16x32_bf16 v[32:35], v[188:191], v[172:175], v[32:35]
    v_pk_fma_f32 v[86:87], v[246:247], v[158:159], v[86:87] op_sel:[0,0,0] op_sel_hi:[0,1,1] neg_lo:[1,0,0] neg_hi:[1,0,0]
    v_mfma_f32_16x16x32_bf16 v[48:51], v[200:203], v[172:175], v[48:51]
    v_pk_fma_f32 v[100:101], v[246:247], v[160:161], v[100:101] op_sel:[0,0,0] op_sel_hi:[0,1,1] neg_lo:[1,0,0] neg_hi:[1,0,0]
    v_pk_fma_f32 v[102:103], v[246:247], v[162:163], v[102:103] op_sel:[0,0,0] op_sel_hi:[0,1,1] neg_lo:[1,0,0] neg_hi:[1,0,0]
    v_mfma_f32_16x16x32_bf16 v[64:67], v[212:215], v[172:175], v[64:67]
    v_cvt_pk_bf16_f32 v112, v36, v37
    v_mfma_f32_16x16x32_bf16 v[80:83], v[224:227], v[172:175], v[80:83]
    v_cvt_pk_bf16_f32 v113, v38, v39
    v_mfma_f32_16x16x32_bf16 v[96:99], v[236:239], v[172:175], v[96:99]
    v_cvt_pk_bf16_f32 v114, v52, v53
    v_cvt_pk_bf16_f32 v115, v54, v55
    v_mfma_f32_16x16x32_bf16 v[32:35], v[192:195], v[176:179], v[32:35]
    v_cvt_pk_bf16_f32 v116, v68, v69
    v_mfma_f32_16x16x32_bf16 v[48:51], v[204:207], v[176:179], v[48:51]
    v_cvt_pk_bf16_f32 v117, v70, v71
    v_mfma_f32_16x16x32_bf16 v[64:67], v[216:219], v[176:179], v[64:67]
    v_cvt_pk_bf16_f32 v118, v84, v85
    v_cvt_pk_bf16_f32 v119, v86, v87
    v_mfma_f32_16x16x32_bf16 v[80:83], v[228:231], v[176:179], v[80:83]
    v_cvt_pk_bf16_f32 v120, v100, v101
    v_mfma_f32_16x16x32_bf16 v[96:99], v[240:243], v[176:179], v[96:99]
    v_cvt_pk_bf16_f32 v121, v102, v103
    v_mfma_f32_16x16x32_bf16 v[36:39], v[184:187], v[112:115], 0
    v_pk_fma_f32 v[40:41], v[248:249], v[144:145], v[40:41] op_sel:[0,0,0] op_sel_hi:[0,1,1] neg_lo:[1,0,0] neg_hi:[1,0,0]
    v_pk_fma_f32 v[42:43], v[248:249], v[146:147], v[42:43] op_sel:[0,0,0] op_sel_hi:[0,1,1] neg_lo:[1,0,0] neg_hi:[1,0,0]
    v_mfma_f32_16x16x32_bf16 v[52:55], v[196:199], v[112:115], 0
    v_pk_fma_f32 v[56:57], v[248:249], v[148:149], v[56:57] op_sel:[0,0,0] op_sel_hi:[0,1,1] neg_lo:[1,0,0] neg_hi:[1,0,0]
    v_mfma_f32_16x16x32_bf16 v[68:71], v[208:211], v[112:115], 0
    v_pk_fma_f32 v[58:59], v[248:249], v[150:151], v[58:59] op_sel:[0,0,0] op_sel_hi:[0,1,1] neg_lo:[1,0,0] neg_hi:[1,0,0]
    v_mfma_f32_16x16x32_bf16 v[84:87], v[220:223], v[112:115], 0
    v_pk_fma_f32 v[72:73], v[248:249], v[152:153], v[72:73] op_sel:[0,0,0] op_sel_hi:[0,1,1] neg_lo:[1,0,0] neg_hi:[1,0,0]
    v_pk_fma_f32 v[74:75], v[248:249], v[154:155], v[74:75] op_sel:[0,0,0] op_sel_hi:[0,1,1] neg_lo:[1,0,0] neg_hi:[1,0,0]
    v_mfma_f32_16x16x32_bf16 v[100:103], v[232:235], v[112:115], 0
    v_pk_fma_f32 v[88:89], v[248:249], v[156:157], v[88:89] op_sel:[0,0,0] op_sel_hi:[0,1,1] neg_lo:[1,0,0] neg_hi:[1,0,0]
    v_mfma_f32_16x16x32_bf16 v[36:39], v[188:191], v[116:119], v[36:39]
    v_pk_fma_f32 v[90:91], v[248:249], v[158:159], v[90:91] op_sel:[0,0,0] op_sel_hi:[0,1,1] neg_lo:[1,0,0] neg_hi:[1,0,0]
    v_mfma_f32_16x16x32_bf16 v[52:55], v[200:203], v[116:119], v[52:55]
    v_pk_fma_f32 v[104:105], v[248:249], v[160:161], v[104:105] op_sel:[0,0,0] op_sel_hi:[0,1,1] neg_lo:[1,0,0] neg_hi:[1,0,0]
    v_pk_fma_f32 v[106:107], v[248:249], v[162:163], v[106:107] op_sel:[0,0,0] op_sel_hi:[0,1,1] neg_lo:[1,0,0] neg_hi:[1,0,0]
    v_mfma_f32_16x16x32_bf16 v[68:71], v[212:215], v[116:119], v[68:71]
    v_cvt_pk_bf16_f32 v124, v40, v41
    v_mfma_f32_16x16x32_bf16 v[84:87], v[224:227], v[116:119], v[84:87]
    v_cvt_pk_bf16_f32 v125, v42, v43
    v_mfma_f32_16x16x32_bf16 v[100:103], v[236:239], v[116:119], v[100:103]
    v_cvt_pk_bf16_f32 v126, v56, v57
    v_cvt_pk_bf16_f32 v127, v58, v59
    v_mfma_f32_16x16x32_bf16 v[36:39], v[192:195], v[120:123], v[36:39]
    v_cvt_pk_bf16_f32 v128, v72, v73
    v_mfma_f32_16x16x32_bf16 v[52:55], v[204:207], v[120:123], v[52:55]
    v_cvt_pk_bf16_f32 v129, v74, v75
    v_mfma_f32_16x16x32_bf16 v[68:71], v[216:219], v[120:123], v[68:71]
    v_cvt_pk_bf16_f32 v130, v88, v89
    v_cvt_pk_bf16_f32 v131, v90, v91
    v_mfma_f32_16x16x32_bf16 v[84:87], v[228:231], v[120:123], v[84:87]
    v_cvt_pk_bf16_f32 v132, v104, v105
    v_mfma_f32_16x16x32_bf16 v[100:103], v[240:243], v[120:123], v[100:103]
    v_cvt_pk_bf16_f32 v133, v106, v107
    v_mfma_f32_16x16x32_bf16 v[40:43], v[184:187], v[124:127], 0
    v_pk_fma_f32 v[44:45], v[250:251], v[144:145], v[44:45] op_sel:[0,0,0] op_sel_hi:[0,1,1] neg_lo:[1,0,0] neg_hi:[1,0,0]
    v_pk_fma_f32 v[46:47], v[250:251], v[146:147], v[46:47] op_sel:[0,0,0] op_sel_hi:[0,1,1] neg_lo:[1,0,0] neg_hi:[1,0,0]
    v_mfma_f32_16x16x32_bf16 v[56:59], v[196:199], v[124:127], 0
    v_pk_fma_f32 v[60:61], v[250:251], v[148:149], v[60:61] op_sel:[0,0,0] op_sel_hi:[0,1,1] neg_lo:[1,0,0] neg_hi:[1,0,0]
    v_mfma_f32_16x16x32_bf16 v[72:75], v[208:211], v[124:127], 0
    v_pk_fma_f32 v[62:63], v[250:251], v[150:151], v[62:63] op_sel:[0,0,0] op_sel_hi:[0,1,1] neg_lo:[1,0,0] neg_hi:[1,0,0]
    v_mfma_f32_16x16x32_bf16 v[88:91], v[220:223], v[124:127], 0
    v_pk_fma_f32 v[76:77], v[250:251], v[152:153], v[76:77] op_sel:[0,0,0] op_sel_hi:[0,1,1] neg_lo:[1,0,0] neg_hi:[1,0,0]
    v_pk_fma_f32 v[78:79], v[250:251], v[154:155], v[78:79] op_sel:[0,0,0] op_sel_hi:[0,1,1] neg_lo:[1,0,0] neg_hi:[1,0,0]
    v_mfma_f32_16x16x32_bf16 v[104:107], v[232:235], v[124:127], 0
    v_pk_fma_f32 v[92:93], v[250:251], v[156:157], v[92:93] op_sel:[0,0,0] op_sel_hi:[0,1,1] neg_lo:[1,0,0] neg_hi:[1,0,0]
    v_mfma_f32_16x16x32_bf16 v[40:43], v[188:191], v[128:131], v[40:43]
    v_pk_fma_f32 v[94:95], v[250:251], v[158:159], v[94:95] op_sel:[0,0,0] op_sel_hi:[0,1,1] neg_lo:[1,0,0] neg_hi:[1,0,0]
    v_mfma_f32_16x16x32_bf16 v[56:59], v[200:203], v[128:131], v[56:59]
    v_pk_fma_f32 v[108:109], v[250:251], v[160:161], v[108:109] op_sel:[0,0,0] op_sel_hi:[0,1,1] neg_lo:[1,0,0] neg_hi:[1,0,0]
    v_pk_fma_f32 v[110:111], v[250:251], v[162:163], v[110:111] op_sel:[0,0,0] op_sel_hi:[0,1,1] neg_lo:[1,0,0] neg_hi:[1,0,0]
    v_mfma_f32_16x16x32_bf16 v[72:75], v[212:215], v[128:131], v[72:75]
    v_cvt_pk_bf16_f32 v168, v44, v45
    v_mfma_f32_16x16x32_bf16 v[88:91], v[224:227], v[128:131], v[88:91]
    v_cvt_pk_bf16_f32 v169, v46, v47
    v_mfma_f32_16x16x32_bf16 v[104:107], v[236:239], v[128:131], v[104:107]
    v_cvt_pk_bf16_f32 v170, v60, v61
    v_cvt_pk_bf16_f32 v171, v62, v63
    v_mfma_f32_16x16x32_bf16 v[40:43], v[192:195], v[132:135], v[40:43]
    v_cvt_pk_bf16_f32 v172, v76, v77
    v_mfma_f32_16x16x32_bf16 v[56:59], v[204:207], v[132:135], v[56:59]
    v_cvt_pk_bf16_f32 v173, v78, v79
    v_mfma_f32_16x16x32_bf16 v[72:75], v[216:219], v[132:135], v[72:75]
    v_cvt_pk_bf16_f32 v174, v92, v93
    v_cvt_pk_bf16_f32 v175, v94, v95
    v_mfma_f32_16x16x32_bf16 v[88:91], v[228:231], v[132:135], v[88:91]
    v_cvt_pk_bf16_f32 v176, v108, v109
    v_mfma_f32_16x16x32_bf16 v[104:107], v[240:243], v[132:135], v[104:107]
    v_cvt_pk_bf16_f32 v177, v110, v111
    v_max3_f32 v164, v32, v33, v34
    v_mfma_f32_16x16x32_bf16 v[44:47], v[184:187], v[168:171], 0
    v_max3_f32 v165, v35, v48, v49
    v_max3_f32 v164, v164, v50, v51
    v_mfma_f32_16x16x32_bf16 v[60:63], v[196:199], v[168:171], 0
    v_max3_f32 v165, v165, v64, v65
    v_max3_f32 v164, v164, v66, v67
    v_max3_f32 v165, v165, v80, v81
    v_mfma_f32_16x16x32_bf16 v[76:79], v[208:211], v[168:171], 0
    v_max3_f32 v164, v164, v82, v83
    v_max3_f32 v165, v165, v96, v97
    v_max3_f32 v164, v164, v98, v99
    v_mfma_f32_16x16x32_bf16 v[92:95], v[220:223], v[168:171], 0
    v_max_f32 v164, v164, v165
    v_mul_f32 v164, v164, v136
    v_mfma_f32_16x16x32_bf16 v[108:111], v[232:235], v[168:171], 0
    v_pk_fma_f32 v[144:145], v[32:33], v[136:137], v[164:165] op_sel:[0,0,0] op_sel_hi:[1,0,0] neg_lo:[0,0,1] neg_hi:[0,0,1]
    v_pk_fma_f32 v[146:147], v[34:35], v[136:137], v[164:165] op_sel:[0,0,0] op_sel_hi:[1,0,0] neg_lo:[0,0,1] neg_hi:[0,0,1]
    v_pk_fma_f32 v[148:149], v[48:49], v[136:137], v[164:165] op_sel:[0,0,0] op_sel_hi:[1,0,0] neg_lo:[0,0,1] neg_hi:[0,0,1]
    v_mfma_f32_16x16x32_bf16 v[44:47], v[188:191], v[172:175], v[44:47]
    v_pk_fma_f32 v[150:151], v[50:51], v[136:137], v[164:165] op_sel:[0,0,0] op_sel_hi:[1,0,0] neg_lo:[0,0,1] neg_hi:[0,0,1]
    v_pk_fma_f32 v[152:153], v[64:65], v[136:137], v[164:165] op_sel:[0,0,0] op_sel_hi:[1,0,0] neg_lo:[0,0,1] neg_hi:[0,0,1]
    v_pk_fma_f32 v[154:155], v[66:67], v[136:137], v[164:165] op_sel:[0,0,0] op_sel_hi:[1,0,0] neg_lo:[0,0,1] neg_hi:[0,0,1]
    v_mfma_f32_16x16x32_bf16 v[60:63], v[200:203], v[172:175], v[60:63]
    v_pk_fma_f32 v[156:157], v[80:81], v[136:137], v[164:165] op_sel:[0,0,0] op_sel_hi:[1,0,0] neg_lo:[0,0,1] neg_hi:[0,0,1]
    v_pk_fma_f32 v[158:159], v[82:83], v[136:137], v[164:165] op_sel:[0,0,0] op_sel_hi:[1,0,0] neg_lo:[0,0,1] neg_hi:[0,0,1]
    v_mfma_f32_16x16x32_bf16 v[76:79], v[212:215], v[172:175], v[76:79]
    v_pk_fma_f32 v[160:161], v[96:97], v[136:137], v[164:165] op_sel:[0,0,0] op_sel_hi:[1,0,0] neg_lo:[0,0,1] neg_hi:[0,0,1]
    v_pk_fma_f32 v[162:163], v[98:99], v[136:137], v[164:165] op_sel:[0,0,0] op_sel_hi:[1,0,0] neg_lo:[0,0,1] neg_hi:[0,0,1]
    v_exp_f32 v144, v144
    v_mfma_f32_16x16x32_bf16 v[92:95], v[224:227], v[172:175], v[92:95]
    v_exp_f32 v145, v145
    v_exp_f32 v146, v146
    v_exp_f32 v147, v147
    v_mfma_f32_16x16x32_bf16 v[108:111], v[236:239], v[172:175], v[108:111]
    v_exp_f32 v148, v148
    v_exp_f32 v149, v149
    v_mfma_f32_16x16x32_bf16 v[44:47], v[192:195], v[176:179], v[44:47]
    v_exp_f32 v150, v150
    v_exp_f32 v151, v151
    v_exp_f32 v152, v152
    v_mfma_f32_16x16x32_bf16 v[60:63], v[204:207], v[176:179], v[60:63]
    v_exp_f32 v153, v153
    v_exp_f32 v154, v154
    v_exp_f32 v155, v155
    v_mfma_f32_16x16x32_bf16 v[76:79], v[216:219], v[176:179], v[76:79]
    v_exp_f32 v156, v156
    v_exp_f32 v157, v157
    v_mfma_f32_16x16x32_bf16 v[92:95], v[228:231], v[176:179], v[92:95]
    v_exp_f32 v158, v158
    v_exp_f32 v159, v159
    v_exp_f32 v160, v160
    v_mfma_f32_16x16x32_bf16 v[108:111], v[240:243], v[176:179], v[108:111]
    v_exp_f32 v161, v161
    v_exp_f32 v162, v162
    v_exp_f32 v163, v163
    v_pk_add_f32 v[166:167], v[144:145], v[146:147]
    v_pk_add_f32 v[164:165], v[148:149], v[150:151]
    v_pk_add_f32 v[166:167], v[166:167], v[152:153]
    v_pk_add_f32 v[164:165], v[164:165], v[154:155]
    v_pk_add_f32 v[166:167], v[166:167], v[156:157]
    v_pk_add_f32 v[164:165], v[164:165], v[158:159]
    v_pk_add_f32 v[166:167], v[166:167], v[160:161]
    v_pk_add_f32 v[164:165], v[164:165], v[162:163]
    v_pk_add_f32 v[166:167], v[166:167], v[164:165]
    v_add_f32 v166, v166, v167
    v_rcp_f32 v166, v166
    s_nop 0
    v_mul_f32 v166, v166, v137
    v_pk_mul_f32 v[144:145], v[144:145], v[166:167] op_sel:[0,0] op_sel_hi:[1,0]
    v_pk_mul_f32 v[146:147], v[146:147], v[166:167] op_sel:[0,0] op_sel_hi:[1,0]
    v_pk_mul_f32 v[148:149], v[148:149], v[166:167] op_sel:[0,0] op_sel_hi:[1,0]
    v_pk_mul_f32 v[150:151], v[150:151], v[166:167] op_sel:[0,0] op_sel_hi:[1,0]
    v_pk_mul_f32 v[152:153], v[152:153], v[166:167] op_sel:[0,0] op_sel_hi:[1,0]
    v_pk_mul_f32 v[154:155], v[154:155], v[166:167] op_sel:[0,0] op_sel_hi:[1,0]
    v_pk_mul_f32 v[156:157], v[156:157], v[166:167] op_sel:[0,0] op_sel_hi:[1,0]
    v_pk_mul_f32 v[158:159], v[158:159], v[166:167] op_sel:[0,0] op_sel_hi:[1,0]
    v_pk_mul_f32 v[160:161], v[160:161], v[166:167] op_sel:[0,0] op_sel_hi:[1,0]
    v_pk_mul_f32 v[162:163], v[162:163], v[166:167] op_sel:[0,0] op_sel_hi:[1,0]
    v_cvt_pk_bf16_f32 v112, v144, v145
    v_cvt_pk_bf16_f32 v113, v146, v147
    v_cvt_pk_bf16_f32 v114, v148, v149
    v_cvt_pk_bf16_f32 v115, v150, v151
    v_cvt_pk_bf16_f32 v116, v152, v153
    v_cvt_pk_bf16_f32 v117, v154, v155
    v_cvt_pk_bf16_f32 v118, v156, v157
    v_cvt_pk_bf16_f32 v119, v158, v159
    v_cvt_pk_bf16_f32 v120, v160, v161
    v_cvt_pk_bf16_f32 v121, v162, v163
    s_barrier
    v_min3_f32 v164, v32, v33, v34
    ds_write_b128 v16, v[112:115] offset:0
    v_min3_f32 v165, v35, v48, v49
    v_min3_f32 v164, v164, v50, v51
    v_min3_f32 v165, v165, v64, v65
    v_min3_f32 v164, v164, v66, v67
    v_min3_f32 v165, v165, v80, v81
    v_min3_f32 v164, v164, v82, v83
    ds_write_b128 v16, v[116:119] offset:16
    v_min3_f32 v165, v165, v96, v97
    v_min3_f32 v164, v164, v98, v99
    v_min_f32 v164, v164, v165
    v_mul_f32 v164, v164, v136
    v_pk_fma_f32 v[144:145], v[32:33], v[136:137], v[164:165] op_sel:[0,0,0] op_sel_hi:[1,0,0] neg_lo:[0,1,0] neg_hi:[0,1,0]
    v_pk_fma_f32 v[146:147], v[34:35], v[136:137], v[164:165] op_sel:[0,0,0] op_sel_hi:[1,0,0] neg_lo:[0,1,0] neg_hi:[0,1,0]
    v_pk_fma_f32 v[148:149], v[48:49], v[136:137], v[164:165] op_sel:[0,0,0] op_sel_hi:[1,0,0] neg_lo:[0,1,0] neg_hi:[0,1,0]
    s_cmp_eq_u32 s31, 3
    s_cbranch_scc0 KVK_0_0
    s_add_u32 s48, s28, 0
    buffer_load_dwordx4 v[184:187], v8, s[20:23], s48 offen offset:0 sc1
    KVK_0_0:
    v_pk_fma_f32 v[150:151], v[50:51], v[136:137], v[164:165] op_sel:[0,0,0] op_sel_hi:[1,0,0] neg_lo:[0,1,0] neg_hi:[0,1,0]
    v_pk_fma_f32 v[152:153], v[64:65], v[136:137], v[164:165] op_sel:[0,0,0] op_sel_hi:[1,0,0] neg_lo:[0,1,0] neg_hi:[0,1,0]
    v_pk_fma_f32 v[154:155], v[66:67], v[136:137], v[164:165] op_sel:[0,0,0] op_sel_hi:[1,0,0] neg_lo:[0,1,0] neg_hi:[0,1,0]
    v_pk_fma_f32 v[156:157], v[80:81], v[136:137], v[164:165] op_sel:[0,0,0] op_sel_hi:[1,0,0] neg_lo:[0,1,0] neg_hi:[0,1,0]
    v_pk_fma_f32 v[158:159], v[82:83], v[136:137], v[164:165] op_sel:[0,0,0] op_sel_hi:[1,0,0] neg_lo:[0,1,0] neg_hi:[0,1,0]
    v_pk_fma_f32 v[160:161], v[96:97], v[136:137], v[164:165] op_sel:[0,0,0] op_sel_hi:[1,0,0] neg_lo:[0,1,0] neg_hi:[0,1,0]
    v_pk_fma_f32 v[162:163], v[98:99], v[136:137], v[164:165] op_sel:[0,0,0] op_sel_hi:[1,0,0] neg_lo:[0,1,0] neg_hi:[0,1,0]
    s_cmp_eq_u32 s31, 3
    s_cbranch_scc0 KVK_0_1
    buffer_load_dwordx4 v[188:191], v8, s[20:23], s48 offen offset:1024 sc1
    KVK_0_1:
    v_exp_f32 v144, v144
    v_exp_f32 v145, v145
    v_exp_f32 v146, v146
    v_exp_f32 v147, v147
    v_exp_f32 v148, v148
    v_exp_f32 v149, v149
    s_cmp_eq_u32 s31, 3
    s_cbranch_scc0 KVK_0_2
    buffer_load_dwordx4 v[192:195], v8, s[20:23], s48 offen offset:2048 sc1
    KVK_0_2:
    v_exp_f32 v150, v150
    v_exp_f32 v151, v151
    v_exp_f32 v152, v152
    v_exp_f32 v153, v153
    v_exp_f32 v154, v154
    v_exp_f32 v155, v155
    v_exp_f32 v156, v156
    s_cmp_eq_u32 s31, 3
    s_cbranch_scc0 KVK_0_3
    buffer_load_dwordx4 v[196:199], v8, s[20:23], s48 offen offset:3072 sc1
    KVK_0_3:
    v_exp_f32 v157, v157
    v_exp_f32 v158, v158
    v_exp_f32 v159, v159
    v_exp_f32 v160, v160
    v_exp_f32 v161, v161
    v_exp_f32 v162, v162
    v_exp_f32 v163, v163
    v_pk_add_f32 v[166:167], v[144:145], v[146:147]
    v_pk_add_f32 v[164:165], v[148:149], v[150:151]
    v_pk_add_f32 v[166:167], v[166:167], v[152:153]
    v_pk_add_f32 v[164:165], v[164:165], v[154:155]
    v_pk_add_f32 v[166:167], v[166:167], v[156:157]
    v_pk_add_f32 v[164:165], v[164:165], v[158:159]
    v_pk_add_f32 v[166:167], v[166:167], v[160:161]
    v_pk_add_f32 v[164:165], v[164:165], v[162:163]
    v_pk_add_f32 v[166:167], v[166:167], v[164:165]
    v_add_f32 v166, v166, v167
    v_rcp_f32 v166, v166
    s_nop 0
    v_mul_f32 v166, v166, v137
    v_pk_mul_f32 v[144:145], v[144:145], v[166:167] op_sel:[0,0] op_sel_hi:[1,0]
    v_pk_mul_f32 v[146:147], v[146:147], v[166:167] op_sel:[0,0] op_sel_hi:[1,0]
    v_pk_mul_f32 v[148:149], v[148:149], v[166:167] op_sel:[0,0] op_sel_hi:[1,0]
    v_pk_mul_f32 v[150:151], v[150:151], v[166:167] op_sel:[0,0] op_sel_hi:[1,0]
    v_pk_mul_f32 v[152:153], v[152:153], v[166:167] op_sel:[0,0] op_sel_hi:[1,0]
    v_pk_mul_f32 v[154:155], v[154:155], v[166:167] op_sel:[0,0] op_sel_hi:[1,0]
    v_pk_mul_f32 v[156:157], v[156:157], v[166:167] op_sel:[0,0] op_sel_hi:[1,0]
    v_pk_mul_f32 v[158:159], v[158:159], v[166:167] op_sel:[0,0] op_sel_hi:[1,0]
    v_pk_mul_f32 v[160:161], v[160:161], v[166:167] op_sel:[0,0] op_sel_hi:[1,0]
    v_pk_mul_f32 v[162:163], v[162:163], v[166:167] op_sel:[0,0] op_sel_hi:[1,0]
    v_cvt_pk_bf16_f32 v122, v144, v145
    v_cvt_pk_bf16_f32 v123, v146, v147
    v_cvt_pk_bf16_f32 v124, v148, v149
    v_cvt_pk_bf16_f32 v125, v150, v151
    v_cvt_pk_bf16_f32 v126, v152, v153
    v_cvt_pk_bf16_f32 v127, v154, v155
    v_cvt_pk_bf16_f32 v128, v156, v157
    v_cvt_pk_bf16_f32 v129, v158, v159
    v_cvt_pk_bf16_f32 v130, v160, v161
    v_cvt_pk_bf16_f32 v131, v162, v163
    v_max3_f32 v164, v36, v37, v38
    ds_write_b128 v16, v[120:123] offset:32
    v_max3_f32 v165, v39, v52, v53
    v_max3_f32 v164, v164, v54, v55
    v_max3_f32 v165, v165, v68, v69
    v_max3_f32 v164, v164, v70, v71
    ds_write_b128 v16, v[124:127] offset:48
    v_max3_f32 v165, v165, v84, v85
    v_max3_f32 v164, v164, v86, v87
    v_max3_f32 v165, v165, v100, v101
    v_max3_f32 v164, v164, v102, v103
    ds_write_b128 v16, v[128:131] offset:64
    v_max_f32 v164, v164, v165
    v_mul_f32 v164, v164, v138
    v_pk_fma_f32 v[144:145], v[36:37], v[138:139], v[164:165] op_sel:[0,0,0] op_sel_hi:[1,0,0] neg_lo:[0,0,1] neg_hi:[0,0,1]
    v_pk_fma_f32 v[146:147], v[38:39], v[138:139], v[164:165] op_sel:[0,0,0] op_sel_hi:[1,0,0] neg_lo:[0,0,1] neg_hi:[0,0,1]
    v_pk_fma_f32 v[148:149], v[52:53], v[138:139], v[164:165] op_sel:[0,0,0] op_sel_hi:[1,0,0] neg_lo:[0,0,1] neg_hi:[0,0,1]
    s_waitcnt lgkmcnt(0)
    v_pk_fma_f32 v[150:151], v[54:55], v[138:139], v[164:165] op_sel:[0,0,0] op_sel_hi:[1,0,0] neg_lo:[0,0,1] neg_hi:[0,0,1]
    v_pk_fma_f32 v[152:153], v[68:69], v[138:139], v[164:165] op_sel:[0,0,0] op_sel_hi:[1,0,0] neg_lo:[0,0,1] neg_hi:[0,0,1]
    v_pk_fma_f32 v[154:155], v[70:71], v[138:139], v[164:165] op_sel:[0,0,0] op_sel_hi:[1,0,0] neg_lo:[0,0,1] neg_hi:[0,0,1]
    v_pk_fma_f32 v[156:157], v[84:85], v[138:139], v[164:165] op_sel:[0,0,0] op_sel_hi:[1,0,0] neg_lo:[0,0,1] neg_hi:[0,0,1]
    s_barrier
    v_pk_fma_f32 v[158:159], v[86:87], v[138:139], v[164:165] op_sel:[0,0,0] op_sel_hi:[1,0,0] neg_lo:[0,0,1] neg_hi:[0,0,1]
    v_pk_fma_f32 v[160:161], v[100:101], v[138:139], v[164:165] op_sel:[0,0,0] op_sel_hi:[1,0,0] neg_lo:[0,0,1] neg_hi:[0,0,1]
    v_pk_fma_f32 v[162:163], v[102:103], v[138:139], v[164:165] op_sel:[0,0,0] op_sel_hi:[1,0,0] neg_lo:[0,0,1] neg_hi:[0,0,1]
    v_exp_f32 v144, v144
    v_exp_f32 v145, v145
    s_cmp_eq_u32 s31, 3
    s_cbranch_scc0 KVK_0_4
    buffer_load_dwordx4 v[200:203], v9, s[20:23], s48 offen offset:0 sc1
    KVK_0_4:
    v_exp_f32 v146, v146
    v_exp_f32 v147, v147
    v_exp_f32 v148, v148
    v_exp_f32 v149, v149
    s_cmp_eq_u32 s31, 3
    s_cbranch_scc0 KVK_1_0
    s_add_u32 s48, s28, 5120
    buffer_load_dwordx4 v[204:207], v8, s[20:23], s48 offen offset:0 sc1
    KVK_1_0:
    v_exp_f32 v150, v150
    v_exp_f32 v151, v151
    v_exp_f32 v152, v152
    v_exp_f32 v153, v153
    v_exp_f32 v154, v154
    s_cmp_eq_u32 s31, 3
    s_cbranch_scc0 KVK_1_1
    buffer_load_dwordx4 v[208:211], v8, s[20:23], s48 offen offset:1024 sc1
    KVK_1_1:
    v_exp_f32 v155, v155
    v_exp_f32 v156, v156
    v_exp_f32 v157, v157
    v_exp_f32 v158, v158
    s_cmp_eq_u32 s31, 3
    s_cbranch_scc0 KVK_1_2
    buffer_load_dwordx4 v[212:215], v8, s[20:23], s48 offen offset:2048 sc1
    KVK_1_2:
    v_exp_f32 v159, v159
    v_exp_f32 v160, v160
    v_exp_f32 v161, v161
    v_exp_f32 v162, v162
    v_exp_f32 v163, v163
    v_pk_add_f32 v[166:167], v[144:145], v[146:147]
    v_pk_add_f32 v[164:165], v[148:149], v[150:151]
    v_pk_add_f32 v[166:167], v[166:167], v[152:153]
    v_pk_add_f32 v[164:165], v[164:165], v[154:155]
    v_pk_add_f32 v[166:167], v[166:167], v[156:157]
    v_pk_add_f32 v[164:165], v[164:165], v[158:159]
    v_pk_add_f32 v[166:167], v[166:167], v[160:161]
    v_pk_add_f32 v[164:165], v[164:165], v[162:163]
    v_pk_add_f32 v[166:167], v[166:167], v[164:165]
    v_add_f32 v166, v166, v167
    v_rcp_f32 v166, v166
    s_nop 0
    v_mul_f32 v166, v166, v139
    v_pk_mul_f32 v[144:145], v[144:145], v[166:167] op_sel:[0,0] op_sel_hi:[1,0]
    v_pk_mul_f32 v[146:147], v[146:147], v[166:167] op_sel:[0,0] op_sel_hi:[1,0]
    v_pk_mul_f32 v[148:149], v[148:149], v[166:167] op_sel:[0,0] op_sel_hi:[1,0]
    v_pk_mul_f32 v[150:151], v[150:151], v[166:167] op_sel:[0,0] op_sel_hi:[1,0]
    v_pk_mul_f32 v[152:153], v[152:153], v[166:167] op_sel:[0,0] op_sel_hi:[1,0]
    v_pk_mul_f32 v[154:155], v[154:155], v[166:167] op_sel:[0,0] op_sel_hi:[1,0]
    v_pk_mul_f32 v[156:157], v[156:157], v[166:167] op_sel:[0,0] op_sel_hi:[1,0]
    v_pk_mul_f32 v[158:159], v[158:159], v[166:167] op_sel:[0,0] op_sel_hi:[1,0]
    v_pk_mul_f32 v[160:161], v[160:161], v[166:167] op_sel:[0,0] op_sel_hi:[1,0]
    v_pk_mul_f32 v[162:163], v[162:163], v[166:167] op_sel:[0,0] op_sel_hi:[1,0]
    v_cvt_pk_bf16_f32 v168, v144, v145
    v_cvt_pk_bf16_f32 v169, v146, v147
    v_cvt_pk_bf16_f32 v170, v148, v149
    v_cvt_pk_bf16_f32 v171, v150, v151
    v_cvt_pk_bf16_f32 v172, v152, v153
    v_cvt_pk_bf16_f32 v173, v154, v155
    v_cvt_pk_bf16_f32 v174, v156, v157
    v_cvt_pk_bf16_f32 v175, v158, v159
    v_cvt_pk_bf16_f32 v176, v160, v161
    v_cvt_pk_bf16_f32 v177, v162, v163
    v_min3_f32 v164, v36, v37, v38
    ds_write_b128 v16, v[168:171] offset:33792
    v_min3_f32 v165, v39, v52, v53
    v_min3_f32 v164, v164, v54, v55
    v_min3_f32 v165, v165, v68, v69
    v_min3_f32 v164, v164, v70, v71
    v_min3_f32 v165, v165, v84, v85
    v_min3_f32 v164, v164, v86, v87
    ds_write_b128 v16, v[172:175] offset:33808
    v_min3_f32 v165, v165, v100, v101
    v_min3_f32 v164, v164, v102, v103
    v_min_f32 v164, v164, v165
    v_mul_f32 v164, v164, v138
    v_pk_fma_f32 v[144:145], v[36:37], v[138:139], v[164:165] op_sel:[0,0,0] op_sel_hi:[1,0,0] neg_lo:[0,1,0] neg_hi:[0,1,0]
    v_pk_fma_f32 v[146:147], v[38:39], v[138:139], v[164:165] op_sel:[0,0,0] op_sel_hi:[1,0,0] neg_lo:[0,1,0] neg_hi:[0,1,0]
    v_pk_fma_f32 v[148:149], v[52:53], v[138:139], v[164:165] op_sel:[0,0,0] op_sel_hi:[1,0,0] neg_lo:[0,1,0] neg_hi:[0,1,0]
    s_cmp_eq_u32 s31, 3
    s_cbranch_scc0 KVK_1_3
    buffer_load_dwordx4 v[216:219], v8, s[20:23], s48 offen offset:3072 sc1
    KVK_1_3:
    v_pk_fma_f32 v[150:151], v[54:55], v[138:139], v[164:165] op_sel:[0,0,0] op_sel_hi:[1,0,0] neg_lo:[0,1,0] neg_hi:[0,1,0]
    v_pk_fma_f32 v[152:153], v[68:69], v[138:139], v[164:165] op_sel:[0,0,0] op_sel_hi:[1,0,0] neg_lo:[0,1,0] neg_hi:[0,1,0]
    v_pk_fma_f32 v[154:155], v[70:71], v[138:139], v[164:165] op_sel:[0,0,0] op_sel_hi:[1,0,0] neg_lo:[0,1,0] neg_hi:[0,1,0]
    v_pk_fma_f32 v[156:157], v[84:85], v[138:139], v[164:165] op_sel:[0,0,0] op_sel_hi:[1,0,0] neg_lo:[0,1,0] neg_hi:[0,1,0]
    v_pk_fma_f32 v[158:159], v[86:87], v[138:139], v[164:165] op_sel:[0,0,0] op_sel_hi:[1,0,0] neg_lo:[0,1,0] neg_hi:[0,1,0]
    v_pk_fma_f32 v[160:161], v[100:101], v[138:139], v[164:165] op_sel:[0,0,0] op_sel_hi:[1,0,0] neg_lo:[0,1,0] neg_hi:[0,1,0]
    v_pk_fma_f32 v[162:163], v[102:103], v[138:139], v[164:165] op_sel:[0,0,0] op_sel_hi:[1,0,0] neg_lo:[0,1,0] neg_hi:[0,1,0]
    s_cmp_eq_u32 s31, 3
    s_cbranch_scc0 KVK_1_4
    buffer_load_dwordx4 v[220:223], v9, s[20:23], s48 offen offset:0 sc1
    KVK_1_4:
    v_exp_f32 v144, v144
    v_exp_f32 v145, v145
    v_exp_f32 v146, v146
    v_exp_f32 v147, v147
    v_exp_f32 v148, v148
    v_exp_f32 v149, v149
    s_cmp_eq_u32 s31, 3
    s_cbranch_scc0 KVK_4_0
    s_add_u32 s48, s28, 20480
    buffer_load_dwordx4 v[224:227], v8, s[20:23], s48 offen offset:0 sc1
    KVK_4_0:
    v_exp_f32 v150, v150
    v_exp_f32 v151, v151
    v_exp_f32 v152, v152
    v_exp_f32 v153, v153
    v_exp_f32 v154, v154
    v_exp_f32 v155, v155
    v_exp_f32 v156, v156
    s_cmp_eq_u32 s31, 3
    s_cbranch_scc0 KVK_4_1
    buffer_load_dwordx4 v[228:231], v8, s[20:23], s48 offen offset:1024 sc1
    KVK_4_1:
    v_exp_f32 v157, v157
    v_exp_f32 v158, v158
    v_exp_f32 v159, v159
    v_exp_f32 v160, v160
    v_exp_f32 v161, v161
    v_exp_f32 v162, v162
    v_exp_f32 v163, v163
    v_pk_add_f32 v[166:167], v[144:145], v[146:147]
    v_pk_add_f32 v[164:165], v[148:149], v[150:151]
    v_pk_add_f32 v[166:167], v[166:167], v[152:153]
    v_pk_add_f32 v[164:165], v[164:165], v[154:155]
    v_pk_add_f32 v[166:167], v[166:167], v[156:157]
    v_pk_add_f32 v[164:165], v[164:165], v[158:159]
    v_pk_add_f32 v[166:167], v[166:167], v[160:161]
    v_pk_add_f32 v[164:165], v[164:165], v[162:163]
    v_pk_add_f32 v[166:167], v[166:167], v[164:165]
    v_add_f32 v166, v166, v167
    v_rcp_f32 v166, v166
    s_nop 0
    v_mul_f32 v166, v166, v139
    v_pk_mul_f32 v[144:145], v[144:145], v[166:167] op_sel:[0,0] op_sel_hi:[1,0]
    v_pk_mul_f32 v[146:147], v[146:147], v[166:167] op_sel:[0,0] op_sel_hi:[1,0]
    v_pk_mul_f32 v[148:149], v[148:149], v[166:167] op_sel:[0,0] op_sel_hi:[1,0]
    v_pk_mul_f32 v[150:151], v[150:151], v[166:167] op_sel:[0,0] op_sel_hi:[1,0]
    v_pk_mul_f32 v[152:153], v[152:153], v[166:167] op_sel:[0,0] op_sel_hi:[1,0]
    v_pk_mul_f32 v[154:155], v[154:155], v[166:167] op_sel:[0,0] op_sel_hi:[1,0]
    v_pk_mul_f32 v[156:157], v[156:157], v[166:167] op_sel:[0,0] op_sel_hi:[1,0]
    v_pk_mul_f32 v[158:159], v[158:159], v[166:167] op_sel:[0,0] op_sel_hi:[1,0]
    v_pk_mul_f32 v[160:161], v[160:161], v[166:167] op_sel:[0,0] op_sel_hi:[1,0]
    v_pk_mul_f32 v[162:163], v[162:163], v[166:167] op_sel:[0,0] op_sel_hi:[1,0]
    v_cvt_pk_bf16_f32 v178, v144, v145
    v_cvt_pk_bf16_f32 v179, v146, v147
    v_cvt_pk_bf16_f32 v180, v148, v149
    v_cvt_pk_bf16_f32 v181, v150, v151
    v_cvt_pk_bf16_f32 v182, v152, v153
    v_cvt_pk_bf16_f32 v183, v154, v155
    v_cvt_pk_bf16_f32 v132, v156, v157
    v_cvt_pk_bf16_f32 v133, v158, v159
    v_cvt_pk_bf16_f32 v134, v160, v161
    v_cvt_pk_bf16_f32 v135, v162, v163
    v_max3_f32 v164, v40, v41, v42
    ds_write_b128 v16, v[176:179] offset:33824
    v_max3_f32 v165, v43, v56, v57
    v_max3_f32 v164, v164, v58, v59
    v_max3_f32 v165, v165, v72, v73
    v_max3_f32 v164, v164, v74, v75
    ds_write_b128 v16, v[180:183] offset:33840
    v_max3_f32 v165, v165, v88, v89
    v_max3_f32 v164, v164, v90, v91
    v_max3_f32 v165, v165, v104, v105
    v_max3_f32 v164, v164, v106, v107
    ds_write_b128 v16, v[132:135] offset:33856
    v_max_f32 v164, v164, v165
    v_mul_f32 v164, v164, v140
    v_pk_fma_f32 v[144:145], v[40:41], v[140:141], v[164:165] op_sel:[0,0,0] op_sel_hi:[1,0,0] neg_lo:[0,0,1] neg_hi:[0,0,1]
    v_pk_fma_f32 v[146:147], v[42:43], v[140:141], v[164:165] op_sel:[0,0,0] op_sel_hi:[1,0,0] neg_lo:[0,0,1] neg_hi:[0,0,1]
    v_pk_fma_f32 v[148:149], v[56:57], v[140:141], v[164:165] op_sel:[0,0,0] op_sel_hi:[1,0,0] neg_lo:[0,0,1] neg_hi:[0,0,1]
    s_waitcnt lgkmcnt(0)
    v_pk_fma_f32 v[150:151], v[58:59], v[140:141], v[164:165] op_sel:[0,0,0] op_sel_hi:[1,0,0] neg_lo:[0,0,1] neg_hi:[0,0,1]
    v_pk_fma_f32 v[152:153], v[72:73], v[140:141], v[164:165] op_sel:[0,0,0] op_sel_hi:[1,0,0] neg_lo:[0,0,1] neg_hi:[0,0,1]
    v_pk_fma_f32 v[154:155], v[74:75], v[140:141], v[164:165] op_sel:[0,0,0] op_sel_hi:[1,0,0] neg_lo:[0,0,1] neg_hi:[0,0,1]
    v_pk_fma_f32 v[156:157], v[88:89], v[140:141], v[164:165] op_sel:[0,0,0] op_sel_hi:[1,0,0] neg_lo:[0,0,1] neg_hi:[0,0,1]
    s_barrier
    v_pk_fma_f32 v[158:159], v[90:91], v[140:141], v[164:165] op_sel:[0,0,0] op_sel_hi:[1,0,0] neg_lo:[0,0,1] neg_hi:[0,0,1]
    v_pk_fma_f32 v[160:161], v[104:105], v[140:141], v[164:165] op_sel:[0,0,0] op_sel_hi:[1,0,0] neg_lo:[0,0,1] neg_hi:[0,0,1]
    v_pk_fma_f32 v[162:163], v[106:107], v[140:141], v[164:165] op_sel:[0,0,0] op_sel_hi:[1,0,0] neg_lo:[0,0,1] neg_hi:[0,0,1]
    v_exp_f32 v144, v144
    v_exp_f32 v145, v145
    s_cmp_eq_u32 s31, 3
    s_cbranch_scc0 KVK_4_2
    buffer_load_dwordx4 v[232:235], v8, s[20:23], s48 offen offset:2048 sc1
    KVK_4_2:
    v_exp_f32 v146, v146
    v_exp_f32 v147, v147
    v_exp_f32 v148, v148
    v_exp_f32 v149, v149
    s_cmp_eq_u32 s31, 3
    s_cbranch_scc0 KVK_4_3
    buffer_load_dwordx4 v[236:239], v8, s[20:23], s48 offen offset:3072 sc1
    KVK_4_3:
    v_exp_f32 v150, v150
    v_exp_f32 v151, v151
    v_exp_f32 v152, v152
    v_exp_f32 v153, v153
    v_exp_f32 v154, v154
    s_cmp_eq_u32 s31, 3
    s_cbranch_scc0 KVK_4_4
    buffer_load_dwordx4 v[240:243], v9, s[20:23], s48 offen offset:0 sc1
    KVK_4_4:
    v_exp_f32 v155, v155
    v_exp_f32 v156, v156
    v_exp_f32 v157, v157
    v_exp_f32 v158, v158
    s_cmp_eq_u32 s31, 3
    s_cbranch_scc0 KVK_2_0
    s_add_u32 s48, s28, 10240
    s_add_u32 m0, s30, 0
    s_nop 0
    buffer_load_dwordx4 v8, s[20:23], s48 offen offset:0 sc1 lds
    KVK_2_0:
    v_exp_f32 v159, v159
    v_exp_f32 v160, v160
    v_exp_f32 v161, v161
    v_exp_f32 v162, v162
    v_exp_f32 v163, v163
    v_pk_add_f32 v[166:167], v[144:145], v[146:147]
    v_pk_add_f32 v[164:165], v[148:149], v[150:151]
    v_pk_add_f32 v[166:167], v[166:167], v[152:153]
    v_pk_add_f32 v[164:165], v[164:165], v[154:155]
    v_pk_add_f32 v[166:167], v[166:167], v[156:157]
    v_pk_add_f32 v[164:165], v[164:165], v[158:159]
    v_pk_add_f32 v[166:167], v[166:167], v[160:161]
    v_pk_add_f32 v[164:165], v[164:165], v[162:163]
    v_pk_add_f32 v[166:167], v[166:167], v[164:165]
    v_add_f32 v166, v166, v167
    v_rcp_f32 v166, v166
    s_nop 0
    v_mul_f32 v166, v166, v141
    v_pk_mul_f32 v[144:145], v[144:145], v[166:167] op_sel:[0,0] op_sel_hi:[1,0]
    v_pk_mul_f32 v[146:147], v[146:147], v[166:167] op_sel:[0,0] op_sel_hi:[1,0]
    v_pk_mul_f32 v[148:149], v[148:149], v[166:167] op_sel:[0,0] op_sel_hi:[1,0]
    v_pk_mul_f32 v[150:151], v[150:151], v[166:167] op_sel:[0,0] op_sel_hi:[1,0]
    v_pk_mul_f32 v[152:153], v[152:153], v[166:167] op_sel:[0,0] op_sel_hi:[1,0]
    v_pk_mul_f32 v[154:155], v[154:155], v[166:167] op_sel:[0,0] op_sel_hi:[1,0]
    v_pk_mul_f32 v[156:157], v[156:157], v[166:167] op_sel:[0,0] op_sel_hi:[1,0]
    v_pk_mul_f32 v[158:159], v[158:159], v[166:167] op_sel:[0,0] op_sel_hi:[1,0]
    v_pk_mul_f32 v[160:161], v[160:161], v[166:167] op_sel:[0,0] op_sel_hi:[1,0]
    v_pk_mul_f32 v[162:163], v[162:163], v[166:167] op_sel:[0,0] op_sel_hi:[1,0]
    v_cvt_pk_bf16_f32 v112, v144, v145
    v_cvt_pk_bf16_f32 v113, v146, v147
    v_cvt_pk_bf16_f32 v114, v148, v149
    v_cvt_pk_bf16_f32 v115, v150, v151
    v_cvt_pk_bf16_f32 v116, v152, v153
    v_cvt_pk_bf16_f32 v117, v154, v155
    v_cvt_pk_bf16_f32 v118, v156, v157
    v_cvt_pk_bf16_f32 v119, v158, v159
    v_cvt_pk_bf16_f32 v120, v160, v161
    v_cvt_pk_bf16_f32 v121, v162, v163
    v_min3_f32 v164, v40, v41, v42
    ds_write_b128 v16, v[112:115] offset:0
    v_min3_f32 v165, v43, v56, v57
    v_min3_f32 v164, v164, v58, v59
    v_min3_f32 v165, v165, v72, v73
    v_min3_f32 v164, v164, v74, v75
    v_min3_f32 v165, v165, v88, v89
    v_min3_f32 v164, v164, v90, v91
    ds_write_b128 v16, v[116:119] offset:16
    v_min3_f32 v165, v165, v104, v105
    v_min3_f32 v164, v164, v106, v107
    v_min_f32 v164, v164, v165
    v_mul_f32 v164, v164, v140
    v_pk_fma_f32 v[144:145], v[40:41], v[140:141], v[164:165] op_sel:[0,0,0] op_sel_hi:[1,0,0] neg_lo:[0,1,0] neg_hi:[0,1,0]
    v_pk_fma_f32 v[146:147], v[42:43], v[140:141], v[164:165] op_sel:[0,0,0] op_sel_hi:[1,0,0] neg_lo:[0,1,0] neg_hi:[0,1,0]
    v_pk_fma_f32 v[148:149], v[56:57], v[140:141], v[164:165] op_sel:[0,0,0] op_sel_hi:[1,0,0] neg_lo:[0,1,0] neg_hi:[0,1,0]
    s_cmp_eq_u32 s31, 3
    s_cbranch_scc0 KVK_2_1
    s_add_u32 m0, s30, 0
    s_nop 0
    buffer_load_dwordx4 v8, s[20:23], s48 offen offset:1024 sc1 lds
    KVK_2_1:
    v_pk_fma_f32 v[150:151], v[58:59], v[140:141], v[164:165] op_sel:[0,0,0] op_sel_hi:[1,0,0] neg_lo:[0,1,0] neg_hi:[0,1,0]
    v_pk_fma_f32 v[152:153], v[72:73], v[140:141], v[164:165] op_sel:[0,0,0] op_sel_hi:[1,0,0] neg_lo:[0,1,0] neg_hi:[0,1,0]
    v_pk_fma_f32 v[154:155], v[74:75], v[140:141], v[164:165] op_sel:[0,0,0] op_sel_hi:[1,0,0] neg_lo:[0,1,0] neg_hi:[0,1,0]
    v_pk_fma_f32 v[156:157], v[88:89], v[140:141], v[164:165] op_sel:[0,0,0] op_sel_hi:[1,0,0] neg_lo:[0,1,0] neg_hi:[0,1,0]
    v_pk_fma_f32 v[158:159], v[90:91], v[140:141], v[164:165] op_sel:[0,0,0] op_sel_hi:[1,0,0] neg_lo:[0,1,0] neg_hi:[0,1,0]
    v_pk_fma_f32 v[160:161], v[104:105], v[140:141], v[164:165] op_sel:[0,0,0] op_sel_hi:[1,0,0] neg_lo:[0,1,0] neg_hi:[0,1,0]
    v_pk_fma_f32 v[162:163], v[106:107], v[140:141], v[164:165] op_sel:[0,0,0] op_sel_hi:[1,0,0] neg_lo:[0,1,0] neg_hi:[0,1,0]
    s_cmp_eq_u32 s31, 3
    s_cbranch_scc0 KVK_2_2
    s_add_u32 m0, s30, 0
    s_nop 0
    buffer_load_dwordx4 v8, s[20:23], s48 offen offset:2048 sc1 lds
    KVK_2_2:
    v_exp_f32 v144, v144
    v_exp_f32 v145, v145
    v_exp_f32 v146, v146
    v_exp_f32 v147, v147
    v_exp_f32 v148, v148
    v_exp_f32 v149, v149
    s_cmp_eq_u32 s31, 3
    s_cbranch_scc0 KVK_2_3
    s_add_u32 m0, s30, 0
    s_nop 0
    buffer_load_dwordx4 v8, s[20:23], s48 offen offset:3072 sc1 lds
    KVK_2_3:
    v_exp_f32 v150, v150
    v_exp_f32 v151, v151
    v_exp_f32 v152, v152
    v_exp_f32 v153, v153
    v_exp_f32 v154, v154
    v_exp_f32 v155, v155
    v_exp_f32 v156, v156
    s_cmp_eq_u32 s31, 3
    s_cbranch_scc0 KVK_2_4
    s_add_u32 m0, s30, 4096
    s_nop 0
    buffer_load_dwordx4 v9, s[20:23], s48 offen offset:0 sc1 lds
    KVK_2_4:
    v_exp_f32 v157, v157
    v_exp_f32 v158, v158
    v_exp_f32 v159, v159
    v_exp_f32 v160, v160
    v_exp_f32 v161, v161
    v_exp_f32 v162, v162
    v_exp_f32 v163, v163
    v_pk_add_f32 v[166:167], v[144:145], v[146:147]
    v_pk_add_f32 v[164:165], v[148:149], v[150:151]
    v_pk_add_f32 v[166:167], v[166:167], v[152:153]
    v_pk_add_f32 v[164:165], v[164:165], v[154:155]
    v_pk_add_f32 v[166:167], v[166:167], v[156:157]
    v_pk_add_f32 v[164:165], v[164:165], v[158:159]
    v_pk_add_f32 v[166:167], v[166:167], v[160:161]
    v_pk_add_f32 v[164:165], v[164:165], v[162:163]
    v_pk_add_f32 v[166:167], v[166:167], v[164:165]
    v_add_f32 v166, v166, v167
    v_rcp_f32 v166, v166
    s_nop 0
    v_mul_f32 v166, v166, v141
    v_pk_mul_f32 v[144:145], v[144:145], v[166:167] op_sel:[0,0] op_sel_hi:[1,0]
    v_pk_mul_f32 v[146:147], v[146:147], v[166:167] op_sel:[0,0] op_sel_hi:[1,0]
    v_pk_mul_f32 v[148:149], v[148:149], v[166:167] op_sel:[0,0] op_sel_hi:[1,0]
    v_pk_mul_f32 v[150:151], v[150:151], v[166:167] op_sel:[0,0] op_sel_hi:[1,0]
    v_pk_mul_f32 v[152:153], v[152:153], v[166:167] op_sel:[0,0] op_sel_hi:[1,0]
    v_pk_mul_f32 v[154:155], v[154:155], v[166:167] op_sel:[0,0] op_sel_hi:[1,0]
    v_pk_mul_f32 v[156:157], v[156:157], v[166:167] op_sel:[0,0] op_sel_hi:[1,0]
    v_pk_mul_f32 v[158:159], v[158:159], v[166:167] op_sel:[0,0] op_sel_hi:[1,0]
    v_pk_mul_f32 v[160:161], v[160:161], v[166:167] op_sel:[0,0] op_sel_hi:[1,0]
    v_pk_mul_f32 v[162:163], v[162:163], v[166:167] op_sel:[0,0] op_sel_hi:[1,0]
    v_cvt_pk_bf16_f32 v122, v144, v145
    v_cvt_pk_bf16_f32 v123, v146, v147
    v_cvt_pk_bf16_f32 v124, v148, v149
    v_cvt_pk_bf16_f32 v125, v150, v151
    v_cvt_pk_bf16_f32 v126, v152, v153
    v_cvt_pk_bf16_f32 v127, v154, v155
    v_cvt_pk_bf16_f32 v128, v156, v157
    v_cvt_pk_bf16_f32 v129, v158, v159
    v_cvt_pk_bf16_f32 v130, v160, v161
    v_cvt_pk_bf16_f32 v131, v162, v163
    v_max3_f32 v164, v44, v45, v46
    ds_write_b128 v16, v[120:123] offset:32
    v_max3_f32 v165, v47, v60, v61
    v_max3_f32 v164, v164, v62, v63
    v_max3_f32 v165, v165, v76, v77
    v_max3_f32 v164, v164, v78, v79
    ds_write_b128 v16, v[124:127] offset:48
    v_max3_f32 v165, v165, v92, v93
    v_max3_f32 v164, v164, v94, v95
    v_max3_f32 v165, v165, v108, v109
    v_max3_f32 v164, v164, v110, v111
    ds_write_b128 v16, v[128:131] offset:64
    v_max_f32 v164, v164, v165
    v_mul_f32 v164, v164, v142
    v_pk_fma_f32 v[144:145], v[44:45], v[142:143], v[164:165] op_sel:[0,0,0] op_sel_hi:[1,0,0] neg_lo:[0,0,1] neg_hi:[0,0,1]
    v_pk_fma_f32 v[146:147], v[46:47], v[142:143], v[164:165] op_sel:[0,0,0] op_sel_hi:[1,0,0] neg_lo:[0,0,1] neg_hi:[0,0,1]
    v_pk_fma_f32 v[148:149], v[60:61], v[142:143], v[164:165] op_sel:[0,0,0] op_sel_hi:[1,0,0] neg_lo:[0,0,1] neg_hi:[0,0,1]
    s_waitcnt lgkmcnt(0)
    v_pk_fma_f32 v[150:151], v[62:63], v[142:143], v[164:165] op_sel:[0,0,0] op_sel_hi:[1,0,0] neg_lo:[0,0,1] neg_hi:[0,0,1]
    v_pk_fma_f32 v[152:153], v[76:77], v[142:143], v[164:165] op_sel:[0,0,0] op_sel_hi:[1,0,0] neg_lo:[0,0,1] neg_hi:[0,0,1]
    v_pk_fma_f32 v[154:155], v[78:79], v[142:143], v[164:165] op_sel:[0,0,0] op_sel_hi:[1,0,0] neg_lo:[0,0,1] neg_hi:[0,0,1]
    v_pk_fma_f32 v[156:157], v[92:93], v[142:143], v[164:165] op_sel:[0,0,0] op_sel_hi:[1,0,0] neg_lo:[0,0,1] neg_hi:[0,0,1]
    s_barrier
    v_pk_fma_f32 v[158:159], v[94:95], v[142:143], v[164:165] op_sel:[0,0,0] op_sel_hi:[1,0,0] neg_lo:[0,0,1] neg_hi:[0,0,1]
    v_pk_fma_f32 v[160:161], v[108:109], v[142:143], v[164:165] op_sel:[0,0,0] op_sel_hi:[1,0,0] neg_lo:[0,0,1] neg_hi:[0,0,1]
    v_pk_fma_f32 v[162:163], v[110:111], v[142:143], v[164:165] op_sel:[0,0,0] op_sel_hi:[1,0,0] neg_lo:[0,0,1] neg_hi:[0,0,1]
    v_exp_f32 v144, v144
    v_exp_f32 v145, v145
    s_cmp_eq_u32 s31, 3
    s_cbranch_scc0 KVK_3_0
    s_add_u32 s48, s28, 15360
    s_add_u32 m0, s30, 5120
    s_nop 0
    buffer_load_dwordx4 v8, s[20:23], s48 offen offset:0 sc1 lds
    KVK_3_0:
    v_exp_f32 v146, v146
    v_exp_f32 v147, v147
    v_exp_f32 v148, v148
    v_exp_f32 v149, v149
    s_cmp_eq_u32 s31, 3
    s_cbranch_scc0 KVK_3_1
    s_add_u32 m0, s30, 5120
    s_nop 0
    buffer_load_dwordx4 v8, s[20:23], s48 offen offset:1024 sc1 lds
    KVK_3_1:
    v_exp_f32 v150, v150
    v_exp_f32 v151, v151
    v_exp_f32 v152, v152
    v_exp_f32 v153, v153
    v_exp_f32 v154, v154
    s_cmp_eq_u32 s31, 3
    s_cbranch_scc0 KVK_3_2
    s_add_u32 m0, s30, 5120
    s_nop 0
    buffer_load_dwordx4 v8, s[20:23], s48 offen offset:2048 sc1 lds
    KVK_3_2:
    v_exp_f32 v155, v155
    v_exp_f32 v156, v156
    v_exp_f32 v157, v157
    v_exp_f32 v158, v158
    s_cmp_eq_u32 s31, 3
    s_cbranch_scc0 KVK_3_3
    s_add_u32 m0, s30, 5120
    s_nop 0
    buffer_load_dwordx4 v8, s[20:23], s48 offen offset:3072 sc1 lds
    KVK_3_3:
    v_exp_f32 v159, v159
    v_exp_f32 v160, v160
    v_exp_f32 v161, v161
    v_exp_f32 v162, v162
    v_exp_f32 v163, v163
    v_pk_add_f32 v[166:167], v[144:145], v[146:147]
    v_pk_add_f32 v[164:165], v[148:149], v[150:151]
    v_pk_add_f32 v[166:167], v[166:167], v[152:153]
    v_pk_add_f32 v[164:165], v[164:165], v[154:155]
    v_pk_add_f32 v[166:167], v[166:167], v[156:157]
    v_pk_add_f32 v[164:165], v[164:165], v[158:159]
    v_pk_add_f32 v[166:167], v[166:167], v[160:161]
    v_pk_add_f32 v[164:165], v[164:165], v[162:163]
    v_pk_add_f32 v[166:167], v[166:167], v[164:165]
    v_add_f32 v166, v166, v167
    v_rcp_f32 v166, v166
    s_nop 0
    v_mul_f32 v166, v166, v143
    v_pk_mul_f32 v[144:145], v[144:145], v[166:167] op_sel:[0,0] op_sel_hi:[1,0]
    v_pk_mul_f32 v[146:147], v[146:147], v[166:167] op_sel:[0,0] op_sel_hi:[1,0]
    v_pk_mul_f32 v[148:149], v[148:149], v[166:167] op_sel:[0,0] op_sel_hi:[1,0]
    v_pk_mul_f32 v[150:151], v[150:151], v[166:167] op_sel:[0,0] op_sel_hi:[1,0]
    v_pk_mul_f32 v[152:153], v[152:153], v[166:167] op_sel:[0,0] op_sel_hi:[1,0]
    v_pk_mul_f32 v[154:155], v[154:155], v[166:167] op_sel:[0,0] op_sel_hi:[1,0]
    v_pk_mul_f32 v[156:157], v[156:157], v[166:167] op_sel:[0,0] op_sel_hi:[1,0]
    v_pk_mul_f32 v[158:159], v[158:159], v[166:167] op_sel:[0,0] op_sel_hi:[1,0]
    v_pk_mul_f32 v[160:161], v[160:161], v[166:167] op_sel:[0,0] op_sel_hi:[1,0]
    v_pk_mul_f32 v[162:163], v[162:163], v[166:167] op_sel:[0,0] op_sel_hi:[1,0]
    v_cvt_pk_bf16_f32 v168, v144, v145
    v_cvt_pk_bf16_f32 v169, v146, v147
    v_cvt_pk_bf16_f32 v170, v148, v149
    v_cvt_pk_bf16_f32 v171, v150, v151
    v_cvt_pk_bf16_f32 v172, v152, v153
    v_cvt_pk_bf16_f32 v173, v154, v155
    v_cvt_pk_bf16_f32 v174, v156, v157
    v_cvt_pk_bf16_f32 v175, v158, v159
    v_cvt_pk_bf16_f32 v176, v160, v161
    v_cvt_pk_bf16_f32 v177, v162, v163
    v_min3_f32 v164, v44, v45, v46
    ds_write_b128 v16, v[168:171] offset:33792
    v_min3_f32 v165, v47, v60, v61
    v_min3_f32 v164, v164, v62, v63
    v_min3_f32 v165, v165, v76, v77
    v_min3_f32 v164, v164, v78, v79
    v_min3_f32 v165, v165, v92, v93
    v_min3_f32 v164, v164, v94, v95
    v_min3_f32 v165, v165, v108, v109
    v_min3_f32 v164, v164, v110, v111
    v_min_f32 v164, v164, v165
    v_mul_f32 v164, v164, v142
    v_pk_fma_f32 v[144:145], v[44:45], v[142:143], v[164:165] op_sel:[0,0,0] op_sel_hi:[1,0,0] neg_lo:[0,1,0] neg_hi:[0,1,0]
    v_pk_fma_f32 v[146:147], v[46:47], v[142:143], v[164:165] op_sel:[0,0,0] op_sel_hi:[1,0,0] neg_lo:[0,1,0] neg_hi:[0,1,0]
    v_pk_fma_f32 v[148:149], v[60:61], v[142:143], v[164:165] op_sel:[0,0,0] op_sel_hi:[1,0,0] neg_lo:[0,1,0] neg_hi:[0,1,0]
    ds_write_b128 v16, v[172:175] offset:33808
    v_pk_fma_f32 v[150:151], v[62:63], v[142:143], v[164:165] op_sel:[0,0,0] op_sel_hi:[1,0,0] neg_lo:[0,1,0] neg_hi:[0,1,0]
    v_pk_fma_f32 v[152:153], v[76:77], v[142:143], v[164:165] op_sel:[0,0,0] op_sel_hi:[1,0,0] neg_lo:[0,1,0] neg_hi:[0,1,0]
    v_pk_fma_f32 v[154:155], v[78:79], v[142:143], v[164:165] op_sel:[0,0,0] op_sel_hi:[1,0,0] neg_lo:[0,1,0] neg_hi:[0,1,0]
    v_pk_fma_f32 v[156:157], v[92:93], v[142:143], v[164:165] op_sel:[0,0,0] op_sel_hi:[1,0,0] neg_lo:[0,1,0] neg_hi:[0,1,0]
    v_pk_fma_f32 v[158:159], v[94:95], v[142:143], v[164:165] op_sel:[0,0,0] op_sel_hi:[1,0,0] neg_lo:[0,1,0] neg_hi:[0,1,0]
    v_pk_fma_f32 v[160:161], v[108:109], v[142:143], v[164:165] op_sel:[0,0,0] op_sel_hi:[1,0,0] neg_lo:[0,1,0] neg_hi:[0,1,0]
    v_pk_fma_f32 v[162:163], v[110:111], v[142:143], v[164:165] op_sel:[0,0,0] op_sel_hi:[1,0,0] neg_lo:[0,1,0] neg_hi:[0,1,0]
    v_exp_f32 v144, v144
    v_exp_f32 v145, v145
    v_exp_f32 v146, v146
    v_exp_f32 v147, v147
    v_exp_f32 v148, v148
    v_exp_f32 v149, v149
    s_cmp_eq_u32 s31, 3
    s_cbranch_scc0 KVK_3_4
    s_add_u32 m0, s30, 9216
    s_nop 0
    buffer_load_dwordx4 v9, s[20:23], s48 offen offset:0 sc1 lds
    KVK_3_4:
    v_exp_f32 v150, v150
    v_exp_f32 v151, v151
    v_exp_f32 v152, v152
    v_exp_f32 v153, v153
    v_exp_f32 v154, v154
    v_exp_f32 v155, v155
    v_exp_f32 v156, v156
    v_exp_f32 v157, v157
    v_exp_f32 v158, v158
    v_exp_f32 v159, v159
    v_exp_f32 v160, v160
    v_exp_f32 v161, v161
    v_exp_f32 v162, v162
    v_exp_f32 v163, v163
    v_pk_add_f32 v[166:167], v[144:145], v[146:147]
    v_pk_add_f32 v[164:165], v[148:149], v[150:151]
    v_pk_add_f32 v[166:167], v[166:167], v[152:153]
    v_pk_add_f32 v[164:165], v[164:165], v[154:155]
    v_pk_add_f32 v[166:167], v[166:167], v[156:157]
    v_pk_add_f32 v[164:165], v[164:165], v[158:159]
    v_pk_add_f32 v[166:167], v[166:167], v[160:161]
    v_pk_add_f32 v[164:165], v[164:165], v[162:163]
    v_pk_add_f32 v[166:167], v[166:167], v[164:165]
    v_add_f32 v166, v166, v167
    v_rcp_f32 v166, v166
    s_nop 0
    v_mul_f32 v166, v166, v143
    v_pk_mul_f32 v[144:145], v[144:145], v[166:167] op_sel:[0,0] op_sel_hi:[1,0]
    v_pk_mul_f32 v[146:147], v[146:147], v[166:167] op_sel:[0,0] op_sel_hi:[1,0]
    v_pk_mul_f32 v[148:149], v[148:149], v[166:167] op_sel:[0,0] op_sel_hi:[1,0]
    v_pk_mul_f32 v[150:151], v[150:151], v[166:167] op_sel:[0,0] op_sel_hi:[1,0]
    v_pk_mul_f32 v[152:153], v[152:153], v[166:167] op_sel:[0,0] op_sel_hi:[1,0]
    v_pk_mul_f32 v[154:155], v[154:155], v[166:167] op_sel:[0,0] op_sel_hi:[1,0]
    v_pk_mul_f32 v[156:157], v[156:157], v[166:167] op_sel:[0,0] op_sel_hi:[1,0]
    v_pk_mul_f32 v[158:159], v[158:159], v[166:167] op_sel:[0,0] op_sel_hi:[1,0]
    v_pk_mul_f32 v[160:161], v[160:161], v[166:167] op_sel:[0,0] op_sel_hi:[1,0]
    v_pk_mul_f32 v[162:163], v[162:163], v[166:167] op_sel:[0,0] op_sel_hi:[1,0]
    v_cvt_pk_bf16_f32 v178, v144, v145
    v_cvt_pk_bf16_f32 v179, v146, v147
    v_cvt_pk_bf16_f32 v180, v148, v149
    v_cvt_pk_bf16_f32 v181, v150, v151
    v_cvt_pk_bf16_f32 v182, v152, v153
    v_cvt_pk_bf16_f32 v183, v154, v155
    v_cvt_pk_bf16_f32 v132, v156, v157
    v_cvt_pk_bf16_f32 v133, v158, v159
    v_cvt_pk_bf16_f32 v134, v160, v161
    v_cvt_pk_bf16_f32 v135, v162, v163
    ds_write_b128 v16, v[176:179] offset:33824
    ds_write_b128 v16, v[180:183] offset:33840
    ds_write_b128 v16, v[132:135] offset:33856
    s_waitcnt lgkmcnt(0)
    s_barrier
KV_DONE:
    s_branch P1_FIN
SPARE:
    s_waitcnt lgkmcnt(0)
    s_mul_i32 s45, s33, 327680
    s_add_u32 s8, s52, s45
    s_addc_u32 s9, s53, 0
    s_and_b32 s9, s9, 0xffff
    s_mov_b32 s10, 327680
    s_mov_b32 s11, 0x20000
    s_mov_b32 s24, s52
    s_and_b32 s25, s53, 0xffff
    s_mov_b32 s26, 2621440
    s_mov_b32 s27, 0x20000
    s_mov_b32 s20, s72
    s_and_b32 s21, s73, 0xffff
    s_mov_b32 s22, 268435456
    s_mov_b32 s23, 0x20000
    s_mov_b32 s4, s70
    s_and_b32 s5, s71, 0xffff
    s_mov_b32 s6, 256
    s_mov_b32 s7, 0x20000
    s_and_b32 s45, s2, 1
    s_lshl_b32 s45, s45, 7
    s_bfe_u32 s46, s2, 0x20001
    s_lshl_b32 s46, s46, 5
    s_add_u32 s45, s45, s46
    s_lshr_b32 s46, s2, 3
    s_add_u32 s45, s45, s46
    s_lshl_b32 s45, s45, 3
    s_add_u32 s50, s45, s32
    s_mul_i32 s45, s50, 1280
    v_lshlrev_b32 v16, 4, v0
    v_lshlrev_b32 v17, 2, v0
    buffer_load_dwordx4 v[244:247], v16, s[24:27], s45 offen
    buffer_load_dword v248, v17, s[24:27], s45 offen offset:1024
    s_mov_b32 s28, s50
    s_and_b32 s34, s2, 3
    s_lshl_b32 s34, s34, 2
    s_bfe_u32 s45, s2, 0x20003
    s_add_u32 s34, s34, s45
    s_and_b32 s45, s32, 1
    s_lshl_b32 s45, s45, 2
    v_add_u32 v16, 0, v0
    v_mul_u32_u24 v17, 205, v16
    v_lshrrev_b32 v17, 14, v17
    v_mul_u32_u24 v18, 80, v17
    v_sub_u32 v16, v16, v18
    v_add_u32 v18, s45, v17
    v_lshlrev_b32 v18, 1, v18
    v_xor_b32 v16, v16, v18
    v_mul_u32_u24 v17, 1280, v17
    v_lshl_add_u32 v32, v16, 4, v17
    v_add_u32 v16, 64, v0
    v_mul_u32_u24 v17, 205, v16
    v_lshrrev_b32 v17, 14, v17
    v_mul_u32_u24 v18, 80, v17
    v_sub_u32 v16, v16, v18
    v_add_u32 v18, s45, v17
    v_lshlrev_b32 v18, 1, v18
    v_xor_b32 v16, v16, v18
    v_mul_u32_u24 v17, 1280, v17
    v_lshl_add_u32 v33, v16, 4, v17
    v_add_u32 v16, 128, v0
    v_mul_u32_u24 v17, 205, v16
    v_lshrrev_b32 v17, 14, v17
    v_mul_u32_u24 v18, 80, v17
    v_sub_u32 v16, v16, v18
    v_add_u32 v18, s45, v17
    v_lshlrev_b32 v18, 1, v18
    v_xor_b32 v16, v16, v18
    v_mul_u32_u24 v17, 1280, v17
    v_lshl_add_u32 v34, v16, 4, v17
    v_add_u32 v16, 192, v0
    v_mul_u32_u24 v17, 205, v16
    v_lshrrev_b32 v17, 14, v17
    v_mul_u32_u24 v18, 80, v17
    v_sub_u32 v16, v16, v18
    v_add_u32 v18, s45, v17
    v_lshlrev_b32 v18, 1, v18
    v_xor_b32 v16, v16, v18
    v_mul_u32_u24 v17, 1280, v17
    v_lshl_add_u32 v35, v16, 4, v17
    v_add_u32 v16, 256, v0
    v_mul_u32_u24 v17, 205, v16
    v_lshrrev_b32 v17, 14, v17
    v_mul_u32_u24 v18, 80, v17
    v_sub_u32 v16, v16, v18
    v_add_u32 v18, s45, v17
    v_lshlrev_b32 v18, 1, v18
    v_xor_b32 v16, v16, v18
    v_mul_u32_u24 v17, 1280, v17
    v_lshl_add_u32 v36, v16, 4, v17
    s_mul_i32 s40, s32, 5120
    s_add_u32 s45, s34, 0
    s_lshr_b32 s46, s45, 2
    s_and_b32 s45, s45, 3
    s_lshl_b32 s47, s46, 3
    s_cmp_eq_u32 s46, 5
    s_cselect_b32 s47, 38, s47
    s_cmp_eq_u32 s46, 6
    s_cselect_b32 s47, 44, s47
    s_cmp_eq_u32 s46, 7
    s_cselect_b32 s47, 49, s47
    s_add_u32 s45, s45, s47
    s_bfe_u32 s46, s32, 0x10001
    s_and_b32 s47, s32, 1
    s_lshr_b32 s48, s32, 2
    s_cmp_ge_u32 s45, 54
    s_cbranch_scc1 RL0_WO
    s_mov_b32 s12, s66
    s_and_b32 s13, s67, 0xffff
    s_mov_b32 s14, 2211840
    s_mov_b32 s15, 0x20000
    s_mul_i32 s50, s45, 86
    s_lshr_b32 s50, s50, 8
    s_mul_i32 s50, s50, 3
    s_sub_u32 s50, s45, s50
    s_cmp_eq_u32 s50, 1
    s_cselect_b32 s50, 4, 3
    s_lshl_b32 s46, s46, s50
    s_cmp_eq_u32 s50, 4
    s_cselect_b32 s50, 3, 4
    s_lshl_b32 s48, s48, s50
    s_lshl_b32 s47, s47, 2
    s_lshl_b32 s36, s45, 5
    s_branch RL0_GO
RL0_WO:
    s_mov_b32 s12, s58
    s_and_b32 s13, s59, 0xffff
    s_mov_b32 s14, 819200
    s_mov_b32 s15, 0x20000
    s_sub_u32 s45, s45, 54
    s_mul_i32 s50, s45, 52
    s_lshr_b32 s50, s50, 8
    s_mul_i32 s36, s50, 160
    s_mul_i32 s50, s50, 5
    s_sub_u32 s45, s45, s50
    s_cmp_eq_u32 s45, 4
    s_cbranch_scc1 RL0_LO
    s_mul_i32 s45, s45, 40
    s_add_u32 s36, s36, s45
    s_mul_i32 s46, s46, 20
    s_lshl_b32 s47, s47, 2
    s_lshl_b32 s48, s48, 3
    s_branch RL0_GO
RL0_LO:
    s_add_u32 s36, s36, 16
    s_xor_b32 s48, s48, s47
    s_mul_i32 s48, s48, 20
    s_mul_i32 s46, s46, 80
    s_mul_i32 s47, s47, 40
RL0_GO:
    s_add_u32 s36, s36, s46
    s_add_u32 s36, s36, s47
    s_add_u32 s36, s36, s48
    s_mul_i32 s36, s36, 1280
    s_add_u32 m0, s40, 0
    s_nop 0
    buffer_load_dwordx4 v32, s[12:15], s36 offen lds
    s_add_u32 m0, s40, 1024
    s_nop 0
    buffer_load_dwordx4 v33, s[12:15], s36 offen lds
    s_add_u32 m0, s40, 2048
    s_nop 0
    buffer_load_dwordx4 v34, s[12:15], s36 offen lds
    s_add_u32 m0, s40, 3072
    s_nop 0
    buffer_load_dwordx4 v35, s[12:15], s36 offen lds
    s_add_u32 m0, s40, 4096
    s_nop 0
    buffer_load_dwordx4 v36, s[12:15], s36 offen lds
    s_add_u32 s45, s34, 16
    s_lshr_b32 s46, s45, 2
    s_and_b32 s45, s45, 3
    s_lshl_b32 s47, s46, 3
    s_cmp_eq_u32 s46, 5
    s_cselect_b32 s47, 38, s47
    s_cmp_eq_u32 s46, 6
    s_cselect_b32 s47, 44, s47
    s_cmp_eq_u32 s46, 7
    s_cselect_b32 s47, 49, s47
    s_add_u32 s45, s45, s47
    s_bfe_u32 s46, s32, 0x10001
    s_and_b32 s47, s32, 1
    s_lshr_b32 s48, s32, 2
    s_cmp_ge_u32 s45, 54
    s_cbranch_scc1 RL1_WO
    s_mov_b32 s12, s66
    s_and_b32 s13, s67, 0xffff
    s_mov_b32 s14, 2211840
    s_mov_b32 s15, 0x20000
    s_mul_i32 s50, s45, 86
    s_lshr_b32 s50, s50, 8
    s_mul_i32 s50, s50, 3
    s_sub_u32 s50, s45, s50
    s_cmp_eq_u32 s50, 1
    s_cselect_b32 s50, 4, 3
    s_lshl_b32 s46, s46, s50
    s_cmp_eq_u32 s50, 4
    s_cselect_b32 s50, 3, 4
    s_lshl_b32 s48, s48, s50
    s_lshl_b32 s47, s47, 2
    s_lshl_b32 s36, s45, 5
    s_branch RL1_GO
RL1_WO:
    s_mov_b32 s12, s58
    s_and_b32 s13, s59, 0xffff
    s_mov_b32 s14, 819200
    s_mov_b32 s15, 0x20000
    s_sub_u32 s45, s45, 54
    s_mul_i32 s50, s45, 52
    s_lshr_b32 s50, s50, 8
    s_mul_i32 s36, s50, 160
    s_mul_i32 s50, s50, 5
    s_sub_u32 s45, s45, s50
    s_cmp_eq_u32 s45, 4
    s_cbranch_scc1 RL1_LO
    s_mul_i32 s45, s45, 40
    s_add_u32 s36, s36, s45
    s_mul_i32 s46, s46, 20
    s_lshl_b32 s47, s47, 2
    s_lshl_b32 s48, s48, 3
    s_branch RL1_GO
RL1_LO:
    s_add_u32 s36, s36, 16
    s_xor_b32 s48, s48, s47
    s_mul_i32 s48, s48, 20
    s_mul_i32 s46, s46, 80
    s_mul_i32 s47, s47, 40
RL1_GO:
    s_add_u32 s36, s36, s46
    s_add_u32 s36, s36, s47
    s_add_u32 s36, s36, s48
    s_mul_i32 s36, s36, 1280
    s_add_u32 m0, s40, 40960
    s_nop 0
    buffer_load_dwordx4 v32, s[12:15], s36 offen lds
    s_add_u32 m0, s40, 41984
    s_nop 0
    buffer_load_dwordx4 v33, s[12:15], s36 offen lds
    s_add_u32 m0, s40, 43008
    s_nop 0
    buffer_load_dwordx4 v34, s[12:15], s36 offen lds
    s_add_u32 m0, s40, 44032
    s_nop 0
    buffer_load_dwordx4 v35, s[12:15], s36 offen lds
    s_add_u32 m0, s40, 45056
    s_nop 0
    buffer_load_dwordx4 v36, s[12:15], s36 offen lds
    s_add_u32 s45, s34, 0
    s_andn2_b32 s46, s45, 3
    s_add_u32 s46, s46, 4
    s_cmp_ge_u32 s45, 18
    s_cselect_b32 s46, 24, s46
    s_cmp_ge_u32 s45, 20
    s_cselect_b32 s46, 28, s46
    s_cmp_ge_u32 s45, 21
    s_cselect_b32 s46, 32, s46
    s_add_u32 s45, s45, s46
    s_bfe_u32 s46, s32, 0x10001
    s_and_b32 s47, s32, 1
    s_lshr_b32 s48, s32, 2
    s_cmp_ge_u32 s45, 54
    s_cbranch_scc1 RL2_WO
    s_mov_b32 s12, s66
    s_and_b32 s13, s67, 0xffff
    s_mov_b32 s14, 2211840
    s_mov_b32 s15, 0x20000
    s_mul_i32 s50, s45, 86
    s_lshr_b32 s50, s50, 8
    s_mul_i32 s50, s50, 3
    s_sub_u32 s50, s45, s50
    s_cmp_eq_u32 s50, 1
    s_cselect_b32 s50, 4, 3
    s_lshl_b32 s46, s46, s50
    s_cmp_eq_u32 s50, 4
    s_cselect_b32 s50, 3, 4
    s_lshl_b32 s48, s48, s50
    s_lshl_b32 s47, s47, 2
    s_lshl_b32 s36, s45, 5
    s_branch RL2_GO
RL2_WO:
    s_mov_b32 s12, s58
    s_and_b32 s13, s59, 0xffff
    s_mov_b32 s14, 819200
    s_mov_b32 s15, 0x20000
    s_sub_u32 s45, s45, 54
    s_mul_i32 s50, s45, 52
    s_lshr_b32 s50, s50, 8
    s_mul_i32 s36, s50, 160
    s_mul_i32 s50, s50, 5
    s_sub_u32 s45, s45, s50
    s_cmp_eq_u32 s45, 4
    s_cbranch_scc1 RL2_LO
    s_mul_i32 s45, s45, 40
    s_add_u32 s36, s36, s45
    s_mul_i32 s46, s46, 20
    s_lshl_b32 s47, s47, 2
    s_lshl_b32 s48, s48, 3
    s_branch RL2_GO
RL2_LO:
    s_add_u32 s36, s36, 16
    s_xor_b32 s48, s48, s47
    s_mul_i32 s48, s48, 20
    s_mul_i32 s46, s46, 80
    s_mul_i32 s47, s47, 40
RL2_GO:
    s_add_u32 s36, s36, s46
    s_add_u32 s36, s36, s47
    s_add_u32 s36, s36, s48
    s_mul_i32 s36, s36, 1280
    s_add_u32 m0, s40, 81920
    s_nop 0
    buffer_load_dwordx4 v32, s[12:15], s36 offen lds
    s_add_u32 m0, s40, 82944
    s_nop 0
    buffer_load_dwordx4 v33, s[12:15], s36 offen lds
    s_add_u32 m0, s40, 83968
    s_nop 0
    buffer_load_dwordx4 v34, s[12:15], s36 offen lds
    s_add_u32 m0, s40, 84992
    s_nop 0
    buffer_load_dwordx4 v35, s[12:15], s36 offen lds
    s_add_u32 m0, s40, 86016
    s_nop 0
    buffer_load_dwordx4 v36, s[12:15], s36 offen lds
    s_add_u32 s45, s34, 16
    s_andn2_b32 s46, s45, 3
    s_add_u32 s46, s46, 4
    s_cmp_ge_u32 s45, 18
    s_cselect_b32 s46, 24, s46
    s_cmp_ge_u32 s45, 20
    s_cselect_b32 s46, 28, s46
    s_cmp_ge_u32 s45, 21
    s_cselect_b32 s46, 32, s46
    s_add_u32 s45, s45, s46
    s_bfe_u32 s46, s32, 0x10001
    s_and_b32 s47, s32, 1
    s_lshr_b32 s48, s32, 2
    s_cmp_ge_u32 s45, 54
    s_cbranch_scc1 RL3_WO
    s_mov_b32 s12, s66
    s_and_b32 s13, s67, 0xffff
    s_mov_b32 s14, 2211840
    s_mov_b32 s15, 0x20000
    s_mul_i32 s50, s45, 86
    s_lshr_b32 s50, s50, 8
    s_mul_i32 s50, s50, 3
    s_sub_u32 s50, s45, s50
    s_cmp_eq_u32 s50, 1
    s_cselect_b32 s50, 4, 3
    s_lshl_b32 s46, s46, s50
    s_cmp_eq_u32 s50, 4
    s_cselect_b32 s50, 3, 4
    s_lshl_b32 s48, s48, s50
    s_lshl_b32 s47, s47, 2
    s_lshl_b32 s36, s45, 5
    s_branch RL3_GO
RL3_WO:
    s_mov_b32 s12, s58
    s_and_b32 s13, s59, 0xffff
    s_mov_b32 s14, 819200
    s_mov_b32 s15, 0x20000
    s_sub_u32 s45, s45, 54
    s_mul_i32 s50, s45, 52
    s_lshr_b32 s50, s50, 8
    s_mul_i32 s36, s50, 160
    s_mul_i32 s50, s50, 5
    s_sub_u32 s45, s45, s50
    s_cmp_eq_u32 s45, 4
    s_cbranch_scc1 RL3_LO
    s_mul_i32 s45, s45, 40
    s_add_u32 s36, s36, s45
    s_mul_i32 s46, s46, 20
    s_lshl_b32 s47, s47, 2
    s_lshl_b32 s48, s48, 3
    s_branch RL3_GO
RL3_LO:
    s_add_u32 s36, s36, 16
    s_xor_b32 s48, s48, s47
    s_mul_i32 s48, s48, 20
    s_mul_i32 s46, s46, 80
    s_mul_i32 s47, s47, 40
RL3_GO:
    s_add_u32 s36, s36, s46
    s_add_u32 s36, s36, s47
    s_add_u32 s36, s36, s48
    s_mul_i32 s36, s36, 1280
    s_add_u32 m0, s40, 122880
    s_nop 0
    buffer_load_dwordx4 v32, s[12:15], s36 offen lds
    s_add_u32 m0, s40, 123904
    s_nop 0
    buffer_load_dwordx4 v33, s[12:15], s36 offen lds
    s_add_u32 m0, s40, 124928
    s_nop 0
    buffer_load_dwordx4 v34, s[12:15], s36 offen lds
    s_add_u32 m0, s40, 125952
    s_nop 0
    buffer_load_dwordx4 v35, s[12:15], s36 offen lds
    s_add_u32 m0, s40, 126976
    s_nop 0
    buffer_load_dwordx4 v36, s[12:15], s36 offen lds
    s_mov_b32 s50, s28
    v_mov_b32 v242, 0
    buffer_load_dwordx2 v[242:243], v242, s[4:7], 0 offen sc1
    v_and_b32 v30, 3, v0
    v_bfe_u32 v16, v0, 2, 2
    v_lshl_add_u32 v30, v16, 3, v30
    v_add_u32 v30, 228, v30
    v_lshlrev_b32 v30, 7, v30
    s_waitcnt vmcnt(21)
    v_lshlrev_b32 v128, 16, v244
    v_and_b32 v129, 0xffff0000, v244
    v_lshlrev_b32 v130, 16, v245
    v_and_b32 v131, 0xffff0000, v245
    v_lshlrev_b32 v132, 16, v246
    v_and_b32 v133, 0xffff0000, v246
    v_lshlrev_b32 v134, 16, v247
    v_and_b32 v135, 0xffff0000, v247
    v_lshlrev_b32 v136, 16, v248
    v_and_b32 v137, 0xffff0000, v248
    v_add_f32 v138, v128, v129
    v_add_f32 v138, v138, v130
    v_add_f32 v138, v138, v131
    v_add_f32 v138, v138, v132
    v_add_f32 v138, v138, v133
    v_add_f32 v138, v138, v134
    v_add_f32 v138, v138, v135
    v_add_f32 v138, v138, v136
    v_add_f32 v138, v138, v137
    s_nop 1
    v_add_f32_dpp v138, v138, v138 row_shr:1 row_mask:0xf bank_mask:0xf bound_ctrl:0
    s_nop 1
    v_add_f32_dpp v138, v138, v138 row_shr:2 row_mask:0xf bank_mask:0xf bound_ctrl:0
    s_nop 1
    v_add_f32_dpp v138, v138, v138 row_shr:4 row_mask:0xf bank_mask:0xf bound_ctrl:0
    s_nop 1
    v_add_f32_dpp v138, v138, v138 row_shr:8 row_mask:0xf bank_mask:0xf bound_ctrl:0
    s_nop 1
    v_add_f32_dpp v138, v138, v138 row_bcast:15 row_mask:0xa bank_mask:0xf
    s_nop 1
    v_add_f32_dpp v138, v138, v138 row_bcast:31 row_mask:0xc bank_mask:0xf
    s_nop 0
    v_readlane_b32 s45, v138, 63
    v_mov_b32 v139, 0x3acccccd
    s_nop 0
    v_mul_f32 v139, s45, v139
    v_sub_f32 v128, v128, v139
    v_sub_f32 v129, v129, v139
    v_sub_f32 v130, v130, v139
    v_sub_f32 v131, v131, v139
    v_sub_f32 v132, v132, v139
    v_sub_f32 v133, v133, v139
    v_sub_f32 v134, v134, v139
    v_sub_f32 v135, v135, v139
    v_sub_f32 v136, v136, v139
    v_sub_f32 v137, v137, v139
    v_mul_f32 v138, v128, v128
    v_fmac_f32 v138, v129, v129
    v_fmac_f32 v138, v130, v130
    v_fmac_f32 v138, v131, v131
    v_fmac_f32 v138, v132, v132
    v_fmac_f32 v138, v133, v133
    v_fmac_f32 v138, v134, v134
    v_fmac_f32 v138, v135, v135
    v_fmac_f32 v138, v136, v136
    v_fmac_f32 v138, v137, v137
    s_nop 1
    v_add_f32_dpp v138, v138, v138 row_shr:1 row_mask:0xf bank_mask:0xf bound_ctrl:0
    s_nop 1
    v_add_f32_dpp v138, v138, v138 row_shr:2 row_mask:0xf bank_mask:0xf bound_ctrl:0
    s_nop 1
    v_add_f32_dpp v138, v138, v138 row_shr:4 row_mask:0xf bank_mask:0xf bound_ctrl:0
    s_nop 1
    v_add_f32_dpp v138, v138, v138 row_shr:8 row_mask:0xf bank_mask:0xf bound_ctrl:0
    s_nop 1
    v_add_f32_dpp v138, v138, v138 row_bcast:15 row_mask:0xa bank_mask:0xf
    s_nop 1
    v_add_f32_dpp v138, v138, v138 row_bcast:31 row_mask:0xc bank_mask:0xf
    s_nop 0
    v_readlane_b32 s45, v138, 63
    v_mov_b32 v138, 0x3acccccd
    s_nop 0
    v_mul_f32 v138, s45, v138
    v_cvt_pk_bf16_f32 v138, v138, v139
    v_and_b32 v128, 0xffff0000, v138
    v_lshlrev_b32 v138, 16, v138
    v_add_f32 v138, 0x3727c5ac, v138
    v_cvt_pk_bf16_f32 v138, v138, v138
    v_lshlrev_b32 v138, 16, v138
    v_sqrt_f32 v138, v138
    s_nop 0
    v_cvt_pk_bf16_f32 v138, v138, v138
    v_lshlrev_b32 v129, 16, v138
    s_lshl_b32 s45, s50, 3
    s_add_u32 s45, s45, 32768
    v_mov_b32 v138, 0
    s_mov_b64 exec, 1
    buffer_store_dwordx2 v[128:129], v138, s[20:23], s45 offen sc1
    s_mov_b64 exec, -1
    v_lshrrev_b32 v16, 2, v0
    v_and_b32 v17, 7, v16
    v_mul_u32_u24 v16, 1280, v16
    v_and_b32 v18, 3, v0
    v_lshl_add_u32 v16, v18, 3, v16
    s_mul_i32 s45, s32, 5
    s_add_u32 s45, s45, 0
    s_and_b32 s46, s45, 7
    s_lshr_b32 s45, s45, 3
    s_lshl_b32 s45, s45, 8
    v_xor_b32 v18, s46, v17
    v_lshl_add_u32 v18, v18, 5, v16
    v_add_u32 v40, s45, v18
    v_add_u32 v45, 81920, v40
    s_mul_i32 s45, s32, 5
    s_add_u32 s45, s45, 1
    s_and_b32 s46, s45, 7
    s_lshr_b32 s45, s45, 3
    s_lshl_b32 s45, s45, 8
    v_xor_b32 v18, s46, v17
    v_lshl_add_u32 v18, v18, 5, v16
    v_add_u32 v41, s45, v18
    v_add_u32 v46, 81920, v41
    s_mul_i32 s45, s32, 5
    s_add_u32 s45, s45, 2
    s_and_b32 s46, s45, 7
    s_lshr_b32 s45, s45, 3
    s_lshl_b32 s45, s45, 8
    v_xor_b32 v18, s46, v17
    v_lshl_add_u32 v18, v18, 5, v16
    v_add_u32 v42, s45, v18
    v_add_u32 v47, 81920, v42
    s_mul_i32 s45, s32, 5
    s_add_u32 s45, s45, 3
    s_and_b32 s46, s45, 7
    s_lshr_b32 s45, s45, 3
    s_lshl_b32 s45, s45, 8
    v_xor_b32 v18, s46, v17
    v_lshl_add_u32 v18, v18, 5, v16
    v_add_u32 v43, s45, v18
    v_add_u32 v48, 81920, v43
    s_mul_i32 s45, s32, 5
    s_add_u32 s45, s45, 4
    s_and_b32 s46, s45, 7
    s_lshr_b32 s45, s45, 3
    s_lshl_b32 s45, s45, 8
    v_xor_b32 v18, s46, v17
    v_lshl_add_u32 v18, v18, 5, v16
    v_add_u32 v44, s45, v18
    v_add_u32 v49, 81920, v44
    v_lshlrev_b32 v50, 4, v0
    v_add_u32 v51, 4096, v50
    s_add_u32 s41, s34, 0
    s_lshr_b32 s46, s41, 2
    s_and_b32 s41, s41, 3
    s_lshl_b32 s47, s46, 3
    s_cmp_eq_u32 s46, 5
    s_cselect_b32 s47, 38, s47
    s_cmp_eq_u32 s46, 6
    s_cselect_b32 s47, 44, s47
    s_cmp_eq_u32 s46, 7
    s_cselect_b32 s47, 49, s47
    s_add_u32 s41, s41, s47
    s_mul_i32 s46, s32, 74
    s_add_u32 s41, s41, s46
    s_mul_i32 s41, s41, 5120
    s_add_u32 s41, s41, 10485760
    s_waitcnt vmcnt(17)
    s_barrier
    ds_read_b64_tr_b16 v[64:65], v40 offset:0
    ds_read_b64_tr_b16 v[66:67], v40 offset:20480
    ds_read_b64_tr_b16 v[68:69], v41 offset:0
    ds_read_b64_tr_b16 v[70:71], v41 offset:20480
    ds_read_b64_tr_b16 v[72:73], v42 offset:0
    ds_read_b64_tr_b16 v[74:75], v42 offset:20480
    ds_read_b64_tr_b16 v[76:77], v43 offset:0
    ds_read_b64_tr_b16 v[78:79], v43 offset:20480
    ds_read_b64_tr_b16 v[80:81], v44 offset:0
    ds_read_b64_tr_b16 v[82:83], v44 offset:20480
    s_waitcnt lgkmcnt(0)
    buffer_store_dwordx4 v[64:67], v50, s[20:23], s41 offen offset:0 sc1
    buffer_store_dwordx4 v[68:71], v50, s[20:23], s41 offen offset:1024 sc1
    buffer_store_dwordx4 v[72:75], v50, s[20:23], s41 offen offset:2048 sc1
    buffer_store_dwordx4 v[76:79], v50, s[20:23], s41 offen offset:3072 sc1
    buffer_store_dwordx4 v[80:83], v51, s[20:23], s41 offen offset:0 sc1
    s_add_u32 s41, s34, 16
    s_lshr_b32 s46, s41, 2
    s_and_b32 s41, s41, 3
    s_lshl_b32 s47, s46, 3
    s_cmp_eq_u32 s46, 5
    s_cselect_b32 s47, 38, s47
    s_cmp_eq_u32 s46, 6
    s_cselect_b32 s47, 44, s47
    s_cmp_eq_u32 s46, 7
    s_cselect_b32 s47, 49, s47
    s_add_u32 s41, s41, s47
    s_mul_i32 s46, s32, 74
    s_add_u32 s41, s41, s46
    s_mul_i32 s41, s41, 5120
    s_add_u32 s41, s41, 10485760
    s_waitcnt vmcnt(17)
    s_barrier
    ds_read_b64_tr_b16 v[84:85], v40 offset:40960
    ds_read_b64_tr_b16 v[86:87], v40 offset:61440
    ds_read_b64_tr_b16 v[88:89], v41 offset:40960
    ds_read_b64_tr_b16 v[90:91], v41 offset:61440
    ds_read_b64_tr_b16 v[92:93], v42 offset:40960
    ds_read_b64_tr_b16 v[94:95], v42 offset:61440
    ds_read_b64_tr_b16 v[96:97], v43 offset:40960
    ds_read_b64_tr_b16 v[98:99], v43 offset:61440
    ds_read_b64_tr_b16 v[100:101], v44 offset:40960
    ds_read_b64_tr_b16 v[102:103], v44 offset:61440
    s_waitcnt lgkmcnt(0)
    buffer_store_dwordx4 v[84:87], v50, s[20:23], s41 offen offset:0 sc1
    buffer_store_dwordx4 v[88:91], v50, s[20:23], s41 offen offset:1024 sc1
    buffer_store_dwordx4 v[92:95], v50, s[20:23], s41 offen offset:2048 sc1
    buffer_store_dwordx4 v[96:99], v50, s[20:23], s41 offen offset:3072 sc1
    buffer_store_dwordx4 v[100:103], v51, s[20:23], s41 offen offset:0 sc1
    s_add_u32 s41, s34, 0
    s_andn2_b32 s46, s41, 3
    s_add_u32 s46, s46, 4
    s_cmp_ge_u32 s41, 18
    s_cselect_b32 s46, 24, s46
    s_cmp_ge_u32 s41, 20
    s_cselect_b32 s46, 28, s46
    s_cmp_ge_u32 s41, 21
    s_cselect_b32 s46, 32, s46
    s_add_u32 s41, s41, s46
    s_mul_i32 s46, s32, 74
    s_add_u32 s41, s41, s46
    s_mul_i32 s41, s41, 5120
    s_add_u32 s41, s41, 10485760
    s_waitcnt vmcnt(0)
    s_barrier
    v_readfirstlane_b32 s82, v242
    v_readfirstlane_b32 s83, v243
    s_cmp_lg_u32 s82, 0
    s_cbranch_scc1 SP_NON_OK
    s_mov_b32 s81, 0
SP_NON_SP:
    s_sleep 2
    v_mov_b32 v242, 0
    buffer_load_dwordx2 v[242:243], v242, s[4:7], 0 offen sc1
    s_waitcnt vmcnt(0)
    v_readfirstlane_b32 s82, v242
    v_readfirstlane_b32 s83, v243
    s_add_u32 s81, s81, 1
    s_cmp_ge_u32 s81, 200000
    s_cbranch_scc1 SP_NON_OK
    s_cmp_eq_u32 s82, 0
    s_cbranch_scc1 SP_NON_SP
SP_NON_OK:
    s_cmp_eq_u32 s32, 1
    s_cbranch_scc0 SP_NP1
    s_add_u32 s45, s82, 1
    v_mov_b32 v16, s45
    v_mov_b32 v17, s83
    v_mov_b32 v18, 0
    s_lshl_b32 s45, s2, 7
    s_mov_b64 exec, 1
    buffer_store_dwordx2 v[16:17], v18, s[20:23], s45 offen sc1
    s_mov_b64 exec, -1
SP_NP1:
    s_cmp_lt_u32 s34, 10
    s_cbranch_scc0 RL_NO5
    s_add_u32 s45, s34, 32
    s_andn2_b32 s46, s45, 3
    s_add_u32 s46, s46, 4
    s_cmp_ge_u32 s45, 18
    s_cselect_b32 s46, 24, s46
    s_cmp_ge_u32 s45, 20
    s_cselect_b32 s46, 28, s46
    s_cmp_ge_u32 s45, 21
    s_cselect_b32 s46, 32, s46
    s_add_u32 s45, s45, s46
    s_bfe_u32 s46, s32, 0x10001
    s_and_b32 s47, s32, 1
    s_lshr_b32 s48, s32, 2
    s_cmp_ge_u32 s45, 54
    s_cbranch_scc1 RL4_WO
    s_mov_b32 s12, s66
    s_and_b32 s13, s67, 0xffff
    s_mov_b32 s14, 2211840
    s_mov_b32 s15, 0x20000
    s_mul_i32 s50, s45, 86
    s_lshr_b32 s50, s50, 8
    s_mul_i32 s50, s50, 3
    s_sub_u32 s50, s45, s50
    s_cmp_eq_u32 s50, 1
    s_cselect_b32 s50, 4, 3
    s_lshl_b32 s46, s46, s50
    s_cmp_eq_u32 s50, 4
    s_cselect_b32 s50, 3, 4
    s_lshl_b32 s48, s48, s50
    s_lshl_b32 s47, s47, 2
    s_lshl_b32 s36, s45, 5
    s_branch RL4_GO
RL4_WO:
    s_mov_b32 s12, s58
    s_and_b32 s13, s59, 0xffff
    s_mov_b32 s14, 819200
    s_mov_b32 s15, 0x20000
    s_sub_u32 s45, s45, 54
    s_mul_i32 s50, s45, 52
    s_lshr_b32 s50, s50, 8
    s_mul_i32 s36, s50, 160
    s_mul_i32 s50, s50, 5
    s_sub_u32 s45, s45, s50
    s_cmp_eq_u32 s45, 4
    s_cbranch_scc1 RL4_LO
    s_mul_i32 s45, s45, 40
    s_add_u32 s36, s36, s45
    s_mul_i32 s46, s46, 20
    s_lshl_b32 s47, s47, 2
    s_lshl_b32 s48, s48, 3
    s_branch RL4_GO
RL4_LO:
    s_add_u32 s36, s36, 16
    s_xor_b32 s48, s48, s47
    s_mul_i32 s48, s48, 20
    s_mul_i32 s46, s46, 80
    s_mul_i32 s47, s47, 40
RL4_GO:
    s_add_u32 s36, s36, s46
    s_add_u32 s36, s36, s47
    s_add_u32 s36, s36, s48
    s_mul_i32 s36, s36, 1280
    s_add_u32 m0, s40, 0
    s_nop 0
    buffer_load_dwordx4 v32, s[12:15], s36 offen lds
    s_add_u32 m0, s40, 1024
    s_nop 0
    buffer_load_dwordx4 v33, s[12:15], s36 offen lds
    s_add_u32 m0, s40, 2048
    s_nop 0
    buffer_load_dwordx4 v34, s[12:15], s36 offen lds
    s_add_u32 m0, s40, 3072
    s_nop 0
    buffer_load_dwordx4 v35, s[12:15], s36 offen lds
    s_add_u32 m0, s40, 4096
    s_nop 0
    buffer_load_dwordx4 v36, s[12:15], s36 offen lds
RL_NO5:
    ds_read_b64_tr_b16 v[64:65], v45 offset:0
    ds_read_b64_tr_b16 v[66:67], v45 offset:20480
    ds_read_b64_tr_b16 v[68:69], v46 offset:0
    ds_read_b64_tr_b16 v[70:71], v46 offset:20480
    ds_read_b64_tr_b16 v[72:73], v47 offset:0
    ds_read_b64_tr_b16 v[74:75], v47 offset:20480
    ds_read_b64_tr_b16 v[76:77], v48 offset:0
    ds_read_b64_tr_b16 v[78:79], v48 offset:20480
    ds_read_b64_tr_b16 v[80:81], v49 offset:0
    ds_read_b64_tr_b16 v[82:83], v49 offset:20480
    s_waitcnt lgkmcnt(0)
    buffer_store_dwordx4 v[64:67], v50, s[20:23], s41 offen offset:0 sc1
    buffer_store_dwordx4 v[68:71], v50, s[20:23], s41 offen offset:1024 sc1
    buffer_store_dwordx4 v[72:75], v50, s[20:23], s41 offen offset:2048 sc1
    buffer_store_dwordx4 v[76:79], v50, s[20:23], s41 offen offset:3072 sc1
    buffer_store_dwordx4 v[80:83], v51, s[20:23], s41 offen offset:0 sc1
    s_add_u32 s41, s34, 16
    s_andn2_b32 s46, s41, 3
    s_add_u32 s46, s46, 4
    s_cmp_ge_u32 s41, 18
    s_cselect_b32 s46, 24, s46
    s_cmp_ge_u32 s41, 20
    s_cselect_b32 s46, 28, s46
    s_cmp_ge_u32 s41, 21
    s_cselect_b32 s46, 32, s46
    s_add_u32 s41, s41, s46
    s_mul_i32 s46, s32, 74
    s_add_u32 s41, s41, s46
    s_mul_i32 s41, s41, 5120
    s_add_u32 s41, s41, 10485760
    s_waitcnt vmcnt(63)
    s_barrier
    ds_read_b64_tr_b16 v[84:85], v45 offset:40960
    ds_read_b64_tr_b16 v[86:87], v45 offset:61440
    ds_read_b64_tr_b16 v[88:89], v46 offset:40960
    ds_read_b64_tr_b16 v[90:91], v46 offset:61440
    ds_read_b64_tr_b16 v[92:93], v47 offset:40960
    ds_read_b64_tr_b16 v[94:95], v47 offset:61440
    ds_read_b64_tr_b16 v[96:97], v48 offset:40960
    ds_read_b64_tr_b16 v[98:99], v48 offset:61440
    ds_read_b64_tr_b16 v[100:101], v49 offset:40960
    ds_read_b64_tr_b16 v[102:103], v49 offset:61440
    s_waitcnt lgkmcnt(0)
    buffer_store_dwordx4 v[84:87], v50, s[20:23], s41 offen offset:0 sc1
    buffer_store_dwordx4 v[88:91], v50, s[20:23], s41 offen offset:1024 sc1
    buffer_store_dwordx4 v[92:95], v50, s[20:23], s41 offen offset:2048 sc1
    buffer_store_dwordx4 v[96:99], v50, s[20:23], s41 offen offset:3072 sc1
    buffer_store_dwordx4 v[100:103], v51, s[20:23], s41 offen offset:0 sc1
    s_cmp_lt_u32 s34, 10
    s_cbranch_scc0 RL_DONE
    s_add_u32 s41, s34, 32
    s_andn2_b32 s46, s41, 3
    s_add_u32 s46, s46, 4
    s_cmp_ge_u32 s41, 18
    s_cselect_b32 s46, 24, s46
    s_cmp_ge_u32 s41, 20
    s_cselect_b32 s46, 28, s46
    s_cmp_ge_u32 s41, 21
    s_cselect_b32 s46, 32, s46
    s_add_u32 s41, s41, s46
    s_mul_i32 s46, s32, 74
    s_add_u32 s41, s41, s46
    s_mul_i32 s41, s41, 5120
    s_add_u32 s41, s41, 10485760
    s_waitcnt vmcnt(10)
    s_barrier
    ds_read_b64_tr_b16 v[64:65], v40 offset:0
    ds_read_b64_tr_b16 v[66:67], v40 offset:20480
    ds_read_b64_tr_b16 v[68:69], v41 offset:0
    ds_read_b64_tr_b16 v[70:71], v41 offset:20480
    ds_read_b64_tr_b16 v[72:73], v42 offset:0
    ds_read_b64_tr_b16 v[74:75], v42 offset:20480
    ds_read_b64_tr_b16 v[76:77], v43 offset:0
    ds_read_b64_tr_b16 v[78:79], v43 offset:20480
    ds_read_b64_tr_b16 v[80:81], v44 offset:0
    ds_read_b64_tr_b16 v[82:83], v44 offset:20480
    s_waitcnt lgkmcnt(0)
    buffer_store_dwordx4 v[64:67], v50, s[20:23], s41 offen offset:0 sc1
    buffer_store_dwordx4 v[68:71], v50, s[20:23], s41 offen offset:1024 sc1
    buffer_store_dwordx4 v[72:75], v50, s[20:23], s41 offen offset:2048 sc1
    buffer_store_dwordx4 v[76:79], v50, s[20:23], s41 offen offset:3072 sc1
    buffer_store_dwordx4 v[80:83], v51, s[20:23], s41 offen offset:0 sc1
RL_DONE:
    s_waitcnt vmcnt(0)
    s_barrier
    s_cmp_eq_u32 s32, 1
    s_cbranch_scc0 SP_NP2
    s_add_u32 s45, s82, 2
    v_mov_b32 v16, s45
    v_mov_b32 v17, s83
    v_mov_b32 v18, 0
    s_lshl_b32 s45, s2, 7
    s_mov_b64 exec, 1
    buffer_store_dwordx2 v[16:17], v18, s[20:23], s45 offen sc1
    s_mov_b64 exec, -1
SP_NP2:
    v_lshlrev_b32 v8, 4, v0
    v_add_u32 v9, 4096, v8
    s_mul_i32 s29, s32, 10240
    s_add_u32 s30, s29, 81920
    s_lshl_b32 s45, s32, 3
    s_cmp_eq_u32 s32, 5
    s_cselect_b32 s45, 38, s45
    s_cmp_eq_u32 s32, 6
    s_cselect_b32 s45, 44, s45
    s_cmp_eq_u32 s32, 7
    s_cselect_b32 s45, 49, s45
    s_bfe_u32 s46, s2, 0x30003
    s_mul_i32 s46, s46, 74
    s_add_u32 s28, s45, s46
    s_mul_i32 s28, s28, 5120
    s_add_u32 s28, s28, 10485760
    s_mov_b32 s81, 0
SP_PSP_SP:
    buffer_load_dwordx2 v[28:29], v30, s[20:23], 0 offen sc1
    s_waitcnt vmcnt(0)
    v_subrev_u32 v16, s82, v28
    v_subrev_u32 v16, 2, v16
    v_xor_b32 v17, s83, v29
    v_cmp_ne_u32 s[74:75], 0, v17
    v_cmp_lt_u32 vcc, 1, v16
    s_nop 0
    s_or_b64 vcc, vcc, s[74:75]
    s_add_u32 s81, s81, 1
    s_cmp_ge_u32 s81, 200000
    s_cbranch_scc1 SP_PSP_OK
    s_cbranch_vccz SP_PSP_OK
    s_sleep 2
    s_branch SP_PSP_SP
SP_PSP_OK:
    s_add_u32 s48, s28, 0
    buffer_load_dwordx4 v[184:187], v8, s[20:23], s48 offen offset:0 sc1
    buffer_load_dwordx4 v[188:191], v8, s[20:23], s48 offen offset:1024 sc1
    buffer_load_dwordx4 v[192:195], v8, s[20:23], s48 offen offset:2048 sc1
    buffer_load_dwordx4 v[196:199], v8, s[20:23], s48 offen offset:3072 sc1
    buffer_load_dwordx4 v[200:203], v9, s[20:23], s48 offen offset:0 sc1
    s_add_u32 s48, s28, 5120
    buffer_load_dwordx4 v[204:207], v8, s[20:23], s48 offen offset:0 sc1
    buffer_load_dwordx4 v[208:211], v8, s[20:23], s48 offen offset:1024 sc1
    buffer_load_dwordx4 v[212:215], v8, s[20:23], s48 offen offset:2048 sc1
    buffer_load_dwordx4 v[216:219], v8, s[20:23], s48 offen offset:3072 sc1
    buffer_load_dwordx4 v[220:223], v9, s[20:23], s48 offen offset:0 sc1
    s_add_u32 s48, s28, 20480
    buffer_load_dwordx4 v[224:227], v8, s[20:23], s48 offen offset:0 sc1
    buffer_load_dwordx4 v[228:231], v8, s[20:23], s48 offen offset:1024 sc1
    buffer_load_dwordx4 v[232:235], v8, s[20:23], s48 offen offset:2048 sc1
    buffer_load_dwordx4 v[236:239], v8, s[20:23], s48 offen offset:3072 sc1
    buffer_load_dwordx4 v[240:243], v9, s[20:23], s48 offen offset:0 sc1
    s_add_u32 s48, s28, 10240
    s_add_u32 m0, s30, 0
    s_nop 0
    buffer_load_dwordx4 v8, s[20:23], s48 offen offset:0 sc1 lds
    s_add_u32 m0, s30, 0
    s_nop 0
    buffer_load_dwordx4 v8, s[20:23], s48 offen offset:1024 sc1 lds
    s_add_u32 m0, s30, 0
    s_nop 0
    buffer_load_dwordx4 v8, s[20:23], s48 offen offset:2048 sc1 lds
    s_add_u32 m0, s30, 0
    s_nop 0
    buffer_load_dwordx4 v8, s[20:23], s48 offen offset:3072 sc1 lds
    s_add_u32 m0, s30, 4096
    s_nop 0
    buffer_load_dwordx4 v9, s[20:23], s48 offen offset:0 sc1 lds
    s_add_u32 s48, s28, 15360
    s_add_u32 m0, s30, 5120
    s_nop 0
    buffer_load_dwordx4 v8, s[20:23], s48 offen offset:0 sc1 lds
    s_add_u32 m0, s30, 5120
    s_nop 0
    buffer_load_dwordx4 v8, s[20:23], s48 offen offset:1024 sc1 lds
    s_add_u32 m0, s30, 5120
    s_nop 0
    buffer_load_dwordx4 v8, s[20:23], s48 offen offset:2048 sc1 lds
    s_add_u32 m0, s30, 5120
    s_nop 0
    buffer_load_dwordx4 v8, s[20:23], s48 offen offset:3072 sc1 lds
    s_add_u32 m0, s30, 9216
    s_nop 0
    buffer_load_dwordx4 v9, s[20:23], s48 offen offset:0 sc1 lds
    s_mov_b32 s31, 3
P1_FIN:
    s_lshr_b32 s45, s2, 6
    s_lshl_b32 s45, s45, 1
    s_and_b32 s46, s2, 3
    s_lshl_b32 s46, s46, 3
    s_add_u32 s45, s45, s46
    s_bfe_u32 s46, s2, 0x10002
    s_add_u32 s45, s45, s46
    s_lshl_b32 s45, s45, 7
    v_mov_b32 v12, s45
    buffer_load_dwordx2 v[20:21], v12, s[20:23], 0 offen sc1
    s_waitcnt vmcnt(0)
P1_FIN2:
    s_add_u32 s45, s82, 2
    v_mov_b32 v16, s45
    v_mov_b32 v17, s83
    s_lshl_b32 s45, s2, 7
    v_mov_b32 v18, s45
    s_cmp_eq_u32 s32, 0
    s_barrier
    s_cbranch_scc0 P2_NP2
    s_mov_b64 exec, 1
    buffer_store_dwordx2 v[16:17], v18, s[20:23], 0 offen sc1
    s_mov_b64 exec, -1
    v_mov_b32 v20, 0
    v_mov_b32 v21, 0
    v_mov_b32 v22, 80896
    ds_write_b64 v22, v[20:21]
    s_waitcnt lgkmcnt(0)
P2_NP2:
    s_barrier
    s_cmp_eq_u32 s38, 0
    s_cbranch_scc0 P2_S
    s_cmp_eq_u32 s32, 7
    s_cbranch_scc0 P2D_W7
    s_or_b32 s45, s35, 2
    s_cmp_eq_u32 s45, 2
    s_cbranch_scc0 P2D_W7
    s_cmp_eq_u32 s31, 0
    s_cbranch_scc1 P2D_W7
    s_add_u32 s48, s28, 15360
    s_add_u32 m0, s30, 9216
    s_nop 0
    buffer_load_dwordx4 v9, s[20:23], s48 offen offset:0 sc1 lds
P2D_W7:
    s_cmp_eq_u32 s31, 3
    s_cbranch_scc1 P2D_HAVE
    v_subrev_u32 v16, s82, v28
    v_subrev_u32 v16, 2, v16
    v_xor_b32 v17, s83, v29
    v_cmp_ne_u32 s[74:75], 0, v17
    v_cmp_lt_u32 vcc, 1, v16
    s_nop 0
    s_or_b64 vcc, vcc, s[74:75]
    s_cbranch_vccz P2D_PSP_OK
    s_mov_b32 s81, 0
P2D_PSP_SP:
    buffer_load_dwordx2 v[28:29], v30, s[20:23], 0 offen sc1
    s_waitcnt vmcnt(0)
    v_subrev_u32 v16, s82, v28
    v_subrev_u32 v16, 2, v16
    v_xor_b32 v17, s83, v29
    v_cmp_ne_u32 s[74:75], 0, v17
    v_cmp_lt_u32 vcc, 1, v16
    s_nop 0
    s_or_b64 vcc, vcc, s[74:75]
    s_add_u32 s81, s81, 1
    s_cmp_ge_u32 s81, 200000
    s_cbranch_scc1 P2D_PSP_OK
    s_cbranch_vccz P2D_PSP_OK
    s_sleep 2
    s_branch P2D_PSP_SP
P2D_PSP_OK:
    s_cmp_eq_u32 s31, 0
    s_cbranch_scc0 P2D_E
    s_add_u32 s48, s28, 0
    buffer_load_dwordx4 v[184:187], v8, s[20:23], s48 offen offset:0 sc1
    buffer_load_dwordx4 v[188:191], v8, s[20:23], s48 offen offset:1024 sc1
    buffer_load_dwordx4 v[192:195], v8, s[20:23], s48 offen offset:2048 sc1
    buffer_load_dwordx4 v[196:199], v8, s[20:23], s48 offen offset:3072 sc1
    buffer_load_dwordx4 v[200:203], v9, s[20:23], s48 offen offset:0 sc1
    s_add_u32 s48, s28, 5120
    buffer_load_dwordx4 v[204:207], v8, s[20:23], s48 offen offset:0 sc1
    buffer_load_dwordx4 v[208:211], v8, s[20:23], s48 offen offset:1024 sc1
    buffer_load_dwordx4 v[212:215], v8, s[20:23], s48 offen offset:2048 sc1
    buffer_load_dwordx4 v[216:219], v8, s[20:23], s48 offen offset:3072 sc1
    buffer_load_dwordx4 v[220:223], v9, s[20:23], s48 offen offset:0 sc1
    s_add_u32 s48, s28, 10240
    s_add_u32 m0, s30, 0
    s_nop 0
    buffer_load_dwordx4 v8, s[20:23], s48 offen offset:0 sc1 lds
    s_add_u32 m0, s30, 0
    s_nop 0
    buffer_load_dwordx4 v8, s[20:23], s48 offen offset:1024 sc1 lds
    s_add_u32 m0, s30, 0
    s_nop 0
    buffer_load_dwordx4 v8, s[20:23], s48 offen offset:2048 sc1 lds
    s_add_u32 m0, s30, 0
    s_nop 0
    buffer_load_dwordx4 v8, s[20:23], s48 offen offset:3072 sc1 lds
    s_add_u32 m0, s30, 4096
    s_nop 0
    buffer_load_dwordx4 v9, s[20:23], s48 offen offset:0 sc1 lds
    s_add_u32 s48, s28, 15360
    s_add_u32 m0, s30, 5120
    s_nop 0
    buffer_load_dwordx4 v8, s[20:23], s48 offen offset:0 sc1 lds
    s_add_u32 m0, s30, 5120
    s_nop 0
    buffer_load_dwordx4 v8, s[20:23], s48 offen offset:1024 sc1 lds
    s_add_u32 m0, s30, 5120
    s_nop 0
    buffer_load_dwordx4 v8, s[20:23], s48 offen offset:2048 sc1 lds
    s_add_u32 m0, s30, 5120
    s_nop 0
    buffer_load_dwordx4 v8, s[20:23], s48 offen offset:3072 sc1 lds
    s_add_u32 m0, s30, 9216
    s_nop 0
    buffer_load_dwordx4 v9, s[20:23], s48 offen offset:0 sc1 lds
    P2D_E:
    s_add_u32 s48, s28, 20480
    buffer_load_dwordx4 v[224:227], v8, s[20:23], s48 offen offset:0 sc1
    buffer_load_dwordx4 v[228:231], v8, s[20:23], s48 offen offset:1024 sc1
    buffer_load_dwordx4 v[232:235], v8, s[20:23], s48 offen offset:2048 sc1
    buffer_load_dwordx4 v[236:239], v8, s[20:23], s48 offen offset:3072 sc1
    buffer_load_dwordx4 v[240:243], v9, s[20:23], s48 offen offset:0 sc1
P2D_HAVE:
    s_add_u32 s48, s28, 30720
    buffer_load_dwordx4 v[144:147], v8, s[20:23], s48 offen offset:0 sc1
    buffer_load_dwordx4 v[148:151], v8, s[20:23], s48 offen offset:1024 sc1
    buffer_load_dwordx4 v[152:155], v8, s[20:23], s48 offen offset:2048 sc1
    buffer_load_dwordx4 v[156:159], v8, s[20:23], s48 offen offset:3072 sc1
    buffer_load_dwordx4 v[160:163], v9, s[20:23], s48 offen offset:0 sc1
    s_add_u32 s48, s28, 25600
    buffer_load_dwordx4 v[164:167], v8, s[20:23], s48 offen offset:0 sc1
    buffer_load_dwordx4 v[168:171], v8, s[20:23], s48 offen offset:1024 sc1
    buffer_load_dwordx4 v[172:175], v8, s[20:23], s48 offen offset:2048 sc1
    buffer_load_dwordx4 v[176:179], v8, s[20:23], s48 offen offset:3072 sc1
    buffer_load_dwordx4 v[180:183], v9, s[20:23], s48 offen offset:0 sc1
    s_add_u32 s48, s28, 35840
    s_add_u32 m0, s29, 0
    s_nop 0
    buffer_load_dwordx4 v8, s[20:23], s48 offen offset:0 sc1 lds
    s_add_u32 m0, s29, 0
    s_nop 0
    buffer_load_dwordx4 v8, s[20:23], s48 offen offset:1024 sc1 lds
    s_add_u32 m0, s29, 0
    s_nop 0
    buffer_load_dwordx4 v8, s[20:23], s48 offen offset:2048 sc1 lds
    s_add_u32 m0, s29, 0
    s_nop 0
    buffer_load_dwordx4 v8, s[20:23], s48 offen offset:3072 sc1 lds
    s_add_u32 m0, s29, 4096
    s_nop 0
    buffer_load_dwordx4 v9, s[20:23], s48 offen offset:0 sc1 lds
    s_lshl_b32 s45, s32, 3
    s_cmp_eq_u32 s32, 5
    s_cselect_b32 s45, 38, s45
    s_cmp_eq_u32 s32, 6
    s_cselect_b32 s45, 44, s45
    s_cmp_eq_u32 s32, 7
    s_cselect_b32 s45, 49, s45
    s_cmp_ge_u32 s32, 4
    s_cselect_b32 s46, 5, 7
    s_cmp_ge_u32 s32, 6
    s_cselect_b32 s46, 4, s46
    s_add_u32 s46, s46, s45
    s_mul_i32 s45, s45, 86
    s_lshr_b32 s45, s45, 8
    s_mul_i32 s46, s46, 86
    s_lshr_b32 s46, s46, 8
    v_add_u32 v16, s45, v0
    v_min_u32 v16, s46, v16
    v_cmp_le_u32 vcc, 14, v16
    s_nop 1
    v_addc_co_u32 v17, vcc, 0, v16, vcc
    v_mul_u32_u24 v31, 52, v17
    v_lshrrev_b32 v31, 8, v31
    v_mul_u32_u24 v16, 5, v31
    v_sub_u32 v16, v17, v16
    v_add_u32 v16, 3, v16
    v_lshlrev_b32 v16, 5, v16
    v_lshl_add_u32 v31, v31, 1, v16
    s_and_b32 s45, s2, 3
    s_lshl_b32 s45, s45, 3
    s_bfe_u32 s46, s2, 0x10002
    s_add_u32 s45, s45, s46
    v_add_u32 v31, s45, v31
    v_lshlrev_b32 v31, 7, v31
    buffer_load_dwordx2 v[24:25], v31, s[20:23], 0 offen sc1
    s_mov_b32 s16, s68
    s_and_b32 s17, s69, 0xffff
    s_mov_b32 s18, 2621440
    s_mov_b32 s19, 0x20000
    s_and_b32 s45, s2, 7
    s_lshl_b32 s45, s45, 4
    s_lshr_b32 s46, s2, 6
    s_lshl_b32 s46, s46, 2
    s_add_u32 s45, s45, s46
    s_mul_i32 s40, s45, 54
    s_lshl_b32 s46, s32, 3
    s_cmp_eq_u32 s32, 5
    s_cselect_b32 s46, 38, s46
    s_cmp_eq_u32 s32, 6
    s_cselect_b32 s46, 44, s46
    s_cmp_eq_u32 s32, 7
    s_cselect_b32 s46, 49, s46
    s_add_u32 s40, s40, s46
    s_lshl_b32 s40, s40, 10
    s_add_u32 s40, s40, 16777216
    v_lshlrev_b32 v1, 4, v0
    v_add_u32 v2, 55296, v1
    v_add_u32 v3, 110592, v1
    v_add_u32 v4, 165888, v1
    v_add_u32 v11, s30, v1
    v_add_u32 v10, s29, v1
    v_and_b32 v16, 15, v0
    v_mul_u32_u24 v16, 320, v16
    v_lshrrev_b32 v17, 4, v0
    v_lshrrev_b32 v18, 1, v0
    v_xor_b32 v17, v17, v18
    v_and_b32 v17, 3, v17
    v_lshl_add_u32 v16, v17, 4, v16
    v_add_u32 v14, s29, v16
    v_add_u32 v15, s30, v16
    s_waitcnt vmcnt(0)
    v_subrev_u32 v16, s82, v24
    v_subrev_u32 v16, 2, v16
    v_xor_b32 v17, s83, v25
    v_cmp_ne_u32 s[74:75], 0, v17
    v_cmp_lt_u32 vcc, 1, v16
    s_nop 0
    s_or_b64 vcc, vcc, s[74:75]
    s_cbranch_vccz P2D_PH_OK
    s_mov_b32 s81, 0
P2D_PH_SP:
    buffer_load_dwordx2 v[24:25], v31, s[20:23], 0 offen sc1
    s_waitcnt vmcnt(0)
    v_subrev_u32 v16, s82, v24
    v_subrev_u32 v16, 2, v16
    v_xor_b32 v17, s83, v25
    v_cmp_ne_u32 s[74:75], 0, v17
    v_cmp_lt_u32 vcc, 1, v16
    s_nop 0
    s_or_b64 vcc, vcc, s[74:75]
    s_add_u32 s81, s81, 1
    s_cmp_ge_u32 s81, 200000
    s_cbranch_scc1 P2D_PH_OK
    s_cbranch_vccz P2D_PH_OK
    s_sleep 2
    s_branch P2D_PH_SP
P2D_PH_OK:
    s_add_u32 s47, s40, 6144
    buffer_load_dwordx4 v[112:115], v1, s[20:23], s47 offen sc1
    buffer_load_dwordx4 v[116:119], v2, s[20:23], s47 offen sc1
    buffer_load_dwordx4 v[120:123], v3, s[20:23], s47 offen sc1
    buffer_load_dwordx4 v[124:127], v4, s[20:23], s47 offen sc1
    s_add_u32 s47, s40, 4096
    buffer_load_dwordx4 v[128:131], v1, s[20:23], s47 offen sc1
    buffer_load_dwordx4 v[132:135], v2, s[20:23], s47 offen sc1
    buffer_load_dwordx4 v[136:139], v3, s[20:23], s47 offen sc1
    buffer_load_dwordx4 v[140:143], v4, s[20:23], s47 offen sc1
    s_waitcnt vmcnt(4)
    v_mfma_f32_16x16x32_bf16 v[32:35], v[144:147], v[112:115], 0
    v_mfma_f32_16x16x32_bf16 v[48:51], v[148:151], v[112:115], 0
    v_mfma_f32_16x16x32_bf16 v[64:67], v[152:155], v[112:115], 0
    v_mfma_f32_16x16x32_bf16 v[80:83], v[156:159], v[112:115], 0
    v_mfma_f32_16x16x32_bf16 v[96:99], v[160:163], v[112:115], 0
    v_mfma_f32_16x16x32_bf16 v[36:39], v[144:147], v[116:119], 0
    v_mfma_f32_16x16x32_bf16 v[52:55], v[148:151], v[116:119], 0
    v_mfma_f32_16x16x32_bf16 v[68:71], v[152:155], v[116:119], 0
    v_mfma_f32_16x16x32_bf16 v[84:87], v[156:159], v[116:119], 0
    v_mfma_f32_16x16x32_bf16 v[100:103], v[160:163], v[116:119], 0
    v_mfma_f32_16x16x32_bf16 v[40:43], v[144:147], v[120:123], 0
    v_mfma_f32_16x16x32_bf16 v[56:59], v[148:151], v[120:123], 0
    v_mfma_f32_16x16x32_bf16 v[72:75], v[152:155], v[120:123], 0
    v_mfma_f32_16x16x32_bf16 v[88:91], v[156:159], v[120:123], 0
    v_mfma_f32_16x16x32_bf16 v[104:107], v[160:163], v[120:123], 0
    v_mfma_f32_16x16x32_bf16 v[44:47], v[144:147], v[124:127], 0
    v_mfma_f32_16x16x32_bf16 v[60:63], v[148:151], v[124:127], 0
    v_mfma_f32_16x16x32_bf16 v[76:79], v[152:155], v[124:127], 0
    v_mfma_f32_16x16x32_bf16 v[92:95], v[156:159], v[124:127], 0
    v_mfma_f32_16x16x32_bf16 v[108:111], v[160:163], v[124:127], 0
    s_add_u32 s47, s40, 5120
    buffer_load_dwordx4 v[144:147], v1, s[20:23], s47 offen sc1
    buffer_load_dwordx4 v[148:151], v2, s[20:23], s47 offen sc1
    buffer_load_dwordx4 v[152:155], v3, s[20:23], s47 offen sc1
    buffer_load_dwordx4 v[156:159], v4, s[20:23], s47 offen sc1
    s_add_u32 s47, s40, 0
    buffer_load_dwordx4 v[112:115], v1, s[20:23], s47 offen sc1
    buffer_load_dwordx4 v[116:119], v2, s[20:23], s47 offen sc1
    buffer_load_dwordx4 v[120:123], v3, s[20:23], s47 offen sc1
    buffer_load_dwordx4 v[124:127], v4, s[20:23], s47 offen sc1
    s_waitcnt vmcnt(8)
    v_mfma_f32_16x16x32_bf16 v[32:35], v[224:227], v[128:131], v[32:35]
    v_mfma_f32_16x16x32_bf16 v[48:51], v[228:231], v[128:131], v[48:51]
    v_mfma_f32_16x16x32_bf16 v[64:67], v[232:235], v[128:131], v[64:67]
    v_mfma_f32_16x16x32_bf16 v[80:83], v[236:239], v[128:131], v[80:83]
    v_mfma_f32_16x16x32_bf16 v[96:99], v[240:243], v[128:131], v[96:99]
    v_mfma_f32_16x16x32_bf16 v[36:39], v[224:227], v[132:135], v[36:39]
    v_mfma_f32_16x16x32_bf16 v[52:55], v[228:231], v[132:135], v[52:55]
    v_mfma_f32_16x16x32_bf16 v[68:71], v[232:235], v[132:135], v[68:71]
    v_mfma_f32_16x16x32_bf16 v[84:87], v[236:239], v[132:135], v[84:87]
    v_mfma_f32_16x16x32_bf16 v[100:103], v[240:243], v[132:135], v[100:103]
    v_mfma_f32_16x16x32_bf16 v[40:43], v[224:227], v[136:139], v[40:43]
    v_mfma_f32_16x16x32_bf16 v[56:59], v[228:231], v[136:139], v[56:59]
    v_mfma_f32_16x16x32_bf16 v[72:75], v[232:235], v[136:139], v[72:75]
    v_mfma_f32_16x16x32_bf16 v[88:91], v[236:239], v[136:139], v[88:91]
    v_mfma_f32_16x16x32_bf16 v[104:107], v[240:243], v[136:139], v[104:107]
    v_mfma_f32_16x16x32_bf16 v[44:47], v[224:227], v[140:143], v[44:47]
    v_mfma_f32_16x16x32_bf16 v[60:63], v[228:231], v[140:143], v[60:63]
    v_mfma_f32_16x16x32_bf16 v[76:79], v[232:235], v[140:143], v[76:79]
    v_mfma_f32_16x16x32_bf16 v[92:95], v[236:239], v[140:143], v[92:95]
    v_mfma_f32_16x16x32_bf16 v[108:111], v[240:243], v[140:143], v[108:111]
    s_add_u32 s47, s40, 1024
    buffer_load_dwordx4 v[128:131], v1, s[20:23], s47 offen sc1
    buffer_load_dwordx4 v[132:135], v2, s[20:23], s47 offen sc1
    buffer_load_dwordx4 v[136:139], v3, s[20:23], s47 offen sc1
    buffer_load_dwordx4 v[140:143], v4, s[20:23], s47 offen sc1
    s_waitcnt vmcnt(21)
    ds_read_b128 v[224:227], v10 offset:0
    ds_read_b128 v[228:231], v10 offset:1024
    ds_read_b128 v[232:235], v10 offset:2048
    ds_read_b128 v[236:239], v10 offset:3072
    ds_read_b128 v[240:243], v10 offset:4096
    s_waitcnt vmcnt(8)
    v_mfma_f32_16x16x32_bf16 v[32:35], v[164:167], v[144:147], v[32:35]
    v_mfma_f32_16x16x32_bf16 v[48:51], v[168:171], v[144:147], v[48:51]
    v_mfma_f32_16x16x32_bf16 v[64:67], v[172:175], v[144:147], v[64:67]
    v_mfma_f32_16x16x32_bf16 v[80:83], v[176:179], v[144:147], v[80:83]
    v_mfma_f32_16x16x32_bf16 v[96:99], v[180:183], v[144:147], v[96:99]
    v_mfma_f32_16x16x32_bf16 v[36:39], v[164:167], v[148:151], v[36:39]
    v_mfma_f32_16x16x32_bf16 v[52:55], v[168:171], v[148:151], v[52:55]
    v_mfma_f32_16x16x32_bf16 v[68:71], v[172:175], v[148:151], v[68:71]
    v_mfma_f32_16x16x32_bf16 v[84:87], v[176:179], v[148:151], v[84:87]
    v_mfma_f32_16x16x32_bf16 v[100:103], v[180:183], v[148:151], v[100:103]
    v_mfma_f32_16x16x32_bf16 v[40:43], v[164:167], v[152:155], v[40:43]
    v_mfma_f32_16x16x32_bf16 v[56:59], v[168:171], v[152:155], v[56:59]
    v_mfma_f32_16x16x32_bf16 v[72:75], v[172:175], v[152:155], v[72:75]
    v_mfma_f32_16x16x32_bf16 v[88:91], v[176:179], v[152:155], v[88:91]
    v_mfma_f32_16x16x32_bf16 v[104:107], v[180:183], v[152:155], v[104:107]
    v_mfma_f32_16x16x32_bf16 v[44:47], v[164:167], v[156:159], v[44:47]
    v_mfma_f32_16x16x32_bf16 v[60:63], v[168:171], v[156:159], v[60:63]
    v_mfma_f32_16x16x32_bf16 v[76:79], v[172:175], v[156:159], v[76:79]
    v_mfma_f32_16x16x32_bf16 v[92:95], v[176:179], v[156:159], v[92:95]
    v_mfma_f32_16x16x32_bf16 v[108:111], v[180:183], v[156:159], v[108:111]
    s_add_u32 s47, s40, 7168
    buffer_load_dwordx4 v[144:147], v1, s[20:23], s47 offen sc1
    buffer_load_dwordx4 v[148:151], v2, s[20:23], s47 offen sc1
    buffer_load_dwordx4 v[152:155], v3, s[20:23], s47 offen sc1
    buffer_load_dwordx4 v[156:159], v4, s[20:23], s47 offen sc1
    s_waitcnt vmcnt(8)
    v_mfma_f32_16x16x32_bf16 v[32:35], v[184:187], v[112:115], v[32:35]
    v_mfma_f32_16x16x32_bf16 v[48:51], v[188:191], v[112:115], v[48:51]
    v_mfma_f32_16x16x32_bf16 v[64:67], v[192:195], v[112:115], v[64:67]
    v_mfma_f32_16x16x32_bf16 v[80:83], v[196:199], v[112:115], v[80:83]
    v_mfma_f32_16x16x32_bf16 v[96:99], v[200:203], v[112:115], v[96:99]
    v_mfma_f32_16x16x32_bf16 v[36:39], v[184:187], v[116:119], v[36:39]
    v_mfma_f32_16x16x32_bf16 v[52:55], v[188:191], v[116:119], v[52:55]
    v_mfma_f32_16x16x32_bf16 v[68:71], v[192:195], v[116:119], v[68:71]
    v_mfma_f32_16x16x32_bf16 v[84:87], v[196:199], v[116:119], v[84:87]
    v_mfma_f32_16x16x32_bf16 v[100:103], v[200:203], v[116:119], v[100:103]
    v_mfma_f32_16x16x32_bf16 v[40:43], v[184:187], v[120:123], v[40:43]
    v_mfma_f32_16x16x32_bf16 v[56:59], v[188:191], v[120:123], v[56:59]
    v_mfma_f32_16x16x32_bf16 v[72:75], v[192:195], v[120:123], v[72:75]
    v_mfma_f32_16x16x32_bf16 v[88:91], v[196:199], v[120:123], v[88:91]
    v_mfma_f32_16x16x32_bf16 v[104:107], v[200:203], v[120:123], v[104:107]
    v_mfma_f32_16x16x32_bf16 v[44:47], v[184:187], v[124:127], v[44:47]
    v_mfma_f32_16x16x32_bf16 v[60:63], v[188:191], v[124:127], v[60:63]
    v_mfma_f32_16x16x32_bf16 v[76:79], v[192:195], v[124:127], v[76:79]
    v_mfma_f32_16x16x32_bf16 v[92:95], v[196:199], v[124:127], v[92:95]
    v_mfma_f32_16x16x32_bf16 v[108:111], v[200:203], v[124:127], v[108:111]
    s_add_u32 s47, s40, 2048
    buffer_load_dwordx4 v[112:115], v1, s[20:23], s47 offen sc1
    buffer_load_dwordx4 v[116:119], v2, s[20:23], s47 offen sc1
    buffer_load_dwordx4 v[120:123], v3, s[20:23], s47 offen sc1
    buffer_load_dwordx4 v[124:127], v4, s[20:23], s47 offen sc1
    s_waitcnt vmcnt(44)
    ds_read_b128 v[184:187], v11 offset:0
    ds_read_b128 v[188:191], v11 offset:1024
    ds_read_b128 v[192:195], v11 offset:2048
    ds_read_b128 v[196:199], v11 offset:3072
    ds_read_b128 v[200:203], v11 offset:4096
    s_and_b32 s45, s2, 7
    s_lshl_b32 s45, s45, 8
    s_lshr_b32 s46, s2, 6
    s_lshl_b32 s46, s46, 6
    s_add_u32 s45, s45, s46
    s_lshl_b32 s46, s37, 4
    s_add_u32 s45, s45, s46
    s_mul_i32 s45, s45, 1280
    s_bfe_u32 s46, s2, 0x30003
    s_mul_i32 s46, s46, 160
    s_add_u32 s45, s45, s46
    v_add_u32 v16, 0, v0
    v_mul_u32_u24 v17, 3277, v16
    v_lshrrev_b32 v17, 16, v17
    v_mul_u32_u24 v17, 1120, v17
    v_lshl_add_u32 v17, v16, 3, v17
    v_add_u32 v164, s45, v17
    buffer_load_dwordx2 v[244:245], v164, s[24:27], 0 offen
    v_add_u32 v16, 64, v0
    v_mul_u32_u24 v17, 3277, v16
    v_lshrrev_b32 v17, 16, v17
    v_mul_u32_u24 v17, 1120, v17
    v_lshl_add_u32 v17, v16, 3, v17
    v_add_u32 v165, s45, v17
    buffer_load_dwordx2 v[246:247], v165, s[24:27], 0 offen
    v_add_u32 v16, 128, v0
    v_mul_u32_u24 v17, 3277, v16
    v_lshrrev_b32 v17, 16, v17
    v_mul_u32_u24 v17, 1120, v17
    v_lshl_add_u32 v17, v16, 3, v17
    v_add_u32 v166, s45, v17
    buffer_load_dwordx2 v[248:249], v166, s[24:27], 0 offen
    v_add_u32 v16, 192, v0
    v_mul_u32_u24 v17, 3277, v16
    v_lshrrev_b32 v17, 16, v17
    v_mul_u32_u24 v17, 1120, v17
    v_lshl_add_u32 v17, v16, 3, v17
    v_add_u32 v167, s45, v17
    buffer_load_dwordx2 v[250:251], v167, s[24:27], 0 offen
    v_add_u32 v16, 256, v0
    v_mul_u32_u24 v17, 3277, v16
    v_lshrrev_b32 v17, 16, v17
    v_mul_u32_u24 v17, 1120, v17
    v_lshl_add_u32 v17, v16, 3, v17
    v_add_u32 v168, s45, v17
    buffer_load_dwordx2 v[252:253], v168, s[24:27], 0 offen
    s_and_b32 s45, s37, 1
    s_mul_i32 s45, s45, 5120
    s_lshr_b32 s46, s37, 1
    s_mul_i32 s46, s46, 81920
    s_add_u32 s45, s45, s46
    v_add_u32 v16, 0, v0
    v_mul_u32_u24 v17, 3277, v16
    v_bfe_u32 v17, v17, 17, 2
    v_xor_b32 v16, v16, v17
    v_lshlrev_b32 v16, 4, v16
    v_add_u32 v169, s45, v16
    v_add_u32 v174, 40960, v169
    v_add_u32 v16, 64, v0
    v_mul_u32_u24 v17, 3277, v16
    v_bfe_u32 v17, v17, 17, 2
    v_xor_b32 v16, v16, v17
    v_lshlrev_b32 v16, 4, v16
    v_add_u32 v170, s45, v16
    v_add_u32 v175, 40960, v170
    v_add_u32 v16, 128, v0
    v_mul_u32_u24 v17, 3277, v16
    v_bfe_u32 v17, v17, 17, 2
    v_xor_b32 v16, v16, v17
    v_lshlrev_b32 v16, 4, v16
    v_add_u32 v171, s45, v16
    v_add_u32 v176, 40960, v171
    v_add_u32 v16, 192, v0
    v_mul_u32_u24 v17, 3277, v16
    v_bfe_u32 v17, v17, 17, 2
    v_xor_b32 v16, v16, v17
    v_lshlrev_b32 v16, 4, v16
    v_add_u32 v172, s45, v16
    v_add_u32 v177, 40960, v172
    v_add_u32 v16, 256, v0
    v_mul_u32_u24 v17, 3277, v16
    v_bfe_u32 v17, v17, 17, 2
    v_xor_b32 v16, v16, v17
    v_lshlrev_b32 v16, 4, v16
    v_add_u32 v173, s45, v16
    v_add_u32 v178, 40960, v173
    s_waitcnt vmcnt(13)
    v_mfma_f32_16x16x32_bf16 v[32:35], v[204:207], v[128:131], v[32:35]
    v_mfma_f32_16x16x32_bf16 v[48:51], v[208:211], v[128:131], v[48:51]
    v_mfma_f32_16x16x32_bf16 v[64:67], v[212:215], v[128:131], v[64:67]
    v_mfma_f32_16x16x32_bf16 v[80:83], v[216:219], v[128:131], v[80:83]
    v_mfma_f32_16x16x32_bf16 v[96:99], v[220:223], v[128:131], v[96:99]
    v_mfma_f32_16x16x32_bf16 v[36:39], v[204:207], v[132:135], v[36:39]
    v_mfma_f32_16x16x32_bf16 v[52:55], v[208:211], v[132:135], v[52:55]
    v_mfma_f32_16x16x32_bf16 v[68:71], v[212:215], v[132:135], v[68:71]
    v_mfma_f32_16x16x32_bf16 v[84:87], v[216:219], v[132:135], v[84:87]
    v_mfma_f32_16x16x32_bf16 v[100:103], v[220:223], v[132:135], v[100:103]
    v_mfma_f32_16x16x32_bf16 v[40:43], v[204:207], v[136:139], v[40:43]
    v_mfma_f32_16x16x32_bf16 v[56:59], v[208:211], v[136:139], v[56:59]
    v_mfma_f32_16x16x32_bf16 v[72:75], v[212:215], v[136:139], v[72:75]
    v_mfma_f32_16x16x32_bf16 v[88:91], v[216:219], v[136:139], v[88:91]
    v_mfma_f32_16x16x32_bf16 v[104:107], v[220:223], v[136:139], v[104:107]
    v_mfma_f32_16x16x32_bf16 v[44:47], v[204:207], v[140:143], v[44:47]
    v_mfma_f32_16x16x32_bf16 v[60:63], v[208:211], v[140:143], v[60:63]
    v_mfma_f32_16x16x32_bf16 v[76:79], v[212:215], v[140:143], v[76:79]
    v_mfma_f32_16x16x32_bf16 v[92:95], v[216:219], v[140:143], v[92:95]
    v_mfma_f32_16x16x32_bf16 v[108:111], v[220:223], v[140:143], v[108:111]
    s_add_u32 s47, s40, 3072
    buffer_load_dwordx4 v[128:131], v1, s[20:23], s47 offen sc1
    buffer_load_dwordx4 v[132:135], v2, s[20:23], s47 offen sc1
    buffer_load_dwordx4 v[136:139], v3, s[20:23], s47 offen sc1
    buffer_load_dwordx4 v[140:143], v4, s[20:23], s47 offen sc1
    s_waitcnt vmcnt(53)
    ds_read_b128 v[204:207], v11 offset:5120
    ds_read_b128 v[208:211], v11 offset:6144
    ds_read_b128 v[212:215], v11 offset:7168
    ds_read_b128 v[216:219], v11 offset:8192
    ds_read_b128 v[220:223], v11 offset:9216
    s_waitcnt vmcnt(13) lgkmcnt(0)
    v_mfma_f32_16x16x32_bf16 v[32:35], v[224:227], v[144:147], v[32:35]
    v_mfma_f32_16x16x32_bf16 v[48:51], v[228:231], v[144:147], v[48:51]
    v_mfma_f32_16x16x32_bf16 v[64:67], v[232:235], v[144:147], v[64:67]
    v_mfma_f32_16x16x32_bf16 v[80:83], v[236:239], v[144:147], v[80:83]
    v_mfma_f32_16x16x32_bf16 v[96:99], v[240:243], v[144:147], v[96:99]
    v_mfma_f32_16x16x32_bf16 v[36:39], v[224:227], v[148:151], v[36:39]
    v_mfma_f32_16x16x32_bf16 v[52:55], v[228:231], v[148:151], v[52:55]
    v_mfma_f32_16x16x32_bf16 v[68:71], v[232:235], v[148:151], v[68:71]
    v_mfma_f32_16x16x32_bf16 v[84:87], v[236:239], v[148:151], v[84:87]
    v_mfma_f32_16x16x32_bf16 v[100:103], v[240:243], v[148:151], v[100:103]
    v_mfma_f32_16x16x32_bf16 v[40:43], v[224:227], v[152:155], v[40:43]
    v_mfma_f32_16x16x32_bf16 v[56:59], v[228:231], v[152:155], v[56:59]
    v_mfma_f32_16x16x32_bf16 v[72:75], v[232:235], v[152:155], v[72:75]
    v_mfma_f32_16x16x32_bf16 v[88:91], v[236:239], v[152:155], v[88:91]
    v_mfma_f32_16x16x32_bf16 v[104:107], v[240:243], v[152:155], v[104:107]
    v_mfma_f32_16x16x32_bf16 v[44:47], v[224:227], v[156:159], v[44:47]
    v_mfma_f32_16x16x32_bf16 v[60:63], v[228:231], v[156:159], v[60:63]
    v_mfma_f32_16x16x32_bf16 v[76:79], v[232:235], v[156:159], v[76:79]
    v_mfma_f32_16x16x32_bf16 v[92:95], v[236:239], v[156:159], v[92:95]
    v_mfma_f32_16x16x32_bf16 v[108:111], v[240:243], v[156:159], v[108:111]
    s_waitcnt vmcnt(9) lgkmcnt(0)
    v_mfma_f32_16x16x32_bf16 v[32:35], v[184:187], v[112:115], v[32:35]
    v_mfma_f32_16x16x32_bf16 v[48:51], v[188:191], v[112:115], v[48:51]
    v_mfma_f32_16x16x32_bf16 v[64:67], v[192:195], v[112:115], v[64:67]
    v_mfma_f32_16x16x32_bf16 v[80:83], v[196:199], v[112:115], v[80:83]
    v_mfma_f32_16x16x32_bf16 v[96:99], v[200:203], v[112:115], v[96:99]
    v_mfma_f32_16x16x32_bf16 v[36:39], v[184:187], v[116:119], v[36:39]
    v_mfma_f32_16x16x32_bf16 v[52:55], v[188:191], v[116:119], v[52:55]
    v_mfma_f32_16x16x32_bf16 v[68:71], v[192:195], v[116:119], v[68:71]
    v_mfma_f32_16x16x32_bf16 v[84:87], v[196:199], v[116:119], v[84:87]
    v_mfma_f32_16x16x32_bf16 v[100:103], v[200:203], v[116:119], v[100:103]
    v_mfma_f32_16x16x32_bf16 v[40:43], v[184:187], v[120:123], v[40:43]
    v_mfma_f32_16x16x32_bf16 v[56:59], v[188:191], v[120:123], v[56:59]
    v_mfma_f32_16x16x32_bf16 v[72:75], v[192:195], v[120:123], v[72:75]
    v_mfma_f32_16x16x32_bf16 v[88:91], v[196:199], v[120:123], v[88:91]
    v_mfma_f32_16x16x32_bf16 v[104:107], v[200:203], v[120:123], v[104:107]
    v_mfma_f32_16x16x32_bf16 v[44:47], v[184:187], v[124:127], v[44:47]
    v_mfma_f32_16x16x32_bf16 v[60:63], v[188:191], v[124:127], v[60:63]
    v_mfma_f32_16x16x32_bf16 v[76:79], v[192:195], v[124:127], v[76:79]
    v_mfma_f32_16x16x32_bf16 v[92:95], v[196:199], v[124:127], v[92:95]
    v_mfma_f32_16x16x32_bf16 v[108:111], v[200:203], v[124:127], v[108:111]
    s_waitcnt vmcnt(0) lgkmcnt(0)
    v_mfma_f32_16x16x32_bf16 v[32:35], v[204:207], v[128:131], v[32:35]
    v_mfma_f32_16x16x32_bf16 v[48:51], v[208:211], v[128:131], v[48:51]
    v_mfma_f32_16x16x32_bf16 v[64:67], v[212:215], v[128:131], v[64:67]
    v_mfma_f32_16x16x32_bf16 v[80:83], v[216:219], v[128:131], v[80:83]
    v_mfma_f32_16x16x32_bf16 v[96:99], v[220:223], v[128:131], v[96:99]
    v_mfma_f32_16x16x32_bf16 v[36:39], v[204:207], v[132:135], v[36:39]
    v_mfma_f32_16x16x32_bf16 v[52:55], v[208:211], v[132:135], v[52:55]
    v_mfma_f32_16x16x32_bf16 v[68:71], v[212:215], v[132:135], v[68:71]
    v_mfma_f32_16x16x32_bf16 v[84:87], v[216:219], v[132:135], v[84:87]
    v_mfma_f32_16x16x32_bf16 v[100:103], v[220:223], v[132:135], v[100:103]
    v_mfma_f32_16x16x32_bf16 v[40:43], v[204:207], v[136:139], v[40:43]
    v_mfma_f32_16x16x32_bf16 v[56:59], v[208:211], v[136:139], v[56:59]
    v_mfma_f32_16x16x32_bf16 v[72:75], v[212:215], v[136:139], v[72:75]
    v_mfma_f32_16x16x32_bf16 v[88:91], v[216:219], v[136:139], v[88:91]
    v_mfma_f32_16x16x32_bf16 v[104:107], v[220:223], v[136:139], v[104:107]
    v_mfma_f32_16x16x32_bf16 v[44:47], v[204:207], v[140:143], v[44:47]
    v_mfma_f32_16x16x32_bf16 v[60:63], v[208:211], v[140:143], v[60:63]
    v_mfma_f32_16x16x32_bf16 v[76:79], v[212:215], v[140:143], v[76:79]
    v_mfma_f32_16x16x32_bf16 v[92:95], v[216:219], v[140:143], v[92:95]
    v_mfma_f32_16x16x32_bf16 v[108:111], v[220:223], v[140:143], v[108:111]
    s_nop 7
    ds_write_b128 v14, v[32:35] offset:0
    ds_write_b128 v14, v[36:39] offset:5120
    ds_write_b128 v15, v[40:43] offset:0
    ds_write_b128 v15, v[44:47] offset:5120
    ds_write_b128 v14, v[48:51] offset:64
    ds_write_b128 v14, v[52:55] offset:5184
    ds_write_b128 v15, v[56:59] offset:64
    ds_write_b128 v15, v[60:63] offset:5184
    ds_write_b128 v14, v[64:67] offset:128
    ds_write_b128 v14, v[68:71] offset:5248
    ds_write_b128 v15, v[72:75] offset:128
    ds_write_b128 v15, v[76:79] offset:5248
    ds_write_b128 v14, v[80:83] offset:192
    ds_write_b128 v14, v[84:87] offset:5312
    ds_write_b128 v15, v[88:91] offset:192
    ds_write_b128 v15, v[92:95] offset:5312
    ds_write_b128 v14, v[96:99] offset:256
    ds_write_b128 v14, v[100:103] offset:5376
    ds_write_b128 v15, v[104:107] offset:256
    ds_write_b128 v15, v[108:111] offset:5376
    s_waitcnt lgkmcnt(0)
    s_barrier
    s_mov_b32 s51, 3216550459
    ds_read_b128 v[32:35], v169 offset:0
    ds_read_b128 v[36:39], v169 offset:10240
    ds_read_b128 v[40:43], v169 offset:20480
    ds_read_b128 v[44:47], v169 offset:30720
    ds_read_b128 v[48:51], v174 offset:0
    ds_read_b128 v[52:55], v174 offset:10240
    ds_read_b128 v[56:59], v174 offset:20480
    ds_read_b128 v[60:63], v174 offset:30720
    ds_read_b128 v[64:67], v170 offset:0
    ds_read_b128 v[68:71], v170 offset:10240
    ds_read_b128 v[72:75], v170 offset:20480
    ds_read_b128 v[76:79], v170 offset:30720
    ds_read_b128 v[80:83], v175 offset:0
    ds_read_b128 v[84:87], v175 offset:10240
    ds_read_b128 v[88:91], v175 offset:20480
    ds_read_b128 v[92:95], v175 offset:30720
    s_waitcnt lgkmcnt(8)
    ds_read_b128 v[96:99], v171 offset:0
    ds_read_b128 v[100:103], v171 offset:10240
    ds_read_b128 v[104:107], v171 offset:20480
    ds_read_b128 v[108:111], v171 offset:30720
    ds_read_b128 v[112:115], v176 offset:0
    ds_read_b128 v[116:119], v176 offset:10240
    ds_read_b128 v[120:123], v176 offset:20480
    ds_read_b128 v[124:127], v176 offset:30720
    v_pk_add_f32 v[32:33], v[32:33], v[36:37]
    v_pk_add_f32 v[34:35], v[34:35], v[38:39]
    v_pk_add_f32 v[40:41], v[40:41], v[44:45]
    v_pk_add_f32 v[42:43], v[42:43], v[46:47]
    v_pk_add_f32 v[48:49], v[48:49], v[52:53]
    v_pk_add_f32 v[50:51], v[50:51], v[54:55]
    v_pk_add_f32 v[56:57], v[56:57], v[60:61]
    v_pk_add_f32 v[58:59], v[58:59], v[62:63]
    v_pk_add_f32 v[32:33], v[32:33], v[40:41]
    v_pk_add_f32 v[34:35], v[34:35], v[42:43]
    v_pk_add_f32 v[48:49], v[48:49], v[56:57]
    v_pk_add_f32 v[50:51], v[50:51], v[58:59]
    v_pk_add_f32 v[184:185], v[32:33], v[48:49]
    v_pk_add_f32 v[186:187], v[34:35], v[50:51]
    v_mul_f32 v16, s51, v184
    v_mul_f32 v17, s51, v185
    v_mul_f32 v18, s51, v186
    v_mul_f32 v19, s51, v187
    v_exp_f32 v16, v16
    v_exp_f32 v17, v17
    v_exp_f32 v18, v18
    v_exp_f32 v19, v19
    v_add_f32 v16, 1.0, v16
    v_add_f32 v17, 1.0, v17
    v_add_f32 v18, 1.0, v18
    v_add_f32 v19, 1.0, v19
    v_rcp_f32 v16, v16
    v_rcp_f32 v17, v17
    v_rcp_f32 v18, v18
    v_rcp_f32 v19, v19
    v_pk_mul_f32 v[184:185], v[184:185], v[16:17]
    v_pk_mul_f32 v[186:187], v[186:187], v[18:19]
    s_waitcnt lgkmcnt(8)
    ds_read_b128 v[32:35], v172 offset:0
    ds_read_b128 v[36:39], v172 offset:10240
    ds_read_b128 v[40:43], v172 offset:20480
    ds_read_b128 v[44:47], v172 offset:30720
    ds_read_b128 v[48:51], v177 offset:0
    ds_read_b128 v[52:55], v177 offset:10240
    ds_read_b128 v[56:59], v177 offset:20480
    ds_read_b128 v[60:63], v177 offset:30720
    v_pk_add_f32 v[64:65], v[64:65], v[68:69]
    v_pk_add_f32 v[66:67], v[66:67], v[70:71]
    v_pk_add_f32 v[72:73], v[72:73], v[76:77]
    v_pk_add_f32 v[74:75], v[74:75], v[78:79]
    v_pk_add_f32 v[80:81], v[80:81], v[84:85]
    v_pk_add_f32 v[82:83], v[82:83], v[86:87]
    v_pk_add_f32 v[88:89], v[88:89], v[92:93]
    v_pk_add_f32 v[90:91], v[90:91], v[94:95]
    v_pk_add_f32 v[64:65], v[64:65], v[72:73]
    v_pk_add_f32 v[66:67], v[66:67], v[74:75]
    v_pk_add_f32 v[80:81], v[80:81], v[88:89]
    v_pk_add_f32 v[82:83], v[82:83], v[90:91]
    v_pk_add_f32 v[188:189], v[64:65], v[80:81]
    v_pk_add_f32 v[190:191], v[66:67], v[82:83]
    v_mul_f32 v16, s51, v188
    v_mul_f32 v17, s51, v189
    v_mul_f32 v18, s51, v190
    v_mul_f32 v19, s51, v191
    v_exp_f32 v16, v16
    v_exp_f32 v17, v17
    v_exp_f32 v18, v18
    v_exp_f32 v19, v19
    v_add_f32 v16, 1.0, v16
    v_add_f32 v17, 1.0, v17
    v_add_f32 v18, 1.0, v18
    v_add_f32 v19, 1.0, v19
    v_rcp_f32 v16, v16
    v_rcp_f32 v17, v17
    v_rcp_f32 v18, v18
    v_rcp_f32 v19, v19
    v_pk_mul_f32 v[188:189], v[188:189], v[16:17]
    v_pk_mul_f32 v[190:191], v[190:191], v[18:19]
    s_waitcnt lgkmcnt(8)
    ds_read_b128 v[64:67], v173 offset:0
    ds_read_b128 v[68:71], v173 offset:10240
    ds_read_b128 v[72:75], v173 offset:20480
    ds_read_b128 v[76:79], v173 offset:30720
    ds_read_b128 v[80:83], v178 offset:0
    ds_read_b128 v[84:87], v178 offset:10240
    ds_read_b128 v[88:91], v178 offset:20480
    ds_read_b128 v[92:95], v178 offset:30720
    v_pk_add_f32 v[96:97], v[96:97], v[100:101]
    v_pk_add_f32 v[98:99], v[98:99], v[102:103]
    v_pk_add_f32 v[104:105], v[104:105], v[108:109]
    v_pk_add_f32 v[106:107], v[106:107], v[110:111]
    v_pk_add_f32 v[112:113], v[112:113], v[116:117]
    v_pk_add_f32 v[114:115], v[114:115], v[118:119]
    v_pk_add_f32 v[120:121], v[120:121], v[124:125]
    v_pk_add_f32 v[122:123], v[122:123], v[126:127]
    v_pk_add_f32 v[96:97], v[96:97], v[104:105]
    v_pk_add_f32 v[98:99], v[98:99], v[106:107]
    v_pk_add_f32 v[112:113], v[112:113], v[120:121]
    v_pk_add_f32 v[114:115], v[114:115], v[122:123]
    v_pk_add_f32 v[192:193], v[96:97], v[112:113]
    v_pk_add_f32 v[194:195], v[98:99], v[114:115]
    v_mul_f32 v16, s51, v192
    v_mul_f32 v17, s51, v193
    v_mul_f32 v18, s51, v194
    v_mul_f32 v19, s51, v195
    v_exp_f32 v16, v16
    v_exp_f32 v17, v17
    v_exp_f32 v18, v18
    v_exp_f32 v19, v19
    v_add_f32 v16, 1.0, v16
    v_add_f32 v17, 1.0, v17
    v_add_f32 v18, 1.0, v18
    v_add_f32 v19, 1.0, v19
    v_rcp_f32 v16, v16
    v_rcp_f32 v17, v17
    v_rcp_f32 v18, v18
    v_rcp_f32 v19, v19
    v_pk_mul_f32 v[192:193], v[192:193], v[16:17]
    v_pk_mul_f32 v[194:195], v[194:195], v[18:19]
    s_waitcnt lgkmcnt(8)
    v_pk_add_f32 v[32:33], v[32:33], v[36:37]
    v_pk_add_f32 v[34:35], v[34:35], v[38:39]
    v_pk_add_f32 v[40:41], v[40:41], v[44:45]
    v_pk_add_f32 v[42:43], v[42:43], v[46:47]
    v_pk_add_f32 v[48:49], v[48:49], v[52:53]
    v_pk_add_f32 v[50:51], v[50:51], v[54:55]
    v_pk_add_f32 v[56:57], v[56:57], v[60:61]
    v_pk_add_f32 v[58:59], v[58:59], v[62:63]
    v_pk_add_f32 v[32:33], v[32:33], v[40:41]
    v_pk_add_f32 v[34:35], v[34:35], v[42:43]
    v_pk_add_f32 v[48:49], v[48:49], v[56:57]
    v_pk_add_f32 v[50:51], v[50:51], v[58:59]
    v_pk_add_f32 v[196:197], v[32:33], v[48:49]
    v_pk_add_f32 v[198:199], v[34:35], v[50:51]
    v_mul_f32 v16, s51, v196
    v_mul_f32 v17, s51, v197
    v_mul_f32 v18, s51, v198
    v_mul_f32 v19, s51, v199
    v_exp_f32 v16, v16
    v_exp_f32 v17, v17
    v_exp_f32 v18, v18
    v_exp_f32 v19, v19
    v_add_f32 v16, 1.0, v16
    v_add_f32 v17, 1.0, v17
    v_add_f32 v18, 1.0, v18
    v_add_f32 v19, 1.0, v19
    v_rcp_f32 v16, v16
    v_rcp_f32 v17, v17
    v_rcp_f32 v18, v18
    v_rcp_f32 v19, v19
    v_pk_mul_f32 v[196:197], v[196:197], v[16:17]
    v_pk_mul_f32 v[198:199], v[198:199], v[18:19]
    s_waitcnt lgkmcnt(0)
    v_pk_add_f32 v[64:65], v[64:65], v[68:69]
    v_pk_add_f32 v[66:67], v[66:67], v[70:71]
    v_pk_add_f32 v[72:73], v[72:73], v[76:77]
    v_pk_add_f32 v[74:75], v[74:75], v[78:79]
    v_pk_add_f32 v[80:81], v[80:81], v[84:85]
    v_pk_add_f32 v[82:83], v[82:83], v[86:87]
    v_pk_add_f32 v[88:89], v[88:89], v[92:93]
    v_pk_add_f32 v[90:91], v[90:91], v[94:95]
    v_pk_add_f32 v[64:65], v[64:65], v[72:73]
    v_pk_add_f32 v[66:67], v[66:67], v[74:75]
    v_pk_add_f32 v[80:81], v[80:81], v[88:89]
    v_pk_add_f32 v[82:83], v[82:83], v[90:91]
    v_pk_add_f32 v[200:201], v[64:65], v[80:81]
    v_pk_add_f32 v[202:203], v[66:67], v[82:83]
    v_mul_f32 v16, s51, v200
    v_mul_f32 v17, s51, v201
    v_mul_f32 v18, s51, v202
    v_mul_f32 v19, s51, v203
    v_exp_f32 v16, v16
    v_exp_f32 v17, v17
    v_exp_f32 v18, v18
    v_exp_f32 v19, v19
    v_add_f32 v16, 1.0, v16
    v_add_f32 v17, 1.0, v17
    v_add_f32 v18, 1.0, v18
    v_add_f32 v19, 1.0, v19
    v_rcp_f32 v16, v16
    v_rcp_f32 v17, v17
    v_rcp_f32 v18, v18
    v_rcp_f32 v19, v19
    v_pk_mul_f32 v[200:201], v[200:201], v[16:17]
    v_pk_mul_f32 v[202:203], v[202:203], v[18:19]
    s_barrier
    s_waitcnt vmcnt(0)
    v_lshlrev_b32 v204, 16, v244
    v_and_b32 v205, 0xffff0000, v244
    v_lshlrev_b32 v206, 16, v245
    v_and_b32 v207, 0xffff0000, v245
    v_lshlrev_b32 v208, 16, v246
    v_and_b32 v209, 0xffff0000, v246
    v_lshlrev_b32 v210, 16, v247
    v_and_b32 v211, 0xffff0000, v247
    v_lshlrev_b32 v212, 16, v248
    v_and_b32 v213, 0xffff0000, v248
    v_lshlrev_b32 v214, 16, v249
    v_and_b32 v215, 0xffff0000, v249
    v_lshlrev_b32 v216, 16, v250
    v_and_b32 v217, 0xffff0000, v250
    v_lshlrev_b32 v218, 16, v251
    v_and_b32 v219, 0xffff0000, v251
    v_lshlrev_b32 v220, 16, v252
    v_and_b32 v221, 0xffff0000, v252
    v_lshlrev_b32 v222, 16, v253
    v_and_b32 v223, 0xffff0000, v253
    s_barrier
    ds_read_b128 v[32:35], v174 offset:0
    ds_read_b128 v[36:39], v174 offset:10240
    ds_read_b128 v[40:43], v174 offset:20480
    ds_read_b128 v[44:47], v174 offset:30720
    ds_read_b128 v[48:51], v175 offset:0
    ds_read_b128 v[52:55], v175 offset:10240
    ds_read_b128 v[56:59], v175 offset:20480
    ds_read_b128 v[60:63], v175 offset:30720
    ds_read_b128 v[64:67], v176 offset:0
    ds_read_b128 v[68:71], v176 offset:10240
    ds_read_b128 v[72:75], v176 offset:20480
    ds_read_b128 v[76:79], v176 offset:30720
    ds_read_b128 v[80:83], v177 offset:0
    ds_read_b128 v[84:87], v177 offset:10240
    ds_read_b128 v[88:91], v177 offset:20480
    ds_read_b128 v[92:95], v177 offset:30720
    ds_read_b128 v[96:99], v178 offset:0
    ds_read_b128 v[100:103], v178 offset:10240
    ds_read_b128 v[104:107], v178 offset:20480
    ds_read_b128 v[108:111], v178 offset:30720
    s_waitcnt lgkmcnt(15)
    v_pk_add_f32 v[32:33], v[32:33], v[36:37]
    v_pk_add_f32 v[40:41], v[40:41], v[44:45]
    v_pk_add_f32 v[34:35], v[34:35], v[38:39]
    v_pk_add_f32 v[42:43], v[42:43], v[46:47]
    v_pk_add_f32 v[32:33], v[32:33], v[40:41]
    v_pk_add_f32 v[34:35], v[34:35], v[42:43]
    v_pk_fma_f32 v[204:205], v[32:33], v[184:185], v[204:205]
    v_pk_fma_f32 v[206:207], v[34:35], v[186:187], v[206:207]
    v_cvt_pk_bf16_f32 v32, v204, v205
    v_cvt_pk_bf16_f32 v33, v206, v207
    buffer_store_dwordx2 v[32:33], v164, s[16:19], 0 offen
    s_waitcnt lgkmcnt(12)
    v_pk_add_f32 v[48:49], v[48:49], v[52:53]
    v_pk_add_f32 v[56:57], v[56:57], v[60:61]
    v_pk_add_f32 v[50:51], v[50:51], v[54:55]
    v_pk_add_f32 v[58:59], v[58:59], v[62:63]
    v_pk_add_f32 v[48:49], v[48:49], v[56:57]
    v_pk_add_f32 v[50:51], v[50:51], v[58:59]
    v_pk_fma_f32 v[208:209], v[48:49], v[188:189], v[208:209]
    v_pk_fma_f32 v[210:211], v[50:51], v[190:191], v[210:211]
    v_cvt_pk_bf16_f32 v48, v208, v209
    v_cvt_pk_bf16_f32 v49, v210, v211
    buffer_store_dwordx2 v[48:49], v165, s[16:19], 0 offen
    s_waitcnt lgkmcnt(8)
    v_pk_add_f32 v[64:65], v[64:65], v[68:69]
    v_pk_add_f32 v[72:73], v[72:73], v[76:77]
    v_pk_add_f32 v[66:67], v[66:67], v[70:71]
    v_pk_add_f32 v[74:75], v[74:75], v[78:79]
    v_pk_add_f32 v[64:65], v[64:65], v[72:73]
    v_pk_add_f32 v[66:67], v[66:67], v[74:75]
    v_pk_fma_f32 v[212:213], v[64:65], v[192:193], v[212:213]
    v_pk_fma_f32 v[214:215], v[66:67], v[194:195], v[214:215]
    v_cvt_pk_bf16_f32 v64, v212, v213
    v_cvt_pk_bf16_f32 v65, v214, v215
    buffer_store_dwordx2 v[64:65], v166, s[16:19], 0 offen
    s_waitcnt lgkmcnt(4)
    v_pk_add_f32 v[80:81], v[80:81], v[84:85]
    v_pk_add_f32 v[88:89], v[88:89], v[92:93]
    v_pk_add_f32 v[82:83], v[82:83], v[86:87]
    v_pk_add_f32 v[90:91], v[90:91], v[94:95]
    v_pk_add_f32 v[80:81], v[80:81], v[88:89]
    v_pk_add_f32 v[82:83], v[82:83], v[90:91]
    v_pk_fma_f32 v[216:217], v[80:81], v[196:197], v[216:217]
    v_pk_fma_f32 v[218:219], v[82:83], v[198:199], v[218:219]
    v_cvt_pk_bf16_f32 v80, v216, v217
    v_cvt_pk_bf16_f32 v81, v218, v219
    buffer_store_dwordx2 v[80:81], v167, s[16:19], 0 offen
    s_waitcnt lgkmcnt(0)
    v_pk_add_f32 v[96:97], v[96:97], v[100:101]
    v_pk_add_f32 v[104:105], v[104:105], v[108:109]
    v_pk_add_f32 v[98:99], v[98:99], v[102:103]
    v_pk_add_f32 v[106:107], v[106:107], v[110:111]
    v_pk_add_f32 v[96:97], v[96:97], v[104:105]
    v_pk_add_f32 v[98:99], v[98:99], v[106:107]
    v_pk_fma_f32 v[220:221], v[96:97], v[200:201], v[220:221]
    v_pk_fma_f32 v[222:223], v[98:99], v[202:203], v[222:223]
    v_cvt_pk_bf16_f32 v96, v220, v221
    v_cvt_pk_bf16_f32 v97, v222, v223
    buffer_store_dwordx2 v[96:97], v168, s[16:19], 0 offen
    s_branch P2_END
P2_S:
    s_setprio 2
    v_subrev_u32 v16, s82, v20
    v_subrev_u32 v16, 2, v16
    v_xor_b32 v17, s83, v21
    v_cmp_ne_u32 s[74:75], 0, v17
    v_cmp_lt_u32 vcc, 1, v16
    s_nop 0
    s_or_b64 vcc, vcc, s[74:75]
    s_cbranch_vccz P2_PQ_OK
    s_mov_b32 s81, 0
P2_PQ_SP:
    buffer_load_dwordx2 v[20:21], v12, s[20:23], 0 offen sc1
    s_waitcnt vmcnt(0)
    v_subrev_u32 v16, s82, v20
    v_subrev_u32 v16, 2, v16
    v_xor_b32 v17, s83, v21
    v_cmp_ne_u32 s[74:75], 0, v17
    v_cmp_lt_u32 vcc, 1, v16
    s_nop 0
    s_or_b64 vcc, vcc, s[74:75]
    s_add_u32 s81, s81, 1
    s_cmp_ge_u32 s81, 200000
    s_cbranch_scc1 P2_PQ_OK
    s_cbranch_vccz P2_PQ_OK
    s_sleep 2
    s_branch P2_PQ_SP
P2_PQ_OK:
    s_lshr_b32 s45, s2, 3
    s_mul_i32 s46, s45, 81920
    s_add_u32 s46, s46, 1048576
    s_and_b32 s47, s2, 7
    s_lshl_b32 s47, s47, 2
    s_add_u32 s47, s47, s37
    s_lshl_b32 s47, s47, 9
    s_add_u32 s45, s46, s47
    s_add_u32 s45, s45, 65536
    s_lshl_b32 s47, s47, 1
    s_add_u32 s46, s46, s47
    s_add_u32 s47, s46, 32768
    v_and_b32 v16, 15, v0
    v_lshlrev_b32 v16, 4, v16
    v_bfe_u32 v17, v0, 4, 1
    v_lshl_add_u32 v17, v17, 3, v16
    v_and_b32 v16, 31, v0
    v_lshlrev_b32 v16, 4, v16
    buffer_load_dwordx4 v[32:35], v16, s[20:23], s46 offen offset:0 sc1
    buffer_load_dwordx4 v[36:39], v16, s[20:23], s47 offen offset:0 sc1
    buffer_load_dwordx2 v[40:41], v17, s[20:23], s45 offen offset:0 sc1
    buffer_load_dwordx4 v[42:45], v16, s[20:23], s46 offen offset:512 sc1
    buffer_load_dwordx4 v[46:49], v16, s[20:23], s47 offen offset:512 sc1
    buffer_load_dwordx2 v[50:51], v17, s[20:23], s45 offen offset:256 sc1
    s_lshr_b32 s45, s2, 5
    s_and_b32 s46, s45, 1
    s_add_u32 s46, s46, 1
    s_lshl_b32 s46, s46, 5
    s_andn2_b32 s45, s45, 1
    s_add_u32 s46, s46, s45
    v_and_b32 v13, 3, v0
    v_bfe_u32 v16, v0, 2, 1
    v_lshl_add_u32 v13, v13, 3, v16
    v_add_u32 v13, s46, v13
    v_lshlrev_b32 v13, 7, v13
    s_lshl_b32 s45, s32, 3
    s_cmp_eq_u32 s32, 5
    s_cselect_b32 s45, 38, s45
    s_cmp_eq_u32 s32, 6
    s_cselect_b32 s45, 44, s45
    s_cmp_eq_u32 s32, 7
    s_cselect_b32 s45, 49, s45
    s_cmp_ge_u32 s32, 4
    s_cselect_b32 s46, 5, 7
    s_cmp_ge_u32 s32, 6
    s_cselect_b32 s46, 4, s46
    s_add_u32 s46, s46, s45
    s_mul_i32 s45, s45, 86
    s_lshr_b32 s45, s45, 8
    s_mul_i32 s46, s46, 86
    s_lshr_b32 s46, s46, 8
    v_add_u32 v16, s45, v0
    v_min_u32 v16, s46, v16
    v_cmp_le_u32 vcc, 14, v16
    s_nop 1
    v_addc_co_u32 v17, vcc, 0, v16, vcc
    v_mul_u32_u24 v31, 52, v17
    v_lshrrev_b32 v31, 8, v31
    v_mul_u32_u24 v16, 5, v31
    v_sub_u32 v16, v17, v16
    v_add_u32 v16, 3, v16
    v_lshlrev_b32 v16, 5, v16
    v_lshl_add_u32 v31, v31, 1, v16
    s_and_b32 s45, s2, 3
    s_lshl_b32 s45, s45, 3
    s_bfe_u32 s46, s2, 0x10002
    s_add_u32 s45, s45, s46
    v_add_u32 v31, s45, v31
    v_lshlrev_b32 v31, 7, v31
    s_and_b32 s45, s2, 7
    s_lshl_b32 s45, s45, 4
    s_lshr_b32 s46, s2, 6
    s_lshl_b32 s46, s46, 2
    s_add_u32 s45, s45, s46
    s_mul_i32 s40, s45, 54
    s_lshl_b32 s46, s32, 3
    s_cmp_eq_u32 s32, 5
    s_cselect_b32 s46, 38, s46
    s_cmp_eq_u32 s32, 6
    s_cselect_b32 s46, 44, s46
    s_cmp_eq_u32 s32, 7
    s_cselect_b32 s46, 49, s46
    s_add_u32 s40, s40, s46
    s_lshl_b32 s40, s40, 10
    s_add_u32 s40, s40, 16777216
    v_lshlrev_b32 v1, 4, v0
    v_add_u32 v2, 55296, v1
    v_add_u32 v3, 110592, v1
    v_add_u32 v4, 165888, v1
    v_add_u32 v11, s30, v1
    v_and_b32 v16, 15, v0
    v_mul_u32_u24 v16, 320, v16
    v_lshrrev_b32 v17, 4, v0
    v_lshrrev_b32 v18, 1, v0
    v_xor_b32 v17, v17, v18
    v_and_b32 v17, 3, v17
    v_lshl_add_u32 v16, v17, 4, v16
    v_add_u32 v14, s29, v16
    v_add_u32 v15, s30, v16
    v_add_u32 v10, s29, v1
    s_cmp_eq_u32 s35, 1
    s_cbranch_scc1 P2_SK
    s_cmp_eq_u32 s32, 7
    s_cbranch_scc0 P2S_W7
    s_or_b32 s45, s35, 2
    s_cmp_eq_u32 s45, 2
    s_cbranch_scc0 P2S_W7
    s_cmp_eq_u32 s31, 0
    s_cbranch_scc1 P2S_W7
    s_add_u32 s48, s28, 15360
    s_add_u32 m0, s30, 9216
    s_nop 0
    buffer_load_dwordx4 v9, s[20:23], s48 offen offset:0 sc1 lds
P2S_W7:
    s_cmp_eq_u32 s31, 3
    s_cbranch_scc1 P2S_HAVE
    v_subrev_u32 v16, s82, v28
    v_subrev_u32 v16, 2, v16
    v_xor_b32 v17, s83, v29
    v_cmp_ne_u32 s[74:75], 0, v17
    v_cmp_lt_u32 vcc, 1, v16
    s_nop 0
    s_or_b64 vcc, vcc, s[74:75]
    s_cbranch_vccz P2S_PSP_OK
    s_mov_b32 s81, 0
P2S_PSP_SP:
    buffer_load_dwordx2 v[28:29], v30, s[20:23], 0 offen sc1
    s_waitcnt vmcnt(0)
    v_subrev_u32 v16, s82, v28
    v_subrev_u32 v16, 2, v16
    v_xor_b32 v17, s83, v29
    v_cmp_ne_u32 s[74:75], 0, v17
    v_cmp_lt_u32 vcc, 1, v16
    s_nop 0
    s_or_b64 vcc, vcc, s[74:75]
    s_add_u32 s81, s81, 1
    s_cmp_ge_u32 s81, 200000
    s_cbranch_scc1 P2S_PSP_OK
    s_cbranch_vccz P2S_PSP_OK
    s_sleep 2
    s_branch P2S_PSP_SP
P2S_PSP_OK:
    s_cmp_eq_u32 s31, 0
    s_cbranch_scc0 P2S_E
    s_add_u32 s48, s28, 0
    buffer_load_dwordx4 v[184:187], v8, s[20:23], s48 offen offset:0 sc1
    buffer_load_dwordx4 v[188:191], v8, s[20:23], s48 offen offset:1024 sc1
    buffer_load_dwordx4 v[192:195], v8, s[20:23], s48 offen offset:2048 sc1
    buffer_load_dwordx4 v[196:199], v8, s[20:23], s48 offen offset:3072 sc1
    buffer_load_dwordx4 v[200:203], v9, s[20:23], s48 offen offset:0 sc1
    s_add_u32 s48, s28, 5120
    buffer_load_dwordx4 v[204:207], v8, s[20:23], s48 offen offset:0 sc1
    buffer_load_dwordx4 v[208:211], v8, s[20:23], s48 offen offset:1024 sc1
    buffer_load_dwordx4 v[212:215], v8, s[20:23], s48 offen offset:2048 sc1
    buffer_load_dwordx4 v[216:219], v8, s[20:23], s48 offen offset:3072 sc1
    buffer_load_dwordx4 v[220:223], v9, s[20:23], s48 offen offset:0 sc1
    s_add_u32 s48, s28, 10240
    s_add_u32 m0, s30, 0
    s_nop 0
    buffer_load_dwordx4 v8, s[20:23], s48 offen offset:0 sc1 lds
    s_add_u32 m0, s30, 0
    s_nop 0
    buffer_load_dwordx4 v8, s[20:23], s48 offen offset:1024 sc1 lds
    s_add_u32 m0, s30, 0
    s_nop 0
    buffer_load_dwordx4 v8, s[20:23], s48 offen offset:2048 sc1 lds
    s_add_u32 m0, s30, 0
    s_nop 0
    buffer_load_dwordx4 v8, s[20:23], s48 offen offset:3072 sc1 lds
    s_add_u32 m0, s30, 4096
    s_nop 0
    buffer_load_dwordx4 v9, s[20:23], s48 offen offset:0 sc1 lds
    s_add_u32 s48, s28, 15360
    s_add_u32 m0, s30, 5120
    s_nop 0
    buffer_load_dwordx4 v8, s[20:23], s48 offen offset:0 sc1 lds
    s_add_u32 m0, s30, 5120
    s_nop 0
    buffer_load_dwordx4 v8, s[20:23], s48 offen offset:1024 sc1 lds
    s_add_u32 m0, s30, 5120
    s_nop 0
    buffer_load_dwordx4 v8, s[20:23], s48 offen offset:2048 sc1 lds
    s_add_u32 m0, s30, 5120
    s_nop 0
    buffer_load_dwordx4 v8, s[20:23], s48 offen offset:3072 sc1 lds
    s_add_u32 m0, s30, 9216
    s_nop 0
    buffer_load_dwordx4 v9, s[20:23], s48 offen offset:0 sc1 lds
    P2S_E:
    s_add_u32 s48, s28, 20480
    buffer_load_dwordx4 v[224:227], v8, s[20:23], s48 offen offset:0 sc1
    buffer_load_dwordx4 v[228:231], v8, s[20:23], s48 offen offset:1024 sc1
    buffer_load_dwordx4 v[232:235], v8, s[20:23], s48 offen offset:2048 sc1
    buffer_load_dwordx4 v[236:239], v8, s[20:23], s48 offen offset:3072 sc1
    buffer_load_dwordx4 v[240:243], v9, s[20:23], s48 offen offset:0 sc1
P2S_HAVE:
    s_cmp_ge_u32 s32, 6
    s_cbranch_scc1 P2S_N5
    s_add_u32 s48, s28, 25600
    buffer_load_dwordx4 v[164:167], v8, s[20:23], s48 offen offset:0 sc1
    buffer_load_dwordx4 v[168:171], v8, s[20:23], s48 offen offset:1024 sc1
    buffer_load_dwordx4 v[172:175], v8, s[20:23], s48 offen offset:2048 sc1
    buffer_load_dwordx4 v[176:179], v8, s[20:23], s48 offen offset:3072 sc1
    buffer_load_dwordx4 v[180:183], v9, s[20:23], s48 offen offset:0 sc1
P2S_N5:
    buffer_load_dwordx2 v[24:25], v31, s[20:23], 0 offen sc1
    s_waitcnt vmcnt(4)
    v_lshrrev_b32 v16, 5, v0
    v_mul_u32_u24 v16, 0x8000, v16
    v_lshl_add_u32 v16, v16, 16, v16
    v_xor_b32 v32, v32, v16
    v_xor_b32 v33, v33, v16
    v_xor_b32 v34, v34, v16
    v_xor_b32 v35, v35, v16
    v_xor_b32 v36, v36, v16
    v_xor_b32 v37, v37, v16
    v_xor_b32 v38, v38, v16
    v_xor_b32 v39, v39, v16
    v_xor_b32 v40, v40, v16
    v_xor_b32 v41, v41, v16
    v_lshlrev_b32 v60, 16, v32
    v_and_b32 v61, 0xffff0000, v32
    v_lshlrev_b32 v62, 16, v33
    v_and_b32 v63, 0xffff0000, v33
    v_lshlrev_b32 v64, 16, v34
    v_and_b32 v65, 0xffff0000, v34
    v_lshlrev_b32 v66, 16, v35
    v_and_b32 v67, 0xffff0000, v35
    v_lshlrev_b32 v68, 16, v36
    v_and_b32 v69, 0xffff0000, v36
    v_lshlrev_b32 v70, 16, v37
    v_and_b32 v71, 0xffff0000, v37
    v_lshlrev_b32 v72, 16, v38
    v_and_b32 v73, 0xffff0000, v38
    v_lshlrev_b32 v74, 16, v39
    v_and_b32 v75, 0xffff0000, v39
    v_lshlrev_b32 v76, 16, v40
    v_and_b32 v77, 0xffff0000, v40
    v_lshlrev_b32 v78, 16, v41
    v_and_b32 v79, 0xffff0000, v41
    v_max3_f32 v100, v60, v61, v62
    v_max3_f32 v101, v63, v64, v65
    v_max3_f32 v100, v100, v66, v67
    v_max3_f32 v101, v101, v68, v69
    v_max3_f32 v100, v100, v70, v71
    v_max3_f32 v101, v101, v72, v73
    v_max3_f32 v100, v100, v74, v75
    v_max3_f32 v101, v101, v76, v77
    v_max3_f32 v100, v100, v78, v79
    v_max_f32 v100, v100, v101
    v_mov_b32 v102, 1069066811
    v_mul_f32 v100, v100, v102
    v_pk_fma_f32 v[80:81], v[60:61], v[102:103], v[100:101] op_sel:[0,0,0] op_sel_hi:[1,0,0] neg_lo:[0,0,1] neg_hi:[0,0,1]
    v_pk_fma_f32 v[82:83], v[62:63], v[102:103], v[100:101] op_sel:[0,0,0] op_sel_hi:[1,0,0] neg_lo:[0,0,1] neg_hi:[0,0,1]
    v_pk_fma_f32 v[84:85], v[64:65], v[102:103], v[100:101] op_sel:[0,0,0] op_sel_hi:[1,0,0] neg_lo:[0,0,1] neg_hi:[0,0,1]
    v_pk_fma_f32 v[86:87], v[66:67], v[102:103], v[100:101] op_sel:[0,0,0] op_sel_hi:[1,0,0] neg_lo:[0,0,1] neg_hi:[0,0,1]
    v_pk_fma_f32 v[88:89], v[68:69], v[102:103], v[100:101] op_sel:[0,0,0] op_sel_hi:[1,0,0] neg_lo:[0,0,1] neg_hi:[0,0,1]
    v_pk_fma_f32 v[90:91], v[70:71], v[102:103], v[100:101] op_sel:[0,0,0] op_sel_hi:[1,0,0] neg_lo:[0,0,1] neg_hi:[0,0,1]
    v_pk_fma_f32 v[92:93], v[72:73], v[102:103], v[100:101] op_sel:[0,0,0] op_sel_hi:[1,0,0] neg_lo:[0,0,1] neg_hi:[0,0,1]
    v_pk_fma_f32 v[94:95], v[74:75], v[102:103], v[100:101] op_sel:[0,0,0] op_sel_hi:[1,0,0] neg_lo:[0,0,1] neg_hi:[0,0,1]
    v_pk_fma_f32 v[96:97], v[76:77], v[102:103], v[100:101] op_sel:[0,0,0] op_sel_hi:[1,0,0] neg_lo:[0,0,1] neg_hi:[0,0,1]
    v_pk_fma_f32 v[98:99], v[78:79], v[102:103], v[100:101] op_sel:[0,0,0] op_sel_hi:[1,0,0] neg_lo:[0,0,1] neg_hi:[0,0,1]
    v_exp_f32 v80, v80
    v_exp_f32 v81, v81
    v_exp_f32 v82, v82
    v_exp_f32 v83, v83
    v_exp_f32 v84, v84
    v_exp_f32 v85, v85
    v_exp_f32 v86, v86
    v_exp_f32 v87, v87
    v_exp_f32 v88, v88
    v_exp_f32 v89, v89
    v_exp_f32 v90, v90
    v_exp_f32 v91, v91
    v_exp_f32 v92, v92
    v_exp_f32 v93, v93
    v_exp_f32 v94, v94
    v_exp_f32 v95, v95
    v_exp_f32 v96, v96
    v_exp_f32 v97, v97
    v_exp_f32 v98, v98
    v_exp_f32 v99, v99
    v_pk_add_f32 v[102:103], v[80:81], v[82:83]
    v_pk_add_f32 v[100:101], v[84:85], v[86:87]
    v_pk_add_f32 v[102:103], v[102:103], v[88:89]
    v_pk_add_f32 v[100:101], v[100:101], v[90:91]
    v_pk_add_f32 v[102:103], v[102:103], v[92:93]
    v_pk_add_f32 v[100:101], v[100:101], v[94:95]
    v_pk_add_f32 v[102:103], v[102:103], v[96:97]
    v_pk_add_f32 v[100:101], v[100:101], v[98:99]
    v_pk_add_f32 v[102:103], v[102:103], v[100:101]
    v_add_f32 v102, v102, v103
    v_rcp_f32 v102, v102
    s_nop 0
    v_pk_mul_f32 v[80:81], v[80:81], v[102:103] op_sel:[0,0] op_sel_hi:[1,0]
    v_pk_mul_f32 v[82:83], v[82:83], v[102:103] op_sel:[0,0] op_sel_hi:[1,0]
    v_pk_mul_f32 v[84:85], v[84:85], v[102:103] op_sel:[0,0] op_sel_hi:[1,0]
    v_pk_mul_f32 v[86:87], v[86:87], v[102:103] op_sel:[0,0] op_sel_hi:[1,0]
    v_pk_mul_f32 v[88:89], v[88:89], v[102:103] op_sel:[0,0] op_sel_hi:[1,0]
    v_pk_mul_f32 v[90:91], v[90:91], v[102:103] op_sel:[0,0] op_sel_hi:[1,0]
    v_pk_mul_f32 v[92:93], v[92:93], v[102:103] op_sel:[0,0] op_sel_hi:[1,0]
    v_pk_mul_f32 v[94:95], v[94:95], v[102:103] op_sel:[0,0] op_sel_hi:[1,0]
    v_pk_mul_f32 v[96:97], v[96:97], v[102:103] op_sel:[0,0] op_sel_hi:[1,0]
    v_pk_mul_f32 v[98:99], v[98:99], v[102:103] op_sel:[0,0] op_sel_hi:[1,0]
    v_cvt_pk_bf16_f32 v112, v80, v81
    v_cvt_pk_bf16_f32 v113, v82, v83
    v_cvt_pk_bf16_f32 v114, v84, v85
    v_cvt_pk_bf16_f32 v115, v86, v87
    v_cvt_pk_bf16_f32 v116, v88, v89
    v_cvt_pk_bf16_f32 v117, v90, v91
    v_cvt_pk_bf16_f32 v118, v92, v93
    v_cvt_pk_bf16_f32 v119, v94, v95
    v_cvt_pk_bf16_f32 v120, v96, v97
    v_cvt_pk_bf16_f32 v121, v98, v99
    v_mov_b32 v122, 0
    v_mov_b32 v123, 0
    ds_write_b128 v10, v[112:115] offset:0
    ds_write_b128 v10, v[116:119] offset:1024
    ds_write_b128 v10, v[120:123] offset:2048
    s_waitcnt vmcnt(1)
    v_lshrrev_b32 v16, 5, v0
    v_mul_u32_u24 v16, 0x8000, v16
    v_lshl_add_u32 v16, v16, 16, v16
    v_xor_b32 v42, v42, v16
    v_xor_b32 v43, v43, v16
    v_xor_b32 v44, v44, v16
    v_xor_b32 v45, v45, v16
    v_xor_b32 v46, v46, v16
    v_xor_b32 v47, v47, v16
    v_xor_b32 v48, v48, v16
    v_xor_b32 v49, v49, v16
    v_xor_b32 v50, v50, v16
    v_xor_b32 v51, v51, v16
    v_lshlrev_b32 v60, 16, v42
    v_and_b32 v61, 0xffff0000, v42
    v_lshlrev_b32 v62, 16, v43
    v_and_b32 v63, 0xffff0000, v43
    v_lshlrev_b32 v64, 16, v44
    v_and_b32 v65, 0xffff0000, v44
    v_lshlrev_b32 v66, 16, v45
    v_and_b32 v67, 0xffff0000, v45
    v_lshlrev_b32 v68, 16, v46
    v_and_b32 v69, 0xffff0000, v46
    v_lshlrev_b32 v70, 16, v47
    v_and_b32 v71, 0xffff0000, v47
    v_lshlrev_b32 v72, 16, v48
    v_and_b32 v73, 0xffff0000, v48
    v_lshlrev_b32 v74, 16, v49
    v_and_b32 v75, 0xffff0000, v49
    v_lshlrev_b32 v76, 16, v50
    v_and_b32 v77, 0xffff0000, v50
    v_lshlrev_b32 v78, 16, v51
    v_and_b32 v79, 0xffff0000, v51
    v_max3_f32 v100, v60, v61, v62
    v_max3_f32 v101, v63, v64, v65
    v_max3_f32 v100, v100, v66, v67
    v_max3_f32 v101, v101, v68, v69
    v_max3_f32 v100, v100, v70, v71
    v_max3_f32 v101, v101, v72, v73
    v_max3_f32 v100, v100, v74, v75
    v_max3_f32 v101, v101, v76, v77
    v_max3_f32 v100, v100, v78, v79
    v_max_f32 v100, v100, v101
    v_mov_b32 v102, 1069066811
    v_mul_f32 v100, v100, v102
    v_pk_fma_f32 v[80:81], v[60:61], v[102:103], v[100:101] op_sel:[0,0,0] op_sel_hi:[1,0,0] neg_lo:[0,0,1] neg_hi:[0,0,1]
    v_pk_fma_f32 v[82:83], v[62:63], v[102:103], v[100:101] op_sel:[0,0,0] op_sel_hi:[1,0,0] neg_lo:[0,0,1] neg_hi:[0,0,1]
    v_pk_fma_f32 v[84:85], v[64:65], v[102:103], v[100:101] op_sel:[0,0,0] op_sel_hi:[1,0,0] neg_lo:[0,0,1] neg_hi:[0,0,1]
    v_pk_fma_f32 v[86:87], v[66:67], v[102:103], v[100:101] op_sel:[0,0,0] op_sel_hi:[1,0,0] neg_lo:[0,0,1] neg_hi:[0,0,1]
    v_pk_fma_f32 v[88:89], v[68:69], v[102:103], v[100:101] op_sel:[0,0,0] op_sel_hi:[1,0,0] neg_lo:[0,0,1] neg_hi:[0,0,1]
    v_pk_fma_f32 v[90:91], v[70:71], v[102:103], v[100:101] op_sel:[0,0,0] op_sel_hi:[1,0,0] neg_lo:[0,0,1] neg_hi:[0,0,1]
    v_pk_fma_f32 v[92:93], v[72:73], v[102:103], v[100:101] op_sel:[0,0,0] op_sel_hi:[1,0,0] neg_lo:[0,0,1] neg_hi:[0,0,1]
    v_pk_fma_f32 v[94:95], v[74:75], v[102:103], v[100:101] op_sel:[0,0,0] op_sel_hi:[1,0,0] neg_lo:[0,0,1] neg_hi:[0,0,1]
    v_pk_fma_f32 v[96:97], v[76:77], v[102:103], v[100:101] op_sel:[0,0,0] op_sel_hi:[1,0,0] neg_lo:[0,0,1] neg_hi:[0,0,1]
    v_pk_fma_f32 v[98:99], v[78:79], v[102:103], v[100:101] op_sel:[0,0,0] op_sel_hi:[1,0,0] neg_lo:[0,0,1] neg_hi:[0,0,1]
    v_exp_f32 v80, v80
    v_exp_f32 v81, v81
    v_exp_f32 v82, v82
    v_exp_f32 v83, v83
    v_exp_f32 v84, v84
    v_exp_f32 v85, v85
    v_exp_f32 v86, v86
    v_exp_f32 v87, v87
    v_exp_f32 v88, v88
    v_exp_f32 v89, v89
    v_exp_f32 v90, v90
    v_exp_f32 v91, v91
    v_exp_f32 v92, v92
    v_exp_f32 v93, v93
    v_exp_f32 v94, v94
    v_exp_f32 v95, v95
    v_exp_f32 v96, v96
    v_exp_f32 v97, v97
    v_exp_f32 v98, v98
    v_exp_f32 v99, v99
    v_pk_add_f32 v[102:103], v[80:81], v[82:83]
    v_pk_add_f32 v[100:101], v[84:85], v[86:87]
    v_pk_add_f32 v[102:103], v[102:103], v[88:89]
    v_pk_add_f32 v[100:101], v[100:101], v[90:91]
    v_pk_add_f32 v[102:103], v[102:103], v[92:93]
    v_pk_add_f32 v[100:101], v[100:101], v[94:95]
    v_pk_add_f32 v[102:103], v[102:103], v[96:97]
    v_pk_add_f32 v[100:101], v[100:101], v[98:99]
    v_pk_add_f32 v[102:103], v[102:103], v[100:101]
    v_add_f32 v102, v102, v103
    v_rcp_f32 v102, v102
    s_nop 0
    v_pk_mul_f32 v[80:81], v[80:81], v[102:103] op_sel:[0,0] op_sel_hi:[1,0]
    v_pk_mul_f32 v[82:83], v[82:83], v[102:103] op_sel:[0,0] op_sel_hi:[1,0]
    v_pk_mul_f32 v[84:85], v[84:85], v[102:103] op_sel:[0,0] op_sel_hi:[1,0]
    v_pk_mul_f32 v[86:87], v[86:87], v[102:103] op_sel:[0,0] op_sel_hi:[1,0]
    v_pk_mul_f32 v[88:89], v[88:89], v[102:103] op_sel:[0,0] op_sel_hi:[1,0]
    v_pk_mul_f32 v[90:91], v[90:91], v[102:103] op_sel:[0,0] op_sel_hi:[1,0]
    v_pk_mul_f32 v[92:93], v[92:93], v[102:103] op_sel:[0,0] op_sel_hi:[1,0]
    v_pk_mul_f32 v[94:95], v[94:95], v[102:103] op_sel:[0,0] op_sel_hi:[1,0]
    v_pk_mul_f32 v[96:97], v[96:97], v[102:103] op_sel:[0,0] op_sel_hi:[1,0]
    v_pk_mul_f32 v[98:99], v[98:99], v[102:103] op_sel:[0,0] op_sel_hi:[1,0]
    v_cvt_pk_bf16_f32 v112, v80, v81
    v_cvt_pk_bf16_f32 v113, v82, v83
    v_cvt_pk_bf16_f32 v114, v84, v85
    v_cvt_pk_bf16_f32 v115, v86, v87
    v_cvt_pk_bf16_f32 v116, v88, v89
    v_cvt_pk_bf16_f32 v117, v90, v91
    v_cvt_pk_bf16_f32 v118, v92, v93
    v_cvt_pk_bf16_f32 v119, v94, v95
    v_cvt_pk_bf16_f32 v120, v96, v97
    v_cvt_pk_bf16_f32 v121, v98, v99
    v_mov_b32 v122, 0
    v_mov_b32 v123, 0
    ds_write_b128 v10, v[112:115] offset:3072
    ds_write_b128 v10, v[116:119] offset:4096
    ds_write_b128 v10, v[120:123] offset:5120
    s_waitcnt vmcnt(0)
    v_subrev_u32 v16, s82, v24
    v_subrev_u32 v16, 2, v16
    v_xor_b32 v17, s83, v25
    v_cmp_ne_u32 s[74:75], 0, v17
    v_cmp_lt_u32 vcc, 1, v16
    s_nop 0
    s_or_b64 vcc, vcc, s[74:75]
    s_cbranch_vccz P2S_PH_OK
    s_mov_b32 s81, 0
P2S_PH_SP:
    buffer_load_dwordx2 v[24:25], v31, s[20:23], 0 offen sc1
    s_waitcnt vmcnt(0)
    v_subrev_u32 v16, s82, v24
    v_subrev_u32 v16, 2, v16
    v_xor_b32 v17, s83, v25
    v_cmp_ne_u32 s[74:75], 0, v17
    v_cmp_lt_u32 vcc, 1, v16
    s_nop 0
    s_or_b64 vcc, vcc, s[74:75]
    s_add_u32 s81, s81, 1
    s_cmp_ge_u32 s81, 200000
    s_cbranch_scc1 P2S_PH_OK
    s_cbranch_vccz P2S_PH_OK
    s_sleep 2
    s_branch P2S_PH_SP
P2S_PH_OK:
    s_cmp_ge_u32 s32, 6
    s_cbranch_scc1 P2S_G5
    s_add_u32 s47, s40, 4096
    buffer_load_dwordx4 v[112:115], v1, s[20:23], s47 offen sc1
    buffer_load_dwordx4 v[116:119], v2, s[20:23], s47 offen sc1
    buffer_load_dwordx4 v[120:123], v3, s[20:23], s47 offen sc1
    buffer_load_dwordx4 v[124:127], v4, s[20:23], s47 offen sc1
    s_add_u32 s47, s40, 5120
    buffer_load_dwordx4 v[128:131], v1, s[20:23], s47 offen sc1
    buffer_load_dwordx4 v[132:135], v2, s[20:23], s47 offen sc1
    buffer_load_dwordx4 v[136:139], v3, s[20:23], s47 offen sc1
    buffer_load_dwordx4 v[140:143], v4, s[20:23], s47 offen sc1
    s_add_u32 s47, s40, 0
    buffer_load_dwordx4 v[144:147], v1, s[20:23], s47 offen sc1
    buffer_load_dwordx4 v[148:151], v2, s[20:23], s47 offen sc1
    buffer_load_dwordx4 v[152:155], v3, s[20:23], s47 offen sc1
    buffer_load_dwordx4 v[156:159], v4, s[20:23], s47 offen sc1
    s_waitcnt vmcnt(8)
    v_mfma_f32_16x16x32_bf16 v[32:35], v[224:227], v[112:115], 0
    v_mfma_f32_16x16x32_bf16 v[48:51], v[228:231], v[112:115], 0
    v_mfma_f32_16x16x32_bf16 v[64:67], v[232:235], v[112:115], 0
    v_mfma_f32_16x16x32_bf16 v[80:83], v[236:239], v[112:115], 0
    v_mfma_f32_16x16x32_bf16 v[96:99], v[240:243], v[112:115], 0
    v_mfma_f32_16x16x32_bf16 v[36:39], v[224:227], v[116:119], 0
    v_mfma_f32_16x16x32_bf16 v[52:55], v[228:231], v[116:119], 0
    v_mfma_f32_16x16x32_bf16 v[68:71], v[232:235], v[116:119], 0
    v_mfma_f32_16x16x32_bf16 v[84:87], v[236:239], v[116:119], 0
    v_mfma_f32_16x16x32_bf16 v[100:103], v[240:243], v[116:119], 0
    v_mfma_f32_16x16x32_bf16 v[40:43], v[224:227], v[120:123], 0
    v_mfma_f32_16x16x32_bf16 v[56:59], v[228:231], v[120:123], 0
    v_mfma_f32_16x16x32_bf16 v[72:75], v[232:235], v[120:123], 0
    v_mfma_f32_16x16x32_bf16 v[88:91], v[236:239], v[120:123], 0
    v_mfma_f32_16x16x32_bf16 v[104:107], v[240:243], v[120:123], 0
    v_mfma_f32_16x16x32_bf16 v[44:47], v[224:227], v[124:127], 0
    v_mfma_f32_16x16x32_bf16 v[60:63], v[228:231], v[124:127], 0
    v_mfma_f32_16x16x32_bf16 v[76:79], v[232:235], v[124:127], 0
    v_mfma_f32_16x16x32_bf16 v[92:95], v[236:239], v[124:127], 0
    v_mfma_f32_16x16x32_bf16 v[108:111], v[240:243], v[124:127], 0
    s_add_u32 s47, s40, 1024
    buffer_load_dwordx4 v[240:243], v1, s[20:23], s47 offen sc1
    buffer_load_dwordx4 v[244:247], v2, s[20:23], s47 offen sc1
    buffer_load_dwordx4 v[248:251], v3, s[20:23], s47 offen sc1
    buffer_load_dwordx4 v[252:255], v4, s[20:23], s47 offen sc1
    s_add_u32 s47, s40, 2048
    buffer_load_dwordx4 v[112:115], v1, s[20:23], s47 offen sc1
    buffer_load_dwordx4 v[116:119], v2, s[20:23], s47 offen sc1
    buffer_load_dwordx4 v[120:123], v3, s[20:23], s47 offen sc1
    buffer_load_dwordx4 v[124:127], v4, s[20:23], s47 offen sc1
    s_waitcnt vmcnt(12)
    v_mfma_f32_16x16x32_bf16 v[32:35], v[164:167], v[128:131], v[32:35]
    v_mfma_f32_16x16x32_bf16 v[48:51], v[168:171], v[128:131], v[48:51]
    v_mfma_f32_16x16x32_bf16 v[64:67], v[172:175], v[128:131], v[64:67]
    v_mfma_f32_16x16x32_bf16 v[80:83], v[176:179], v[128:131], v[80:83]
    v_mfma_f32_16x16x32_bf16 v[96:99], v[180:183], v[128:131], v[96:99]
    v_mfma_f32_16x16x32_bf16 v[36:39], v[164:167], v[132:135], v[36:39]
    v_mfma_f32_16x16x32_bf16 v[52:55], v[168:171], v[132:135], v[52:55]
    v_mfma_f32_16x16x32_bf16 v[68:71], v[172:175], v[132:135], v[68:71]
    v_mfma_f32_16x16x32_bf16 v[84:87], v[176:179], v[132:135], v[84:87]
    v_mfma_f32_16x16x32_bf16 v[100:103], v[180:183], v[132:135], v[100:103]
    v_mfma_f32_16x16x32_bf16 v[40:43], v[164:167], v[136:139], v[40:43]
    v_mfma_f32_16x16x32_bf16 v[56:59], v[168:171], v[136:139], v[56:59]
    v_mfma_f32_16x16x32_bf16 v[72:75], v[172:175], v[136:139], v[72:75]
    v_mfma_f32_16x16x32_bf16 v[88:91], v[176:179], v[136:139], v[88:91]
    v_mfma_f32_16x16x32_bf16 v[104:107], v[180:183], v[136:139], v[104:107]
    v_mfma_f32_16x16x32_bf16 v[44:47], v[164:167], v[140:143], v[44:47]
    v_mfma_f32_16x16x32_bf16 v[60:63], v[168:171], v[140:143], v[60:63]
    v_mfma_f32_16x16x32_bf16 v[76:79], v[172:175], v[140:143], v[76:79]
    v_mfma_f32_16x16x32_bf16 v[92:95], v[176:179], v[140:143], v[92:95]
    v_mfma_f32_16x16x32_bf16 v[108:111], v[180:183], v[140:143], v[108:111]
    s_add_u32 s47, s40, 3072
    buffer_load_dwordx4 v[128:131], v1, s[20:23], s47 offen sc1
    buffer_load_dwordx4 v[132:135], v2, s[20:23], s47 offen sc1
    buffer_load_dwordx4 v[136:139], v3, s[20:23], s47 offen sc1
    buffer_load_dwordx4 v[140:143], v4, s[20:23], s47 offen sc1
    s_waitcnt vmcnt(12)
    v_mfma_f32_16x16x32_bf16 v[32:35], v[184:187], v[144:147], v[32:35]
    v_mfma_f32_16x16x32_bf16 v[48:51], v[188:191], v[144:147], v[48:51]
    v_mfma_f32_16x16x32_bf16 v[64:67], v[192:195], v[144:147], v[64:67]
    v_mfma_f32_16x16x32_bf16 v[80:83], v[196:199], v[144:147], v[80:83]
    v_mfma_f32_16x16x32_bf16 v[96:99], v[200:203], v[144:147], v[96:99]
    v_mfma_f32_16x16x32_bf16 v[36:39], v[184:187], v[148:151], v[36:39]
    v_mfma_f32_16x16x32_bf16 v[52:55], v[188:191], v[148:151], v[52:55]
    v_mfma_f32_16x16x32_bf16 v[68:71], v[192:195], v[148:151], v[68:71]
    v_mfma_f32_16x16x32_bf16 v[84:87], v[196:199], v[148:151], v[84:87]
    v_mfma_f32_16x16x32_bf16 v[100:103], v[200:203], v[148:151], v[100:103]
    v_mfma_f32_16x16x32_bf16 v[40:43], v[184:187], v[152:155], v[40:43]
    v_mfma_f32_16x16x32_bf16 v[56:59], v[188:191], v[152:155], v[56:59]
    v_mfma_f32_16x16x32_bf16 v[72:75], v[192:195], v[152:155], v[72:75]
    v_mfma_f32_16x16x32_bf16 v[88:91], v[196:199], v[152:155], v[88:91]
    v_mfma_f32_16x16x32_bf16 v[104:107], v[200:203], v[152:155], v[104:107]
    v_mfma_f32_16x16x32_bf16 v[44:47], v[184:187], v[156:159], v[44:47]
    v_mfma_f32_16x16x32_bf16 v[60:63], v[188:191], v[156:159], v[60:63]
    v_mfma_f32_16x16x32_bf16 v[76:79], v[192:195], v[156:159], v[76:79]
    v_mfma_f32_16x16x32_bf16 v[92:95], v[196:199], v[156:159], v[92:95]
    v_mfma_f32_16x16x32_bf16 v[108:111], v[200:203], v[156:159], v[108:111]
    s_waitcnt vmcnt(31)
    ds_read_b128 v[184:187], v11 offset:0
    ds_read_b128 v[188:191], v11 offset:1024
    ds_read_b128 v[192:195], v11 offset:2048
    ds_read_b128 v[196:199], v11 offset:3072
    ds_read_b128 v[200:203], v11 offset:4096
    s_waitcnt vmcnt(8)
    v_mfma_f32_16x16x32_bf16 v[32:35], v[204:207], v[240:243], v[32:35]
    v_mfma_f32_16x16x32_bf16 v[48:51], v[208:211], v[240:243], v[48:51]
    v_mfma_f32_16x16x32_bf16 v[64:67], v[212:215], v[240:243], v[64:67]
    v_mfma_f32_16x16x32_bf16 v[80:83], v[216:219], v[240:243], v[80:83]
    v_mfma_f32_16x16x32_bf16 v[96:99], v[220:223], v[240:243], v[96:99]
    v_mfma_f32_16x16x32_bf16 v[36:39], v[204:207], v[244:247], v[36:39]
    v_mfma_f32_16x16x32_bf16 v[52:55], v[208:211], v[244:247], v[52:55]
    v_mfma_f32_16x16x32_bf16 v[68:71], v[212:215], v[244:247], v[68:71]
    v_mfma_f32_16x16x32_bf16 v[84:87], v[216:219], v[244:247], v[84:87]
    v_mfma_f32_16x16x32_bf16 v[100:103], v[220:223], v[244:247], v[100:103]
    v_mfma_f32_16x16x32_bf16 v[40:43], v[204:207], v[248:251], v[40:43]
    v_mfma_f32_16x16x32_bf16 v[56:59], v[208:211], v[248:251], v[56:59]
    v_mfma_f32_16x16x32_bf16 v[72:75], v[212:215], v[248:251], v[72:75]
    v_mfma_f32_16x16x32_bf16 v[88:91], v[216:219], v[248:251], v[88:91]
    v_mfma_f32_16x16x32_bf16 v[104:107], v[220:223], v[248:251], v[104:107]
    v_mfma_f32_16x16x32_bf16 v[44:47], v[204:207], v[252:255], v[44:47]
    v_mfma_f32_16x16x32_bf16 v[60:63], v[208:211], v[252:255], v[60:63]
    v_mfma_f32_16x16x32_bf16 v[76:79], v[212:215], v[252:255], v[76:79]
    v_mfma_f32_16x16x32_bf16 v[92:95], v[216:219], v[252:255], v[92:95]
    v_mfma_f32_16x16x32_bf16 v[108:111], v[220:223], v[252:255], v[108:111]
    s_waitcnt vmcnt(31)
    ds_read_b128 v[204:207], v11 offset:5120
    ds_read_b128 v[208:211], v11 offset:6144
    ds_read_b128 v[212:215], v11 offset:7168
    ds_read_b128 v[216:219], v11 offset:8192
    ds_read_b128 v[220:223], v11 offset:9216
    s_waitcnt vmcnt(4) lgkmcnt(0)
    v_mfma_f32_16x16x32_bf16 v[32:35], v[184:187], v[112:115], v[32:35]
    v_mfma_f32_16x16x32_bf16 v[48:51], v[188:191], v[112:115], v[48:51]
    v_mfma_f32_16x16x32_bf16 v[64:67], v[192:195], v[112:115], v[64:67]
    v_mfma_f32_16x16x32_bf16 v[80:83], v[196:199], v[112:115], v[80:83]
    v_mfma_f32_16x16x32_bf16 v[96:99], v[200:203], v[112:115], v[96:99]
    v_mfma_f32_16x16x32_bf16 v[36:39], v[184:187], v[116:119], v[36:39]
    v_mfma_f32_16x16x32_bf16 v[52:55], v[188:191], v[116:119], v[52:55]
    v_mfma_f32_16x16x32_bf16 v[68:71], v[192:195], v[116:119], v[68:71]
    v_mfma_f32_16x16x32_bf16 v[84:87], v[196:199], v[116:119], v[84:87]
    v_mfma_f32_16x16x32_bf16 v[100:103], v[200:203], v[116:119], v[100:103]
    v_mfma_f32_16x16x32_bf16 v[40:43], v[184:187], v[120:123], v[40:43]
    v_mfma_f32_16x16x32_bf16 v[56:59], v[188:191], v[120:123], v[56:59]
    v_mfma_f32_16x16x32_bf16 v[72:75], v[192:195], v[120:123], v[72:75]
    v_mfma_f32_16x16x32_bf16 v[88:91], v[196:199], v[120:123], v[88:91]
    v_mfma_f32_16x16x32_bf16 v[104:107], v[200:203], v[120:123], v[104:107]
    v_mfma_f32_16x16x32_bf16 v[44:47], v[184:187], v[124:127], v[44:47]
    v_mfma_f32_16x16x32_bf16 v[60:63], v[188:191], v[124:127], v[60:63]
    v_mfma_f32_16x16x32_bf16 v[76:79], v[192:195], v[124:127], v[76:79]
    v_mfma_f32_16x16x32_bf16 v[92:95], v[196:199], v[124:127], v[92:95]
    v_mfma_f32_16x16x32_bf16 v[108:111], v[200:203], v[124:127], v[108:111]
    buffer_load_dwordx2 v[22:23], v13, s[20:23], 0 offen sc1
    s_waitcnt vmcnt(1) lgkmcnt(0)
    v_mfma_f32_16x16x32_bf16 v[32:35], v[204:207], v[128:131], v[32:35]
    v_mfma_f32_16x16x32_bf16 v[48:51], v[208:211], v[128:131], v[48:51]
    v_mfma_f32_16x16x32_bf16 v[64:67], v[212:215], v[128:131], v[64:67]
    v_mfma_f32_16x16x32_bf16 v[80:83], v[216:219], v[128:131], v[80:83]
    v_mfma_f32_16x16x32_bf16 v[96:99], v[220:223], v[128:131], v[96:99]
    v_mfma_f32_16x16x32_bf16 v[36:39], v[204:207], v[132:135], v[36:39]
    v_mfma_f32_16x16x32_bf16 v[52:55], v[208:211], v[132:135], v[52:55]
    v_mfma_f32_16x16x32_bf16 v[68:71], v[212:215], v[132:135], v[68:71]
    v_mfma_f32_16x16x32_bf16 v[84:87], v[216:219], v[132:135], v[84:87]
    v_mfma_f32_16x16x32_bf16 v[100:103], v[220:223], v[132:135], v[100:103]
    v_mfma_f32_16x16x32_bf16 v[40:43], v[204:207], v[136:139], v[40:43]
    v_mfma_f32_16x16x32_bf16 v[56:59], v[208:211], v[136:139], v[56:59]
    v_mfma_f32_16x16x32_bf16 v[72:75], v[212:215], v[136:139], v[72:75]
    v_mfma_f32_16x16x32_bf16 v[88:91], v[216:219], v[136:139], v[88:91]
    v_mfma_f32_16x16x32_bf16 v[104:107], v[220:223], v[136:139], v[104:107]
    v_mfma_f32_16x16x32_bf16 v[44:47], v[204:207], v[140:143], v[44:47]
    v_mfma_f32_16x16x32_bf16 v[60:63], v[208:211], v[140:143], v[60:63]
    v_mfma_f32_16x16x32_bf16 v[76:79], v[212:215], v[140:143], v[76:79]
    v_mfma_f32_16x16x32_bf16 v[92:95], v[216:219], v[140:143], v[92:95]
    v_mfma_f32_16x16x32_bf16 v[108:111], v[220:223], v[140:143], v[108:111]
    s_branch P2S_GD
P2S_G5:
    s_add_u32 s47, s40, 4096
    buffer_load_dwordx4 v[112:115], v1, s[20:23], s47 offen sc1
    buffer_load_dwordx4 v[116:119], v2, s[20:23], s47 offen sc1
    buffer_load_dwordx4 v[120:123], v3, s[20:23], s47 offen sc1
    buffer_load_dwordx4 v[124:127], v4, s[20:23], s47 offen sc1
    s_add_u32 s47, s40, 0
    buffer_load_dwordx4 v[128:131], v1, s[20:23], s47 offen sc1
    buffer_load_dwordx4 v[132:135], v2, s[20:23], s47 offen sc1
    buffer_load_dwordx4 v[136:139], v3, s[20:23], s47 offen sc1
    buffer_load_dwordx4 v[140:143], v4, s[20:23], s47 offen sc1
    s_add_u32 s47, s40, 1024
    buffer_load_dwordx4 v[144:147], v1, s[20:23], s47 offen sc1
    buffer_load_dwordx4 v[148:151], v2, s[20:23], s47 offen sc1
    buffer_load_dwordx4 v[152:155], v3, s[20:23], s47 offen sc1
    buffer_load_dwordx4 v[156:159], v4, s[20:23], s47 offen sc1
    s_waitcnt vmcnt(8)
    v_mfma_f32_16x16x32_bf16 v[32:35], v[224:227], v[112:115], 0
    v_mfma_f32_16x16x32_bf16 v[48:51], v[228:231], v[112:115], 0
    v_mfma_f32_16x16x32_bf16 v[64:67], v[232:235], v[112:115], 0
    v_mfma_f32_16x16x32_bf16 v[80:83], v[236:239], v[112:115], 0
    v_mfma_f32_16x16x32_bf16 v[96:99], v[240:243], v[112:115], 0
    v_mfma_f32_16x16x32_bf16 v[36:39], v[224:227], v[116:119], 0
    v_mfma_f32_16x16x32_bf16 v[52:55], v[228:231], v[116:119], 0
    v_mfma_f32_16x16x32_bf16 v[68:71], v[232:235], v[116:119], 0
    v_mfma_f32_16x16x32_bf16 v[84:87], v[236:239], v[116:119], 0
    v_mfma_f32_16x16x32_bf16 v[100:103], v[240:243], v[116:119], 0
    v_mfma_f32_16x16x32_bf16 v[40:43], v[224:227], v[120:123], 0
    v_mfma_f32_16x16x32_bf16 v[56:59], v[228:231], v[120:123], 0
    v_mfma_f32_16x16x32_bf16 v[72:75], v[232:235], v[120:123], 0
    v_mfma_f32_16x16x32_bf16 v[88:91], v[236:239], v[120:123], 0
    v_mfma_f32_16x16x32_bf16 v[104:107], v[240:243], v[120:123], 0
    v_mfma_f32_16x16x32_bf16 v[44:47], v[224:227], v[124:127], 0
    v_mfma_f32_16x16x32_bf16 v[60:63], v[228:231], v[124:127], 0
    v_mfma_f32_16x16x32_bf16 v[76:79], v[232:235], v[124:127], 0
    v_mfma_f32_16x16x32_bf16 v[92:95], v[236:239], v[124:127], 0
    v_mfma_f32_16x16x32_bf16 v[108:111], v[240:243], v[124:127], 0
    s_add_u32 s47, s40, 2048
    buffer_load_dwordx4 v[240:243], v1, s[20:23], s47 offen sc1
    buffer_load_dwordx4 v[244:247], v2, s[20:23], s47 offen sc1
    buffer_load_dwordx4 v[248:251], v3, s[20:23], s47 offen sc1
    buffer_load_dwordx4 v[252:255], v4, s[20:23], s47 offen sc1
    s_add_u32 s47, s40, 3072
    buffer_load_dwordx4 v[112:115], v1, s[20:23], s47 offen sc1
    buffer_load_dwordx4 v[116:119], v2, s[20:23], s47 offen sc1
    buffer_load_dwordx4 v[120:123], v3, s[20:23], s47 offen sc1
    buffer_load_dwordx4 v[124:127], v4, s[20:23], s47 offen sc1
    s_waitcnt vmcnt(12)
    v_mfma_f32_16x16x32_bf16 v[32:35], v[184:187], v[128:131], v[32:35]
    v_mfma_f32_16x16x32_bf16 v[48:51], v[188:191], v[128:131], v[48:51]
    v_mfma_f32_16x16x32_bf16 v[64:67], v[192:195], v[128:131], v[64:67]
    v_mfma_f32_16x16x32_bf16 v[80:83], v[196:199], v[128:131], v[80:83]
    v_mfma_f32_16x16x32_bf16 v[96:99], v[200:203], v[128:131], v[96:99]
    v_mfma_f32_16x16x32_bf16 v[36:39], v[184:187], v[132:135], v[36:39]
    v_mfma_f32_16x16x32_bf16 v[52:55], v[188:191], v[132:135], v[52:55]
    v_mfma_f32_16x16x32_bf16 v[68:71], v[192:195], v[132:135], v[68:71]
    v_mfma_f32_16x16x32_bf16 v[84:87], v[196:199], v[132:135], v[84:87]
    v_mfma_f32_16x16x32_bf16 v[100:103], v[200:203], v[132:135], v[100:103]
    v_mfma_f32_16x16x32_bf16 v[40:43], v[184:187], v[136:139], v[40:43]
    v_mfma_f32_16x16x32_bf16 v[56:59], v[188:191], v[136:139], v[56:59]
    v_mfma_f32_16x16x32_bf16 v[72:75], v[192:195], v[136:139], v[72:75]
    v_mfma_f32_16x16x32_bf16 v[88:91], v[196:199], v[136:139], v[88:91]
    v_mfma_f32_16x16x32_bf16 v[104:107], v[200:203], v[136:139], v[104:107]
    v_mfma_f32_16x16x32_bf16 v[44:47], v[184:187], v[140:143], v[44:47]
    v_mfma_f32_16x16x32_bf16 v[60:63], v[188:191], v[140:143], v[60:63]
    v_mfma_f32_16x16x32_bf16 v[76:79], v[192:195], v[140:143], v[76:79]
    v_mfma_f32_16x16x32_bf16 v[92:95], v[196:199], v[140:143], v[92:95]
    v_mfma_f32_16x16x32_bf16 v[108:111], v[200:203], v[140:143], v[108:111]
    s_waitcnt vmcnt(27)
    ds_read_b128 v[184:187], v11 offset:0
    ds_read_b128 v[188:191], v11 offset:1024
    ds_read_b128 v[192:195], v11 offset:2048
    ds_read_b128 v[196:199], v11 offset:3072
    ds_read_b128 v[200:203], v11 offset:4096
    s_waitcnt vmcnt(8)
    v_mfma_f32_16x16x32_bf16 v[32:35], v[204:207], v[144:147], v[32:35]
    v_mfma_f32_16x16x32_bf16 v[48:51], v[208:211], v[144:147], v[48:51]
    v_mfma_f32_16x16x32_bf16 v[64:67], v[212:215], v[144:147], v[64:67]
    v_mfma_f32_16x16x32_bf16 v[80:83], v[216:219], v[144:147], v[80:83]
    v_mfma_f32_16x16x32_bf16 v[96:99], v[220:223], v[144:147], v[96:99]
    v_mfma_f32_16x16x32_bf16 v[36:39], v[204:207], v[148:151], v[36:39]
    v_mfma_f32_16x16x32_bf16 v[52:55], v[208:211], v[148:151], v[52:55]
    v_mfma_f32_16x16x32_bf16 v[68:71], v[212:215], v[148:151], v[68:71]
    v_mfma_f32_16x16x32_bf16 v[84:87], v[216:219], v[148:151], v[84:87]
    v_mfma_f32_16x16x32_bf16 v[100:103], v[220:223], v[148:151], v[100:103]
    v_mfma_f32_16x16x32_bf16 v[40:43], v[204:207], v[152:155], v[40:43]
    v_mfma_f32_16x16x32_bf16 v[56:59], v[208:211], v[152:155], v[56:59]
    v_mfma_f32_16x16x32_bf16 v[72:75], v[212:215], v[152:155], v[72:75]
    v_mfma_f32_16x16x32_bf16 v[88:91], v[216:219], v[152:155], v[88:91]
    v_mfma_f32_16x16x32_bf16 v[104:107], v[220:223], v[152:155], v[104:107]
    v_mfma_f32_16x16x32_bf16 v[44:47], v[204:207], v[156:159], v[44:47]
    v_mfma_f32_16x16x32_bf16 v[60:63], v[208:211], v[156:159], v[60:63]
    v_mfma_f32_16x16x32_bf16 v[76:79], v[212:215], v[156:159], v[76:79]
    v_mfma_f32_16x16x32_bf16 v[92:95], v[216:219], v[156:159], v[92:95]
    v_mfma_f32_16x16x32_bf16 v[108:111], v[220:223], v[156:159], v[108:111]
    s_waitcnt vmcnt(27)
    ds_read_b128 v[204:207], v11 offset:5120
    ds_read_b128 v[208:211], v11 offset:6144
    ds_read_b128 v[212:215], v11 offset:7168
    ds_read_b128 v[216:219], v11 offset:8192
    ds_read_b128 v[220:223], v11 offset:9216
    s_waitcnt vmcnt(4) lgkmcnt(0)
    v_mfma_f32_16x16x32_bf16 v[32:35], v[184:187], v[240:243], v[32:35]
    v_mfma_f32_16x16x32_bf16 v[48:51], v[188:191], v[240:243], v[48:51]
    v_mfma_f32_16x16x32_bf16 v[64:67], v[192:195], v[240:243], v[64:67]
    v_mfma_f32_16x16x32_bf16 v[80:83], v[196:199], v[240:243], v[80:83]
    v_mfma_f32_16x16x32_bf16 v[96:99], v[200:203], v[240:243], v[96:99]
    v_mfma_f32_16x16x32_bf16 v[36:39], v[184:187], v[244:247], v[36:39]
    v_mfma_f32_16x16x32_bf16 v[52:55], v[188:191], v[244:247], v[52:55]
    v_mfma_f32_16x16x32_bf16 v[68:71], v[192:195], v[244:247], v[68:71]
    v_mfma_f32_16x16x32_bf16 v[84:87], v[196:199], v[244:247], v[84:87]
    v_mfma_f32_16x16x32_bf16 v[100:103], v[200:203], v[244:247], v[100:103]
    v_mfma_f32_16x16x32_bf16 v[40:43], v[184:187], v[248:251], v[40:43]
    v_mfma_f32_16x16x32_bf16 v[56:59], v[188:191], v[248:251], v[56:59]
    v_mfma_f32_16x16x32_bf16 v[72:75], v[192:195], v[248:251], v[72:75]
    v_mfma_f32_16x16x32_bf16 v[88:91], v[196:199], v[248:251], v[88:91]
    v_mfma_f32_16x16x32_bf16 v[104:107], v[200:203], v[248:251], v[104:107]
    v_mfma_f32_16x16x32_bf16 v[44:47], v[184:187], v[252:255], v[44:47]
    v_mfma_f32_16x16x32_bf16 v[60:63], v[188:191], v[252:255], v[60:63]
    v_mfma_f32_16x16x32_bf16 v[76:79], v[192:195], v[252:255], v[76:79]
    v_mfma_f32_16x16x32_bf16 v[92:95], v[196:199], v[252:255], v[92:95]
    v_mfma_f32_16x16x32_bf16 v[108:111], v[200:203], v[252:255], v[108:111]
    buffer_load_dwordx2 v[22:23], v13, s[20:23], 0 offen sc1
    s_waitcnt vmcnt(1) lgkmcnt(0)
    v_mfma_f32_16x16x32_bf16 v[32:35], v[204:207], v[112:115], v[32:35]
    v_mfma_f32_16x16x32_bf16 v[48:51], v[208:211], v[112:115], v[48:51]
    v_mfma_f32_16x16x32_bf16 v[64:67], v[212:215], v[112:115], v[64:67]
    v_mfma_f32_16x16x32_bf16 v[80:83], v[216:219], v[112:115], v[80:83]
    v_mfma_f32_16x16x32_bf16 v[96:99], v[220:223], v[112:115], v[96:99]
    v_mfma_f32_16x16x32_bf16 v[36:39], v[204:207], v[116:119], v[36:39]
    v_mfma_f32_16x16x32_bf16 v[52:55], v[208:211], v[116:119], v[52:55]
    v_mfma_f32_16x16x32_bf16 v[68:71], v[212:215], v[116:119], v[68:71]
    v_mfma_f32_16x16x32_bf16 v[84:87], v[216:219], v[116:119], v[84:87]
    v_mfma_f32_16x16x32_bf16 v[100:103], v[220:223], v[116:119], v[100:103]
    v_mfma_f32_16x16x32_bf16 v[40:43], v[204:207], v[120:123], v[40:43]
    v_mfma_f32_16x16x32_bf16 v[56:59], v[208:211], v[120:123], v[56:59]
    v_mfma_f32_16x16x32_bf16 v[72:75], v[212:215], v[120:123], v[72:75]
    v_mfma_f32_16x16x32_bf16 v[88:91], v[216:219], v[120:123], v[88:91]
    v_mfma_f32_16x16x32_bf16 v[104:107], v[220:223], v[120:123], v[104:107]
    v_mfma_f32_16x16x32_bf16 v[44:47], v[204:207], v[124:127], v[44:47]
    v_mfma_f32_16x16x32_bf16 v[60:63], v[208:211], v[124:127], v[60:63]
    v_mfma_f32_16x16x32_bf16 v[76:79], v[212:215], v[124:127], v[76:79]
    v_mfma_f32_16x16x32_bf16 v[92:95], v[216:219], v[124:127], v[92:95]
    v_mfma_f32_16x16x32_bf16 v[108:111], v[220:223], v[124:127], v[108:111]
P2S_GD:
    v_min_u32 v16, 52, v0
    s_mul_i32 s46, s37, 53
    v_add_u32 v16, s46, v16
    v_min_u32 v16, 209, v16
    v_lshlrev_b32 v112, 4, v16
    s_lshr_b32 s45, s2, 3
    s_mul_i32 s78, s45, 3360
    s_add_u32 s78, s78, 4194304
    s_waitcnt vmcnt(0)
    v_subrev_u32 v18, s82, v22
    v_subrev_u32 v18, 2, v18
    v_xor_b32 v19, s83, v23
    v_cmp_ne_u32 s[74:75], 0, v19
    v_cmp_lt_u32 vcc, 1, v18
    s_nop 0
    s_or_b64 vcc, vcc, s[74:75]
    s_cbranch_vccz P2_PK_OK
    s_mov_b32 s81, 0
P2_PK_SP:
    buffer_load_dwordx2 v[22:23], v13, s[20:23], 0 offen sc1
    s_waitcnt vmcnt(0)
    v_subrev_u32 v18, s82, v22
    v_subrev_u32 v18, 2, v18
    v_xor_b32 v19, s83, v23
    v_cmp_ne_u32 s[74:75], 0, v19
    v_cmp_lt_u32 vcc, 1, v18
    s_nop 0
    s_or_b64 vcc, vcc, s[74:75]
    s_add_u32 s81, s81, 1
    s_cmp_ge_u32 s81, 200000
    s_cbranch_scc1 P2_PK_OK
    s_cbranch_vccz P2_PK_OK
    s_sleep 2
    s_branch P2_PK_SP
P2_PK_OK:
    buffer_load_dwordx4 v[116:119], v112, s[20:23], s78 offen sc1
    s_add_u32 s78, s78, 107520
    buffer_load_dwordx4 v[120:123], v112, s[20:23], s78 offen sc1
    s_add_u32 s78, s78, 107520
    buffer_load_dwordx4 v[124:127], v112, s[20:23], s78 offen sc1
    s_add_u32 s78, s78, 107520
    buffer_load_dwordx4 v[128:131], v112, s[20:23], s78 offen sc1
    s_add_u32 s78, s78, 107520
    buffer_load_dwordx4 v[132:135], v112, s[20:23], s78 offen sc1
    s_add_u32 s78, s78, 107520
    buffer_load_dwordx4 v[136:139], v112, s[20:23], s78 offen sc1
    s_add_u32 s78, s78, 107520
    buffer_load_dwordx4 v[140:143], v112, s[20:23], s78 offen sc1
    s_add_u32 s78, s78, 107520
    buffer_load_dwordx4 v[144:147], v112, s[20:23], s78 offen sc1
    ds_read_b128 v[148:151], v10 offset:0
    ds_read_b128 v[152:155], v10 offset:1024
    ds_read_b128 v[156:159], v10 offset:2048
    ds_read_b128 v[160:163], v10 offset:3072
    ds_read_b128 v[164:167], v10 offset:4096
    ds_read_b128 v[168:171], v10 offset:5120
    v_mul_u32_u24 v17, 3121, v16
    v_lshrrev_b32 v17, 16, v17
    v_mul_u32_u24 v18, 21, v17
    v_sub_u32 v18, v16, v18
    v_cmp_le_u32 vcc, 5, v17
    s_nop 1
    v_cndmask_b32 v19, 0, 1, vcc
    v_mul_u32_u24 v114, 5, v19
    v_sub_u32 v17, v17, v114
    v_lshl_add_u32 v19, v19, 5, v18
    v_lshlrev_b32 v19, 4, v19
    v_lshrrev_b32 v114, 1, v17
    v_lshl_add_u32 v19, v114, 10, v19
    v_and_b32 v114, 1, v17
    v_lshl_add_u32 v19, v114, 3, v19
    v_add_u32 v113, 77824, v19
    v_cmp_eq_u32 s[8:9], 4, v17
    v_cmp_eq_u32 s[10:11], 20, v18
    v_lshlrev_b32 v114, 4, v0
    v_add_u32 v114, 77824, v114
    s_lshr_b32 s45, s2, 3
    s_and_b32 s46, s2, 7
    s_lshl_b32 s46, s46, 2
    s_add_u32 s46, s46, s37
    s_mul_i32 s46, s46, 80
    s_lshr_b32 s47, s45, 3
    s_mul_i32 s47, s47, 5
    s_add_u32 s46, s46, s47
    s_lshl_b32 s46, s46, 10
    s_add_u32 s46, s46, 6291456
    s_and_b32 s45, s45, 7
    s_lshl_b32 s76, s45, 9
    s_add_u32 s76, s76, s46
    s_lshr_b32 s47, s45, 1
    s_xor_b32 s45, s45, s47
    s_and_b32 s45, s45, 1
    s_lshl_b32 s45, s45, 3
    s_lshl_b32 s47, s47, 8
    s_add_u32 s45, s45, s47
    s_add_u32 s45, s45, s46
    s_add_u32 s77, s45, 4096
    v_bfe_u32 v112, v0, 4, 1
    v_mul_u32_u24 v112, 20480, v112
    v_and_b32 v16, 15, v0
    v_lshl_add_u32 v112, v16, 4, v112
    v_lshrrev_b32 v115, 5, v0
    v_lshl_add_u32 v115, v115, 8, v112
    s_waitcnt lgkmcnt(0)
    ds_write_b128 v15, v[40:43] offset:0
    ds_write_b128 v15, v[44:47] offset:5120
    ds_write_b128 v15, v[56:59] offset:64
    ds_write_b128 v15, v[60:63] offset:5184
    ds_write_b128 v15, v[72:75] offset:128
    ds_write_b128 v15, v[76:79] offset:5248
    ds_write_b128 v15, v[88:91] offset:192
    ds_write_b128 v15, v[92:95] offset:5312
    ds_write_b128 v15, v[104:107] offset:256
    ds_write_b128 v15, v[108:111] offset:5376
    s_waitcnt vmcnt(0)
    v_pk_add_f32 v[116:117], v[116:117], v[120:121]
    v_pk_add_f32 v[118:119], v[118:119], v[122:123]
    v_pk_add_f32 v[124:125], v[124:125], v[128:129]
    v_pk_add_f32 v[126:127], v[126:127], v[130:131]
    v_pk_add_f32 v[132:133], v[132:133], v[136:137]
    v_pk_add_f32 v[134:135], v[134:135], v[138:139]
    v_pk_add_f32 v[140:141], v[140:141], v[144:145]
    v_pk_add_f32 v[142:143], v[142:143], v[146:147]
    v_pk_add_f32 v[116:117], v[116:117], v[124:125]
    v_pk_add_f32 v[118:119], v[118:119], v[126:127]
    v_pk_add_f32 v[132:133], v[132:133], v[140:141]
    v_pk_add_f32 v[134:135], v[134:135], v[142:143]
    v_pk_add_f32 v[116:117], v[116:117], v[132:133]
    v_pk_add_f32 v[118:119], v[118:119], v[134:135]
    v_cvt_pk_bf16_f32 v120, v116, v117
    v_cvt_pk_bf16_f32 v121, v118, v119
    v_mov_b32 v122, 0
    v_mov_b32 v123, 0
    ds_write_b64 v113, v[120:121]
    s_mov_b64 exec, s[8:9]
    ds_write_b64 v113, v[122:123] offset:8
    s_mov_b64 exec, s[10:11]
    ds_write_b64 v113, v[120:121] offset:64
    s_and_b64 exec, s[8:9], s[10:11]
    ds_write_b64 v113, v[122:123] offset:72
    s_mov_b64 exec, -1
    s_waitcnt lgkmcnt(0)
    v_mov_b32 v16, 80896
    v_mov_b32 v17, 1
    s_mov_b64 exec, 1
    ds_add_u32 v16, v17
    s_mov_b64 exec, -1
    v_mov_b32 v16, 80896
    s_mov_b32 s81, 0
P2_CA_SP:
    ds_read_b32 v17, v16
    s_waitcnt lgkmcnt(0)
    v_readfirstlane_b32 s45, v17
    s_add_u32 s81, s81, 1
    s_cmp_ge_u32 s81, 1600000
    s_cbranch_scc1 P2_CA_OK
    s_cmp_lt_u32 s45, 4
    s_cbranch_scc1 P2_CA_SP
P2_CA_OK:
    ds_read_b128 v[116:119], v114 offset:0
    ds_read_b128 v[120:123], v114 offset:1024
    ds_read_b128 v[124:127], v114 offset:2048
    v_cmp_gt_u32 vcc, 32, v0
    s_waitcnt lgkmcnt(2)
    v_mfma_f32_32x32x16_bf16 v[172:187], v[116:119], v[148:151], 0
    v_mfma_f32_32x32x16_bf16 v[188:203], v[116:119], v[160:163], 0
    s_waitcnt lgkmcnt(1)
    v_mfma_f32_32x32x16_bf16 v[172:187], v[120:123], v[152:155], v[172:187]
    v_mfma_f32_32x32x16_bf16 v[188:203], v[120:123], v[164:167], v[188:203]
    s_waitcnt lgkmcnt(0)
    v_mfma_f32_32x32x16_bf16 v[172:187], v[124:127], v[156:159], v[172:187]
    v_mfma_f32_32x32x16_bf16 v[188:203], v[124:127], v[168:171], v[188:203]
    s_nop 10
    v_cndmask_b32 v186, v180, v184, vcc
    v_add_f32 v186, 0x358637bd, v186
    v_rcp_f32 v186, v186
    s_nop 0
    v_pk_mul_f32 v[172:173], v[172:173], v[186:187] op_sel:[0,0] op_sel_hi:[1,0]
    v_pk_mul_f32 v[174:175], v[174:175], v[186:187] op_sel:[0,0] op_sel_hi:[1,0]
    v_pk_mul_f32 v[176:177], v[176:177], v[186:187] op_sel:[0,0] op_sel_hi:[1,0]
    v_pk_mul_f32 v[178:179], v[178:179], v[186:187] op_sel:[0,0] op_sel_hi:[1,0]
    v_pk_mul_f32 v[180:181], v[180:181], v[186:187] op_sel:[0,0] op_sel_hi:[1,0]
    v_pk_mul_f32 v[182:183], v[182:183], v[186:187] op_sel:[0,0] op_sel_hi:[1,0]
    v_cvt_pk_bf16_f32 v148, v172, v173
    v_cvt_pk_bf16_f32 v149, v174, v175
    v_cvt_pk_bf16_f32 v150, v176, v177
    v_cvt_pk_bf16_f32 v151, v178, v179
    v_cvt_pk_bf16_f32 v152, v180, v181
    v_cvt_pk_bf16_f32 v153, v182, v183
    buffer_store_dwordx4 v[148:151], v115, s[20:23], s76 offen sc1
    s_mov_b32 exec_hi, 0
    buffer_store_dwordx2 v[152:153], v112, s[20:23], s77 offen sc1
    s_mov_b64 exec, -1
    s_add_u32 s76, s76, 40960
    s_add_u32 s77, s77, 40960
    v_cndmask_b32 v202, v196, v200, vcc
    v_add_f32 v202, 0x358637bd, v202
    v_rcp_f32 v202, v202
    s_nop 0
    v_pk_mul_f32 v[188:189], v[188:189], v[202:203] op_sel:[0,0] op_sel_hi:[1,0]
    v_pk_mul_f32 v[190:191], v[190:191], v[202:203] op_sel:[0,0] op_sel_hi:[1,0]
    v_pk_mul_f32 v[192:193], v[192:193], v[202:203] op_sel:[0,0] op_sel_hi:[1,0]
    v_pk_mul_f32 v[194:195], v[194:195], v[202:203] op_sel:[0,0] op_sel_hi:[1,0]
    v_pk_mul_f32 v[196:197], v[196:197], v[202:203] op_sel:[0,0] op_sel_hi:[1,0]
    v_pk_mul_f32 v[198:199], v[198:199], v[202:203] op_sel:[0,0] op_sel_hi:[1,0]
    v_cvt_pk_bf16_f32 v160, v188, v189
    v_cvt_pk_bf16_f32 v161, v190, v191
    v_cvt_pk_bf16_f32 v162, v192, v193
    v_cvt_pk_bf16_f32 v163, v194, v195
    v_cvt_pk_bf16_f32 v164, v196, v197
    v_cvt_pk_bf16_f32 v165, v198, v199
    buffer_store_dwordx4 v[160:163], v115, s[20:23], s76 offen sc1
    s_mov_b32 exec_hi, 0
    buffer_store_dwordx2 v[164:165], v112, s[20:23], s77 offen sc1
    s_mov_b64 exec, -1
    ds_write_b128 v14, v[32:35] offset:0
    ds_write_b128 v14, v[48:51] offset:64
    ds_write_b128 v14, v[64:67] offset:128
    ds_write_b128 v14, v[80:83] offset:192
    ds_write_b128 v14, v[96:99] offset:256
    s_add_u32 s45, s82, 3
    v_mov_b32 v16, s45
    v_mov_b32 v17, s83
    s_lshl_b32 s45, s2, 7
    v_mov_b32 v18, s45
    s_cmp_eq_u32 s32, 7
    s_cbranch_scc0 P2S_N7
    s_waitcnt vmcnt(0)
    v_mov_b32 v20, 80900
    s_mov_b32 s81, 0
P2S_CB_SP:
    ds_read_b32 v21, v20
    s_waitcnt lgkmcnt(0)
    v_readfirstlane_b32 s45, v21
    s_add_u32 s81, s81, 1
    s_cmp_ge_u32 s81, 1600000
    s_cbranch_scc1 P2S_CB_OK
    s_cmp_lt_u32 s45, 3
    s_cbranch_scc1 P2S_CB_SP
P2S_CB_OK:
    s_mov_b64 exec, 1
    buffer_store_dwordx2 v[16:17], v18, s[20:23], 0 offen sc1
    s_mov_b64 exec, -1
    ds_write_b128 v14, v[36:39] offset:5120
    ds_write_b128 v14, v[52:55] offset:5184
    ds_write_b128 v14, v[68:71] offset:5248
    ds_write_b128 v14, v[84:87] offset:5312
    ds_write_b128 v14, v[100:103] offset:5376
    s_branch P2S_N7b
P2S_N7:
    ds_write_b128 v14, v[36:39] offset:5120
    ds_write_b128 v14, v[52:55] offset:5184
    ds_write_b128 v14, v[68:71] offset:5248
    ds_write_b128 v14, v[84:87] offset:5312
    ds_write_b128 v14, v[100:103] offset:5376
    s_waitcnt vmcnt(0)
    v_mov_b32 v20, 80900
    v_mov_b32 v21, 1
    s_mov_b64 exec, 1
    ds_add_u32 v20, v21
    s_mov_b64 exec, -1
P2S_N7b:
    s_branch P2_SJ
P2_SK:
    v_min_u32 v16, 52, v0
    s_mul_i32 s46, s37, 53
    v_add_u32 v16, s46, v16
    v_min_u32 v16, 209, v16
    v_lshlrev_b32 v56, 4, v16
    s_lshr_b32 s45, s2, 3
    s_mul_i32 s78, s45, 3360
    s_add_u32 s78, s78, 4194304
    v_mov_b32 v52, v16
    buffer_load_dwordx2 v[22:23], v13, s[20:23], 0 offen sc1
    s_waitcnt vmcnt(4)
    v_lshrrev_b32 v16, 5, v0
    v_mul_u32_u24 v16, 0x8000, v16
    v_lshl_add_u32 v16, v16, 16, v16
    v_xor_b32 v32, v32, v16
    v_xor_b32 v33, v33, v16
    v_xor_b32 v34, v34, v16
    v_xor_b32 v35, v35, v16
    v_xor_b32 v36, v36, v16
    v_xor_b32 v37, v37, v16
    v_xor_b32 v38, v38, v16
    v_xor_b32 v39, v39, v16
    v_xor_b32 v40, v40, v16
    v_xor_b32 v41, v41, v16
    v_lshlrev_b32 v60, 16, v32
    v_and_b32 v61, 0xffff0000, v32
    v_lshlrev_b32 v62, 16, v33
    v_and_b32 v63, 0xffff0000, v33
    v_lshlrev_b32 v64, 16, v34
    v_and_b32 v65, 0xffff0000, v34
    v_lshlrev_b32 v66, 16, v35
    v_and_b32 v67, 0xffff0000, v35
    v_lshlrev_b32 v68, 16, v36
    v_and_b32 v69, 0xffff0000, v36
    v_lshlrev_b32 v70, 16, v37
    v_and_b32 v71, 0xffff0000, v37
    v_lshlrev_b32 v72, 16, v38
    v_and_b32 v73, 0xffff0000, v38
    v_lshlrev_b32 v74, 16, v39
    v_and_b32 v75, 0xffff0000, v39
    v_lshlrev_b32 v76, 16, v40
    v_and_b32 v77, 0xffff0000, v40
    v_lshlrev_b32 v78, 16, v41
    v_and_b32 v79, 0xffff0000, v41
    v_max3_f32 v100, v60, v61, v62
    v_max3_f32 v101, v63, v64, v65
    v_max3_f32 v100, v100, v66, v67
    v_max3_f32 v101, v101, v68, v69
    v_max3_f32 v100, v100, v70, v71
    v_max3_f32 v101, v101, v72, v73
    v_max3_f32 v100, v100, v74, v75
    v_max3_f32 v101, v101, v76, v77
    v_max3_f32 v100, v100, v78, v79
    v_max_f32 v100, v100, v101
    v_mov_b32 v102, 1069066811
    v_mul_f32 v100, v100, v102
    v_pk_fma_f32 v[80:81], v[60:61], v[102:103], v[100:101] op_sel:[0,0,0] op_sel_hi:[1,0,0] neg_lo:[0,0,1] neg_hi:[0,0,1]
    v_pk_fma_f32 v[82:83], v[62:63], v[102:103], v[100:101] op_sel:[0,0,0] op_sel_hi:[1,0,0] neg_lo:[0,0,1] neg_hi:[0,0,1]
    v_pk_fma_f32 v[84:85], v[64:65], v[102:103], v[100:101] op_sel:[0,0,0] op_sel_hi:[1,0,0] neg_lo:[0,0,1] neg_hi:[0,0,1]
    v_pk_fma_f32 v[86:87], v[66:67], v[102:103], v[100:101] op_sel:[0,0,0] op_sel_hi:[1,0,0] neg_lo:[0,0,1] neg_hi:[0,0,1]
    v_pk_fma_f32 v[88:89], v[68:69], v[102:103], v[100:101] op_sel:[0,0,0] op_sel_hi:[1,0,0] neg_lo:[0,0,1] neg_hi:[0,0,1]
    v_pk_fma_f32 v[90:91], v[70:71], v[102:103], v[100:101] op_sel:[0,0,0] op_sel_hi:[1,0,0] neg_lo:[0,0,1] neg_hi:[0,0,1]
    v_pk_fma_f32 v[92:93], v[72:73], v[102:103], v[100:101] op_sel:[0,0,0] op_sel_hi:[1,0,0] neg_lo:[0,0,1] neg_hi:[0,0,1]
    v_pk_fma_f32 v[94:95], v[74:75], v[102:103], v[100:101] op_sel:[0,0,0] op_sel_hi:[1,0,0] neg_lo:[0,0,1] neg_hi:[0,0,1]
    v_pk_fma_f32 v[96:97], v[76:77], v[102:103], v[100:101] op_sel:[0,0,0] op_sel_hi:[1,0,0] neg_lo:[0,0,1] neg_hi:[0,0,1]
    v_pk_fma_f32 v[98:99], v[78:79], v[102:103], v[100:101] op_sel:[0,0,0] op_sel_hi:[1,0,0] neg_lo:[0,0,1] neg_hi:[0,0,1]
    v_exp_f32 v80, v80
    v_exp_f32 v81, v81
    v_exp_f32 v82, v82
    v_exp_f32 v83, v83
    v_exp_f32 v84, v84
    v_exp_f32 v85, v85
    v_exp_f32 v86, v86
    v_exp_f32 v87, v87
    v_exp_f32 v88, v88
    v_exp_f32 v89, v89
    v_exp_f32 v90, v90
    v_exp_f32 v91, v91
    v_exp_f32 v92, v92
    v_exp_f32 v93, v93
    v_exp_f32 v94, v94
    v_exp_f32 v95, v95
    v_exp_f32 v96, v96
    v_exp_f32 v97, v97
    v_exp_f32 v98, v98
    v_exp_f32 v99, v99
    v_pk_add_f32 v[102:103], v[80:81], v[82:83]
    v_pk_add_f32 v[100:101], v[84:85], v[86:87]
    v_pk_add_f32 v[102:103], v[102:103], v[88:89]
    v_pk_add_f32 v[100:101], v[100:101], v[90:91]
    v_pk_add_f32 v[102:103], v[102:103], v[92:93]
    v_pk_add_f32 v[100:101], v[100:101], v[94:95]
    v_pk_add_f32 v[102:103], v[102:103], v[96:97]
    v_pk_add_f32 v[100:101], v[100:101], v[98:99]
    v_pk_add_f32 v[102:103], v[102:103], v[100:101]
    v_add_f32 v102, v102, v103
    v_rcp_f32 v102, v102
    s_nop 0
    v_pk_mul_f32 v[80:81], v[80:81], v[102:103] op_sel:[0,0] op_sel_hi:[1,0]
    v_pk_mul_f32 v[82:83], v[82:83], v[102:103] op_sel:[0,0] op_sel_hi:[1,0]
    v_pk_mul_f32 v[84:85], v[84:85], v[102:103] op_sel:[0,0] op_sel_hi:[1,0]
    v_pk_mul_f32 v[86:87], v[86:87], v[102:103] op_sel:[0,0] op_sel_hi:[1,0]
    v_pk_mul_f32 v[88:89], v[88:89], v[102:103] op_sel:[0,0] op_sel_hi:[1,0]
    v_pk_mul_f32 v[90:91], v[90:91], v[102:103] op_sel:[0,0] op_sel_hi:[1,0]
    v_pk_mul_f32 v[92:93], v[92:93], v[102:103] op_sel:[0,0] op_sel_hi:[1,0]
    v_pk_mul_f32 v[94:95], v[94:95], v[102:103] op_sel:[0,0] op_sel_hi:[1,0]
    v_pk_mul_f32 v[96:97], v[96:97], v[102:103] op_sel:[0,0] op_sel_hi:[1,0]
    v_pk_mul_f32 v[98:99], v[98:99], v[102:103] op_sel:[0,0] op_sel_hi:[1,0]
    v_cvt_pk_bf16_f32 v140, v80, v81
    v_cvt_pk_bf16_f32 v141, v82, v83
    v_cvt_pk_bf16_f32 v142, v84, v85
    v_cvt_pk_bf16_f32 v143, v86, v87
    v_cvt_pk_bf16_f32 v144, v88, v89
    v_cvt_pk_bf16_f32 v145, v90, v91
    v_cvt_pk_bf16_f32 v146, v92, v93
    v_cvt_pk_bf16_f32 v147, v94, v95
    v_cvt_pk_bf16_f32 v148, v96, v97
    v_cvt_pk_bf16_f32 v149, v98, v99
    v_mov_b32 v150, 0
    v_mov_b32 v151, 0
    s_waitcnt vmcnt(0)
    v_subrev_u32 v18, s82, v22
    v_subrev_u32 v18, 2, v18
    v_xor_b32 v19, s83, v23
    v_cmp_ne_u32 s[74:75], 0, v19
    v_cmp_lt_u32 vcc, 1, v18
    s_nop 0
    s_or_b64 vcc, vcc, s[74:75]
    s_cbranch_vccz P2K_PK_OK
    s_mov_b32 s81, 0
P2K_PK_SP:
    buffer_load_dwordx2 v[22:23], v13, s[20:23], 0 offen sc1
    s_waitcnt vmcnt(0)
    v_subrev_u32 v18, s82, v22
    v_subrev_u32 v18, 2, v18
    v_xor_b32 v19, s83, v23
    v_cmp_ne_u32 s[74:75], 0, v19
    v_cmp_lt_u32 vcc, 1, v18
    s_nop 0
    s_or_b64 vcc, vcc, s[74:75]
    s_add_u32 s81, s81, 1
    s_cmp_ge_u32 s81, 200000
    s_cbranch_scc1 P2K_PK_OK
    s_cbranch_vccz P2K_PK_OK
    s_sleep 2
    s_branch P2K_PK_SP
P2K_PK_OK:
    buffer_load_dwordx4 v[108:111], v56, s[20:23], s78 offen sc1
    s_add_u32 s78, s78, 107520
    buffer_load_dwordx4 v[112:115], v56, s[20:23], s78 offen sc1
    s_add_u32 s78, s78, 107520
    buffer_load_dwordx4 v[116:119], v56, s[20:23], s78 offen sc1
    s_add_u32 s78, s78, 107520
    buffer_load_dwordx4 v[120:123], v56, s[20:23], s78 offen sc1
    s_add_u32 s78, s78, 107520
    buffer_load_dwordx4 v[124:127], v56, s[20:23], s78 offen sc1
    s_add_u32 s78, s78, 107520
    buffer_load_dwordx4 v[128:131], v56, s[20:23], s78 offen sc1
    s_add_u32 s78, s78, 107520
    buffer_load_dwordx4 v[132:135], v56, s[20:23], s78 offen sc1
    s_add_u32 s78, s78, 107520
    buffer_load_dwordx4 v[136:139], v56, s[20:23], s78 offen sc1
    v_lshrrev_b32 v16, 5, v0
    v_mul_u32_u24 v16, 0x8000, v16
    v_lshl_add_u32 v16, v16, 16, v16
    v_xor_b32 v42, v42, v16
    v_xor_b32 v43, v43, v16
    v_xor_b32 v44, v44, v16
    v_xor_b32 v45, v45, v16
    v_xor_b32 v46, v46, v16
    v_xor_b32 v47, v47, v16
    v_xor_b32 v48, v48, v16
    v_xor_b32 v49, v49, v16
    v_xor_b32 v50, v50, v16
    v_xor_b32 v51, v51, v16
    v_lshlrev_b32 v60, 16, v42
    v_and_b32 v61, 0xffff0000, v42
    v_lshlrev_b32 v62, 16, v43
    v_and_b32 v63, 0xffff0000, v43
    v_lshlrev_b32 v64, 16, v44
    v_and_b32 v65, 0xffff0000, v44
    v_lshlrev_b32 v66, 16, v45
    v_and_b32 v67, 0xffff0000, v45
    v_lshlrev_b32 v68, 16, v46
    v_and_b32 v69, 0xffff0000, v46
    v_lshlrev_b32 v70, 16, v47
    v_and_b32 v71, 0xffff0000, v47
    v_lshlrev_b32 v72, 16, v48
    v_and_b32 v73, 0xffff0000, v48
    v_lshlrev_b32 v74, 16, v49
    v_and_b32 v75, 0xffff0000, v49
    v_lshlrev_b32 v76, 16, v50
    v_and_b32 v77, 0xffff0000, v50
    v_lshlrev_b32 v78, 16, v51
    v_and_b32 v79, 0xffff0000, v51
    v_max3_f32 v100, v60, v61, v62
    v_max3_f32 v101, v63, v64, v65
    v_max3_f32 v100, v100, v66, v67
    v_max3_f32 v101, v101, v68, v69
    v_max3_f32 v100, v100, v70, v71
    v_max3_f32 v101, v101, v72, v73
    v_max3_f32 v100, v100, v74, v75
    v_max3_f32 v101, v101, v76, v77
    v_max3_f32 v100, v100, v78, v79
    v_max_f32 v100, v100, v101
    v_mov_b32 v102, 1069066811
    v_mul_f32 v100, v100, v102
    v_pk_fma_f32 v[80:81], v[60:61], v[102:103], v[100:101] op_sel:[0,0,0] op_sel_hi:[1,0,0] neg_lo:[0,0,1] neg_hi:[0,0,1]
    v_pk_fma_f32 v[82:83], v[62:63], v[102:103], v[100:101] op_sel:[0,0,0] op_sel_hi:[1,0,0] neg_lo:[0,0,1] neg_hi:[0,0,1]
    v_pk_fma_f32 v[84:85], v[64:65], v[102:103], v[100:101] op_sel:[0,0,0] op_sel_hi:[1,0,0] neg_lo:[0,0,1] neg_hi:[0,0,1]
    v_pk_fma_f32 v[86:87], v[66:67], v[102:103], v[100:101] op_sel:[0,0,0] op_sel_hi:[1,0,0] neg_lo:[0,0,1] neg_hi:[0,0,1]
    v_pk_fma_f32 v[88:89], v[68:69], v[102:103], v[100:101] op_sel:[0,0,0] op_sel_hi:[1,0,0] neg_lo:[0,0,1] neg_hi:[0,0,1]
    v_pk_fma_f32 v[90:91], v[70:71], v[102:103], v[100:101] op_sel:[0,0,0] op_sel_hi:[1,0,0] neg_lo:[0,0,1] neg_hi:[0,0,1]
    v_pk_fma_f32 v[92:93], v[72:73], v[102:103], v[100:101] op_sel:[0,0,0] op_sel_hi:[1,0,0] neg_lo:[0,0,1] neg_hi:[0,0,1]
    v_pk_fma_f32 v[94:95], v[74:75], v[102:103], v[100:101] op_sel:[0,0,0] op_sel_hi:[1,0,0] neg_lo:[0,0,1] neg_hi:[0,0,1]
    v_pk_fma_f32 v[96:97], v[76:77], v[102:103], v[100:101] op_sel:[0,0,0] op_sel_hi:[1,0,0] neg_lo:[0,0,1] neg_hi:[0,0,1]
    v_pk_fma_f32 v[98:99], v[78:79], v[102:103], v[100:101] op_sel:[0,0,0] op_sel_hi:[1,0,0] neg_lo:[0,0,1] neg_hi:[0,0,1]
    v_exp_f32 v80, v80
    v_exp_f32 v81, v81
    v_exp_f32 v82, v82
    v_exp_f32 v83, v83
    v_exp_f32 v84, v84
    v_exp_f32 v85, v85
    v_exp_f32 v86, v86
    v_exp_f32 v87, v87
    v_exp_f32 v88, v88
    v_exp_f32 v89, v89
    v_exp_f32 v90, v90
    v_exp_f32 v91, v91
    v_exp_f32 v92, v92
    v_exp_f32 v93, v93
    v_exp_f32 v94, v94
    v_exp_f32 v95, v95
    v_exp_f32 v96, v96
    v_exp_f32 v97, v97
    v_exp_f32 v98, v98
    v_exp_f32 v99, v99
    v_pk_add_f32 v[102:103], v[80:81], v[82:83]
    v_pk_add_f32 v[100:101], v[84:85], v[86:87]
    v_pk_add_f32 v[102:103], v[102:103], v[88:89]
    v_pk_add_f32 v[100:101], v[100:101], v[90:91]
    v_pk_add_f32 v[102:103], v[102:103], v[92:93]
    v_pk_add_f32 v[100:101], v[100:101], v[94:95]
    v_pk_add_f32 v[102:103], v[102:103], v[96:97]
    v_pk_add_f32 v[100:101], v[100:101], v[98:99]
    v_pk_add_f32 v[102:103], v[102:103], v[100:101]
    v_add_f32 v102, v102, v103
    v_rcp_f32 v102, v102
    s_nop 0
    v_pk_mul_f32 v[80:81], v[80:81], v[102:103] op_sel:[0,0] op_sel_hi:[1,0]
    v_pk_mul_f32 v[82:83], v[82:83], v[102:103] op_sel:[0,0] op_sel_hi:[1,0]
    v_pk_mul_f32 v[84:85], v[84:85], v[102:103] op_sel:[0,0] op_sel_hi:[1,0]
    v_pk_mul_f32 v[86:87], v[86:87], v[102:103] op_sel:[0,0] op_sel_hi:[1,0]
    v_pk_mul_f32 v[88:89], v[88:89], v[102:103] op_sel:[0,0] op_sel_hi:[1,0]
    v_pk_mul_f32 v[90:91], v[90:91], v[102:103] op_sel:[0,0] op_sel_hi:[1,0]
    v_pk_mul_f32 v[92:93], v[92:93], v[102:103] op_sel:[0,0] op_sel_hi:[1,0]
    v_pk_mul_f32 v[94:95], v[94:95], v[102:103] op_sel:[0,0] op_sel_hi:[1,0]
    v_pk_mul_f32 v[96:97], v[96:97], v[102:103] op_sel:[0,0] op_sel_hi:[1,0]
    v_pk_mul_f32 v[98:99], v[98:99], v[102:103] op_sel:[0,0] op_sel_hi:[1,0]
    v_cvt_pk_bf16_f32 v152, v80, v81
    v_cvt_pk_bf16_f32 v153, v82, v83
    v_cvt_pk_bf16_f32 v154, v84, v85
    v_cvt_pk_bf16_f32 v155, v86, v87
    v_cvt_pk_bf16_f32 v156, v88, v89
    v_cvt_pk_bf16_f32 v157, v90, v91
    v_cvt_pk_bf16_f32 v158, v92, v93
    v_cvt_pk_bf16_f32 v159, v94, v95
    v_cvt_pk_bf16_f32 v160, v96, v97
    v_cvt_pk_bf16_f32 v161, v98, v99
    v_mov_b32 v162, 0
    v_mov_b32 v163, 0
    v_mov_b32 v16, v52
    v_mul_u32_u24 v17, 3121, v16
    v_lshrrev_b32 v17, 16, v17
    v_mul_u32_u24 v18, 21, v17
    v_sub_u32 v18, v16, v18
    v_cmp_le_u32 vcc, 5, v17
    s_nop 1
    v_cndmask_b32 v19, 0, 1, vcc
    v_mul_u32_u24 v54, 5, v19
    v_sub_u32 v17, v17, v54
    v_lshl_add_u32 v19, v19, 5, v18
    v_lshlrev_b32 v19, 4, v19
    v_lshrrev_b32 v54, 1, v17
    v_lshl_add_u32 v19, v54, 10, v19
    v_and_b32 v54, 1, v17
    v_lshl_add_u32 v19, v54, 3, v19
    v_add_u32 v53, 77824, v19
    v_cmp_eq_u32 s[8:9], 4, v17
    v_cmp_eq_u32 s[10:11], 20, v18
    v_lshlrev_b32 v54, 4, v0
    v_add_u32 v54, 77824, v54
    s_lshr_b32 s45, s2, 3
    s_and_b32 s46, s2, 7
    s_lshl_b32 s46, s46, 2
    s_add_u32 s46, s46, s37
    s_mul_i32 s46, s46, 80
    s_lshr_b32 s47, s45, 3
    s_mul_i32 s47, s47, 5
    s_add_u32 s46, s46, s47
    s_lshl_b32 s46, s46, 10
    s_add_u32 s46, s46, 6291456
    s_and_b32 s45, s45, 7
    s_lshl_b32 s76, s45, 9
    s_add_u32 s76, s76, s46
    s_lshr_b32 s47, s45, 1
    s_xor_b32 s45, s45, s47
    s_and_b32 s45, s45, 1
    s_lshl_b32 s45, s45, 3
    s_lshl_b32 s47, s47, 8
    s_add_u32 s45, s45, s47
    s_add_u32 s45, s45, s46
    s_add_u32 s77, s45, 4096
    v_bfe_u32 v52, v0, 4, 1
    v_mul_u32_u24 v52, 20480, v52
    v_and_b32 v16, 15, v0
    v_lshl_add_u32 v52, v16, 4, v52
    v_lshrrev_b32 v55, 5, v0
    v_lshl_add_u32 v55, v55, 8, v52
    s_waitcnt vmcnt(0)
    v_pk_add_f32 v[108:109], v[108:109], v[112:113]
    v_pk_add_f32 v[110:111], v[110:111], v[114:115]
    v_pk_add_f32 v[116:117], v[116:117], v[120:121]
    v_pk_add_f32 v[118:119], v[118:119], v[122:123]
    v_pk_add_f32 v[124:125], v[124:125], v[128:129]
    v_pk_add_f32 v[126:127], v[126:127], v[130:131]
    v_pk_add_f32 v[132:133], v[132:133], v[136:137]
    v_pk_add_f32 v[134:135], v[134:135], v[138:139]
    v_pk_add_f32 v[108:109], v[108:109], v[116:117]
    v_pk_add_f32 v[110:111], v[110:111], v[118:119]
    v_pk_add_f32 v[124:125], v[124:125], v[132:133]
    v_pk_add_f32 v[126:127], v[126:127], v[134:135]
    v_pk_add_f32 v[108:109], v[108:109], v[124:125]
    v_pk_add_f32 v[110:111], v[110:111], v[126:127]
    v_cvt_pk_bf16_f32 v112, v108, v109
    v_cvt_pk_bf16_f32 v113, v110, v111
    v_mov_b32 v114, 0
    v_mov_b32 v115, 0
    ds_write_b64 v53, v[112:113]
    s_mov_b64 exec, s[8:9]
    ds_write_b64 v53, v[114:115] offset:8
    s_mov_b64 exec, s[10:11]
    ds_write_b64 v53, v[112:113] offset:64
    s_and_b64 exec, s[8:9], s[10:11]
    ds_write_b64 v53, v[114:115] offset:72
    s_mov_b64 exec, -1
    s_waitcnt lgkmcnt(0)
    v_mov_b32 v16, 80896
    v_mov_b32 v17, 1
    s_mov_b64 exec, 1
    ds_add_u32 v16, v17
    s_mov_b64 exec, -1
    v_mov_b32 v16, 80896
    s_mov_b32 s81, 0
P2K_CA_SP:
    ds_read_b32 v17, v16
    s_waitcnt lgkmcnt(0)
    v_readfirstlane_b32 s45, v17
    s_add_u32 s81, s81, 1
    s_cmp_ge_u32 s81, 1600000
    s_cbranch_scc1 P2K_CA_OK
    s_cmp_lt_u32 s45, 4
    s_cbranch_scc1 P2K_CA_SP
P2K_CA_OK:
    ds_read_b128 v[108:111], v54 offset:0
    ds_read_b128 v[112:115], v54 offset:1024
    ds_read_b128 v[116:119], v54 offset:2048
    v_cmp_gt_u32 vcc, 32, v0
    s_waitcnt lgkmcnt(2)
    v_mfma_f32_32x32x16_bf16 v[60:75], v[108:111], v[140:143], 0
    v_mfma_f32_32x32x16_bf16 v[76:91], v[108:111], v[152:155], 0
    s_waitcnt lgkmcnt(1)
    v_mfma_f32_32x32x16_bf16 v[60:75], v[112:115], v[144:147], v[60:75]
    v_mfma_f32_32x32x16_bf16 v[76:91], v[112:115], v[156:159], v[76:91]
    s_waitcnt lgkmcnt(0)
    v_mfma_f32_32x32x16_bf16 v[60:75], v[116:119], v[148:151], v[60:75]
    v_mfma_f32_32x32x16_bf16 v[76:91], v[116:119], v[160:163], v[76:91]
    s_nop 10
    v_cndmask_b32 v74, v68, v72, vcc
    v_add_f32 v74, 0x358637bd, v74
    v_rcp_f32 v74, v74
    s_nop 0
    v_pk_mul_f32 v[60:61], v[60:61], v[74:75] op_sel:[0,0] op_sel_hi:[1,0]
    v_pk_mul_f32 v[62:63], v[62:63], v[74:75] op_sel:[0,0] op_sel_hi:[1,0]
    v_pk_mul_f32 v[64:65], v[64:65], v[74:75] op_sel:[0,0] op_sel_hi:[1,0]
    v_pk_mul_f32 v[66:67], v[66:67], v[74:75] op_sel:[0,0] op_sel_hi:[1,0]
    v_pk_mul_f32 v[68:69], v[68:69], v[74:75] op_sel:[0,0] op_sel_hi:[1,0]
    v_pk_mul_f32 v[70:71], v[70:71], v[74:75] op_sel:[0,0] op_sel_hi:[1,0]
    v_cvt_pk_bf16_f32 v140, v60, v61
    v_cvt_pk_bf16_f32 v141, v62, v63
    v_cvt_pk_bf16_f32 v142, v64, v65
    v_cvt_pk_bf16_f32 v143, v66, v67
    v_cvt_pk_bf16_f32 v144, v68, v69
    v_cvt_pk_bf16_f32 v145, v70, v71
    buffer_store_dwordx4 v[140:143], v55, s[20:23], s76 offen sc1
    s_mov_b32 exec_hi, 0
    buffer_store_dwordx2 v[144:145], v52, s[20:23], s77 offen sc1
    s_mov_b64 exec, -1
    s_add_u32 s76, s76, 40960
    s_add_u32 s77, s77, 40960
    v_cndmask_b32 v90, v84, v88, vcc
    v_add_f32 v90, 0x358637bd, v90
    v_rcp_f32 v90, v90
    s_nop 0
    v_pk_mul_f32 v[76:77], v[76:77], v[90:91] op_sel:[0,0] op_sel_hi:[1,0]
    v_pk_mul_f32 v[78:79], v[78:79], v[90:91] op_sel:[0,0] op_sel_hi:[1,0]
    v_pk_mul_f32 v[80:81], v[80:81], v[90:91] op_sel:[0,0] op_sel_hi:[1,0]
    v_pk_mul_f32 v[82:83], v[82:83], v[90:91] op_sel:[0,0] op_sel_hi:[1,0]
    v_pk_mul_f32 v[84:85], v[84:85], v[90:91] op_sel:[0,0] op_sel_hi:[1,0]
    v_pk_mul_f32 v[86:87], v[86:87], v[90:91] op_sel:[0,0] op_sel_hi:[1,0]
    v_cvt_pk_bf16_f32 v152, v76, v77
    v_cvt_pk_bf16_f32 v153, v78, v79
    v_cvt_pk_bf16_f32 v154, v80, v81
    v_cvt_pk_bf16_f32 v155, v82, v83
    v_cvt_pk_bf16_f32 v156, v84, v85
    v_cvt_pk_bf16_f32 v157, v86, v87
    buffer_store_dwordx4 v[152:155], v55, s[20:23], s76 offen sc1
    s_mov_b32 exec_hi, 0
    buffer_store_dwordx2 v[156:157], v52, s[20:23], s77 offen sc1
    s_mov_b64 exec, -1
    s_add_u32 s45, s82, 3
    v_mov_b32 v16, s45
    v_mov_b32 v17, s83
    s_lshl_b32 s45, s2, 7
    v_mov_b32 v18, s45
    s_cmp_eq_u32 s32, 7
    s_cbranch_scc0 P2K_N7
    s_waitcnt vmcnt(0)
    v_mov_b32 v20, 80900
    s_mov_b32 s81, 0
P2K_CB_SP:
    ds_read_b32 v21, v20
    s_waitcnt lgkmcnt(0)
    v_readfirstlane_b32 s45, v21
    s_add_u32 s81, s81, 1
    s_cmp_ge_u32 s81, 1600000
    s_cbranch_scc1 P2K_CB_OK
    s_cmp_lt_u32 s45, 3
    s_cbranch_scc1 P2K_CB_SP
P2K_CB_OK:
    s_mov_b64 exec, 1
    buffer_store_dwordx2 v[16:17], v18, s[20:23], 0 offen sc1
    s_mov_b64 exec, -1
    s_branch P2K_N7b
P2K_N7:
    s_waitcnt vmcnt(0)
    v_mov_b32 v20, 80900
    v_mov_b32 v21, 1
    s_mov_b64 exec, 1
    ds_add_u32 v20, v21
    s_mov_b64 exec, -1
P2K_N7b:
    s_cmp_eq_u32 s32, 7
    s_cbranch_scc0 P2K_W7
    s_or_b32 s45, s35, 2
    s_cmp_eq_u32 s45, 2
    s_cbranch_scc0 P2K_W7
    s_cmp_eq_u32 s31, 0
    s_cbranch_scc1 P2K_W7
    s_add_u32 s48, s28, 15360
    s_add_u32 m0, s30, 9216
    s_nop 0
    buffer_load_dwordx4 v9, s[20:23], s48 offen offset:0 sc1 lds
P2K_W7:
    s_cmp_eq_u32 s31, 3
    s_cbranch_scc1 P2K_HAVE
    v_subrev_u32 v16, s82, v28
    v_subrev_u32 v16, 2, v16
    v_xor_b32 v17, s83, v29
    v_cmp_ne_u32 s[74:75], 0, v17
    v_cmp_lt_u32 vcc, 1, v16
    s_nop 0
    s_or_b64 vcc, vcc, s[74:75]
    s_cbranch_vccz P2K_PSP_OK
    s_mov_b32 s81, 0
P2K_PSP_SP:
    buffer_load_dwordx2 v[28:29], v30, s[20:23], 0 offen sc1
    s_waitcnt vmcnt(0)
    v_subrev_u32 v16, s82, v28
    v_subrev_u32 v16, 2, v16
    v_xor_b32 v17, s83, v29
    v_cmp_ne_u32 s[74:75], 0, v17
    v_cmp_lt_u32 vcc, 1, v16
    s_nop 0
    s_or_b64 vcc, vcc, s[74:75]
    s_add_u32 s81, s81, 1
    s_cmp_ge_u32 s81, 200000
    s_cbranch_scc1 P2K_PSP_OK
    s_cbranch_vccz P2K_PSP_OK
    s_sleep 2
    s_branch P2K_PSP_SP
P2K_PSP_OK:
    s_cmp_eq_u32 s31, 0
    s_cbranch_scc0 P2K_E
    s_add_u32 s48, s28, 0
    buffer_load_dwordx4 v[184:187], v8, s[20:23], s48 offen offset:0 sc1
    buffer_load_dwordx4 v[188:191], v8, s[20:23], s48 offen offset:1024 sc1
    buffer_load_dwordx4 v[192:195], v8, s[20:23], s48 offen offset:2048 sc1
    buffer_load_dwordx4 v[196:199], v8, s[20:23], s48 offen offset:3072 sc1
    buffer_load_dwordx4 v[200:203], v9, s[20:23], s48 offen offset:0 sc1
    s_add_u32 s48, s28, 5120
    buffer_load_dwordx4 v[204:207], v8, s[20:23], s48 offen offset:0 sc1
    buffer_load_dwordx4 v[208:211], v8, s[20:23], s48 offen offset:1024 sc1
    buffer_load_dwordx4 v[212:215], v8, s[20:23], s48 offen offset:2048 sc1
    buffer_load_dwordx4 v[216:219], v8, s[20:23], s48 offen offset:3072 sc1
    buffer_load_dwordx4 v[220:223], v9, s[20:23], s48 offen offset:0 sc1
    s_add_u32 s48, s28, 10240
    s_add_u32 m0, s30, 0
    s_nop 0
    buffer_load_dwordx4 v8, s[20:23], s48 offen offset:0 sc1 lds
    s_add_u32 m0, s30, 0
    s_nop 0
    buffer_load_dwordx4 v8, s[20:23], s48 offen offset:1024 sc1 lds
    s_add_u32 m0, s30, 0
    s_nop 0
    buffer_load_dwordx4 v8, s[20:23], s48 offen offset:2048 sc1 lds
    s_add_u32 m0, s30, 0
    s_nop 0
    buffer_load_dwordx4 v8, s[20:23], s48 offen offset:3072 sc1 lds
    s_add_u32 m0, s30, 4096
    s_nop 0
    buffer_load_dwordx4 v9, s[20:23], s48 offen offset:0 sc1 lds
    s_add_u32 s48, s28, 15360
    s_add_u32 m0, s30, 5120
    s_nop 0
    buffer_load_dwordx4 v8, s[20:23], s48 offen offset:0 sc1 lds
    s_add_u32 m0, s30, 5120
    s_nop 0
    buffer_load_dwordx4 v8, s[20:23], s48 offen offset:1024 sc1 lds
    s_add_u32 m0, s30, 5120
    s_nop 0
    buffer_load_dwordx4 v8, s[20:23], s48 offen offset:2048 sc1 lds
    s_add_u32 m0, s30, 5120
    s_nop 0
    buffer_load_dwordx4 v8, s[20:23], s48 offen offset:3072 sc1 lds
    s_add_u32 m0, s30, 9216
    s_nop 0
    buffer_load_dwordx4 v9, s[20:23], s48 offen offset:0 sc1 lds
    P2K_E:
    s_add_u32 s48, s28, 20480
    buffer_load_dwordx4 v[224:227], v8, s[20:23], s48 offen offset:0 sc1
    buffer_load_dwordx4 v[228:231], v8, s[20:23], s48 offen offset:1024 sc1
    buffer_load_dwordx4 v[232:235], v8, s[20:23], s48 offen offset:2048 sc1
    buffer_load_dwordx4 v[236:239], v8, s[20:23], s48 offen offset:3072 sc1
    buffer_load_dwordx4 v[240:243], v9, s[20:23], s48 offen offset:0 sc1
P2K_HAVE:
    s_cmp_ge_u32 s32, 6
    s_cbranch_scc1 P2K_N5
    s_add_u32 s48, s28, 25600
    buffer_load_dwordx4 v[164:167], v8, s[20:23], s48 offen offset:0 sc1
    buffer_load_dwordx4 v[168:171], v8, s[20:23], s48 offen offset:1024 sc1
    buffer_load_dwordx4 v[172:175], v8, s[20:23], s48 offen offset:2048 sc1
    buffer_load_dwordx4 v[176:179], v8, s[20:23], s48 offen offset:3072 sc1
    buffer_load_dwordx4 v[180:183], v9, s[20:23], s48 offen offset:0 sc1
P2K_N5:
    buffer_load_dwordx2 v[24:25], v31, s[20:23], 0 offen sc1
    s_waitcnt vmcnt(0)
    v_subrev_u32 v16, s82, v24
    v_subrev_u32 v16, 2, v16
    v_xor_b32 v17, s83, v25
    v_cmp_ne_u32 s[74:75], 0, v17
    v_cmp_lt_u32 vcc, 1, v16
    s_nop 0
    s_or_b64 vcc, vcc, s[74:75]
    s_cbranch_vccz P2K_PH_OK
    s_mov_b32 s81, 0
P2K_PH_SP:
    buffer_load_dwordx2 v[24:25], v31, s[20:23], 0 offen sc1
    s_waitcnt vmcnt(0)
    v_subrev_u32 v16, s82, v24
    v_subrev_u32 v16, 2, v16
    v_xor_b32 v17, s83, v25
    v_cmp_ne_u32 s[74:75], 0, v17
    v_cmp_lt_u32 vcc, 1, v16
    s_nop 0
    s_or_b64 vcc, vcc, s[74:75]
    s_add_u32 s81, s81, 1
    s_cmp_ge_u32 s81, 200000
    s_cbranch_scc1 P2K_PH_OK
    s_cbranch_vccz P2K_PH_OK
    s_sleep 2
    s_branch P2K_PH_SP
P2K_PH_OK:
    s_cmp_ge_u32 s32, 6
    s_cbranch_scc1 P2K_G5
    s_add_u32 s47, s40, 4096
    buffer_load_dwordx4 v[112:115], v1, s[20:23], s47 offen sc1
    buffer_load_dwordx4 v[116:119], v2, s[20:23], s47 offen sc1
    buffer_load_dwordx4 v[120:123], v3, s[20:23], s47 offen sc1
    buffer_load_dwordx4 v[124:127], v4, s[20:23], s47 offen sc1
    s_add_u32 s47, s40, 5120
    buffer_load_dwordx4 v[128:131], v1, s[20:23], s47 offen sc1
    buffer_load_dwordx4 v[132:135], v2, s[20:23], s47 offen sc1
    buffer_load_dwordx4 v[136:139], v3, s[20:23], s47 offen sc1
    buffer_load_dwordx4 v[140:143], v4, s[20:23], s47 offen sc1
    s_add_u32 s47, s40, 0
    buffer_load_dwordx4 v[144:147], v1, s[20:23], s47 offen sc1
    buffer_load_dwordx4 v[148:151], v2, s[20:23], s47 offen sc1
    buffer_load_dwordx4 v[152:155], v3, s[20:23], s47 offen sc1
    buffer_load_dwordx4 v[156:159], v4, s[20:23], s47 offen sc1
    s_waitcnt vmcnt(8)
    v_mfma_f32_16x16x32_bf16 v[32:35], v[224:227], v[112:115], 0
    v_mfma_f32_16x16x32_bf16 v[48:51], v[228:231], v[112:115], 0
    v_mfma_f32_16x16x32_bf16 v[64:67], v[232:235], v[112:115], 0
    v_mfma_f32_16x16x32_bf16 v[80:83], v[236:239], v[112:115], 0
    v_mfma_f32_16x16x32_bf16 v[96:99], v[240:243], v[112:115], 0
    v_mfma_f32_16x16x32_bf16 v[36:39], v[224:227], v[116:119], 0
    v_mfma_f32_16x16x32_bf16 v[52:55], v[228:231], v[116:119], 0
    v_mfma_f32_16x16x32_bf16 v[68:71], v[232:235], v[116:119], 0
    v_mfma_f32_16x16x32_bf16 v[84:87], v[236:239], v[116:119], 0
    v_mfma_f32_16x16x32_bf16 v[100:103], v[240:243], v[116:119], 0
    v_mfma_f32_16x16x32_bf16 v[40:43], v[224:227], v[120:123], 0
    v_mfma_f32_16x16x32_bf16 v[56:59], v[228:231], v[120:123], 0
    v_mfma_f32_16x16x32_bf16 v[72:75], v[232:235], v[120:123], 0
    v_mfma_f32_16x16x32_bf16 v[88:91], v[236:239], v[120:123], 0
    v_mfma_f32_16x16x32_bf16 v[104:107], v[240:243], v[120:123], 0
    v_mfma_f32_16x16x32_bf16 v[44:47], v[224:227], v[124:127], 0
    v_mfma_f32_16x16x32_bf16 v[60:63], v[228:231], v[124:127], 0
    v_mfma_f32_16x16x32_bf16 v[76:79], v[232:235], v[124:127], 0
    v_mfma_f32_16x16x32_bf16 v[92:95], v[236:239], v[124:127], 0
    v_mfma_f32_16x16x32_bf16 v[108:111], v[240:243], v[124:127], 0
    s_add_u32 s47, s40, 1024
    buffer_load_dwordx4 v[240:243], v1, s[20:23], s47 offen sc1
    buffer_load_dwordx4 v[244:247], v2, s[20:23], s47 offen sc1
    buffer_load_dwordx4 v[248:251], v3, s[20:23], s47 offen sc1
    buffer_load_dwordx4 v[252:255], v4, s[20:23], s47 offen sc1
    s_add_u32 s47, s40, 2048
    buffer_load_dwordx4 v[112:115], v1, s[20:23], s47 offen sc1
    buffer_load_dwordx4 v[116:119], v2, s[20:23], s47 offen sc1
    buffer_load_dwordx4 v[120:123], v3, s[20:23], s47 offen sc1
    buffer_load_dwordx4 v[124:127], v4, s[20:23], s47 offen sc1
    s_waitcnt vmcnt(12)
    v_mfma_f32_16x16x32_bf16 v[32:35], v[164:167], v[128:131], v[32:35]
    v_mfma_f32_16x16x32_bf16 v[48:51], v[168:171], v[128:131], v[48:51]
    v_mfma_f32_16x16x32_bf16 v[64:67], v[172:175], v[128:131], v[64:67]
    v_mfma_f32_16x16x32_bf16 v[80:83], v[176:179], v[128:131], v[80:83]
    v_mfma_f32_16x16x32_bf16 v[96:99], v[180:183], v[128:131], v[96:99]
    v_mfma_f32_16x16x32_bf16 v[36:39], v[164:167], v[132:135], v[36:39]
    v_mfma_f32_16x16x32_bf16 v[52:55], v[168:171], v[132:135], v[52:55]
    v_mfma_f32_16x16x32_bf16 v[68:71], v[172:175], v[132:135], v[68:71]
    v_mfma_f32_16x16x32_bf16 v[84:87], v[176:179], v[132:135], v[84:87]
    v_mfma_f32_16x16x32_bf16 v[100:103], v[180:183], v[132:135], v[100:103]
    v_mfma_f32_16x16x32_bf16 v[40:43], v[164:167], v[136:139], v[40:43]
    v_mfma_f32_16x16x32_bf16 v[56:59], v[168:171], v[136:139], v[56:59]
    v_mfma_f32_16x16x32_bf16 v[72:75], v[172:175], v[136:139], v[72:75]
    v_mfma_f32_16x16x32_bf16 v[88:91], v[176:179], v[136:139], v[88:91]
    v_mfma_f32_16x16x32_bf16 v[104:107], v[180:183], v[136:139], v[104:107]
    v_mfma_f32_16x16x32_bf16 v[44:47], v[164:167], v[140:143], v[44:47]
    v_mfma_f32_16x16x32_bf16 v[60:63], v[168:171], v[140:143], v[60:63]
    v_mfma_f32_16x16x32_bf16 v[76:79], v[172:175], v[140:143], v[76:79]
    v_mfma_f32_16x16x32_bf16 v[92:95], v[176:179], v[140:143], v[92:95]
    v_mfma_f32_16x16x32_bf16 v[108:111], v[180:183], v[140:143], v[108:111]
    s_add_u32 s47, s40, 3072
    buffer_load_dwordx4 v[128:131], v1, s[20:23], s47 offen sc1
    buffer_load_dwordx4 v[132:135], v2, s[20:23], s47 offen sc1
    buffer_load_dwordx4 v[136:139], v3, s[20:23], s47 offen sc1
    buffer_load_dwordx4 v[140:143], v4, s[20:23], s47 offen sc1
    s_waitcnt vmcnt(12)
    v_mfma_f32_16x16x32_bf16 v[32:35], v[184:187], v[144:147], v[32:35]
    v_mfma_f32_16x16x32_bf16 v[48:51], v[188:191], v[144:147], v[48:51]
    v_mfma_f32_16x16x32_bf16 v[64:67], v[192:195], v[144:147], v[64:67]
    v_mfma_f32_16x16x32_bf16 v[80:83], v[196:199], v[144:147], v[80:83]
    v_mfma_f32_16x16x32_bf16 v[96:99], v[200:203], v[144:147], v[96:99]
    v_mfma_f32_16x16x32_bf16 v[36:39], v[184:187], v[148:151], v[36:39]
    v_mfma_f32_16x16x32_bf16 v[52:55], v[188:191], v[148:151], v[52:55]
    v_mfma_f32_16x16x32_bf16 v[68:71], v[192:195], v[148:151], v[68:71]
    v_mfma_f32_16x16x32_bf16 v[84:87], v[196:199], v[148:151], v[84:87]
    v_mfma_f32_16x16x32_bf16 v[100:103], v[200:203], v[148:151], v[100:103]
    v_mfma_f32_16x16x32_bf16 v[40:43], v[184:187], v[152:155], v[40:43]
    v_mfma_f32_16x16x32_bf16 v[56:59], v[188:191], v[152:155], v[56:59]
    v_mfma_f32_16x16x32_bf16 v[72:75], v[192:195], v[152:155], v[72:75]
    v_mfma_f32_16x16x32_bf16 v[88:91], v[196:199], v[152:155], v[88:91]
    v_mfma_f32_16x16x32_bf16 v[104:107], v[200:203], v[152:155], v[104:107]
    v_mfma_f32_16x16x32_bf16 v[44:47], v[184:187], v[156:159], v[44:47]
    v_mfma_f32_16x16x32_bf16 v[60:63], v[188:191], v[156:159], v[60:63]
    v_mfma_f32_16x16x32_bf16 v[76:79], v[192:195], v[156:159], v[76:79]
    v_mfma_f32_16x16x32_bf16 v[92:95], v[196:199], v[156:159], v[92:95]
    v_mfma_f32_16x16x32_bf16 v[108:111], v[200:203], v[156:159], v[108:111]
    s_waitcnt vmcnt(25)
    ds_read_b128 v[184:187], v11 offset:0
    ds_read_b128 v[188:191], v11 offset:1024
    ds_read_b128 v[192:195], v11 offset:2048
    ds_read_b128 v[196:199], v11 offset:3072
    ds_read_b128 v[200:203], v11 offset:4096
    s_waitcnt vmcnt(8)
    v_mfma_f32_16x16x32_bf16 v[32:35], v[204:207], v[240:243], v[32:35]
    v_mfma_f32_16x16x32_bf16 v[48:51], v[208:211], v[240:243], v[48:51]
    v_mfma_f32_16x16x32_bf16 v[64:67], v[212:215], v[240:243], v[64:67]
    v_mfma_f32_16x16x32_bf16 v[80:83], v[216:219], v[240:243], v[80:83]
    v_mfma_f32_16x16x32_bf16 v[96:99], v[220:223], v[240:243], v[96:99]
    v_mfma_f32_16x16x32_bf16 v[36:39], v[204:207], v[244:247], v[36:39]
    v_mfma_f32_16x16x32_bf16 v[52:55], v[208:211], v[244:247], v[52:55]
    v_mfma_f32_16x16x32_bf16 v[68:71], v[212:215], v[244:247], v[68:71]
    v_mfma_f32_16x16x32_bf16 v[84:87], v[216:219], v[244:247], v[84:87]
    v_mfma_f32_16x16x32_bf16 v[100:103], v[220:223], v[244:247], v[100:103]
    v_mfma_f32_16x16x32_bf16 v[40:43], v[204:207], v[248:251], v[40:43]
    v_mfma_f32_16x16x32_bf16 v[56:59], v[208:211], v[248:251], v[56:59]
    v_mfma_f32_16x16x32_bf16 v[72:75], v[212:215], v[248:251], v[72:75]
    v_mfma_f32_16x16x32_bf16 v[88:91], v[216:219], v[248:251], v[88:91]
    v_mfma_f32_16x16x32_bf16 v[104:107], v[220:223], v[248:251], v[104:107]
    v_mfma_f32_16x16x32_bf16 v[44:47], v[204:207], v[252:255], v[44:47]
    v_mfma_f32_16x16x32_bf16 v[60:63], v[208:211], v[252:255], v[60:63]
    v_mfma_f32_16x16x32_bf16 v[76:79], v[212:215], v[252:255], v[76:79]
    v_mfma_f32_16x16x32_bf16 v[92:95], v[216:219], v[252:255], v[92:95]
    v_mfma_f32_16x16x32_bf16 v[108:111], v[220:223], v[252:255], v[108:111]
    s_waitcnt vmcnt(25)
    ds_read_b128 v[204:207], v11 offset:5120
    ds_read_b128 v[208:211], v11 offset:6144
    ds_read_b128 v[212:215], v11 offset:7168
    ds_read_b128 v[216:219], v11 offset:8192
    ds_read_b128 v[220:223], v11 offset:9216
    s_waitcnt vmcnt(4) lgkmcnt(0)
    v_mfma_f32_16x16x32_bf16 v[32:35], v[184:187], v[112:115], v[32:35]
    v_mfma_f32_16x16x32_bf16 v[48:51], v[188:191], v[112:115], v[48:51]
    v_mfma_f32_16x16x32_bf16 v[64:67], v[192:195], v[112:115], v[64:67]
    v_mfma_f32_16x16x32_bf16 v[80:83], v[196:199], v[112:115], v[80:83]
    v_mfma_f32_16x16x32_bf16 v[96:99], v[200:203], v[112:115], v[96:99]
    v_mfma_f32_16x16x32_bf16 v[36:39], v[184:187], v[116:119], v[36:39]
    v_mfma_f32_16x16x32_bf16 v[52:55], v[188:191], v[116:119], v[52:55]
    v_mfma_f32_16x16x32_bf16 v[68:71], v[192:195], v[116:119], v[68:71]
    v_mfma_f32_16x16x32_bf16 v[84:87], v[196:199], v[116:119], v[84:87]
    v_mfma_f32_16x16x32_bf16 v[100:103], v[200:203], v[116:119], v[100:103]
    v_mfma_f32_16x16x32_bf16 v[40:43], v[184:187], v[120:123], v[40:43]
    v_mfma_f32_16x16x32_bf16 v[56:59], v[188:191], v[120:123], v[56:59]
    v_mfma_f32_16x16x32_bf16 v[72:75], v[192:195], v[120:123], v[72:75]
    v_mfma_f32_16x16x32_bf16 v[88:91], v[196:199], v[120:123], v[88:91]
    v_mfma_f32_16x16x32_bf16 v[104:107], v[200:203], v[120:123], v[104:107]
    v_mfma_f32_16x16x32_bf16 v[44:47], v[184:187], v[124:127], v[44:47]
    v_mfma_f32_16x16x32_bf16 v[60:63], v[188:191], v[124:127], v[60:63]
    v_mfma_f32_16x16x32_bf16 v[76:79], v[192:195], v[124:127], v[76:79]
    v_mfma_f32_16x16x32_bf16 v[92:95], v[196:199], v[124:127], v[92:95]
    v_mfma_f32_16x16x32_bf16 v[108:111], v[200:203], v[124:127], v[108:111]
    s_waitcnt vmcnt(0) lgkmcnt(0)
    v_mfma_f32_16x16x32_bf16 v[32:35], v[204:207], v[128:131], v[32:35]
    v_mfma_f32_16x16x32_bf16 v[48:51], v[208:211], v[128:131], v[48:51]
    v_mfma_f32_16x16x32_bf16 v[64:67], v[212:215], v[128:131], v[64:67]
    v_mfma_f32_16x16x32_bf16 v[80:83], v[216:219], v[128:131], v[80:83]
    v_mfma_f32_16x16x32_bf16 v[96:99], v[220:223], v[128:131], v[96:99]
    v_mfma_f32_16x16x32_bf16 v[36:39], v[204:207], v[132:135], v[36:39]
    v_mfma_f32_16x16x32_bf16 v[52:55], v[208:211], v[132:135], v[52:55]
    v_mfma_f32_16x16x32_bf16 v[68:71], v[212:215], v[132:135], v[68:71]
    v_mfma_f32_16x16x32_bf16 v[84:87], v[216:219], v[132:135], v[84:87]
    v_mfma_f32_16x16x32_bf16 v[100:103], v[220:223], v[132:135], v[100:103]
    v_mfma_f32_16x16x32_bf16 v[40:43], v[204:207], v[136:139], v[40:43]
    v_mfma_f32_16x16x32_bf16 v[56:59], v[208:211], v[136:139], v[56:59]
    v_mfma_f32_16x16x32_bf16 v[72:75], v[212:215], v[136:139], v[72:75]
    v_mfma_f32_16x16x32_bf16 v[88:91], v[216:219], v[136:139], v[88:91]
    v_mfma_f32_16x16x32_bf16 v[104:107], v[220:223], v[136:139], v[104:107]
    v_mfma_f32_16x16x32_bf16 v[44:47], v[204:207], v[140:143], v[44:47]
    v_mfma_f32_16x16x32_bf16 v[60:63], v[208:211], v[140:143], v[60:63]
    v_mfma_f32_16x16x32_bf16 v[76:79], v[212:215], v[140:143], v[76:79]
    v_mfma_f32_16x16x32_bf16 v[92:95], v[216:219], v[140:143], v[92:95]
    v_mfma_f32_16x16x32_bf16 v[108:111], v[220:223], v[140:143], v[108:111]
    s_branch P2K_GD
P2K_G5:
    s_add_u32 s47, s40, 4096
    buffer_load_dwordx4 v[112:115], v1, s[20:23], s47 offen sc1
    buffer_load_dwordx4 v[116:119], v2, s[20:23], s47 offen sc1
    buffer_load_dwordx4 v[120:123], v3, s[20:23], s47 offen sc1
    buffer_load_dwordx4 v[124:127], v4, s[20:23], s47 offen sc1
    s_add_u32 s47, s40, 0
    buffer_load_dwordx4 v[128:131], v1, s[20:23], s47 offen sc1
    buffer_load_dwordx4 v[132:135], v2, s[20:23], s47 offen sc1
    buffer_load_dwordx4 v[136:139], v3, s[20:23], s47 offen sc1
    buffer_load_dwordx4 v[140:143], v4, s[20:23], s47 offen sc1
    s_add_u32 s47, s40, 1024
    buffer_load_dwordx4 v[144:147], v1, s[20:23], s47 offen sc1
    buffer_load_dwordx4 v[148:151], v2, s[20:23], s47 offen sc1
    buffer_load_dwordx4 v[152:155], v3, s[20:23], s47 offen sc1
    buffer_load_dwordx4 v[156:159], v4, s[20:23], s47 offen sc1
    s_waitcnt vmcnt(8)
    v_mfma_f32_16x16x32_bf16 v[32:35], v[224:227], v[112:115], 0
    v_mfma_f32_16x16x32_bf16 v[48:51], v[228:231], v[112:115], 0
    v_mfma_f32_16x16x32_bf16 v[64:67], v[232:235], v[112:115], 0
    v_mfma_f32_16x16x32_bf16 v[80:83], v[236:239], v[112:115], 0
    v_mfma_f32_16x16x32_bf16 v[96:99], v[240:243], v[112:115], 0
    v_mfma_f32_16x16x32_bf16 v[36:39], v[224:227], v[116:119], 0
    v_mfma_f32_16x16x32_bf16 v[52:55], v[228:231], v[116:119], 0
    v_mfma_f32_16x16x32_bf16 v[68:71], v[232:235], v[116:119], 0
    v_mfma_f32_16x16x32_bf16 v[84:87], v[236:239], v[116:119], 0
    v_mfma_f32_16x16x32_bf16 v[100:103], v[240:243], v[116:119], 0
    v_mfma_f32_16x16x32_bf16 v[40:43], v[224:227], v[120:123], 0
    v_mfma_f32_16x16x32_bf16 v[56:59], v[228:231], v[120:123], 0
    v_mfma_f32_16x16x32_bf16 v[72:75], v[232:235], v[120:123], 0
    v_mfma_f32_16x16x32_bf16 v[88:91], v[236:239], v[120:123], 0
    v_mfma_f32_16x16x32_bf16 v[104:107], v[240:243], v[120:123], 0
    v_mfma_f32_16x16x32_bf16 v[44:47], v[224:227], v[124:127], 0
    v_mfma_f32_16x16x32_bf16 v[60:63], v[228:231], v[124:127], 0
    v_mfma_f32_16x16x32_bf16 v[76:79], v[232:235], v[124:127], 0
    v_mfma_f32_16x16x32_bf16 v[92:95], v[236:239], v[124:127], 0
    v_mfma_f32_16x16x32_bf16 v[108:111], v[240:243], v[124:127], 0
    s_add_u32 s47, s40, 2048
    buffer_load_dwordx4 v[240:243], v1, s[20:23], s47 offen sc1
    buffer_load_dwordx4 v[244:247], v2, s[20:23], s47 offen sc1
    buffer_load_dwordx4 v[248:251], v3, s[20:23], s47 offen sc1
    buffer_load_dwordx4 v[252:255], v4, s[20:23], s47 offen sc1
    s_add_u32 s47, s40, 3072
    buffer_load_dwordx4 v[112:115], v1, s[20:23], s47 offen sc1
    buffer_load_dwordx4 v[116:119], v2, s[20:23], s47 offen sc1
    buffer_load_dwordx4 v[120:123], v3, s[20:23], s47 offen sc1
    buffer_load_dwordx4 v[124:127], v4, s[20:23], s47 offen sc1
    s_waitcnt vmcnt(12)
    v_mfma_f32_16x16x32_bf16 v[32:35], v[184:187], v[128:131], v[32:35]
    v_mfma_f32_16x16x32_bf16 v[48:51], v[188:191], v[128:131], v[48:51]
    v_mfma_f32_16x16x32_bf16 v[64:67], v[192:195], v[128:131], v[64:67]
    v_mfma_f32_16x16x32_bf16 v[80:83], v[196:199], v[128:131], v[80:83]
    v_mfma_f32_16x16x32_bf16 v[96:99], v[200:203], v[128:131], v[96:99]
    v_mfma_f32_16x16x32_bf16 v[36:39], v[184:187], v[132:135], v[36:39]
    v_mfma_f32_16x16x32_bf16 v[52:55], v[188:191], v[132:135], v[52:55]
    v_mfma_f32_16x16x32_bf16 v[68:71], v[192:195], v[132:135], v[68:71]
    v_mfma_f32_16x16x32_bf16 v[84:87], v[196:199], v[132:135], v[84:87]
    v_mfma_f32_16x16x32_bf16 v[100:103], v[200:203], v[132:135], v[100:103]
    v_mfma_f32_16x16x32_bf16 v[40:43], v[184:187], v[136:139], v[40:43]
    v_mfma_f32_16x16x32_bf16 v[56:59], v[188:191], v[136:139], v[56:59]
    v_mfma_f32_16x16x32_bf16 v[72:75], v[192:195], v[136:139], v[72:75]
    v_mfma_f32_16x16x32_bf16 v[88:91], v[196:199], v[136:139], v[88:91]
    v_mfma_f32_16x16x32_bf16 v[104:107], v[200:203], v[136:139], v[104:107]
    v_mfma_f32_16x16x32_bf16 v[44:47], v[184:187], v[140:143], v[44:47]
    v_mfma_f32_16x16x32_bf16 v[60:63], v[188:191], v[140:143], v[60:63]
    v_mfma_f32_16x16x32_bf16 v[76:79], v[192:195], v[140:143], v[76:79]
    v_mfma_f32_16x16x32_bf16 v[92:95], v[196:199], v[140:143], v[92:95]
    v_mfma_f32_16x16x32_bf16 v[108:111], v[200:203], v[140:143], v[108:111]
    s_waitcnt vmcnt(21)
    ds_read_b128 v[184:187], v11 offset:0
    ds_read_b128 v[188:191], v11 offset:1024
    ds_read_b128 v[192:195], v11 offset:2048
    ds_read_b128 v[196:199], v11 offset:3072
    ds_read_b128 v[200:203], v11 offset:4096
    s_waitcnt vmcnt(8)
    v_mfma_f32_16x16x32_bf16 v[32:35], v[204:207], v[144:147], v[32:35]
    v_mfma_f32_16x16x32_bf16 v[48:51], v[208:211], v[144:147], v[48:51]
    v_mfma_f32_16x16x32_bf16 v[64:67], v[212:215], v[144:147], v[64:67]
    v_mfma_f32_16x16x32_bf16 v[80:83], v[216:219], v[144:147], v[80:83]
    v_mfma_f32_16x16x32_bf16 v[96:99], v[220:223], v[144:147], v[96:99]
    v_mfma_f32_16x16x32_bf16 v[36:39], v[204:207], v[148:151], v[36:39]
    v_mfma_f32_16x16x32_bf16 v[52:55], v[208:211], v[148:151], v[52:55]
    v_mfma_f32_16x16x32_bf16 v[68:71], v[212:215], v[148:151], v[68:71]
    v_mfma_f32_16x16x32_bf16 v[84:87], v[216:219], v[148:151], v[84:87]
    v_mfma_f32_16x16x32_bf16 v[100:103], v[220:223], v[148:151], v[100:103]
    v_mfma_f32_16x16x32_bf16 v[40:43], v[204:207], v[152:155], v[40:43]
    v_mfma_f32_16x16x32_bf16 v[56:59], v[208:211], v[152:155], v[56:59]
    v_mfma_f32_16x16x32_bf16 v[72:75], v[212:215], v[152:155], v[72:75]
    v_mfma_f32_16x16x32_bf16 v[88:91], v[216:219], v[152:155], v[88:91]
    v_mfma_f32_16x16x32_bf16 v[104:107], v[220:223], v[152:155], v[104:107]
    v_mfma_f32_16x16x32_bf16 v[44:47], v[204:207], v[156:159], v[44:47]
    v_mfma_f32_16x16x32_bf16 v[60:63], v[208:211], v[156:159], v[60:63]
    v_mfma_f32_16x16x32_bf16 v[76:79], v[212:215], v[156:159], v[76:79]
    v_mfma_f32_16x16x32_bf16 v[92:95], v[216:219], v[156:159], v[92:95]
    v_mfma_f32_16x16x32_bf16 v[108:111], v[220:223], v[156:159], v[108:111]
    s_waitcnt vmcnt(21)
    ds_read_b128 v[204:207], v11 offset:5120
    ds_read_b128 v[208:211], v11 offset:6144
    ds_read_b128 v[212:215], v11 offset:7168
    ds_read_b128 v[216:219], v11 offset:8192
    ds_read_b128 v[220:223], v11 offset:9216
    s_waitcnt vmcnt(4) lgkmcnt(0)
    v_mfma_f32_16x16x32_bf16 v[32:35], v[184:187], v[240:243], v[32:35]
    v_mfma_f32_16x16x32_bf16 v[48:51], v[188:191], v[240:243], v[48:51]
    v_mfma_f32_16x16x32_bf16 v[64:67], v[192:195], v[240:243], v[64:67]
    v_mfma_f32_16x16x32_bf16 v[80:83], v[196:199], v[240:243], v[80:83]
    v_mfma_f32_16x16x32_bf16 v[96:99], v[200:203], v[240:243], v[96:99]
    v_mfma_f32_16x16x32_bf16 v[36:39], v[184:187], v[244:247], v[36:39]
    v_mfma_f32_16x16x32_bf16 v[52:55], v[188:191], v[244:247], v[52:55]
    v_mfma_f32_16x16x32_bf16 v[68:71], v[192:195], v[244:247], v[68:71]
    v_mfma_f32_16x16x32_bf16 v[84:87], v[196:199], v[244:247], v[84:87]
    v_mfma_f32_16x16x32_bf16 v[100:103], v[200:203], v[244:247], v[100:103]
    v_mfma_f32_16x16x32_bf16 v[40:43], v[184:187], v[248:251], v[40:43]
    v_mfma_f32_16x16x32_bf16 v[56:59], v[188:191], v[248:251], v[56:59]
    v_mfma_f32_16x16x32_bf16 v[72:75], v[192:195], v[248:251], v[72:75]
    v_mfma_f32_16x16x32_bf16 v[88:91], v[196:199], v[248:251], v[88:91]
    v_mfma_f32_16x16x32_bf16 v[104:107], v[200:203], v[248:251], v[104:107]
    v_mfma_f32_16x16x32_bf16 v[44:47], v[184:187], v[252:255], v[44:47]
    v_mfma_f32_16x16x32_bf16 v[60:63], v[188:191], v[252:255], v[60:63]
    v_mfma_f32_16x16x32_bf16 v[76:79], v[192:195], v[252:255], v[76:79]
    v_mfma_f32_16x16x32_bf16 v[92:95], v[196:199], v[252:255], v[92:95]
    v_mfma_f32_16x16x32_bf16 v[108:111], v[200:203], v[252:255], v[108:111]
    s_waitcnt vmcnt(0) lgkmcnt(0)
    v_mfma_f32_16x16x32_bf16 v[32:35], v[204:207], v[112:115], v[32:35]
    v_mfma_f32_16x16x32_bf16 v[48:51], v[208:211], v[112:115], v[48:51]
    v_mfma_f32_16x16x32_bf16 v[64:67], v[212:215], v[112:115], v[64:67]
    v_mfma_f32_16x16x32_bf16 v[80:83], v[216:219], v[112:115], v[80:83]
    v_mfma_f32_16x16x32_bf16 v[96:99], v[220:223], v[112:115], v[96:99]
    v_mfma_f32_16x16x32_bf16 v[36:39], v[204:207], v[116:119], v[36:39]
    v_mfma_f32_16x16x32_bf16 v[52:55], v[208:211], v[116:119], v[52:55]
    v_mfma_f32_16x16x32_bf16 v[68:71], v[212:215], v[116:119], v[68:71]
    v_mfma_f32_16x16x32_bf16 v[84:87], v[216:219], v[116:119], v[84:87]
    v_mfma_f32_16x16x32_bf16 v[100:103], v[220:223], v[116:119], v[100:103]
    v_mfma_f32_16x16x32_bf16 v[40:43], v[204:207], v[120:123], v[40:43]
    v_mfma_f32_16x16x32_bf16 v[56:59], v[208:211], v[120:123], v[56:59]
    v_mfma_f32_16x16x32_bf16 v[72:75], v[212:215], v[120:123], v[72:75]
    v_mfma_f32_16x16x32_bf16 v[88:91], v[216:219], v[120:123], v[88:91]
    v_mfma_f32_16x16x32_bf16 v[104:107], v[220:223], v[120:123], v[104:107]
    v_mfma_f32_16x16x32_bf16 v[44:47], v[204:207], v[124:127], v[44:47]
    v_mfma_f32_16x16x32_bf16 v[60:63], v[208:211], v[124:127], v[60:63]
    v_mfma_f32_16x16x32_bf16 v[76:79], v[212:215], v[124:127], v[76:79]
    v_mfma_f32_16x16x32_bf16 v[92:95], v[216:219], v[124:127], v[92:95]
    v_mfma_f32_16x16x32_bf16 v[108:111], v[220:223], v[124:127], v[108:111]
P2K_GD:
    s_nop 7
    ds_write_b128 v14, v[32:35] offset:0
    ds_write_b128 v14, v[36:39] offset:5120
    ds_write_b128 v15, v[40:43] offset:0
    ds_write_b128 v15, v[44:47] offset:5120
    ds_write_b128 v14, v[48:51] offset:64
    ds_write_b128 v14, v[52:55] offset:5184
    ds_write_b128 v15, v[56:59] offset:64
    ds_write_b128 v15, v[60:63] offset:5184
    ds_write_b128 v14, v[64:67] offset:128
    ds_write_b128 v14, v[68:71] offset:5248
    ds_write_b128 v15, v[72:75] offset:128
    ds_write_b128 v15, v[76:79] offset:5248
    ds_write_b128 v14, v[80:83] offset:192
    ds_write_b128 v14, v[84:87] offset:5312
    ds_write_b128 v15, v[88:91] offset:192
    ds_write_b128 v15, v[92:95] offset:5312
    ds_write_b128 v14, v[96:99] offset:256
    ds_write_b128 v14, v[100:103] offset:5376
    ds_write_b128 v15, v[104:107] offset:256
    ds_write_b128 v15, v[108:111] offset:5376
P2_SJ:
    s_bfe_u32 s45, s2, 0x30003
    s_mul_i32 s45, s45, 74
    s_mul_i32 s46, s37, 5
    s_add_u32 s45, s45, s46
    s_add_u32 s45, s45, 54
    s_mul_i32 s28, s45, 5120
    s_add_u32 s28, s28, 10485760
    v_and_b32 v31, 7, v0
    s_lshl_b32 s45, s37, 3
    v_add_u32 v31, s45, v31
    v_lshlrev_b32 v31, 3, v31
    s_and_b32 s45, s2, 7
    v_add_u32 v31, s45, v31
    v_lshlrev_b32 v31, 7, v31
    s_add_u32 s48, s28, 0
    buffer_load_dwordx4 v[224:227], v8, s[20:23], s48 offen offset:0 sc1
    buffer_load_dwordx4 v[228:231], v8, s[20:23], s48 offen offset:1024 sc1
    buffer_load_dwordx4 v[232:235], v8, s[20:23], s48 offen offset:2048 sc1
    buffer_load_dwordx4 v[236:239], v8, s[20:23], s48 offen offset:3072 sc1
    buffer_load_dwordx4 v[240:243], v9, s[20:23], s48 offen offset:0 sc1
    s_add_u32 s48, s28, 5120
    buffer_load_dwordx4 v[164:167], v8, s[20:23], s48 offen offset:0 sc1
    buffer_load_dwordx4 v[168:171], v8, s[20:23], s48 offen offset:1024 sc1
    buffer_load_dwordx4 v[172:175], v8, s[20:23], s48 offen offset:2048 sc1
    buffer_load_dwordx4 v[176:179], v8, s[20:23], s48 offen offset:3072 sc1
    buffer_load_dwordx4 v[180:183], v9, s[20:23], s48 offen offset:0 sc1
    s_add_u32 s48, s28, 10240
    buffer_load_dwordx4 v[184:187], v8, s[20:23], s48 offen offset:0 sc1
    buffer_load_dwordx4 v[188:191], v8, s[20:23], s48 offen offset:1024 sc1
    buffer_load_dwordx4 v[192:195], v8, s[20:23], s48 offen offset:2048 sc1
    buffer_load_dwordx4 v[196:199], v8, s[20:23], s48 offen offset:3072 sc1
    buffer_load_dwordx4 v[200:203], v9, s[20:23], s48 offen offset:0 sc1
    s_add_u32 s48, s28, 15360
    buffer_load_dwordx4 v[204:207], v8, s[20:23], s48 offen offset:0 sc1
    buffer_load_dwordx4 v[208:211], v8, s[20:23], s48 offen offset:1024 sc1
    buffer_load_dwordx4 v[212:215], v8, s[20:23], s48 offen offset:2048 sc1
    buffer_load_dwordx4 v[216:219], v8, s[20:23], s48 offen offset:3072 sc1
    buffer_load_dwordx4 v[220:223], v9, s[20:23], s48 offen offset:0 sc1
    s_and_b32 s45, s2, 7
    s_lshl_b32 s45, s45, 4
    s_lshr_b32 s46, s2, 6
    s_lshl_b32 s46, s46, 2
    s_add_u32 s45, s45, s46
    s_mul_i32 s40, s45, 20
    s_mul_i32 s46, s37, 5
    s_add_u32 s40, s40, s46
    s_lshl_b32 s40, s40, 10
    s_add_u32 s40, s40, 6291456
    v_lshlrev_b32 v1, 4, v0
    v_add_u32 v2, 20480, v1
    v_add_u32 v3, 40960, v1
    v_add_u32 v4, 61440, v1
    s_waitcnt lgkmcnt(0)
    s_barrier
    s_mov_b32 s81, 0
P2_PO_SP:
    buffer_load_dwordx2 v[250:251], v31, s[20:23], 0 offen sc1
    s_waitcnt vmcnt(0)
    v_subrev_u32 v16, s82, v250
    v_subrev_u32 v16, 3, v16
    v_xor_b32 v17, s83, v251
    v_cmp_ne_u32 s[74:75], 0, v17
    v_cmp_lt_u32 vcc, 0, v16
    s_nop 0
    s_or_b64 vcc, vcc, s[74:75]
    s_add_u32 s81, s81, 1
    s_cmp_ge_u32 s81, 200000
    s_cbranch_scc1 P2_PO_OK
    s_cbranch_vccz P2_PO_OK
    s_sleep 2
    s_branch P2_PO_SP
P2_PO_OK:
    s_add_u32 s47, s40, 0
    buffer_load_dwordx4 v[112:115], v1, s[20:23], s47 offen sc1
    buffer_load_dwordx4 v[116:119], v2, s[20:23], s47 offen sc1
    buffer_load_dwordx4 v[120:123], v3, s[20:23], s47 offen sc1
    buffer_load_dwordx4 v[124:127], v4, s[20:23], s47 offen sc1
    s_add_u32 s47, s40, 1024
    buffer_load_dwordx4 v[128:131], v1, s[20:23], s47 offen sc1
    buffer_load_dwordx4 v[132:135], v2, s[20:23], s47 offen sc1
    buffer_load_dwordx4 v[136:139], v3, s[20:23], s47 offen sc1
    buffer_load_dwordx4 v[140:143], v4, s[20:23], s47 offen sc1
    s_add_u32 s47, s40, 2048
    buffer_load_dwordx4 v[144:147], v1, s[20:23], s47 offen sc1
    buffer_load_dwordx4 v[148:151], v2, s[20:23], s47 offen sc1
    buffer_load_dwordx4 v[152:155], v3, s[20:23], s47 offen sc1
    buffer_load_dwordx4 v[156:159], v4, s[20:23], s47 offen sc1
    s_waitcnt vmcnt(8)
    v_mfma_f32_16x16x32_bf16 v[32:35], v[224:227], v[112:115], 0
    v_mfma_f32_16x16x32_bf16 v[48:51], v[228:231], v[112:115], 0
    v_mfma_f32_16x16x32_bf16 v[64:67], v[232:235], v[112:115], 0
    v_mfma_f32_16x16x32_bf16 v[80:83], v[236:239], v[112:115], 0
    v_mfma_f32_16x16x32_bf16 v[96:99], v[240:243], v[112:115], 0
    v_mfma_f32_16x16x32_bf16 v[36:39], v[224:227], v[116:119], 0
    v_mfma_f32_16x16x32_bf16 v[52:55], v[228:231], v[116:119], 0
    v_mfma_f32_16x16x32_bf16 v[68:71], v[232:235], v[116:119], 0
    v_mfma_f32_16x16x32_bf16 v[84:87], v[236:239], v[116:119], 0
    v_mfma_f32_16x16x32_bf16 v[100:103], v[240:243], v[116:119], 0
    v_mfma_f32_16x16x32_bf16 v[40:43], v[224:227], v[120:123], 0
    v_mfma_f32_16x16x32_bf16 v[56:59], v[228:231], v[120:123], 0
    v_mfma_f32_16x16x32_bf16 v[72:75], v[232:235], v[120:123], 0
    v_mfma_f32_16x16x32_bf16 v[88:91], v[236:239], v[120:123], 0
    v_mfma_f32_16x16x32_bf16 v[104:107], v[240:243], v[120:123], 0
    v_mfma_f32_16x16x32_bf16 v[44:47], v[224:227], v[124:127], 0
    v_mfma_f32_16x16x32_bf16 v[60:63], v[228:231], v[124:127], 0
    v_mfma_f32_16x16x32_bf16 v[76:79], v[232:235], v[124:127], 0
    v_mfma_f32_16x16x32_bf16 v[92:95], v[236:239], v[124:127], 0
    v_mfma_f32_16x16x32_bf16 v[108:111], v[240:243], v[124:127], 0
    s_add_u32 s47, s40, 3072
    buffer_load_dwordx4 v[112:115], v1, s[20:23], s47 offen sc1
    buffer_load_dwordx4 v[116:119], v2, s[20:23], s47 offen sc1
    buffer_load_dwordx4 v[120:123], v3, s[20:23], s47 offen sc1
    buffer_load_dwordx4 v[124:127], v4, s[20:23], s47 offen sc1
    s_add_u32 s48, s28, 20480
    buffer_load_dwordx4 v[224:227], v8, s[20:23], s48 offen offset:0 sc1
    buffer_load_dwordx4 v[228:231], v8, s[20:23], s48 offen offset:1024 sc1
    buffer_load_dwordx4 v[232:235], v8, s[20:23], s48 offen offset:2048 sc1
    buffer_load_dwordx4 v[236:239], v8, s[20:23], s48 offen offset:3072 sc1
    buffer_load_dwordx4 v[240:243], v9, s[20:23], s48 offen offset:0 sc1
    s_waitcnt vmcnt(13)
    v_mfma_f32_16x16x32_bf16 v[32:35], v[164:167], v[128:131], v[32:35]
    v_mfma_f32_16x16x32_bf16 v[48:51], v[168:171], v[128:131], v[48:51]
    v_mfma_f32_16x16x32_bf16 v[64:67], v[172:175], v[128:131], v[64:67]
    v_mfma_f32_16x16x32_bf16 v[80:83], v[176:179], v[128:131], v[80:83]
    v_mfma_f32_16x16x32_bf16 v[96:99], v[180:183], v[128:131], v[96:99]
    v_mfma_f32_16x16x32_bf16 v[36:39], v[164:167], v[132:135], v[36:39]
    v_mfma_f32_16x16x32_bf16 v[52:55], v[168:171], v[132:135], v[52:55]
    v_mfma_f32_16x16x32_bf16 v[68:71], v[172:175], v[132:135], v[68:71]
    v_mfma_f32_16x16x32_bf16 v[84:87], v[176:179], v[132:135], v[84:87]
    v_mfma_f32_16x16x32_bf16 v[100:103], v[180:183], v[132:135], v[100:103]
    v_mfma_f32_16x16x32_bf16 v[40:43], v[164:167], v[136:139], v[40:43]
    v_mfma_f32_16x16x32_bf16 v[56:59], v[168:171], v[136:139], v[56:59]
    v_mfma_f32_16x16x32_bf16 v[72:75], v[172:175], v[136:139], v[72:75]
    v_mfma_f32_16x16x32_bf16 v[88:91], v[176:179], v[136:139], v[88:91]
    v_mfma_f32_16x16x32_bf16 v[104:107], v[180:183], v[136:139], v[104:107]
    v_mfma_f32_16x16x32_bf16 v[44:47], v[164:167], v[140:143], v[44:47]
    v_mfma_f32_16x16x32_bf16 v[60:63], v[168:171], v[140:143], v[60:63]
    v_mfma_f32_16x16x32_bf16 v[76:79], v[172:175], v[140:143], v[76:79]
    v_mfma_f32_16x16x32_bf16 v[92:95], v[176:179], v[140:143], v[92:95]
    v_mfma_f32_16x16x32_bf16 v[108:111], v[180:183], v[140:143], v[108:111]
    s_add_u32 s47, s40, 4096
    buffer_load_dwordx4 v[128:131], v1, s[20:23], s47 offen sc1
    buffer_load_dwordx4 v[132:135], v2, s[20:23], s47 offen sc1
    buffer_load_dwordx4 v[136:139], v3, s[20:23], s47 offen sc1
    buffer_load_dwordx4 v[140:143], v4, s[20:23], s47 offen sc1
    s_waitcnt vmcnt(13)
    v_mfma_f32_16x16x32_bf16 v[32:35], v[184:187], v[144:147], v[32:35]
    v_mfma_f32_16x16x32_bf16 v[48:51], v[188:191], v[144:147], v[48:51]
    v_mfma_f32_16x16x32_bf16 v[64:67], v[192:195], v[144:147], v[64:67]
    v_mfma_f32_16x16x32_bf16 v[80:83], v[196:199], v[144:147], v[80:83]
    v_mfma_f32_16x16x32_bf16 v[96:99], v[200:203], v[144:147], v[96:99]
    v_mfma_f32_16x16x32_bf16 v[36:39], v[184:187], v[148:151], v[36:39]
    v_mfma_f32_16x16x32_bf16 v[52:55], v[188:191], v[148:151], v[52:55]
    v_mfma_f32_16x16x32_bf16 v[68:71], v[192:195], v[148:151], v[68:71]
    v_mfma_f32_16x16x32_bf16 v[84:87], v[196:199], v[148:151], v[84:87]
    v_mfma_f32_16x16x32_bf16 v[100:103], v[200:203], v[148:151], v[100:103]
    v_mfma_f32_16x16x32_bf16 v[40:43], v[184:187], v[152:155], v[40:43]
    v_mfma_f32_16x16x32_bf16 v[56:59], v[188:191], v[152:155], v[56:59]
    v_mfma_f32_16x16x32_bf16 v[72:75], v[192:195], v[152:155], v[72:75]
    v_mfma_f32_16x16x32_bf16 v[88:91], v[196:199], v[152:155], v[88:91]
    v_mfma_f32_16x16x32_bf16 v[104:107], v[200:203], v[152:155], v[104:107]
    v_mfma_f32_16x16x32_bf16 v[44:47], v[184:187], v[156:159], v[44:47]
    v_mfma_f32_16x16x32_bf16 v[60:63], v[188:191], v[156:159], v[60:63]
    v_mfma_f32_16x16x32_bf16 v[76:79], v[192:195], v[156:159], v[76:79]
    v_mfma_f32_16x16x32_bf16 v[92:95], v[196:199], v[156:159], v[92:95]
    v_mfma_f32_16x16x32_bf16 v[108:111], v[200:203], v[156:159], v[108:111]
    s_waitcnt vmcnt(9)
    v_mfma_f32_16x16x32_bf16 v[32:35], v[204:207], v[112:115], v[32:35]
    v_mfma_f32_16x16x32_bf16 v[48:51], v[208:211], v[112:115], v[48:51]
    v_mfma_f32_16x16x32_bf16 v[64:67], v[212:215], v[112:115], v[64:67]
    v_mfma_f32_16x16x32_bf16 v[80:83], v[216:219], v[112:115], v[80:83]
    v_mfma_f32_16x16x32_bf16 v[96:99], v[220:223], v[112:115], v[96:99]
    v_mfma_f32_16x16x32_bf16 v[36:39], v[204:207], v[116:119], v[36:39]
    v_mfma_f32_16x16x32_bf16 v[52:55], v[208:211], v[116:119], v[52:55]
    v_mfma_f32_16x16x32_bf16 v[68:71], v[212:215], v[116:119], v[68:71]
    v_mfma_f32_16x16x32_bf16 v[84:87], v[216:219], v[116:119], v[84:87]
    v_mfma_f32_16x16x32_bf16 v[100:103], v[220:223], v[116:119], v[100:103]
    v_mfma_f32_16x16x32_bf16 v[40:43], v[204:207], v[120:123], v[40:43]
    v_mfma_f32_16x16x32_bf16 v[56:59], v[208:211], v[120:123], v[56:59]
    v_mfma_f32_16x16x32_bf16 v[72:75], v[212:215], v[120:123], v[72:75]
    v_mfma_f32_16x16x32_bf16 v[88:91], v[216:219], v[120:123], v[88:91]
    v_mfma_f32_16x16x32_bf16 v[104:107], v[220:223], v[120:123], v[104:107]
    v_mfma_f32_16x16x32_bf16 v[44:47], v[204:207], v[124:127], v[44:47]
    v_mfma_f32_16x16x32_bf16 v[60:63], v[208:211], v[124:127], v[60:63]
    v_mfma_f32_16x16x32_bf16 v[76:79], v[212:215], v[124:127], v[76:79]
    v_mfma_f32_16x16x32_bf16 v[92:95], v[216:219], v[124:127], v[92:95]
    v_mfma_f32_16x16x32_bf16 v[108:111], v[220:223], v[124:127], v[108:111]
    s_waitcnt vmcnt(0)
    v_mfma_f32_16x16x32_bf16 v[32:35], v[224:227], v[128:131], v[32:35]
    v_mfma_f32_16x16x32_bf16 v[48:51], v[228:231], v[128:131], v[48:51]
    v_mfma_f32_16x16x32_bf16 v[64:67], v[232:235], v[128:131], v[64:67]
    v_mfma_f32_16x16x32_bf16 v[80:83], v[236:239], v[128:131], v[80:83]
    v_mfma_f32_16x16x32_bf16 v[96:99], v[240:243], v[128:131], v[96:99]
    v_mfma_f32_16x16x32_bf16 v[36:39], v[224:227], v[132:135], v[36:39]
    v_mfma_f32_16x16x32_bf16 v[52:55], v[228:231], v[132:135], v[52:55]
    v_mfma_f32_16x16x32_bf16 v[68:71], v[232:235], v[132:135], v[68:71]
    v_mfma_f32_16x16x32_bf16 v[84:87], v[236:239], v[132:135], v[84:87]
    v_mfma_f32_16x16x32_bf16 v[100:103], v[240:243], v[132:135], v[100:103]
    v_mfma_f32_16x16x32_bf16 v[40:43], v[224:227], v[136:139], v[40:43]
    v_mfma_f32_16x16x32_bf16 v[56:59], v[228:231], v[136:139], v[56:59]
    v_mfma_f32_16x16x32_bf16 v[72:75], v[232:235], v[136:139], v[72:75]
    v_mfma_f32_16x16x32_bf16 v[88:91], v[236:239], v[136:139], v[88:91]
    v_mfma_f32_16x16x32_bf16 v[104:107], v[240:243], v[136:139], v[104:107]
    v_mfma_f32_16x16x32_bf16 v[44:47], v[224:227], v[140:143], v[44:47]
    v_mfma_f32_16x16x32_bf16 v[60:63], v[228:231], v[140:143], v[60:63]
    v_mfma_f32_16x16x32_bf16 v[76:79], v[232:235], v[140:143], v[76:79]
    v_mfma_f32_16x16x32_bf16 v[92:95], v[236:239], v[140:143], v[92:95]
    v_mfma_f32_16x16x32_bf16 v[108:111], v[240:243], v[140:143], v[108:111]
    s_barrier
    ds_write_b128 v14, v[32:35] offset:0
    ds_write_b128 v14, v[36:39] offset:5120
    ds_write_b128 v15, v[40:43] offset:0
    ds_write_b128 v15, v[44:47] offset:5120
    ds_write_b128 v14, v[48:51] offset:64
    ds_write_b128 v14, v[52:55] offset:5184
    ds_write_b128 v15, v[56:59] offset:64
    ds_write_b128 v15, v[60:63] offset:5184
    ds_write_b128 v14, v[64:67] offset:128
    ds_write_b128 v14, v[68:71] offset:5248
    ds_write_b128 v15, v[72:75] offset:128
    ds_write_b128 v15, v[76:79] offset:5248
    ds_write_b128 v14, v[80:83] offset:192
    ds_write_b128 v14, v[84:87] offset:5312
    ds_write_b128 v15, v[88:91] offset:192
    ds_write_b128 v15, v[92:95] offset:5312
    ds_write_b128 v14, v[96:99] offset:256
    ds_write_b128 v14, v[100:103] offset:5376
    ds_write_b128 v15, v[104:107] offset:256
    ds_write_b128 v15, v[108:111] offset:5376
    s_waitcnt lgkmcnt(0)
    s_barrier
P2_END:
K_END:
K_LAST:
    s_endpgm

.section .rodata,"a"
.p2align 6
.amdhsa_kernel recurrent_scan__linear_kernel_hedgehog__swiglu_ffn__prompt_kernel
  .amdhsa_next_free_vgpr 256
  .amdhsa_next_free_sgpr 102
  .amdhsa_accum_offset 256
  .amdhsa_group_segment_fixed_size 0
  .amdhsa_kernarg_size 88
  .amdhsa_user_sgpr_count 2
  .amdhsa_user_sgpr_kernarg_segment_ptr 1
  .amdhsa_system_sgpr_workgroup_id_x 1
.end_amdhsa_kernel
```
